```python
import torch

def _softmax(x, axis=-1):
    return torch.softmax(x, dim=axis)

def _gelu(x):
    return torch.nn.functional.gelu(x, approximate='tanh')

def _silu(x):
    return torch.nn.functional.silu(x)

def _sigmoid(x):
    return torch.sigmoid(x)

def _layernorm(x, axis=-1, eps=1e-05):
    m = x.mean(dim=axis, keepdim=True)
    v = x.var(dim=axis, keepdim=True, unbiased=False)
    return (x - m) / torch.sqrt(v + eps)

def _scatter_add(tgt, idx, src, axis=0):
    return tgt.clone().index_add_(axis, idx, src)

def _segment_sum(src, seg, n):
    out = torch.zeros((n,) + src.shape[1:], dtype=src.dtype)
    return out.index_add_(0, seg, src)

def _pad(x, pw):
    flat = tuple((v for pair in reversed(pw) for v in pair))
    return torch.nn.functional.pad(x, flat)
kernel_name = 'interleave_layers__ssm_conv_h3__memory_aug_recurrent_mem_tr__prompt'

def setup_inputs():

    _w = lambda a: (lambda t: t.to(torch.bfloat16) if t.is_floating_point() else t)(torch.as_tensor(a))

    def _A_setup():
        B, S, D = (1, 2048, 512)
        ks = 4
        return {'q': _w((lambda *s: torch.randn(*s, dtype=torch.bfloat16) * 0.05)(B, S, D)), 'k': _w((lambda *s: torch.randn(*s, dtype=torch.bfloat16) * 0.2)(B, S, D)), 'v': _w((lambda *s: torch.randn(*s, dtype=torch.bfloat16) * 0.2)(B, S, D)), 'shift_k': _w((lambda *s: torch.randn(*s, dtype=torch.bfloat16) * 0.2)(D, ks) * 0.5), 'ssm_k': _w((lambda *s: torch.randn(*s, dtype=torch.bfloat16) * 0.4)(D, S) * (1.0 / S ** 0.5)), 'ssm_D': _w((lambda *s: torch.randn(*s, dtype=torch.bfloat16) * 0.2)(D))}
    _A_in = _A_setup()

    def _B_setup():
        B, S, Dm = (1, 2048, 512)
        H, Dh = (32, 128)
        M, seg = (8, 32)
        seg = min(seg, S)
        S = S // seg * seg
        return {'x': _w((lambda *s: torch.randn(*s, dtype=torch.bfloat16) * 0.05)(B, S, Dm)), 'mem0': _w((lambda *s: torch.randn(*s, dtype=torch.bfloat16) * 0.2)(B, M, Dm)), 'Wq': _w((lambda *s: torch.randn(*s, dtype=torch.bfloat16) * 1.6)(Dm, H, Dh) * Dm ** (-0.5)), 'Wk': _w((lambda *s: torch.randn(*s, dtype=torch.bfloat16) * 1.6)(Dm, H, Dh) * Dm ** (-0.5)), 'Wv': _w((lambda *s: torch.randn(*s, dtype=torch.bfloat16) * 0.2)(Dm, H, Dh) * Dm ** (-0.5)), 'Wo': _w((lambda *s: torch.randn(*s, dtype=torch.bfloat16) * 0.2)(H, Dh, Dm) * (H * Dh) ** (-0.5)), 'seg_len': seg}
    _B_in = _B_setup()
    return {'A_q': _A_in['q'], 'A_k': _A_in['k'], 'A_v': _A_in['v'], 'A_shift_k': _A_in['shift_k'], 'A_ssm_k': _A_in['ssm_k'], 'A_ssm_D': _A_in['ssm_D'], 'B_x': _B_in['x'], 'B_mem0': _B_in['mem0'], 'B_Wq': _B_in['Wq'], 'B_Wk': _B_in['Wk'], 'B_Wv': _B_in['Wv'], 'B_Wo': _B_in['Wo'], 'B_seg_len': _B_in['seg_len']}

def reference(A_q, A_k, A_v, A_shift_k, A_ssm_k, A_ssm_D, B_x, B_mem0, B_Wq, B_Wk, B_Wv, B_Wo, B_seg_len):

    def _A_ref(q, k, v, shift_k, ssm_k, ssm_D):
        B, S, D = q.shape
        ks = shift_k.shape[-1]
        k_pad = _pad(k, ((0, 0), (ks - 1, 0), (0, 0)))
        k_shift = torch.zeros_like(k)
        for t in range(ks):
            k_shift = k_shift + k_pad[:, t:t + S, :] * shift_k[:, ks - 1 - t][None, None, :]
        kv = k_shift * v
        L = 2 * S
        kv_pad = _pad(kv, ((0, 0), (0, S), (0, 0)))
        kf_pad = _pad(ssm_k, ((0, 0), (0, S)))
        kv_f = (lambda x, axes=(-2, -1): torch.fft.rfft2(x.float(), dim=axes))(kv_pad[:, None, :, :], axes=(1, 2))
        kf_f = (lambda x, axes=(-2, -1): torch.fft.rfft2(x.float(), dim=axes))(kf_pad[:, None, :], axes=(1, 2))
        kf_f = (lambda x, *d: x.permute(*d))(kf_f, 1, 2, 0)
        y_f = kv_f * kf_f[None, :, :, :]
        y = (lambda x, s, axes=(-2, -1): torch.fft.irfft2(x, s=s, dim=axes).to(torch.bfloat16))(y_f, (1, L), axes=(1, 2))[:, 0, :S, :]
        y = y + kv * ssm_D[None, None, :]
        return q * y

    def _B_ref(x, mem0, Wq, Wk, Wv, Wo, seg_len):
        B, S, Dm = x.shape
        H, Dh = (Wq.shape[1], Wq.shape[2])
        M = mem0.shape[1]
        scale = Dh ** (-0.5)
        n_seg = S // seg_len
        L = M + seg_len
        idx = torch.arange(L)
        mask = (idx[:, None] < M) | (idx[:, None] >= idx[None, :])
        mem = mem0
        outs = []
        for s in range(n_seg):
            xs = x[:, s * seg_len:(s + 1) * seg_len, :].clone()
            h = torch.concatenate([mem, xs], axis=1)
            q = torch.einsum('btd,dhe->bhte', h, Wq)
            k = torch.einsum('btd,dhe->bhte', h, Wk)
            v = torch.einsum('btd,dhe->bhte', h, Wv)
            scores = torch.einsum('bhqe,bhke->bhqk', q, k) * scale
            scores = torch.where(mask[None, None], scores, -1000000000.0)
            p = _softmax(scores, axis=-1)
            o = torch.einsum('bhqk,bhke->bhqe', p, v)
            o = torch.einsum('bhte,hed->btd', o, Wo)
            mem = o[:, :M, :].clone()
            outs.append(o[:, M:, :])
        return torch.concatenate(outs, axis=1)
    x = A_q
    x = x + _A_ref(_layernorm(x, axis=-1), A_k, A_v, A_shift_k, A_ssm_k, A_ssm_D)
    x = x + _B_ref(_layernorm(x, axis=-1), B_mem0, B_Wq, B_Wk, B_Wv, B_Wo, B_seg_len)
    x = x + _A_ref(_layernorm(x, axis=-1), A_k, A_v, A_shift_k, A_ssm_k, A_ssm_D)
    x = x + _B_ref(_layernorm(x, axis=-1), B_mem0, B_Wq, B_Wk, B_Wv, B_Wo, B_seg_len)
    return x
```

```asm
; @launch grid=(256,1,1) block=(256,1,1) lds=163840
.amdgcn_target "amdgcn-amd-amdhsa--gfx950"
.text
.globl interleave_layers__ssm_conv_h3__memory_aug_recurrent_mem_tr__prompt_kernel
.p2align 8
.type interleave_layers__ssm_conv_h3__memory_aug_recurrent_mem_tr__prompt_kernel,@function
interleave_layers__ssm_conv_h3__memory_aug_recurrent_mem_tr__prompt_kernel:
    s_cmp_ge_u32 s2, 256
    s_cbranch_scc1 L_end
    s_load_dwordx16 s[64:79], s[0:1], 0
    s_load_dwordx16 s[80:95], s[0:1], 64
    s_and_b32 s4, s2, 7
    s_lshr_b32 s5, s2, 3
    s_lshl_b32 s4, s4, 2
    s_lshr_b32 s4, 0x36274150, s4
    s_and_b32 s4, s4, 7
    v_lshrrev_b32 v1, 6, v0
    s_nop 0
    v_readfirstlane_b32 s6, v1
    s_mov_b32 s98, 1048576
    s_waitcnt lgkmcnt(0)
    s_mov_b32 s8, s94
    s_and_b32 s9, s95, 0xffff
    s_mov_b32 s10, 0x10000000
    s_mov_b32 s11, 0x20000
    s_mov_b32 s28, s92
    s_and_b32 s29, s93, 0xffff
    s_mov_b32 s30, 0x100
    s_mov_b32 s31, 0x20000
    s_cmp_lg_u32 s4, 4
    s_cbranch_scc1 L_nc
    v_and_b32 v1, 63, v0
    v_lshlrev_b32 v1, 4, v1
    v_mov_b32 v4, 0
    v_mov_b32 v5, 0
    v_mov_b32 v6, 0
    v_mov_b32 v7, 0
    s_lshl_b32 s3, s5, 2
    s_add_u32 s3, s3, s6
    s_lshl_b32 s3, s3, 10
    s_add_u32 s7, s3, 524288
    buffer_store_dwordx4 v[4:7], v1, s[8:11], s7 offen sc1
    s_add_u32 s7, s3, 0
    buffer_store_dwordx4 v[4:7], v1, s[8:11], s7 offen sc1
    s_add_u32 s7, s3, 131072
    buffer_store_dwordx4 v[4:7], v1, s[8:11], s7 offen sc1
    s_add_u32 s7, s3, 262144
    buffer_store_dwordx4 v[4:7], v1, s[8:11], s7 offen sc1
    s_add_u32 s7, s3, 393216
    buffer_store_dwordx4 v[4:7], v1, s[8:11], s7 offen sc1
    s_waitcnt vmcnt(0)
    s_barrier
    s_cmp_lg_u32 s6, 0
    s_cbranch_scc1 L_nc0
    v_mov_b32 v2, 1
    s_mov_b64 exec, 1
    buffer_atomic_add v2, v4, s[28:31], 0 offen offset:0 sc1
    s_mov_b64 exec, -1
L_nc0:
    s_barrier
    v_lshlrev_b32 v2, 3, v1
    s_lshl_b32 s3, s3, 5
    v_bfe_u32 v9, v0, 1, 5
    v_lshlrev_b32 v9, 10, v9
    v_and_b32 v10, 1, v0
    v_lshl_add_u32 v9, v10, 7, v9
    s_mov_b32 s20, s82
    s_and_b32 s21, s83, 0xffff
    s_mov_b32 s22, 0x400000
    s_mov_b32 s23, 0x20000
    buffer_load_dword v127, v9, s[20:23], s3 offen offset:256
    s_mov_b32 exec_lo, 0xc000c000
    s_mov_b32 exec_hi, 0xc000c000
    buffer_load_dword v127, v9, s[20:23], s3 offen offset:768
    s_mov_b64 exec, -1
    s_mov_b32 s20, s84
    s_and_b32 s21, s85, 0xffff
    s_mov_b32 s22, 0x400000
    s_mov_b32 s23, 0x20000
    buffer_load_dword v127, v9, s[20:23], s3 offen offset:256
    s_mov_b32 exec_lo, 0xc000c000
    s_mov_b32 exec_hi, 0xc000c000
    buffer_load_dword v127, v9, s[20:23], s3 offen offset:768
    s_mov_b64 exec, -1
    s_mov_b32 s20, s80
    s_and_b32 s21, s81, 0xffff
    s_mov_b32 s22, 0x400000
    s_mov_b32 s23, 0x20000
    buffer_load_dword v127, v9, s[20:23], s3 offen offset:256
    s_mov_b32 exec_lo, 0xc000c000
    s_mov_b32 exec_hi, 0xc000c000
    buffer_load_dword v127, v9, s[20:23], s3 offen offset:768
    s_mov_b64 exec, -1
    s_mov_b32 s20, s86
    s_and_b32 s21, s87, 0xffff
    s_mov_b32 s22, 0x400000
    s_mov_b32 s23, 0x20000
    buffer_load_dword v127, v2, s[20:23], s3 offen
    s_add_u32 s3, s3, 8192
    buffer_load_dword v127, v2, s[20:23], s3 offen
    s_add_u32 s3, s3, 8192
    buffer_load_dword v127, v2, s[20:23], s3 offen
    s_add_u32 s3, s3, 8192
    buffer_load_dword v127, v2, s[20:23], s3 offen
    s_add_u32 s3, s3, 8192
Lc_1:
    buffer_load_dword v2, v4, s[28:31], 0 offen offset:0 sc1
    s_waitcnt vmcnt(0)
    v_cmp_gt_u32 vcc, 32, v2
    s_cbranch_vccz Lcd_2
    s_sleep 2
    s_sub_u32 s98, s98, 1
    s_cbranch_scc1 L_end
    s_branch Lc_1
Lcd_2:
    s_mov_b32 s3, 575488
Lw_3:
    buffer_load_dword v2, v4, s[8:11], s3 offen offset:0 sc1
    s_waitcnt vmcnt(0)
    v_cmp_eq_u32 vcc, 0, v2
    s_cbranch_vccz Lwd_4
    s_sleep 8
    s_sub_u32 s98, s98, 1
    s_cbranch_scc1 L_end
    s_branch Lw_3
Lwd_4:
L_nc:
    s_cmp_lg_u32 s4, 3
    s_cbranch_scc1 L_nq
    s_cmp_lt_u32 s5, 16
    s_cbranch_scc1 L_main
    s_and_b32 s32, s5, 15
    s_branch L_pre_early
L_nq:
    s_lshr_b32 s3, 0xe2, s4
    s_bitcmp0_b32 s3, 0
    s_cbranch_scc1 L_main
    s_mov_b32 s32, 128
    s_cmp_eq_u32 s4, 5
    s_cselect_b32 s32, 16, s32
    s_add_u32 s32, s32, s5
    s_max_u32 s7, s4, 4
    s_and_b32 s7, s7, 3
    s_lshl_b32 s7, s7, 5
    s_add_u32 s7, s7, s5
    s_mov_b32 s12, s66
    s_and_b32 s13, s67, 0xffff
    s_mov_b32 s14, 0x200000
    s_mov_b32 s15, 0x20000
    s_mov_b32 s16, s68
    s_and_b32 s17, s69, 0xffff
    s_mov_b32 s18, 0x200000
    s_mov_b32 s19, 0x20000
    s_mov_b32 s20, s72
    s_and_b32 s21, s73, 0xffff
    s_mov_b32 s22, 0x200000
    s_mov_b32 s23, 0x20000
    s_mov_b32 s24, s64
    s_and_b32 s25, s65, 0xffff
    s_mov_b32 s26, 0x200000
    s_mov_b32 s27, 0x20000
    s_mov_b32 s40, s70
    s_and_b32 s41, s71, 0xffff
    s_mov_b32 s42, 0x1000
    s_mov_b32 s43, 0x20000
    s_lshl_b32 s3, s7, 3
    s_load_dwordx2 s[36:37], s[74:75], s3
    v_and_b32 v1, 63, v0
    v_lshlrev_b32 v2, 4, v1
    v_and_b32 v3, 15, v0
    v_bfe_u32 v4, v0, 4, 2
    s_lshr_b32 s44, s7, 5
    s_lshl_b32 s45, s5, 16
    s_lshl_b32 s3, s44, 8
    s_add_u32 s45, s45, s3
    v_lshrrev_b32 v8, 4, v0
    v_lshlrev_b32 v6, 12, v8
    v_lshl_add_u32 v6, v3, 4, v6
    v_add_u32 v6, s45, v6
    v_subrev_u32 v5, 3072, v6
    buffer_load_dwordx4 v[12:15], v5, s[12:15], 0 offen offset:0
    buffer_load_dwordx4 v[16:19], v5, s[12:15], 0 offen offset:1024
    buffer_load_dwordx4 v[20:23], v5, s[12:15], 0 offen offset:2048
    buffer_load_dwordx4 v[24:27], v6, s[12:15], 0 offen offset:0
    buffer_load_dwordx4 v[28:31], v6, s[12:15], 0 offen offset:1024
    buffer_load_dwordx4 v[32:35], v6, s[12:15], 0 offen offset:2048
    buffer_load_dwordx4 v[36:39], v6, s[12:15], 0 offen offset:3072
    buffer_load_dwordx4 v[40:43], v6, s[16:19], 0 offen offset:0
    buffer_load_dwordx4 v[44:47], v6, s[16:19], 0 offen offset:1024
    buffer_load_dwordx4 v[48:51], v6, s[16:19], 0 offen offset:2048
    buffer_load_dwordx4 v[52:55], v6, s[16:19], 0 offen offset:3072
    v_lshlrev_b32 v7, 6, v3
    s_lshl_b32 s3, s44, 10
    buffer_load_dwordx4 v[56:59], v7, s[40:43], s3 offen offset:0
    buffer_load_dwordx4 v[60:63], v7, s[40:43], s3 offen offset:16
    buffer_load_dwordx4 v[64:67], v7, s[40:43], s3 offen offset:32
    buffer_load_dwordx4 v[68:71], v7, s[40:43], s3 offen offset:48
    s_lshl_b32 s38, s7, 2
    s_add_u32 s38, s38, s6
    s_lshl_b32 s39, s38, 12
    s_mul_i32 s33, s6, 16640
    s_add_u32 m0, s33, 32
    s_add_u32 s3, s39, 0
    buffer_load_dwordx4 v2, s[20:23], s3 offen offset:0 lds
    buffer_load_dwordx4 v2, s[20:23], s3 offen offset:1024 lds
    buffer_load_dwordx4 v2, s[20:23], s3 offen offset:2048 lds
    buffer_load_dwordx4 v2, s[20:23], s3 offen offset:3072 lds
    s_lshl_b32 s46, s32, 4
    s_lshl_b32 s3, s6, 2
    s_add_u32 s46, s46, s3
    s_lshl_b32 s47, s46, 10
    buffer_load_dwordx4 v[100:103], v2, s[24:27], s47 offen offset:0
    buffer_load_dwordx4 v[104:107], v2, s[24:27], s47 offen offset:1024
    buffer_load_dwordx4 v[108:111], v2, s[24:27], s47 offen offset:2048
    buffer_load_dwordx4 v[112:115], v2, s[24:27], s47 offen offset:3072
    s_mul_i32 s45, s44, 540672
    s_add_u32 s45, s45, 16781184
    s_lshl_b32 s3, s5, 7
    s_sub_u32 s45, s45, s3
    s_mov_b32 s48, 4224
    s_mov_b32 s49, 16640
    v_lshrrev_b32 v117, 3, v0
    v_and_b32 v116, 7, v0
    v_lshlrev_b32 v116, 4, v116
    v_mad_u32_u24 v118, v117, s49, v116
    v_mad_u32_u24 v116, v117, s48, v116
    v_mov_b32 v10, 0
    v_mov_b32 v11, 0
    s_mul_i32 s34, s6, 4608
    s_add_u32 s34, s34, 66560
    v_lshlrev_b32 v7, 3, v1
    v_add_u32 v9, s34, v7
    ds_write_b64 v9, v[10:11] offset:4096
    v_and_b32 v9, 24, v7
    v_add_u32 v9, s33, v9
    ds_write_b64 v9, v[10:11] offset:0
    s_waitcnt lgkmcnt(0)
    s_bitcmp1_b32 s6, 1
    s_cselect_b32 s36, s37, s36
    s_lshl_b32 s37, s36, 16
    s_and_b32 s36, s36, 0xffff0000
    s_bitcmp1_b32 s6, 0
    s_cselect_b32 s36, s36, s37
    v_mul_u32_u24 v9, 1040, v3
    v_lshlrev_b32 v8, 3, v8
    v_sub_u32 v9, v9, v8
    v_add_u32 v9, 85112, v9
    s_waitcnt vmcnt(8)
    v_lshlrev_b32 v72, 16, v12
    v_lshlrev_b32 v73, 16, v16
    v_lshlrev_b32 v74, 16, v20
    v_lshlrev_b32 v75, 16, v24
    v_lshlrev_b32 v76, 16, v28
    v_lshlrev_b32 v77, 16, v32
    v_lshlrev_b32 v78, 16, v36
    v_lshlrev_b32 v80, 16, v40
    v_lshlrev_b32 v81, 16, v44
    v_lshlrev_b32 v82, 16, v48
    v_lshlrev_b32 v83, 16, v52
    v_lshlrev_b32 v84, 16, v56
    v_and_b32 v85, 0xffff0000, v56
    v_lshlrev_b32 v86, 16, v57
    v_and_b32 v87, 0xffff0000, v57
    v_mul_f32 v88, v87, v72
    v_mul_f32 v89, v87, v73
    v_mul_f32 v90, v87, v74
    v_mul_f32 v91, v87, v75
    v_fmac_f32 v88, v86, v73
    v_fmac_f32 v89, v86, v74
    v_fmac_f32 v90, v86, v75
    v_fmac_f32 v91, v86, v76
    v_fmac_f32 v88, v85, v74
    v_fmac_f32 v89, v85, v75
    v_fmac_f32 v90, v85, v76
    v_fmac_f32 v91, v85, v77
    v_fmac_f32 v88, v84, v75
    v_fmac_f32 v89, v84, v76
    v_fmac_f32 v90, v84, v77
    v_fmac_f32 v91, v84, v78
    v_pk_mul_f32 v[88:89], v[88:89], v[80:81]
    v_pk_mul_f32 v[90:91], v[90:91], v[82:83]
    v_cvt_pk_bf16_f32 v92, v91, v90
    v_cvt_pk_bf16_f32 v93, v89, v88
    ds_write_b64 v9, v[92:93] offset:0
    v_and_b32 v72, 0xffff0000, v12
    v_and_b32 v73, 0xffff0000, v16
    v_and_b32 v74, 0xffff0000, v20
    v_and_b32 v75, 0xffff0000, v24
    v_and_b32 v76, 0xffff0000, v28
    v_and_b32 v77, 0xffff0000, v32
    v_and_b32 v78, 0xffff0000, v36
    v_and_b32 v80, 0xffff0000, v40
    v_and_b32 v81, 0xffff0000, v44
    v_and_b32 v82, 0xffff0000, v48
    v_and_b32 v83, 0xffff0000, v52
    v_lshlrev_b32 v84, 16, v58
    v_and_b32 v85, 0xffff0000, v58
    v_lshlrev_b32 v86, 16, v59
    v_and_b32 v87, 0xffff0000, v59
    v_mul_f32 v88, v87, v72
    v_mul_f32 v89, v87, v73
    v_mul_f32 v90, v87, v74
    v_mul_f32 v91, v87, v75
    v_fmac_f32 v88, v86, v73
    v_fmac_f32 v89, v86, v74
    v_fmac_f32 v90, v86, v75
    v_fmac_f32 v91, v86, v76
    v_fmac_f32 v88, v85, v74
    v_fmac_f32 v89, v85, v75
    v_fmac_f32 v90, v85, v76
    v_fmac_f32 v91, v85, v77
    v_fmac_f32 v88, v84, v75
    v_fmac_f32 v89, v84, v76
    v_fmac_f32 v90, v84, v77
    v_fmac_f32 v91, v84, v78
    v_pk_mul_f32 v[88:89], v[88:89], v[80:81]
    v_pk_mul_f32 v[90:91], v[90:91], v[82:83]
    v_cvt_pk_bf16_f32 v94, v91, v90
    v_cvt_pk_bf16_f32 v95, v89, v88
    ds_write_b64 v9, v[94:95] offset:128
    v_lshlrev_b32 v72, 16, v13
    v_lshlrev_b32 v73, 16, v17
    v_lshlrev_b32 v74, 16, v21
    v_lshlrev_b32 v75, 16, v25
    v_lshlrev_b32 v76, 16, v29
    v_lshlrev_b32 v77, 16, v33
    v_lshlrev_b32 v78, 16, v37
    v_lshlrev_b32 v80, 16, v41
    v_lshlrev_b32 v81, 16, v45
    v_lshlrev_b32 v82, 16, v49
    v_lshlrev_b32 v83, 16, v53
    v_lshlrev_b32 v84, 16, v60
    v_and_b32 v85, 0xffff0000, v60
    v_lshlrev_b32 v86, 16, v61
    v_and_b32 v87, 0xffff0000, v61
    v_mul_f32 v88, v87, v72
    v_mul_f32 v89, v87, v73
    v_mul_f32 v90, v87, v74
    v_mul_f32 v91, v87, v75
    v_fmac_f32 v88, v86, v73
    v_fmac_f32 v89, v86, v74
    v_fmac_f32 v90, v86, v75
    v_fmac_f32 v91, v86, v76
    v_fmac_f32 v88, v85, v74
    v_fmac_f32 v89, v85, v75
    v_fmac_f32 v90, v85, v76
    v_fmac_f32 v91, v85, v77
    v_fmac_f32 v88, v84, v75
    v_fmac_f32 v89, v84, v76
    v_fmac_f32 v90, v84, v77
    v_fmac_f32 v91, v84, v78
    v_pk_mul_f32 v[88:89], v[88:89], v[80:81]
    v_pk_mul_f32 v[90:91], v[90:91], v[82:83]
    v_cvt_pk_bf16_f32 v96, v91, v90
    v_cvt_pk_bf16_f32 v97, v89, v88
    ds_write_b64 v9, v[96:97] offset:256
    v_and_b32 v72, 0xffff0000, v13
    v_and_b32 v73, 0xffff0000, v17
    v_and_b32 v74, 0xffff0000, v21
    v_and_b32 v75, 0xffff0000, v25
    v_and_b32 v76, 0xffff0000, v29
    v_and_b32 v77, 0xffff0000, v33
    v_and_b32 v78, 0xffff0000, v37
    v_and_b32 v80, 0xffff0000, v41
    v_and_b32 v81, 0xffff0000, v45
    v_and_b32 v82, 0xffff0000, v49
    v_and_b32 v83, 0xffff0000, v53
    v_lshlrev_b32 v84, 16, v62
    v_and_b32 v85, 0xffff0000, v62
    v_lshlrev_b32 v86, 16, v63
    v_and_b32 v87, 0xffff0000, v63
    v_mul_f32 v88, v87, v72
    v_mul_f32 v89, v87, v73
    v_mul_f32 v90, v87, v74
    v_mul_f32 v91, v87, v75
    v_fmac_f32 v88, v86, v73
    v_fmac_f32 v89, v86, v74
    v_fmac_f32 v90, v86, v75
    v_fmac_f32 v91, v86, v76
    v_fmac_f32 v88, v85, v74
    v_fmac_f32 v89, v85, v75
    v_fmac_f32 v90, v85, v76
    v_fmac_f32 v91, v85, v77
    v_fmac_f32 v88, v84, v75
    v_fmac_f32 v89, v84, v76
    v_fmac_f32 v90, v84, v77
    v_fmac_f32 v91, v84, v78
    v_pk_mul_f32 v[88:89], v[88:89], v[80:81]
    v_pk_mul_f32 v[90:91], v[90:91], v[82:83]
    v_cvt_pk_bf16_f32 v98, v91, v90
    v_cvt_pk_bf16_f32 v99, v89, v88
    ds_write_b64 v9, v[98:99] offset:384
    v_lshlrev_b32 v72, 16, v14
    v_lshlrev_b32 v73, 16, v18
    v_lshlrev_b32 v74, 16, v22
    v_lshlrev_b32 v75, 16, v26
    v_lshlrev_b32 v76, 16, v30
    v_lshlrev_b32 v77, 16, v34
    v_lshlrev_b32 v78, 16, v38
    v_lshlrev_b32 v80, 16, v42
    v_lshlrev_b32 v81, 16, v46
    v_lshlrev_b32 v82, 16, v50
    v_lshlrev_b32 v83, 16, v54
    v_lshlrev_b32 v84, 16, v64
    v_and_b32 v85, 0xffff0000, v64
    v_lshlrev_b32 v86, 16, v65
    v_and_b32 v87, 0xffff0000, v65
    v_mul_f32 v88, v87, v72
    v_mul_f32 v89, v87, v73
    v_mul_f32 v90, v87, v74
    v_mul_f32 v91, v87, v75
    v_fmac_f32 v88, v86, v73
    v_fmac_f32 v89, v86, v74
    v_fmac_f32 v90, v86, v75
    v_fmac_f32 v91, v86, v76
    v_fmac_f32 v88, v85, v74
    v_fmac_f32 v89, v85, v75
    v_fmac_f32 v90, v85, v76
    v_fmac_f32 v91, v85, v77
    v_fmac_f32 v88, v84, v75
    v_fmac_f32 v89, v84, v76
    v_fmac_f32 v90, v84, v77
    v_fmac_f32 v91, v84, v78
    v_pk_mul_f32 v[88:89], v[88:89], v[80:81]
    v_pk_mul_f32 v[90:91], v[90:91], v[82:83]
    v_cvt_pk_bf16_f32 v92, v91, v90
    v_cvt_pk_bf16_f32 v93, v89, v88
    ds_write_b64 v9, v[92:93] offset:512
    v_and_b32 v72, 0xffff0000, v14
    v_and_b32 v73, 0xffff0000, v18
    v_and_b32 v74, 0xffff0000, v22
    v_and_b32 v75, 0xffff0000, v26
    v_and_b32 v76, 0xffff0000, v30
    v_and_b32 v77, 0xffff0000, v34
    v_and_b32 v78, 0xffff0000, v38
    v_and_b32 v80, 0xffff0000, v42
    v_and_b32 v81, 0xffff0000, v46
    v_and_b32 v82, 0xffff0000, v50
    v_and_b32 v83, 0xffff0000, v54
    v_lshlrev_b32 v84, 16, v66
    v_and_b32 v85, 0xffff0000, v66
    v_lshlrev_b32 v86, 16, v67
    v_and_b32 v87, 0xffff0000, v67
    v_mul_f32 v88, v87, v72
    v_mul_f32 v89, v87, v73
    v_mul_f32 v90, v87, v74
    v_mul_f32 v91, v87, v75
    v_fmac_f32 v88, v86, v73
    v_fmac_f32 v89, v86, v74
    v_fmac_f32 v90, v86, v75
    v_fmac_f32 v91, v86, v76
    v_fmac_f32 v88, v85, v74
    v_fmac_f32 v89, v85, v75
    v_fmac_f32 v90, v85, v76
    v_fmac_f32 v91, v85, v77
    v_fmac_f32 v88, v84, v75
    v_fmac_f32 v89, v84, v76
    v_fmac_f32 v90, v84, v77
    v_fmac_f32 v91, v84, v78
    v_pk_mul_f32 v[88:89], v[88:89], v[80:81]
    v_pk_mul_f32 v[90:91], v[90:91], v[82:83]
    v_cvt_pk_bf16_f32 v94, v91, v90
    v_cvt_pk_bf16_f32 v95, v89, v88
    ds_write_b64 v9, v[94:95] offset:640
    v_lshlrev_b32 v72, 16, v15
    v_lshlrev_b32 v73, 16, v19
    v_lshlrev_b32 v74, 16, v23
    v_lshlrev_b32 v75, 16, v27
    v_lshlrev_b32 v76, 16, v31
    v_lshlrev_b32 v77, 16, v35
    v_lshlrev_b32 v78, 16, v39
    v_lshlrev_b32 v80, 16, v43
    v_lshlrev_b32 v81, 16, v47
    v_lshlrev_b32 v82, 16, v51
    v_lshlrev_b32 v83, 16, v55
    v_lshlrev_b32 v84, 16, v68
    v_and_b32 v85, 0xffff0000, v68
    v_lshlrev_b32 v86, 16, v69
    v_and_b32 v87, 0xffff0000, v69
    v_mul_f32 v88, v87, v72
    v_mul_f32 v89, v87, v73
    v_mul_f32 v90, v87, v74
    v_mul_f32 v91, v87, v75
    v_fmac_f32 v88, v86, v73
    v_fmac_f32 v89, v86, v74
    v_fmac_f32 v90, v86, v75
    v_fmac_f32 v91, v86, v76
    v_fmac_f32 v88, v85, v74
    v_fmac_f32 v89, v85, v75
    v_fmac_f32 v90, v85, v76
    v_fmac_f32 v91, v85, v77
    v_fmac_f32 v88, v84, v75
    v_fmac_f32 v89, v84, v76
    v_fmac_f32 v90, v84, v77
    v_fmac_f32 v91, v84, v78
    v_pk_mul_f32 v[88:89], v[88:89], v[80:81]
    v_pk_mul_f32 v[90:91], v[90:91], v[82:83]
    v_cvt_pk_bf16_f32 v96, v91, v90
    v_cvt_pk_bf16_f32 v97, v89, v88
    ds_write_b64 v9, v[96:97] offset:768
    v_and_b32 v72, 0xffff0000, v15
    v_and_b32 v73, 0xffff0000, v19
    v_and_b32 v74, 0xffff0000, v23
    v_and_b32 v75, 0xffff0000, v27
    v_and_b32 v76, 0xffff0000, v31
    v_and_b32 v77, 0xffff0000, v35
    v_and_b32 v78, 0xffff0000, v39
    v_and_b32 v80, 0xffff0000, v43
    v_and_b32 v81, 0xffff0000, v47
    v_and_b32 v82, 0xffff0000, v51
    v_and_b32 v83, 0xffff0000, v55
    v_lshlrev_b32 v84, 16, v70
    v_and_b32 v85, 0xffff0000, v70
    v_lshlrev_b32 v86, 16, v71
    v_and_b32 v87, 0xffff0000, v71
    v_mul_f32 v88, v87, v72
    v_mul_f32 v89, v87, v73
    v_mul_f32 v90, v87, v74
    v_mul_f32 v91, v87, v75
    v_fmac_f32 v88, v86, v73
    v_fmac_f32 v89, v86, v74
    v_fmac_f32 v90, v86, v75
    v_fmac_f32 v91, v86, v76
    v_fmac_f32 v88, v85, v74
    v_fmac_f32 v89, v85, v75
    v_fmac_f32 v90, v85, v76
    v_fmac_f32 v91, v85, v77
    v_fmac_f32 v88, v84, v75
    v_fmac_f32 v89, v84, v76
    v_fmac_f32 v90, v84, v77
    v_fmac_f32 v91, v84, v78
    v_pk_mul_f32 v[88:89], v[88:89], v[80:81]
    v_pk_mul_f32 v[90:91], v[90:91], v[82:83]
    v_cvt_pk_bf16_f32 v98, v91, v90
    v_cvt_pk_bf16_f32 v99, v89, v88
    ds_write_b64 v9, v[98:99] offset:896
    v_lshlrev_b32 v7, 4, v0
    s_lshl_b32 s3, s6, 4
    s_add_u32 s3, s3, 84992
    v_add_u32 v7, s3, v7
    s_waitcnt lgkmcnt(0)
    s_barrier
    buffer_load_dword v119, off, s[28:31], 0 sc1
    ds_read_b128 v[12:15], v7 offset:0
    ds_read_b128 v[16:19], v7 offset:4160
    ds_read_b128 v[20:23], v7 offset:8320
    ds_read_b128 v[24:27], v7 offset:12480
    s_waitcnt lgkmcnt(3)
    buffer_store_dwordx4 v[12:15], v116, s[8:11], s45 offen sc1
    s_add_u32 s45, s45, 135168
    s_waitcnt lgkmcnt(2)
    buffer_store_dwordx4 v[16:19], v116, s[8:11], s45 offen sc1
    s_add_u32 s45, s45, 135168
    s_waitcnt lgkmcnt(1)
    buffer_store_dwordx4 v[20:23], v116, s[8:11], s45 offen sc1
    s_add_u32 s45, s45, 135168
    s_waitcnt lgkmcnt(0)
    buffer_store_dwordx4 v[24:27], v116, s[8:11], s45 offen sc1
    s_add_u32 s45, s45, 135168
    v_lshlrev_b32 v8, 1, v3
    v_lshl_add_u32 v8, v4, 4, v8
    v_add_u32 v8, s33, v8
    v_mov_b32 v5, 0
    s_add_u32 m0, s33, 8352
    s_add_u32 s3, s39, 4
    buffer_load_dwordx4 v2, s[20:23], s3 offen offset:0 lds
    s_add_u32 m0, s33, 4192
    s_add_u32 s3, s39, 2
    buffer_load_dwordx4 v2, s[20:23], s3 offen offset:0 lds
    s_add_u32 m0, s33, 12512
    s_add_u32 s3, s39, 6
    buffer_load_dwordx4 v2, s[20:23], s3 offen offset:0 lds
    s_waitcnt vmcnt(3)
    v_cmp_gt_u32 vcc, 32, v119
    s_cbranch_vccz Lsk_5
Lc_6:
    buffer_load_dword v6, v5, s[28:31], 0 offen offset:0 sc1
    s_waitcnt vmcnt(0)
    v_cmp_gt_u32 vcc, 32, v6
    s_cbranch_vccz Lcd_7
    s_sleep 2
    s_sub_u32 s98, s98, 1
    s_cbranch_scc1 L_end
    s_branch Lc_6
Lcd_7:
Lsk_5:
    s_lshl_b32 s48, s7, 7
    s_lshl_b32 s3, s6, 29
    s_add_u32 s48, s48, s3
    v_mov_b32 v7, 1
    s_add_u32 s3, s48, 606208
    s_barrier
    buffer_store_dword v7, off, s[8:11], s3 sc1
    s_waitcnt vmcnt(1)
    ds_read_b128 a[0:3], v8 offset:2
    v_add_u32 v9, 1, v3
    v_and_b32 v8, 3, v9
    v_mul_u32_u24 v8, 4160, v8
    v_lshrrev_b32 v9, 2, v9
    v_lshl_add_u32 v8, v9, 3, v8
    v_lshl_add_u32 v8, v4, 4, v8
    v_add_u32 v37, s33, v8
    ds_read_b64 a[4:5], v37 offset:64
    ds_read_b64 a[6:7], v37 offset:72
    ds_read_b64 a[8:9], v37 offset:128
    ds_read_b64 a[10:11], v37 offset:136
    ds_read_b64 a[12:13], v37 offset:192
    ds_read_b64 a[14:15], v37 offset:200
    s_waitcnt lgkmcnt(6)
    ds_read_b64 a[16:17], v37 offset:256
    ds_read_b64 a[18:19], v37 offset:264
    ds_read_b64 a[20:21], v37 offset:320
    ds_read_b64 a[22:23], v37 offset:328
    ds_read_b64 a[24:25], v37 offset:384
    ds_read_b64 a[26:27], v37 offset:392
    ds_read_b64 a[28:29], v37 offset:448
    ds_read_b64 a[30:31], v37 offset:456
    s_waitcnt lgkmcnt(6)
    v_lshlrev_b32 v8, 5, v3
    v_sub_u32 v8, 480, v8
    v_lshl_add_u32 v8, v4, 4, v8
    v_add_u32 v8, s34, v8
    v_lshlrev_b32 v9, 5, v3
    v_lshl_add_u32 v9, v4, 3, v9
    v_sub_u32 v34, 504, v9
    v_add_u32 v34, s34, v34
    v_mul_u32_u24 v35, 144, v3
    v_lshl_add_u32 v35, v4, 3, v35
    s_lshl_b32 s3, s6, 5
    s_add_u32 s3, s3, 84992
    v_add_u32 v35, s3, v35
    v_lshrrev_b32 v9, 3, v0
    v_add_u32 v36, v0, v9
    v_lshlrev_b32 v36, 4, v36
    v_add_u32 v36, 84992, v36
    v_and_b32 v9, 7, v0
    v_lshlrev_b32 v9, 7, v9
    s_lshl_b32 s3, s44, 12
    s_add_u32 s49, s3, 606208
    s_mul_i32 s45, s38, 4224
    s_add_u32 s45, s45, 16777216
Lw_8:
    buffer_load_dword v6, v9, s[8:11], s49 offen offset:0 sc1
    s_waitcnt vmcnt(0)
    v_cmp_eq_u32 vcc, 0, v6
    s_cbranch_vccz Lwd_9
    s_sleep 1
    s_sub_u32 s98, s98, 1
    s_cbranch_scc1 L_end
    s_branch Lw_8
Lwd_9:
    s_mov_b32 m0, s34
    s_lshl_b32 s35, s7, 7
    s_add_u32 s35, s35, 20971520
    buffer_load_dwordx4 v2, s[8:11], s45 offen offset:3072 sc1 lds
    s_waitcnt vmcnt(0) lgkmcnt(0)
    ds_read_b128 v[10:13], v8 offset:3584
    ds_read_b128 v[14:17], v8 offset:3648
    ds_read_b128 v[18:21], v8 offset:3712
    ds_read_b128 v[22:25], v8 offset:3776
    ds_read_b128 v[26:29], v8 offset:3840
    ds_read_b128 v[30:33], v8 offset:3904
    s_waitcnt lgkmcnt(5)
    v_mfma_f32_16x16x32_bf16 v[40:43], a[0:3], v[10:13], 0
    ds_read_b128 v[10:13], v8 offset:3968
    s_waitcnt lgkmcnt(5)
    v_mfma_f32_16x16x32_bf16 v[40:43], a[4:7], v[14:17], v[40:43]
    ds_read_b128 v[14:17], v8 offset:4032
    s_waitcnt lgkmcnt(5)
    v_mfma_f32_16x16x32_bf16 v[40:43], a[8:11], v[18:21], v[40:43]
    s_waitcnt lgkmcnt(4)
    v_mfma_f32_16x16x32_bf16 v[40:43], a[12:15], v[22:25], v[40:43]
    s_waitcnt lgkmcnt(3)
    v_mfma_f32_16x16x32_bf16 v[40:43], a[16:19], v[26:29], v[40:43]
    s_waitcnt lgkmcnt(2)
    v_mfma_f32_16x16x32_bf16 v[40:43], a[20:23], v[30:33], v[40:43]
    s_waitcnt lgkmcnt(1)
    v_mfma_f32_16x16x32_bf16 v[40:43], a[24:27], v[10:13], v[40:43]
    s_waitcnt lgkmcnt(0)
    v_mfma_f32_16x16x32_bf16 v[40:43], a[28:31], v[14:17], v[40:43]
    ds_read_b64 v[80:81], v34 offset:3584
    s_waitcnt lgkmcnt(0)
    v_lshlrev_b32 v11, 16, v81
    v_and_b32 v10, 0xffff0000, v81
    v_lshlrev_b32 v13, 16, v80
    v_and_b32 v12, 0xffff0000, v80
    s_nop 1
    v_fmac_f32 v40, s36, v10
    v_fmac_f32 v41, s36, v11
    v_fmac_f32 v42, s36, v12
    v_fmac_f32 v43, s36, v13
    v_cvt_pk_bf16_f32 v40, v40, v41
    v_cvt_pk_bf16_f32 v41, v42, v43
    ds_write_b64 v35, v[40:41] offset:0
    s_waitcnt lgkmcnt(0)
    s_barrier
    s_cmp_lg_u32 s6, 0
    s_cbranch_scc1 Lsk_10
    ds_read_b128 v[72:75], v36
    ds_read_b128 v[76:79], v36 offset:1152
    s_add_u32 s3, s35, 133120
    s_waitcnt lgkmcnt(0)
    buffer_store_dwordx4 v[72:75], v118, s[8:11], s35 offen sc1
    buffer_store_dwordx4 v[76:79], v118, s[8:11], s3 offen sc1
    s_waitcnt vmcnt(0)
    s_lshl_b32 s3, s44, 7
    s_add_u32 s3, s3, 576064
    v_mov_b32 v6, 1
    s_mov_b64 exec, 1
    buffer_atomic_add v6, off, s[8:11], s3 sc0 sc1
    s_mov_b64 exec, -1
    s_lshl_b32 s3, s44, 7
    s_add_u32 s3, s3, 576512
    s_waitcnt vmcnt(0)
    v_readfirstlane_b32 s37, v6
    s_cmp_lg_u32 s37, 31
    s_cbranch_scc1 Lsk_10
    buffer_store_dword v7, off, s[8:11], s3 sc1
Lsk_10:
    s_add_u32 m0, s33, 8352
    s_add_u32 s3, s39, 4
    buffer_load_dwordx4 v2, s[20:23], s3 offen offset:1024 lds
    buffer_load_dwordx4 v2, s[20:23], s3 offen offset:2048 lds
    buffer_load_dwordx4 v2, s[20:23], s3 offen offset:3072 lds
    s_add_u32 m0, s33, 4192
    s_add_u32 s3, s39, 2
    buffer_load_dwordx4 v2, s[20:23], s3 offen offset:1024 lds
    buffer_load_dwordx4 v2, s[20:23], s3 offen offset:2048 lds
    buffer_load_dwordx4 v2, s[20:23], s3 offen offset:3072 lds
    s_add_u32 m0, s33, 12512
    s_add_u32 s3, s39, 6
    buffer_load_dwordx4 v2, s[20:23], s3 offen offset:1024 lds
    buffer_load_dwordx4 v2, s[20:23], s3 offen offset:2048 lds
    buffer_load_dwordx4 v2, s[20:23], s3 offen offset:3072 lds
    v_and_b32 v9, 31, v0
    v_lshlrev_b32 v9, 7, v9
    s_mov_b32 s39, s35
Lw_11:
    buffer_load_dword v6, v9, s[8:11], s49 offen offset:0 sc1
    s_waitcnt vmcnt(0)
    v_cmp_eq_u32 vcc, 0, v6
    s_cbranch_vccz Lwd_12
    s_sleep 1
    s_sub_u32 s98, s98, 1
    s_cbranch_scc1 L_end
    s_branch Lw_11
Lwd_12:
    s_mov_b32 m0, s34
    s_nop 0
    buffer_load_dwordx4 v2, s[8:11], s45 offen offset:0 sc1 lds
    buffer_load_dwordx4 v2, s[8:11], s45 offen offset:1024 sc1 lds
    buffer_load_dwordx4 v2, s[8:11], s45 offen offset:2048 sc1 lds
    ds_read_b64 a[32:33], v37 offset:512
    ds_read_b64 a[34:35], v37 offset:520
    ds_read_b64 a[36:37], v37 offset:576
    ds_read_b64 a[38:39], v37 offset:584
    ds_read_b64 a[40:41], v37 offset:640
    ds_read_b64 a[42:43], v37 offset:648
    ds_read_b64 a[44:45], v37 offset:704
    ds_read_b64 a[46:47], v37 offset:712
    s_waitcnt lgkmcnt(6)
    ds_read_b64 a[48:49], v37 offset:768
    ds_read_b64 a[50:51], v37 offset:776
    ds_read_b64 a[52:53], v37 offset:832
    ds_read_b64 a[54:55], v37 offset:840
    ds_read_b64 a[56:57], v37 offset:896
    ds_read_b64 a[58:59], v37 offset:904
    ds_read_b64 a[60:61], v37 offset:960
    ds_read_b64 a[62:63], v37 offset:968
    s_waitcnt lgkmcnt(6)
    ds_read_b64 a[64:65], v37 offset:1024
    ds_read_b64 a[66:67], v37 offset:1032
    ds_read_b64 a[68:69], v37 offset:1088
    ds_read_b64 a[70:71], v37 offset:1096
    ds_read_b64 a[72:73], v37 offset:1152
    ds_read_b64 a[74:75], v37 offset:1160
    ds_read_b64 a[76:77], v37 offset:1216
    ds_read_b64 a[78:79], v37 offset:1224
    s_waitcnt lgkmcnt(6)
    ds_read_b64 a[80:81], v37 offset:1280
    ds_read_b64 a[82:83], v37 offset:1288
    ds_read_b64 a[84:85], v37 offset:1344
    ds_read_b64 a[86:87], v37 offset:1352
    ds_read_b64 a[88:89], v37 offset:1408
    ds_read_b64 a[90:91], v37 offset:1416
    ds_read_b64 a[92:93], v37 offset:1472
    ds_read_b64 a[94:95], v37 offset:1480
    s_waitcnt lgkmcnt(6)
    ds_read_b64 a[96:97], v37 offset:1536
    ds_read_b64 a[98:99], v37 offset:1544
    ds_read_b64 a[100:101], v37 offset:1600
    ds_read_b64 a[102:103], v37 offset:1608
    ds_read_b64 a[104:105], v37 offset:1664
    ds_read_b64 a[106:107], v37 offset:1672
    ds_read_b64 a[108:109], v37 offset:1728
    ds_read_b64 a[110:111], v37 offset:1736
    s_waitcnt lgkmcnt(6)
    ds_read_b64 a[112:113], v37 offset:1792
    ds_read_b64 a[114:115], v37 offset:1800
    ds_read_b64 a[116:117], v37 offset:1856
    ds_read_b64 a[118:119], v37 offset:1864
    ds_read_b64 a[120:121], v37 offset:1920
    ds_read_b64 a[122:123], v37 offset:1928
    ds_read_b64 a[124:125], v37 offset:1984
    ds_read_b64 a[126:127], v37 offset:1992
    s_waitcnt lgkmcnt(6)
    ds_read_b64 a[128:129], v37 offset:2048
    ds_read_b64 a[130:131], v37 offset:2056
    ds_read_b64 a[132:133], v37 offset:2112
    ds_read_b64 a[134:135], v37 offset:2120
    ds_read_b64 a[136:137], v37 offset:2176
    ds_read_b64 a[138:139], v37 offset:2184
    ds_read_b64 a[140:141], v37 offset:2240
    ds_read_b64 a[142:143], v37 offset:2248
    s_waitcnt lgkmcnt(6)
    ds_read_b64 a[144:145], v37 offset:2304
    ds_read_b64 a[146:147], v37 offset:2312
    ds_read_b64 a[148:149], v37 offset:2368
    ds_read_b64 a[150:151], v37 offset:2376
    ds_read_b64 a[152:153], v37 offset:2432
    ds_read_b64 a[154:155], v37 offset:2440
    ds_read_b64 a[156:157], v37 offset:2496
    ds_read_b64 a[158:159], v37 offset:2504
    s_waitcnt lgkmcnt(6)
    ds_read_b64 a[160:161], v37 offset:2560
    ds_read_b64 a[162:163], v37 offset:2568
    ds_read_b64 a[164:165], v37 offset:2624
    ds_read_b64 a[166:167], v37 offset:2632
    ds_read_b64 a[168:169], v37 offset:2688
    ds_read_b64 a[170:171], v37 offset:2696
    ds_read_b64 a[172:173], v37 offset:2752
    ds_read_b64 a[174:175], v37 offset:2760
    s_waitcnt lgkmcnt(6)
    ds_read_b64 a[176:177], v37 offset:2816
    ds_read_b64 a[178:179], v37 offset:2824
    ds_read_b64 a[180:181], v37 offset:2880
    ds_read_b64 a[182:183], v37 offset:2888
    ds_read_b64 a[184:185], v37 offset:2944
    ds_read_b64 a[186:187], v37 offset:2952
    ds_read_b64 a[188:189], v37 offset:3008
    ds_read_b64 a[190:191], v37 offset:3016
    s_waitcnt lgkmcnt(6)
    ds_read_b64 a[192:193], v37 offset:3072
    ds_read_b64 a[194:195], v37 offset:3080
    ds_read_b64 a[196:197], v37 offset:3136
    ds_read_b64 a[198:199], v37 offset:3144
    ds_read_b64 a[200:201], v37 offset:3200
    ds_read_b64 a[202:203], v37 offset:3208
    ds_read_b64 a[204:205], v37 offset:3264
    ds_read_b64 a[206:207], v37 offset:3272
    s_waitcnt lgkmcnt(6)
    ds_read_b64 a[208:209], v37 offset:3328
    ds_read_b64 a[210:211], v37 offset:3336
    ds_read_b64 a[212:213], v37 offset:3392
    ds_read_b64 a[214:215], v37 offset:3400
    ds_read_b64 a[216:217], v37 offset:3456
    ds_read_b64 a[218:219], v37 offset:3464
    ds_read_b64 a[220:221], v37 offset:3520
    ds_read_b64 a[222:223], v37 offset:3528
    s_waitcnt lgkmcnt(6)
    ds_read_b64 a[224:225], v37 offset:3584
    ds_read_b64 a[226:227], v37 offset:3592
    ds_read_b64 a[228:229], v37 offset:3648
    ds_read_b64 a[230:231], v37 offset:3656
    ds_read_b64 a[232:233], v37 offset:3712
    ds_read_b64 a[234:235], v37 offset:3720
    ds_read_b64 a[236:237], v37 offset:3776
    ds_read_b64 a[238:239], v37 offset:3784
    s_waitcnt lgkmcnt(6)
    ds_read_b64 a[240:241], v37 offset:3840
    ds_read_b64 a[242:243], v37 offset:3848
    ds_read_b64 a[244:245], v37 offset:3904
    ds_read_b64 a[246:247], v37 offset:3912
    ds_read_b64 a[248:249], v37 offset:3968
    ds_read_b64 a[250:251], v37 offset:3976
    ds_read_b64 a[252:253], v37 offset:4032
    ds_read_b64 a[254:255], v37 offset:4040
    s_waitcnt lgkmcnt(6)
    s_waitcnt vmcnt(0) lgkmcnt(0)
    ds_read_b128 v[10:13], v8 offset:4032
    ds_read_b128 v[14:17], v8 offset:3968
    ds_read_b128 v[18:21], v8 offset:3904
    ds_read_b128 v[22:25], v8 offset:3840
    ds_read_b128 v[26:29], v8 offset:3776
    ds_read_b128 v[30:33], v8 offset:3712
    s_waitcnt lgkmcnt(5)
    v_mfma_f32_16x16x32_bf16 v[44:47], a[60:63], v[10:13], 0
    v_mfma_f32_16x16x32_bf16 v[48:51], a[92:95], v[10:13], 0
    v_mfma_f32_16x16x32_bf16 v[52:55], a[124:127], v[10:13], 0
    v_mfma_f32_16x16x32_bf16 v[56:59], a[156:159], v[10:13], 0
    v_mfma_f32_16x16x32_bf16 v[60:63], a[188:191], v[10:13], 0
    v_mfma_f32_16x16x32_bf16 v[64:67], a[220:223], v[10:13], 0
    v_mfma_f32_16x16x32_bf16 v[68:71], a[252:255], v[10:13], 0
    ds_read_b128 v[10:13], v8 offset:3648
    s_waitcnt lgkmcnt(5)
    v_mfma_f32_16x16x32_bf16 v[44:47], a[56:59], v[14:17], v[44:47]
    v_mfma_f32_16x16x32_bf16 v[48:51], a[88:91], v[14:17], v[48:51]
    v_mfma_f32_16x16x32_bf16 v[52:55], a[120:123], v[14:17], v[52:55]
    v_mfma_f32_16x16x32_bf16 v[56:59], a[152:155], v[14:17], v[56:59]
    v_mfma_f32_16x16x32_bf16 v[60:63], a[184:187], v[14:17], v[60:63]
    v_mfma_f32_16x16x32_bf16 v[64:67], a[216:219], v[14:17], v[64:67]
    v_mfma_f32_16x16x32_bf16 v[68:71], a[248:251], v[14:17], v[68:71]
    ds_read_b128 v[14:17], v8 offset:3584
    s_waitcnt lgkmcnt(5)
    v_mfma_f32_16x16x32_bf16 v[44:47], a[52:55], v[18:21], v[44:47]
    v_mfma_f32_16x16x32_bf16 v[48:51], a[84:87], v[18:21], v[48:51]
    v_mfma_f32_16x16x32_bf16 v[52:55], a[116:119], v[18:21], v[52:55]
    v_mfma_f32_16x16x32_bf16 v[56:59], a[148:151], v[18:21], v[56:59]
    v_mfma_f32_16x16x32_bf16 v[60:63], a[180:183], v[18:21], v[60:63]
    v_mfma_f32_16x16x32_bf16 v[64:67], a[212:215], v[18:21], v[64:67]
    v_mfma_f32_16x16x32_bf16 v[68:71], a[244:247], v[18:21], v[68:71]
    ds_read_b128 v[18:21], v8 offset:3520
    s_waitcnt lgkmcnt(5)
    v_mfma_f32_16x16x32_bf16 v[44:47], a[48:51], v[22:25], v[44:47]
    v_mfma_f32_16x16x32_bf16 v[48:51], a[80:83], v[22:25], v[48:51]
    v_mfma_f32_16x16x32_bf16 v[52:55], a[112:115], v[22:25], v[52:55]
    v_mfma_f32_16x16x32_bf16 v[56:59], a[144:147], v[22:25], v[56:59]
    v_mfma_f32_16x16x32_bf16 v[60:63], a[176:179], v[22:25], v[60:63]
    v_mfma_f32_16x16x32_bf16 v[64:67], a[208:211], v[22:25], v[64:67]
    v_mfma_f32_16x16x32_bf16 v[68:71], a[240:243], v[22:25], v[68:71]
    ds_read_b128 v[22:25], v8 offset:3456
    s_waitcnt lgkmcnt(5)
    v_mfma_f32_16x16x32_bf16 v[44:47], a[44:47], v[26:29], v[44:47]
    v_mfma_f32_16x16x32_bf16 v[48:51], a[76:79], v[26:29], v[48:51]
    v_mfma_f32_16x16x32_bf16 v[52:55], a[108:111], v[26:29], v[52:55]
    v_mfma_f32_16x16x32_bf16 v[56:59], a[140:143], v[26:29], v[56:59]
    v_mfma_f32_16x16x32_bf16 v[60:63], a[172:175], v[26:29], v[60:63]
    v_mfma_f32_16x16x32_bf16 v[64:67], a[204:207], v[26:29], v[64:67]
    v_mfma_f32_16x16x32_bf16 v[68:71], a[236:239], v[26:29], v[68:71]
    ds_read_b128 v[26:29], v8 offset:3392
    s_waitcnt lgkmcnt(5)
    v_mfma_f32_16x16x32_bf16 v[44:47], a[40:43], v[30:33], v[44:47]
    v_mfma_f32_16x16x32_bf16 v[48:51], a[72:75], v[30:33], v[48:51]
    v_mfma_f32_16x16x32_bf16 v[52:55], a[104:107], v[30:33], v[52:55]
    v_mfma_f32_16x16x32_bf16 v[56:59], a[136:139], v[30:33], v[56:59]
    v_mfma_f32_16x16x32_bf16 v[60:63], a[168:171], v[30:33], v[60:63]
    v_mfma_f32_16x16x32_bf16 v[64:67], a[200:203], v[30:33], v[64:67]
    v_mfma_f32_16x16x32_bf16 v[68:71], a[232:235], v[30:33], v[68:71]
    ds_read_b128 v[30:33], v8 offset:3328
    s_waitcnt lgkmcnt(5)
    v_mfma_f32_16x16x32_bf16 v[44:47], a[36:39], v[10:13], v[44:47]
    v_mfma_f32_16x16x32_bf16 v[48:51], a[68:71], v[10:13], v[48:51]
    v_mfma_f32_16x16x32_bf16 v[52:55], a[100:103], v[10:13], v[52:55]
    v_mfma_f32_16x16x32_bf16 v[56:59], a[132:135], v[10:13], v[56:59]
    v_mfma_f32_16x16x32_bf16 v[60:63], a[164:167], v[10:13], v[60:63]
    v_mfma_f32_16x16x32_bf16 v[64:67], a[196:199], v[10:13], v[64:67]
    v_mfma_f32_16x16x32_bf16 v[68:71], a[228:231], v[10:13], v[68:71]
    ds_read_b128 v[10:13], v8 offset:3264
    s_waitcnt lgkmcnt(5)
    v_mfma_f32_16x16x32_bf16 v[44:47], a[32:35], v[14:17], v[44:47]
    v_mfma_f32_16x16x32_bf16 v[48:51], a[64:67], v[14:17], v[48:51]
    v_mfma_f32_16x16x32_bf16 v[52:55], a[96:99], v[14:17], v[52:55]
    v_mfma_f32_16x16x32_bf16 v[56:59], a[128:131], v[14:17], v[56:59]
    v_mfma_f32_16x16x32_bf16 v[60:63], a[160:163], v[14:17], v[60:63]
    v_mfma_f32_16x16x32_bf16 v[64:67], a[192:195], v[14:17], v[64:67]
    v_mfma_f32_16x16x32_bf16 v[68:71], a[224:227], v[14:17], v[68:71]
    ds_read_b128 v[14:17], v8 offset:3200
    s_waitcnt lgkmcnt(5)
    v_mfma_f32_16x16x32_bf16 v[44:47], a[28:31], v[18:21], v[44:47]
    v_mfma_f32_16x16x32_bf16 v[48:51], a[60:63], v[18:21], v[48:51]
    v_mfma_f32_16x16x32_bf16 v[52:55], a[92:95], v[18:21], v[52:55]
    v_mfma_f32_16x16x32_bf16 v[56:59], a[124:127], v[18:21], v[56:59]
    v_mfma_f32_16x16x32_bf16 v[60:63], a[156:159], v[18:21], v[60:63]
    v_mfma_f32_16x16x32_bf16 v[64:67], a[188:191], v[18:21], v[64:67]
    v_mfma_f32_16x16x32_bf16 v[68:71], a[220:223], v[18:21], v[68:71]
    ds_read_b128 v[18:21], v8 offset:3136
    s_waitcnt lgkmcnt(5)
    v_mfma_f32_16x16x32_bf16 v[44:47], a[24:27], v[22:25], v[44:47]
    v_mfma_f32_16x16x32_bf16 v[48:51], a[56:59], v[22:25], v[48:51]
    v_mfma_f32_16x16x32_bf16 v[52:55], a[88:91], v[22:25], v[52:55]
    v_mfma_f32_16x16x32_bf16 v[56:59], a[120:123], v[22:25], v[56:59]
    v_mfma_f32_16x16x32_bf16 v[60:63], a[152:155], v[22:25], v[60:63]
    v_mfma_f32_16x16x32_bf16 v[64:67], a[184:187], v[22:25], v[64:67]
    v_mfma_f32_16x16x32_bf16 v[68:71], a[216:219], v[22:25], v[68:71]
    ds_read_b128 v[22:25], v8 offset:3072
    s_waitcnt lgkmcnt(5)
    v_mfma_f32_16x16x32_bf16 v[44:47], a[20:23], v[26:29], v[44:47]
    v_mfma_f32_16x16x32_bf16 v[48:51], a[52:55], v[26:29], v[48:51]
    v_mfma_f32_16x16x32_bf16 v[52:55], a[84:87], v[26:29], v[52:55]
    v_mfma_f32_16x16x32_bf16 v[56:59], a[116:119], v[26:29], v[56:59]
    v_mfma_f32_16x16x32_bf16 v[60:63], a[148:151], v[26:29], v[60:63]
    v_mfma_f32_16x16x32_bf16 v[64:67], a[180:183], v[26:29], v[64:67]
    v_mfma_f32_16x16x32_bf16 v[68:71], a[212:215], v[26:29], v[68:71]
    ds_read_b128 v[26:29], v8 offset:3008
    s_waitcnt lgkmcnt(5)
    v_mfma_f32_16x16x32_bf16 v[44:47], a[16:19], v[30:33], v[44:47]
    v_mfma_f32_16x16x32_bf16 v[48:51], a[48:51], v[30:33], v[48:51]
    v_mfma_f32_16x16x32_bf16 v[52:55], a[80:83], v[30:33], v[52:55]
    v_mfma_f32_16x16x32_bf16 v[56:59], a[112:115], v[30:33], v[56:59]
    v_mfma_f32_16x16x32_bf16 v[60:63], a[144:147], v[30:33], v[60:63]
    v_mfma_f32_16x16x32_bf16 v[64:67], a[176:179], v[30:33], v[64:67]
    v_mfma_f32_16x16x32_bf16 v[68:71], a[208:211], v[30:33], v[68:71]
    ds_read_b128 v[30:33], v8 offset:2944
    s_waitcnt lgkmcnt(5)
    v_mfma_f32_16x16x32_bf16 v[44:47], a[12:15], v[10:13], v[44:47]
    v_mfma_f32_16x16x32_bf16 v[48:51], a[44:47], v[10:13], v[48:51]
    v_mfma_f32_16x16x32_bf16 v[52:55], a[76:79], v[10:13], v[52:55]
    v_mfma_f32_16x16x32_bf16 v[56:59], a[108:111], v[10:13], v[56:59]
    v_mfma_f32_16x16x32_bf16 v[60:63], a[140:143], v[10:13], v[60:63]
    v_mfma_f32_16x16x32_bf16 v[64:67], a[172:175], v[10:13], v[64:67]
    v_mfma_f32_16x16x32_bf16 v[68:71], a[204:207], v[10:13], v[68:71]
    ds_read_b128 v[10:13], v8 offset:2880
    s_waitcnt lgkmcnt(5)
    v_mfma_f32_16x16x32_bf16 v[44:47], a[8:11], v[14:17], v[44:47]
    v_mfma_f32_16x16x32_bf16 v[48:51], a[40:43], v[14:17], v[48:51]
    v_mfma_f32_16x16x32_bf16 v[52:55], a[72:75], v[14:17], v[52:55]
    v_mfma_f32_16x16x32_bf16 v[56:59], a[104:107], v[14:17], v[56:59]
    v_mfma_f32_16x16x32_bf16 v[60:63], a[136:139], v[14:17], v[60:63]
    v_mfma_f32_16x16x32_bf16 v[64:67], a[168:171], v[14:17], v[64:67]
    v_mfma_f32_16x16x32_bf16 v[68:71], a[200:203], v[14:17], v[68:71]
    ds_read_b128 v[14:17], v8 offset:2816
    s_waitcnt lgkmcnt(5)
    v_mfma_f32_16x16x32_bf16 v[44:47], a[4:7], v[18:21], v[44:47]
    v_mfma_f32_16x16x32_bf16 v[48:51], a[36:39], v[18:21], v[48:51]
    v_mfma_f32_16x16x32_bf16 v[52:55], a[68:71], v[18:21], v[52:55]
    v_mfma_f32_16x16x32_bf16 v[56:59], a[100:103], v[18:21], v[56:59]
    v_mfma_f32_16x16x32_bf16 v[60:63], a[132:135], v[18:21], v[60:63]
    v_mfma_f32_16x16x32_bf16 v[64:67], a[164:167], v[18:21], v[64:67]
    v_mfma_f32_16x16x32_bf16 v[68:71], a[196:199], v[18:21], v[68:71]
    ds_read_b128 v[18:21], v8 offset:2752
    s_waitcnt lgkmcnt(5)
    v_mfma_f32_16x16x32_bf16 v[44:47], a[0:3], v[22:25], v[44:47]
    v_mfma_f32_16x16x32_bf16 v[48:51], a[32:35], v[22:25], v[48:51]
    v_mfma_f32_16x16x32_bf16 v[52:55], a[64:67], v[22:25], v[52:55]
    v_mfma_f32_16x16x32_bf16 v[56:59], a[96:99], v[22:25], v[56:59]
    v_mfma_f32_16x16x32_bf16 v[60:63], a[128:131], v[22:25], v[60:63]
    v_mfma_f32_16x16x32_bf16 v[64:67], a[160:163], v[22:25], v[64:67]
    v_mfma_f32_16x16x32_bf16 v[68:71], a[192:195], v[22:25], v[68:71]
    ds_read_b128 v[22:25], v8 offset:2688
    s_waitcnt lgkmcnt(5)
    v_mfma_f32_16x16x32_bf16 v[48:51], a[28:31], v[26:29], v[48:51]
    v_mfma_f32_16x16x32_bf16 v[52:55], a[60:63], v[26:29], v[52:55]
    v_mfma_f32_16x16x32_bf16 v[56:59], a[92:95], v[26:29], v[56:59]
    v_mfma_f32_16x16x32_bf16 v[60:63], a[124:127], v[26:29], v[60:63]
    v_mfma_f32_16x16x32_bf16 v[64:67], a[156:159], v[26:29], v[64:67]
    v_mfma_f32_16x16x32_bf16 v[68:71], a[188:191], v[26:29], v[68:71]
    ds_read_b128 v[26:29], v8 offset:2624
    s_waitcnt lgkmcnt(5)
    v_mfma_f32_16x16x32_bf16 v[48:51], a[24:27], v[30:33], v[48:51]
    v_mfma_f32_16x16x32_bf16 v[52:55], a[56:59], v[30:33], v[52:55]
    v_mfma_f32_16x16x32_bf16 v[56:59], a[88:91], v[30:33], v[56:59]
    v_mfma_f32_16x16x32_bf16 v[60:63], a[120:123], v[30:33], v[60:63]
    v_mfma_f32_16x16x32_bf16 v[64:67], a[152:155], v[30:33], v[64:67]
    v_mfma_f32_16x16x32_bf16 v[68:71], a[184:187], v[30:33], v[68:71]
    ds_read_b128 v[30:33], v8 offset:2560
    s_waitcnt lgkmcnt(5)
    v_mfma_f32_16x16x32_bf16 v[48:51], a[20:23], v[10:13], v[48:51]
    v_mfma_f32_16x16x32_bf16 v[52:55], a[52:55], v[10:13], v[52:55]
    v_mfma_f32_16x16x32_bf16 v[56:59], a[84:87], v[10:13], v[56:59]
    v_mfma_f32_16x16x32_bf16 v[60:63], a[116:119], v[10:13], v[60:63]
    v_mfma_f32_16x16x32_bf16 v[64:67], a[148:151], v[10:13], v[64:67]
    v_mfma_f32_16x16x32_bf16 v[68:71], a[180:183], v[10:13], v[68:71]
    ds_read_b128 v[10:13], v8 offset:2496
    s_waitcnt lgkmcnt(5)
    v_mfma_f32_16x16x32_bf16 v[48:51], a[16:19], v[14:17], v[48:51]
    v_mfma_f32_16x16x32_bf16 v[52:55], a[48:51], v[14:17], v[52:55]
    v_mfma_f32_16x16x32_bf16 v[56:59], a[80:83], v[14:17], v[56:59]
    v_mfma_f32_16x16x32_bf16 v[60:63], a[112:115], v[14:17], v[60:63]
    v_mfma_f32_16x16x32_bf16 v[64:67], a[144:147], v[14:17], v[64:67]
    v_mfma_f32_16x16x32_bf16 v[68:71], a[176:179], v[14:17], v[68:71]
    ds_read_b128 v[14:17], v8 offset:2432
    s_waitcnt lgkmcnt(5)
    v_mfma_f32_16x16x32_bf16 v[48:51], a[12:15], v[18:21], v[48:51]
    v_mfma_f32_16x16x32_bf16 v[52:55], a[44:47], v[18:21], v[52:55]
    v_mfma_f32_16x16x32_bf16 v[56:59], a[76:79], v[18:21], v[56:59]
    v_mfma_f32_16x16x32_bf16 v[60:63], a[108:111], v[18:21], v[60:63]
    v_mfma_f32_16x16x32_bf16 v[64:67], a[140:143], v[18:21], v[64:67]
    v_mfma_f32_16x16x32_bf16 v[68:71], a[172:175], v[18:21], v[68:71]
    ds_read_b128 v[18:21], v8 offset:2368
    s_waitcnt lgkmcnt(5)
    v_mfma_f32_16x16x32_bf16 v[48:51], a[8:11], v[22:25], v[48:51]
    v_mfma_f32_16x16x32_bf16 v[52:55], a[40:43], v[22:25], v[52:55]
    v_mfma_f32_16x16x32_bf16 v[56:59], a[72:75], v[22:25], v[56:59]
    v_mfma_f32_16x16x32_bf16 v[60:63], a[104:107], v[22:25], v[60:63]
    v_mfma_f32_16x16x32_bf16 v[64:67], a[136:139], v[22:25], v[64:67]
    v_mfma_f32_16x16x32_bf16 v[68:71], a[168:171], v[22:25], v[68:71]
    ds_read_b128 v[22:25], v8 offset:2304
    s_waitcnt lgkmcnt(5)
    v_mfma_f32_16x16x32_bf16 v[48:51], a[4:7], v[26:29], v[48:51]
    v_mfma_f32_16x16x32_bf16 v[52:55], a[36:39], v[26:29], v[52:55]
    v_mfma_f32_16x16x32_bf16 v[56:59], a[68:71], v[26:29], v[56:59]
    v_mfma_f32_16x16x32_bf16 v[60:63], a[100:103], v[26:29], v[60:63]
    v_mfma_f32_16x16x32_bf16 v[64:67], a[132:135], v[26:29], v[64:67]
    v_mfma_f32_16x16x32_bf16 v[68:71], a[164:167], v[26:29], v[68:71]
    ds_read_b128 v[26:29], v8 offset:2240
    s_waitcnt lgkmcnt(5)
    v_mfma_f32_16x16x32_bf16 v[48:51], a[0:3], v[30:33], v[48:51]
    v_mfma_f32_16x16x32_bf16 v[52:55], a[32:35], v[30:33], v[52:55]
    v_mfma_f32_16x16x32_bf16 v[56:59], a[64:67], v[30:33], v[56:59]
    v_mfma_f32_16x16x32_bf16 v[60:63], a[96:99], v[30:33], v[60:63]
    v_mfma_f32_16x16x32_bf16 v[64:67], a[128:131], v[30:33], v[64:67]
    v_mfma_f32_16x16x32_bf16 v[68:71], a[160:163], v[30:33], v[68:71]
    ds_read_b128 v[30:33], v8 offset:2176
    s_waitcnt lgkmcnt(5)
    v_mfma_f32_16x16x32_bf16 v[52:55], a[28:31], v[10:13], v[52:55]
    v_mfma_f32_16x16x32_bf16 v[56:59], a[60:63], v[10:13], v[56:59]
    v_mfma_f32_16x16x32_bf16 v[60:63], a[92:95], v[10:13], v[60:63]
    v_mfma_f32_16x16x32_bf16 v[64:67], a[124:127], v[10:13], v[64:67]
    v_mfma_f32_16x16x32_bf16 v[68:71], a[156:159], v[10:13], v[68:71]
    ds_read_b128 v[10:13], v8 offset:2112
    s_waitcnt lgkmcnt(5)
    v_mfma_f32_16x16x32_bf16 v[52:55], a[24:27], v[14:17], v[52:55]
    v_mfma_f32_16x16x32_bf16 v[56:59], a[56:59], v[14:17], v[56:59]
    v_mfma_f32_16x16x32_bf16 v[60:63], a[88:91], v[14:17], v[60:63]
    v_mfma_f32_16x16x32_bf16 v[64:67], a[120:123], v[14:17], v[64:67]
    v_mfma_f32_16x16x32_bf16 v[68:71], a[152:155], v[14:17], v[68:71]
    ds_read_b128 v[14:17], v8 offset:2048
    s_waitcnt lgkmcnt(5)
    v_mfma_f32_16x16x32_bf16 v[52:55], a[20:23], v[18:21], v[52:55]
    v_mfma_f32_16x16x32_bf16 v[56:59], a[52:55], v[18:21], v[56:59]
    v_mfma_f32_16x16x32_bf16 v[60:63], a[84:87], v[18:21], v[60:63]
    v_mfma_f32_16x16x32_bf16 v[64:67], a[116:119], v[18:21], v[64:67]
    v_mfma_f32_16x16x32_bf16 v[68:71], a[148:151], v[18:21], v[68:71]
    ds_read_b128 v[18:21], v8 offset:1984
    s_waitcnt lgkmcnt(5)
    v_mfma_f32_16x16x32_bf16 v[52:55], a[16:19], v[22:25], v[52:55]
    v_mfma_f32_16x16x32_bf16 v[56:59], a[48:51], v[22:25], v[56:59]
    v_mfma_f32_16x16x32_bf16 v[60:63], a[80:83], v[22:25], v[60:63]
    v_mfma_f32_16x16x32_bf16 v[64:67], a[112:115], v[22:25], v[64:67]
    v_mfma_f32_16x16x32_bf16 v[68:71], a[144:147], v[22:25], v[68:71]
    ds_read_b128 v[22:25], v8 offset:1920
    s_waitcnt lgkmcnt(5)
    v_mfma_f32_16x16x32_bf16 v[52:55], a[12:15], v[26:29], v[52:55]
    v_mfma_f32_16x16x32_bf16 v[56:59], a[44:47], v[26:29], v[56:59]
    v_mfma_f32_16x16x32_bf16 v[60:63], a[76:79], v[26:29], v[60:63]
    v_mfma_f32_16x16x32_bf16 v[64:67], a[108:111], v[26:29], v[64:67]
    v_mfma_f32_16x16x32_bf16 v[68:71], a[140:143], v[26:29], v[68:71]
    ds_read_b128 v[26:29], v8 offset:1856
    s_waitcnt lgkmcnt(5)
    v_mfma_f32_16x16x32_bf16 v[52:55], a[8:11], v[30:33], v[52:55]
    v_mfma_f32_16x16x32_bf16 v[56:59], a[40:43], v[30:33], v[56:59]
    v_mfma_f32_16x16x32_bf16 v[60:63], a[72:75], v[30:33], v[60:63]
    v_mfma_f32_16x16x32_bf16 v[64:67], a[104:107], v[30:33], v[64:67]
    v_mfma_f32_16x16x32_bf16 v[68:71], a[136:139], v[30:33], v[68:71]
    ds_read_b128 v[30:33], v8 offset:1792
    s_waitcnt lgkmcnt(5)
    v_mfma_f32_16x16x32_bf16 v[52:55], a[4:7], v[10:13], v[52:55]
    v_mfma_f32_16x16x32_bf16 v[56:59], a[36:39], v[10:13], v[56:59]
    v_mfma_f32_16x16x32_bf16 v[60:63], a[68:71], v[10:13], v[60:63]
    v_mfma_f32_16x16x32_bf16 v[64:67], a[100:103], v[10:13], v[64:67]
    v_mfma_f32_16x16x32_bf16 v[68:71], a[132:135], v[10:13], v[68:71]
    ds_read_b128 v[10:13], v8 offset:1728
    s_waitcnt lgkmcnt(5)
    v_mfma_f32_16x16x32_bf16 v[52:55], a[0:3], v[14:17], v[52:55]
    v_mfma_f32_16x16x32_bf16 v[56:59], a[32:35], v[14:17], v[56:59]
    v_mfma_f32_16x16x32_bf16 v[60:63], a[64:67], v[14:17], v[60:63]
    v_mfma_f32_16x16x32_bf16 v[64:67], a[96:99], v[14:17], v[64:67]
    v_mfma_f32_16x16x32_bf16 v[68:71], a[128:131], v[14:17], v[68:71]
    ds_read_b128 v[14:17], v8 offset:1664
    s_waitcnt lgkmcnt(5)
    v_mfma_f32_16x16x32_bf16 v[56:59], a[28:31], v[18:21], v[56:59]
    v_mfma_f32_16x16x32_bf16 v[60:63], a[60:63], v[18:21], v[60:63]
    v_mfma_f32_16x16x32_bf16 v[64:67], a[92:95], v[18:21], v[64:67]
    v_mfma_f32_16x16x32_bf16 v[68:71], a[124:127], v[18:21], v[68:71]
    ds_read_b128 v[18:21], v8 offset:1600
    s_waitcnt lgkmcnt(5)
    v_mfma_f32_16x16x32_bf16 v[56:59], a[24:27], v[22:25], v[56:59]
    v_mfma_f32_16x16x32_bf16 v[60:63], a[56:59], v[22:25], v[60:63]
    v_mfma_f32_16x16x32_bf16 v[64:67], a[88:91], v[22:25], v[64:67]
    v_mfma_f32_16x16x32_bf16 v[68:71], a[120:123], v[22:25], v[68:71]
    ds_read_b128 v[22:25], v8 offset:1536
    s_waitcnt lgkmcnt(5)
    v_mfma_f32_16x16x32_bf16 v[56:59], a[20:23], v[26:29], v[56:59]
    v_mfma_f32_16x16x32_bf16 v[60:63], a[52:55], v[26:29], v[60:63]
    v_mfma_f32_16x16x32_bf16 v[64:67], a[84:87], v[26:29], v[64:67]
    v_mfma_f32_16x16x32_bf16 v[68:71], a[116:119], v[26:29], v[68:71]
    ds_read_b128 v[26:29], v8 offset:1472
    s_waitcnt lgkmcnt(5)
    v_mfma_f32_16x16x32_bf16 v[56:59], a[16:19], v[30:33], v[56:59]
    v_mfma_f32_16x16x32_bf16 v[60:63], a[48:51], v[30:33], v[60:63]
    v_mfma_f32_16x16x32_bf16 v[64:67], a[80:83], v[30:33], v[64:67]
    v_mfma_f32_16x16x32_bf16 v[68:71], a[112:115], v[30:33], v[68:71]
    ds_read_b128 v[30:33], v8 offset:1408
    s_waitcnt lgkmcnt(5)
    v_mfma_f32_16x16x32_bf16 v[56:59], a[12:15], v[10:13], v[56:59]
    v_mfma_f32_16x16x32_bf16 v[60:63], a[44:47], v[10:13], v[60:63]
    v_mfma_f32_16x16x32_bf16 v[64:67], a[76:79], v[10:13], v[64:67]
    v_mfma_f32_16x16x32_bf16 v[68:71], a[108:111], v[10:13], v[68:71]
    ds_read_b128 v[10:13], v8 offset:1344
    s_waitcnt lgkmcnt(5)
    v_mfma_f32_16x16x32_bf16 v[56:59], a[8:11], v[14:17], v[56:59]
    v_mfma_f32_16x16x32_bf16 v[60:63], a[40:43], v[14:17], v[60:63]
    v_mfma_f32_16x16x32_bf16 v[64:67], a[72:75], v[14:17], v[64:67]
    v_mfma_f32_16x16x32_bf16 v[68:71], a[104:107], v[14:17], v[68:71]
    ds_read_b128 v[14:17], v8 offset:1280
    s_waitcnt lgkmcnt(5)
    v_mfma_f32_16x16x32_bf16 v[56:59], a[4:7], v[18:21], v[56:59]
    v_mfma_f32_16x16x32_bf16 v[60:63], a[36:39], v[18:21], v[60:63]
    v_mfma_f32_16x16x32_bf16 v[64:67], a[68:71], v[18:21], v[64:67]
    v_mfma_f32_16x16x32_bf16 v[68:71], a[100:103], v[18:21], v[68:71]
    ds_read_b128 v[18:21], v8 offset:1216
    s_waitcnt lgkmcnt(5)
    v_mfma_f32_16x16x32_bf16 v[56:59], a[0:3], v[22:25], v[56:59]
    v_mfma_f32_16x16x32_bf16 v[60:63], a[32:35], v[22:25], v[60:63]
    v_mfma_f32_16x16x32_bf16 v[64:67], a[64:67], v[22:25], v[64:67]
    v_mfma_f32_16x16x32_bf16 v[68:71], a[96:99], v[22:25], v[68:71]
    ds_read_b128 v[22:25], v8 offset:1152
    s_waitcnt lgkmcnt(5)
    v_mfma_f32_16x16x32_bf16 v[60:63], a[28:31], v[26:29], v[60:63]
    v_mfma_f32_16x16x32_bf16 v[64:67], a[60:63], v[26:29], v[64:67]
    v_mfma_f32_16x16x32_bf16 v[68:71], a[92:95], v[26:29], v[68:71]
    ds_read_b128 v[26:29], v8 offset:1088
    s_waitcnt lgkmcnt(5)
    v_mfma_f32_16x16x32_bf16 v[60:63], a[24:27], v[30:33], v[60:63]
    v_mfma_f32_16x16x32_bf16 v[64:67], a[56:59], v[30:33], v[64:67]
    v_mfma_f32_16x16x32_bf16 v[68:71], a[88:91], v[30:33], v[68:71]
    ds_read_b128 v[30:33], v8 offset:1024
    s_waitcnt lgkmcnt(5)
    v_mfma_f32_16x16x32_bf16 v[60:63], a[20:23], v[10:13], v[60:63]
    v_mfma_f32_16x16x32_bf16 v[64:67], a[52:55], v[10:13], v[64:67]
    v_mfma_f32_16x16x32_bf16 v[68:71], a[84:87], v[10:13], v[68:71]
    ds_read_b128 v[10:13], v8 offset:960
    s_waitcnt lgkmcnt(5)
    v_mfma_f32_16x16x32_bf16 v[60:63], a[16:19], v[14:17], v[60:63]
    v_mfma_f32_16x16x32_bf16 v[64:67], a[48:51], v[14:17], v[64:67]
    v_mfma_f32_16x16x32_bf16 v[68:71], a[80:83], v[14:17], v[68:71]
    ds_read_b128 v[14:17], v8 offset:896
    s_waitcnt lgkmcnt(5)
    v_mfma_f32_16x16x32_bf16 v[60:63], a[12:15], v[18:21], v[60:63]
    v_mfma_f32_16x16x32_bf16 v[64:67], a[44:47], v[18:21], v[64:67]
    v_mfma_f32_16x16x32_bf16 v[68:71], a[76:79], v[18:21], v[68:71]
    ds_read_b128 v[18:21], v8 offset:832
    s_waitcnt lgkmcnt(5)
    v_mfma_f32_16x16x32_bf16 v[60:63], a[8:11], v[22:25], v[60:63]
    v_mfma_f32_16x16x32_bf16 v[64:67], a[40:43], v[22:25], v[64:67]
    v_mfma_f32_16x16x32_bf16 v[68:71], a[72:75], v[22:25], v[68:71]
    ds_read_b128 v[22:25], v8 offset:768
    s_waitcnt lgkmcnt(5)
    v_mfma_f32_16x16x32_bf16 v[60:63], a[4:7], v[26:29], v[60:63]
    v_mfma_f32_16x16x32_bf16 v[64:67], a[36:39], v[26:29], v[64:67]
    v_mfma_f32_16x16x32_bf16 v[68:71], a[68:71], v[26:29], v[68:71]
    ds_read_b128 v[26:29], v8 offset:704
    s_waitcnt lgkmcnt(5)
    v_mfma_f32_16x16x32_bf16 v[60:63], a[0:3], v[30:33], v[60:63]
    v_mfma_f32_16x16x32_bf16 v[64:67], a[32:35], v[30:33], v[64:67]
    v_mfma_f32_16x16x32_bf16 v[68:71], a[64:67], v[30:33], v[68:71]
    ds_read_b128 v[30:33], v8 offset:640
    s_waitcnt lgkmcnt(5)
    v_mfma_f32_16x16x32_bf16 v[64:67], a[28:31], v[10:13], v[64:67]
    v_mfma_f32_16x16x32_bf16 v[68:71], a[60:63], v[10:13], v[68:71]
    ds_read_b128 v[10:13], v8 offset:576
    s_waitcnt lgkmcnt(5)
    v_mfma_f32_16x16x32_bf16 v[64:67], a[24:27], v[14:17], v[64:67]
    v_mfma_f32_16x16x32_bf16 v[68:71], a[56:59], v[14:17], v[68:71]
    ds_read_b128 v[14:17], v8 offset:512
    s_waitcnt lgkmcnt(5)
    v_mfma_f32_16x16x32_bf16 v[64:67], a[20:23], v[18:21], v[64:67]
    v_mfma_f32_16x16x32_bf16 v[68:71], a[52:55], v[18:21], v[68:71]
    ds_read_b128 v[18:21], v8 offset:448
    s_waitcnt lgkmcnt(5)
    v_mfma_f32_16x16x32_bf16 v[64:67], a[16:19], v[22:25], v[64:67]
    v_mfma_f32_16x16x32_bf16 v[68:71], a[48:51], v[22:25], v[68:71]
    ds_read_b128 v[22:25], v8 offset:384
    s_waitcnt lgkmcnt(5)
    v_mfma_f32_16x16x32_bf16 v[64:67], a[12:15], v[26:29], v[64:67]
    v_mfma_f32_16x16x32_bf16 v[68:71], a[44:47], v[26:29], v[68:71]
    ds_read_b128 v[26:29], v8 offset:320
    s_waitcnt lgkmcnt(5)
    v_mfma_f32_16x16x32_bf16 v[64:67], a[8:11], v[30:33], v[64:67]
    v_mfma_f32_16x16x32_bf16 v[68:71], a[40:43], v[30:33], v[68:71]
    ds_read_b128 v[30:33], v8 offset:256
    s_waitcnt lgkmcnt(5)
    v_mfma_f32_16x16x32_bf16 v[64:67], a[4:7], v[10:13], v[64:67]
    v_mfma_f32_16x16x32_bf16 v[68:71], a[36:39], v[10:13], v[68:71]
    ds_read_b128 v[10:13], v8 offset:192
    s_waitcnt lgkmcnt(5)
    v_mfma_f32_16x16x32_bf16 v[64:67], a[0:3], v[14:17], v[64:67]
    v_mfma_f32_16x16x32_bf16 v[68:71], a[32:35], v[14:17], v[68:71]
    ds_read_b128 v[14:17], v8 offset:128
    s_waitcnt lgkmcnt(5)
    v_mfma_f32_16x16x32_bf16 v[68:71], a[28:31], v[18:21], v[68:71]
    ds_read_b128 v[18:21], v8 offset:64
    s_waitcnt lgkmcnt(5)
    v_mfma_f32_16x16x32_bf16 v[68:71], a[24:27], v[22:25], v[68:71]
    ds_read_b128 v[22:25], v8 offset:0
    s_waitcnt lgkmcnt(5)
    v_mfma_f32_16x16x32_bf16 v[68:71], a[20:23], v[26:29], v[68:71]
    s_waitcnt lgkmcnt(4)
    v_mfma_f32_16x16x32_bf16 v[68:71], a[16:19], v[30:33], v[68:71]
    s_waitcnt lgkmcnt(3)
    v_mfma_f32_16x16x32_bf16 v[68:71], a[12:15], v[10:13], v[68:71]
    s_waitcnt lgkmcnt(2)
    v_mfma_f32_16x16x32_bf16 v[68:71], a[8:11], v[14:17], v[68:71]
    s_waitcnt lgkmcnt(1)
    v_mfma_f32_16x16x32_bf16 v[68:71], a[4:7], v[18:21], v[68:71]
    s_waitcnt lgkmcnt(0)
    v_mfma_f32_16x16x32_bf16 v[68:71], a[0:3], v[22:25], v[68:71]
    ds_read_b64 v[82:83], v34 offset:3072
    ds_read_b64 v[84:85], v34 offset:2560
    ds_read_b64 v[86:87], v34 offset:2048
    ds_read_b64 v[88:89], v34 offset:1536
    ds_read_b64 v[90:91], v34 offset:1024
    ds_read_b64 v[92:93], v34 offset:512
    ds_read_b64 v[94:95], v34 offset:0
    s_waitcnt lgkmcnt(0)
    v_lshlrev_b32 v11, 16, v83
    v_and_b32 v10, 0xffff0000, v83
    v_lshlrev_b32 v13, 16, v82
    v_and_b32 v12, 0xffff0000, v82
    v_fmac_f32 v44, s36, v10
    v_fmac_f32 v45, s36, v11
    v_fmac_f32 v46, s36, v12
    v_fmac_f32 v47, s36, v13
    v_cvt_pk_bf16_f32 v44, v44, v45
    v_cvt_pk_bf16_f32 v45, v46, v47
    ds_write_b64 v35, v[44:45] offset:2304
    v_lshlrev_b32 v11, 16, v85
    v_and_b32 v10, 0xffff0000, v85
    v_lshlrev_b32 v13, 16, v84
    v_and_b32 v12, 0xffff0000, v84
    v_fmac_f32 v48, s36, v10
    v_fmac_f32 v49, s36, v11
    v_fmac_f32 v50, s36, v12
    v_fmac_f32 v51, s36, v13
    v_cvt_pk_bf16_f32 v48, v48, v49
    v_cvt_pk_bf16_f32 v49, v50, v51
    ds_write_b64 v35, v[48:49] offset:4608
    v_lshlrev_b32 v11, 16, v87
    v_and_b32 v10, 0xffff0000, v87
    v_lshlrev_b32 v13, 16, v86
    v_and_b32 v12, 0xffff0000, v86
    v_fmac_f32 v52, s36, v10
    v_fmac_f32 v53, s36, v11
    v_fmac_f32 v54, s36, v12
    v_fmac_f32 v55, s36, v13
    v_cvt_pk_bf16_f32 v52, v52, v53
    v_cvt_pk_bf16_f32 v53, v54, v55
    ds_write_b64 v35, v[52:53] offset:6912
    v_lshlrev_b32 v11, 16, v89
    v_and_b32 v10, 0xffff0000, v89
    v_lshlrev_b32 v13, 16, v88
    v_and_b32 v12, 0xffff0000, v88
    v_fmac_f32 v56, s36, v10
    v_fmac_f32 v57, s36, v11
    v_fmac_f32 v58, s36, v12
    v_fmac_f32 v59, s36, v13
    v_cvt_pk_bf16_f32 v56, v56, v57
    v_cvt_pk_bf16_f32 v57, v58, v59
    ds_write_b64 v35, v[56:57] offset:9216
    v_lshlrev_b32 v11, 16, v91
    v_and_b32 v10, 0xffff0000, v91
    v_lshlrev_b32 v13, 16, v90
    v_and_b32 v12, 0xffff0000, v90
    v_fmac_f32 v60, s36, v10
    v_fmac_f32 v61, s36, v11
    v_fmac_f32 v62, s36, v12
    v_fmac_f32 v63, s36, v13
    v_cvt_pk_bf16_f32 v60, v60, v61
    v_cvt_pk_bf16_f32 v61, v62, v63
    ds_write_b64 v35, v[60:61] offset:11520
    v_lshlrev_b32 v11, 16, v93
    v_and_b32 v10, 0xffff0000, v93
    v_lshlrev_b32 v13, 16, v92
    v_and_b32 v12, 0xffff0000, v92
    v_fmac_f32 v64, s36, v10
    v_fmac_f32 v65, s36, v11
    v_fmac_f32 v66, s36, v12
    v_fmac_f32 v67, s36, v13
    v_cvt_pk_bf16_f32 v64, v64, v65
    v_cvt_pk_bf16_f32 v65, v66, v67
    ds_write_b64 v35, v[64:65] offset:13824
    v_lshlrev_b32 v11, 16, v95
    v_and_b32 v10, 0xffff0000, v95
    v_lshlrev_b32 v13, 16, v94
    v_and_b32 v12, 0xffff0000, v94
    v_fmac_f32 v68, s36, v10
    v_fmac_f32 v69, s36, v11
    v_fmac_f32 v70, s36, v12
    v_fmac_f32 v71, s36, v13
    v_cvt_pk_bf16_f32 v68, v68, v69
    v_cvt_pk_bf16_f32 v69, v70, v71
    ds_write_b64 v35, v[68:69] offset:16128
    s_waitcnt lgkmcnt(0)
    s_barrier
    ds_read_b128 v[12:15], v36 offset:0
    ds_read_b128 v[16:19], v36 offset:4608
    ds_read_b128 v[20:23], v36 offset:9216
    ds_read_b128 v[24:27], v36 offset:13824
    s_waitcnt lgkmcnt(3)
    buffer_store_dwordx4 v[12:15], v118, s[8:11], s39 offen sc1
    s_add_u32 s39, s39, 532480
    s_waitcnt lgkmcnt(2)
    buffer_store_dwordx4 v[16:19], v118, s[8:11], s39 offen sc1
    s_add_u32 s39, s39, 532480
    s_waitcnt lgkmcnt(1)
    buffer_store_dwordx4 v[20:23], v118, s[8:11], s39 offen sc1
    s_add_u32 s39, s39, 532480
    s_waitcnt lgkmcnt(0)
    buffer_store_dwordx4 v[24:27], v118, s[8:11], s39 offen sc1
    s_add_u32 s39, s39, 532480
    s_waitcnt vmcnt(0)
    s_barrier
    s_cmp_lg_u32 s6, 0
    s_cbranch_scc1 Lsk_13
    s_lshl_b32 s3, s44, 7
    s_add_u32 s3, s3, 576000
    v_mov_b32 v6, 1
    s_mov_b64 exec, 1
    buffer_atomic_add v6, off, s[8:11], s3 sc0 sc1
    s_mov_b64 exec, -1
    s_lshl_b32 s3, s44, 7
    s_add_u32 s3, s3, 575488
    s_waitcnt vmcnt(0)
    v_readfirstlane_b32 s37, v6
    s_cmp_lg_u32 s37, 31
    s_cbranch_scc1 Lsk_13
    buffer_store_dword v7, off, s[8:11], s3 sc1
Lsk_13:
    s_mov_b32 s48, 575488
    s_cmp_ge_u32 s32, 128
    s_cbranch_scc1 L_pre_end
    s_lshl_b32 s49, s5, 7
    s_add_u32 s49, s49, 12288
Lw_14:
    buffer_load_dword v6, v5, s[8:11], s49 offen offset:0 sc1
    s_waitcnt vmcnt(0)
    v_cmp_eq_u32 vcc, 0, v6
    s_cbranch_vccz Lwd_15
    s_sleep 8
    s_sub_u32 s98, s98, 1
    s_cbranch_scc1 L_end
    s_branch Lw_14
Lwd_15:
    s_branch L_pre_c
L_pre_early:
    s_mov_b32 s24, s64
    s_and_b32 s25, s65, 0xffff
    s_mov_b32 s26, 0x200000
    s_mov_b32 s27, 0x20000
    v_and_b32 v1, 63, v0
    v_lshlrev_b32 v2, 4, v1
    v_and_b32 v3, 15, v0
    v_bfe_u32 v4, v0, 4, 2
    v_mov_b32 v5, 0
    s_mov_b32 s48, 576512
Lc_16:
    buffer_load_dword v6, v5, s[28:31], 0 offen offset:0 sc1
    s_waitcnt vmcnt(0)
    v_cmp_gt_u32 vcc, 32, v6
    s_cbranch_vccz Lcd_17
    s_sleep 2
    s_sub_u32 s98, s98, 1
    s_cbranch_scc1 L_end
    s_branch Lc_16
Lcd_17:
L_pre_x:
    s_lshl_b32 s46, s32, 4
    s_lshl_b32 s3, s6, 2
    s_add_u32 s46, s46, s3
    s_lshl_b32 s47, s46, 10
    buffer_load_dwordx4 v[100:103], v2, s[24:27], s47 offen offset:0
    buffer_load_dwordx4 v[104:107], v2, s[24:27], s47 offen offset:1024
    buffer_load_dwordx4 v[108:111], v2, s[24:27], s47 offen offset:2048
    buffer_load_dwordx4 v[112:115], v2, s[24:27], s47 offen offset:3072
    s_waitcnt vmcnt(0)
L_pre_c:
    v_lshlrev_b32 v120, 16, v100
    v_and_b32 v121, 0xffff0000, v100
    v_lshlrev_b32 v122, 16, v101
    v_and_b32 v123, 0xffff0000, v101
    v_lshlrev_b32 v124, 16, v102
    v_and_b32 v125, 0xffff0000, v102
    v_lshlrev_b32 v126, 16, v103
    v_and_b32 v127, 0xffff0000, v103
    v_lshlrev_b32 v152, 16, v104
    v_and_b32 v153, 0xffff0000, v104
    v_lshlrev_b32 v154, 16, v105
    v_and_b32 v155, 0xffff0000, v105
    v_lshlrev_b32 v156, 16, v106
    v_and_b32 v157, 0xffff0000, v106
    v_lshlrev_b32 v158, 16, v107
    v_and_b32 v159, 0xffff0000, v107
    v_lshlrev_b32 v184, 16, v108
    v_and_b32 v185, 0xffff0000, v108
    v_lshlrev_b32 v186, 16, v109
    v_and_b32 v187, 0xffff0000, v109
    v_lshlrev_b32 v188, 16, v110
    v_and_b32 v189, 0xffff0000, v110
    v_lshlrev_b32 v190, 16, v111
    v_and_b32 v191, 0xffff0000, v111
    v_lshlrev_b32 v216, 16, v112
    v_and_b32 v217, 0xffff0000, v112
    v_lshlrev_b32 v218, 16, v113
    v_and_b32 v219, 0xffff0000, v113
    v_lshlrev_b32 v220, 16, v114
    v_and_b32 v221, 0xffff0000, v114
    v_lshlrev_b32 v222, 16, v115
    v_and_b32 v223, 0xffff0000, v115
    v_pk_add_f32 v[136:137], v[120:121], v[122:123]
    v_pk_add_f32 v[138:139], v[124:125], v[126:127]
    v_pk_add_f32 v[136:137], v[136:137], v[138:139]
    v_add_f32 v136, v136, v137
    v_pk_add_f32 v[168:169], v[152:153], v[154:155]
    v_pk_add_f32 v[170:171], v[156:157], v[158:159]
    v_pk_add_f32 v[168:169], v[168:169], v[170:171]
    v_add_f32 v168, v168, v169
    v_pk_add_f32 v[200:201], v[184:185], v[186:187]
    v_pk_add_f32 v[202:203], v[188:189], v[190:191]
    v_pk_add_f32 v[200:201], v[200:201], v[202:203]
    v_add_f32 v200, v200, v201
    v_pk_add_f32 v[232:233], v[216:217], v[218:219]
    v_pk_add_f32 v[234:235], v[220:221], v[222:223]
    v_pk_add_f32 v[232:233], v[232:233], v[234:235]
    v_add_f32 v232, v232, v233
    v_add_f32_dpp v136, v136, v136 quad_perm:[1,0,3,2] row_mask:0xf bank_mask:0xf
    v_add_f32_dpp v168, v168, v168 quad_perm:[1,0,3,2] row_mask:0xf bank_mask:0xf
    v_add_f32_dpp v200, v200, v200 quad_perm:[1,0,3,2] row_mask:0xf bank_mask:0xf
    v_add_f32_dpp v232, v232, v232 quad_perm:[1,0,3,2] row_mask:0xf bank_mask:0xf
    v_add_f32_dpp v136, v136, v136 quad_perm:[2,3,0,1] row_mask:0xf bank_mask:0xf
    v_add_f32_dpp v168, v168, v168 quad_perm:[2,3,0,1] row_mask:0xf bank_mask:0xf
    v_add_f32_dpp v200, v200, v200 quad_perm:[2,3,0,1] row_mask:0xf bank_mask:0xf
    v_add_f32_dpp v232, v232, v232 quad_perm:[2,3,0,1] row_mask:0xf bank_mask:0xf
    v_add_f32_dpp v136, v136, v136 row_half_mirror row_mask:0xf bank_mask:0xf
    v_add_f32_dpp v168, v168, v168 row_half_mirror row_mask:0xf bank_mask:0xf
    v_add_f32_dpp v200, v200, v200 row_half_mirror row_mask:0xf bank_mask:0xf
    v_add_f32_dpp v232, v232, v232 row_half_mirror row_mask:0xf bank_mask:0xf
    v_add_f32_dpp v136, v136, v136 row_mirror row_mask:0xf bank_mask:0xf
    v_add_f32_dpp v168, v168, v168 row_mirror row_mask:0xf bank_mask:0xf
    v_add_f32_dpp v200, v200, v200 row_mirror row_mask:0xf bank_mask:0xf
    v_add_f32_dpp v232, v232, v232 row_mirror row_mask:0xf bank_mask:0xf
    v_mov_b32 v137, v136
    v_mov_b32 v169, v168
    v_mov_b32 v201, v200
    v_mov_b32 v233, v232
    v_permlane16_swap_b32 v137, v136
    v_permlane16_swap_b32 v169, v168
    v_permlane16_swap_b32 v201, v200
    v_permlane16_swap_b32 v233, v232
    v_add_f32 v136, v136, v137
    v_add_f32 v168, v168, v169
    v_add_f32 v200, v200, v201
    v_add_f32 v232, v232, v233
    v_mov_b32 v137, v136
    v_mov_b32 v169, v168
    v_mov_b32 v201, v200
    v_mov_b32 v233, v232
    v_permlane32_swap_b32 v137, v136
    v_permlane32_swap_b32 v169, v168
    v_permlane32_swap_b32 v201, v200
    v_permlane32_swap_b32 v233, v232
    v_add_f32 v136, v136, v137
    v_add_f32 v168, v168, v169
    v_add_f32 v200, v200, v201
    v_add_f32 v232, v232, v233
    v_mul_f32 v136, 0x3b000000, v136
    v_pk_add_f32 v[128:129], v[120:121], v[136:137] op_sel_hi:[1,0] neg_lo:[0,1] neg_hi:[0,1]
    v_pk_add_f32 v[130:131], v[122:123], v[136:137] op_sel_hi:[1,0] neg_lo:[0,1] neg_hi:[0,1]
    v_pk_add_f32 v[132:133], v[124:125], v[136:137] op_sel_hi:[1,0] neg_lo:[0,1] neg_hi:[0,1]
    v_pk_add_f32 v[134:135], v[126:127], v[136:137] op_sel_hi:[1,0] neg_lo:[0,1] neg_hi:[0,1]
    v_pk_mul_f32 v[138:139], v[128:129], v[128:129]
    v_pk_fma_f32 v[138:139], v[130:131], v[130:131], v[138:139]
    v_pk_fma_f32 v[138:139], v[132:133], v[132:133], v[138:139]
    v_pk_fma_f32 v[138:139], v[134:135], v[134:135], v[138:139]
    v_add_f32 v138, v138, v139
    v_mul_f32 v168, 0x3b000000, v168
    v_pk_add_f32 v[160:161], v[152:153], v[168:169] op_sel_hi:[1,0] neg_lo:[0,1] neg_hi:[0,1]
    v_pk_add_f32 v[162:163], v[154:155], v[168:169] op_sel_hi:[1,0] neg_lo:[0,1] neg_hi:[0,1]
    v_pk_add_f32 v[164:165], v[156:157], v[168:169] op_sel_hi:[1,0] neg_lo:[0,1] neg_hi:[0,1]
    v_pk_add_f32 v[166:167], v[158:159], v[168:169] op_sel_hi:[1,0] neg_lo:[0,1] neg_hi:[0,1]
    v_pk_mul_f32 v[170:171], v[160:161], v[160:161]
    v_pk_fma_f32 v[170:171], v[162:163], v[162:163], v[170:171]
    v_pk_fma_f32 v[170:171], v[164:165], v[164:165], v[170:171]
    v_pk_fma_f32 v[170:171], v[166:167], v[166:167], v[170:171]
    v_add_f32 v170, v170, v171
    v_mul_f32 v200, 0x3b000000, v200
    v_pk_add_f32 v[192:193], v[184:185], v[200:201] op_sel_hi:[1,0] neg_lo:[0,1] neg_hi:[0,1]
    v_pk_add_f32 v[194:195], v[186:187], v[200:201] op_sel_hi:[1,0] neg_lo:[0,1] neg_hi:[0,1]
    v_pk_add_f32 v[196:197], v[188:189], v[200:201] op_sel_hi:[1,0] neg_lo:[0,1] neg_hi:[0,1]
    v_pk_add_f32 v[198:199], v[190:191], v[200:201] op_sel_hi:[1,0] neg_lo:[0,1] neg_hi:[0,1]
    v_pk_mul_f32 v[202:203], v[192:193], v[192:193]
    v_pk_fma_f32 v[202:203], v[194:195], v[194:195], v[202:203]
    v_pk_fma_f32 v[202:203], v[196:197], v[196:197], v[202:203]
    v_pk_fma_f32 v[202:203], v[198:199], v[198:199], v[202:203]
    v_add_f32 v202, v202, v203
    v_mul_f32 v232, 0x3b000000, v232
    v_pk_add_f32 v[224:225], v[216:217], v[232:233] op_sel_hi:[1,0] neg_lo:[0,1] neg_hi:[0,1]
    v_pk_add_f32 v[226:227], v[218:219], v[232:233] op_sel_hi:[1,0] neg_lo:[0,1] neg_hi:[0,1]
    v_pk_add_f32 v[228:229], v[220:221], v[232:233] op_sel_hi:[1,0] neg_lo:[0,1] neg_hi:[0,1]
    v_pk_add_f32 v[230:231], v[222:223], v[232:233] op_sel_hi:[1,0] neg_lo:[0,1] neg_hi:[0,1]
    v_pk_mul_f32 v[234:235], v[224:225], v[224:225]
    v_pk_fma_f32 v[234:235], v[226:227], v[226:227], v[234:235]
    v_pk_fma_f32 v[234:235], v[228:229], v[228:229], v[234:235]
    v_pk_fma_f32 v[234:235], v[230:231], v[230:231], v[234:235]
    v_add_f32 v234, v234, v235
    v_cvt_pk_bf16_f32 v136, v136, v136
    v_and_b32 v136, 0xffff0000, v136
    v_pk_add_f32 v[128:129], v[120:121], v[136:137] op_sel_hi:[1,0] neg_lo:[0,1] neg_hi:[0,1]
    v_pk_add_f32 v[130:131], v[122:123], v[136:137] op_sel_hi:[1,0] neg_lo:[0,1] neg_hi:[0,1]
    v_pk_add_f32 v[132:133], v[124:125], v[136:137] op_sel_hi:[1,0] neg_lo:[0,1] neg_hi:[0,1]
    v_pk_add_f32 v[134:135], v[126:127], v[136:137] op_sel_hi:[1,0] neg_lo:[0,1] neg_hi:[0,1]
    v_cvt_pk_bf16_f32 v129, v128, v129
    v_lshlrev_b32 v128, 16, v129
    v_and_b32 v129, 0xffff0000, v129
    v_cvt_pk_bf16_f32 v131, v130, v131
    v_lshlrev_b32 v130, 16, v131
    v_and_b32 v131, 0xffff0000, v131
    v_add_f32_dpp v138, v138, v138 quad_perm:[1,0,3,2] row_mask:0xf bank_mask:0xf
    v_add_f32_dpp v170, v170, v170 quad_perm:[1,0,3,2] row_mask:0xf bank_mask:0xf
    v_add_f32_dpp v202, v202, v202 quad_perm:[1,0,3,2] row_mask:0xf bank_mask:0xf
    v_add_f32_dpp v234, v234, v234 quad_perm:[1,0,3,2] row_mask:0xf bank_mask:0xf
    v_cvt_pk_bf16_f32 v133, v132, v133
    v_lshlrev_b32 v132, 16, v133
    v_and_b32 v133, 0xffff0000, v133
    v_cvt_pk_bf16_f32 v135, v134, v135
    v_lshlrev_b32 v134, 16, v135
    v_and_b32 v135, 0xffff0000, v135
    v_cvt_pk_bf16_f32 v168, v168, v168
    v_and_b32 v168, 0xffff0000, v168
    v_pk_add_f32 v[160:161], v[152:153], v[168:169] op_sel_hi:[1,0] neg_lo:[0,1] neg_hi:[0,1]
    v_pk_add_f32 v[162:163], v[154:155], v[168:169] op_sel_hi:[1,0] neg_lo:[0,1] neg_hi:[0,1]
    v_pk_add_f32 v[164:165], v[156:157], v[168:169] op_sel_hi:[1,0] neg_lo:[0,1] neg_hi:[0,1]
    v_pk_add_f32 v[166:167], v[158:159], v[168:169] op_sel_hi:[1,0] neg_lo:[0,1] neg_hi:[0,1]
    v_add_f32_dpp v138, v138, v138 quad_perm:[2,3,0,1] row_mask:0xf bank_mask:0xf
    v_add_f32_dpp v170, v170, v170 quad_perm:[2,3,0,1] row_mask:0xf bank_mask:0xf
    v_add_f32_dpp v202, v202, v202 quad_perm:[2,3,0,1] row_mask:0xf bank_mask:0xf
    v_add_f32_dpp v234, v234, v234 quad_perm:[2,3,0,1] row_mask:0xf bank_mask:0xf
    v_cvt_pk_bf16_f32 v161, v160, v161
    v_lshlrev_b32 v160, 16, v161
    v_and_b32 v161, 0xffff0000, v161
    v_cvt_pk_bf16_f32 v163, v162, v163
    v_lshlrev_b32 v162, 16, v163
    v_and_b32 v163, 0xffff0000, v163
    v_cvt_pk_bf16_f32 v165, v164, v165
    v_lshlrev_b32 v164, 16, v165
    v_and_b32 v165, 0xffff0000, v165
    v_cvt_pk_bf16_f32 v167, v166, v167
    v_lshlrev_b32 v166, 16, v167
    v_and_b32 v167, 0xffff0000, v167
    v_add_f32_dpp v138, v138, v138 row_half_mirror row_mask:0xf bank_mask:0xf
    v_add_f32_dpp v170, v170, v170 row_half_mirror row_mask:0xf bank_mask:0xf
    v_add_f32_dpp v202, v202, v202 row_half_mirror row_mask:0xf bank_mask:0xf
    v_add_f32_dpp v234, v234, v234 row_half_mirror row_mask:0xf bank_mask:0xf
    v_cvt_pk_bf16_f32 v200, v200, v200
    v_and_b32 v200, 0xffff0000, v200
    v_pk_add_f32 v[192:193], v[184:185], v[200:201] op_sel_hi:[1,0] neg_lo:[0,1] neg_hi:[0,1]
    v_pk_add_f32 v[194:195], v[186:187], v[200:201] op_sel_hi:[1,0] neg_lo:[0,1] neg_hi:[0,1]
    v_pk_add_f32 v[196:197], v[188:189], v[200:201] op_sel_hi:[1,0] neg_lo:[0,1] neg_hi:[0,1]
    v_pk_add_f32 v[198:199], v[190:191], v[200:201] op_sel_hi:[1,0] neg_lo:[0,1] neg_hi:[0,1]
    v_cvt_pk_bf16_f32 v193, v192, v193
    v_lshlrev_b32 v192, 16, v193
    v_and_b32 v193, 0xffff0000, v193
    v_cvt_pk_bf16_f32 v195, v194, v195
    v_lshlrev_b32 v194, 16, v195
    v_and_b32 v195, 0xffff0000, v195
    v_add_f32_dpp v138, v138, v138 row_mirror row_mask:0xf bank_mask:0xf
    v_add_f32_dpp v170, v170, v170 row_mirror row_mask:0xf bank_mask:0xf
    v_add_f32_dpp v202, v202, v202 row_mirror row_mask:0xf bank_mask:0xf
    v_add_f32_dpp v234, v234, v234 row_mirror row_mask:0xf bank_mask:0xf
    v_mov_b32 v139, v138
    v_mov_b32 v171, v170
    v_mov_b32 v203, v202
    v_mov_b32 v235, v234
    v_cvt_pk_bf16_f32 v197, v196, v197
    v_lshlrev_b32 v196, 16, v197
    v_and_b32 v197, 0xffff0000, v197
    v_cvt_pk_bf16_f32 v199, v198, v199
    v_lshlrev_b32 v198, 16, v199
    v_and_b32 v199, 0xffff0000, v199
    v_cvt_pk_bf16_f32 v232, v232, v232
    v_and_b32 v232, 0xffff0000, v232
    v_pk_add_f32 v[224:225], v[216:217], v[232:233] op_sel_hi:[1,0] neg_lo:[0,1] neg_hi:[0,1]
    v_pk_add_f32 v[226:227], v[218:219], v[232:233] op_sel_hi:[1,0] neg_lo:[0,1] neg_hi:[0,1]
    v_pk_add_f32 v[228:229], v[220:221], v[232:233] op_sel_hi:[1,0] neg_lo:[0,1] neg_hi:[0,1]
    v_pk_add_f32 v[230:231], v[222:223], v[232:233] op_sel_hi:[1,0] neg_lo:[0,1] neg_hi:[0,1]
    v_permlane16_swap_b32 v139, v138
    v_permlane16_swap_b32 v171, v170
    v_permlane16_swap_b32 v203, v202
    v_permlane16_swap_b32 v235, v234
    v_add_f32 v138, v138, v139
    v_add_f32 v170, v170, v171
    v_add_f32 v202, v202, v203
    v_add_f32 v234, v234, v235
    v_mov_b32 v139, v138
    v_mov_b32 v171, v170
    v_mov_b32 v203, v202
    v_mov_b32 v235, v234
    v_cvt_pk_bf16_f32 v225, v224, v225
    v_lshlrev_b32 v224, 16, v225
    v_and_b32 v225, 0xffff0000, v225
    v_cvt_pk_bf16_f32 v227, v226, v227
    v_lshlrev_b32 v226, 16, v227
    v_and_b32 v227, 0xffff0000, v227
    v_cvt_pk_bf16_f32 v229, v228, v229
    v_lshlrev_b32 v228, 16, v229
    v_and_b32 v229, 0xffff0000, v229
    v_cvt_pk_bf16_f32 v231, v230, v231
    v_lshlrev_b32 v230, 16, v231
    v_and_b32 v231, 0xffff0000, v231
    v_permlane32_swap_b32 v139, v138
    v_permlane32_swap_b32 v171, v170
    v_permlane32_swap_b32 v203, v202
    v_permlane32_swap_b32 v235, v234
    v_add_f32 v138, v138, v139
    v_add_f32 v170, v170, v171
    v_add_f32 v202, v202, v203
    v_add_f32 v234, v234, v235
    v_mul_f32 v138, 0x3b000000, v138
    v_cvt_pk_bf16_f32 v138, v138, v138
    v_and_b32 v138, 0xffff0000, v138
    v_add_f32 v138, 0x3727c5ac, v138
    v_cvt_pk_bf16_f32 v138, v138, v138
    v_and_b32 v138, 0xffff0000, v138
    v_sqrt_f32 v138, v138
    s_nop 0
    v_cvt_pk_bf16_f32 v138, v138, v138
    v_and_b32 v138, 0xffff0000, v138
    v_rcp_f32 v138, v138
    s_nop 0
    v_pk_mul_f32 v[128:129], v[128:129], v[138:139] op_sel_hi:[1,0]
    v_pk_mul_f32 v[130:131], v[130:131], v[138:139] op_sel_hi:[1,0]
    v_pk_mul_f32 v[132:133], v[132:133], v[138:139] op_sel_hi:[1,0]
    v_pk_mul_f32 v[134:135], v[134:135], v[138:139] op_sel_hi:[1,0]
    v_mul_f32 v170, 0x3b000000, v170
    v_cvt_pk_bf16_f32 v170, v170, v170
    v_and_b32 v170, 0xffff0000, v170
    v_add_f32 v170, 0x3727c5ac, v170
    v_cvt_pk_bf16_f32 v170, v170, v170
    v_and_b32 v170, 0xffff0000, v170
    v_sqrt_f32 v170, v170
    s_nop 0
    v_cvt_pk_bf16_f32 v170, v170, v170
    v_and_b32 v170, 0xffff0000, v170
    v_rcp_f32 v170, v170
    s_nop 0
    v_pk_mul_f32 v[160:161], v[160:161], v[170:171] op_sel_hi:[1,0]
    v_pk_mul_f32 v[162:163], v[162:163], v[170:171] op_sel_hi:[1,0]
    v_pk_mul_f32 v[164:165], v[164:165], v[170:171] op_sel_hi:[1,0]
    v_pk_mul_f32 v[166:167], v[166:167], v[170:171] op_sel_hi:[1,0]
    v_mul_f32 v202, 0x3b000000, v202
    v_cvt_pk_bf16_f32 v202, v202, v202
    v_and_b32 v202, 0xffff0000, v202
    v_add_f32 v202, 0x3727c5ac, v202
    v_cvt_pk_bf16_f32 v202, v202, v202
    v_and_b32 v202, 0xffff0000, v202
    v_sqrt_f32 v202, v202
    s_nop 0
    v_cvt_pk_bf16_f32 v202, v202, v202
    v_and_b32 v202, 0xffff0000, v202
    v_rcp_f32 v202, v202
    s_nop 0
    v_pk_mul_f32 v[192:193], v[192:193], v[202:203] op_sel_hi:[1,0]
    v_pk_mul_f32 v[194:195], v[194:195], v[202:203] op_sel_hi:[1,0]
    v_pk_mul_f32 v[196:197], v[196:197], v[202:203] op_sel_hi:[1,0]
    v_pk_mul_f32 v[198:199], v[198:199], v[202:203] op_sel_hi:[1,0]
    v_mul_f32 v234, 0x3b000000, v234
    v_cvt_pk_bf16_f32 v234, v234, v234
    v_and_b32 v234, 0xffff0000, v234
    v_add_f32 v234, 0x3727c5ac, v234
    v_cvt_pk_bf16_f32 v234, v234, v234
    v_and_b32 v234, 0xffff0000, v234
    v_sqrt_f32 v234, v234
    s_nop 0
    v_cvt_pk_bf16_f32 v234, v234, v234
    v_and_b32 v234, 0xffff0000, v234
    v_rcp_f32 v234, v234
    s_nop 0
    v_pk_mul_f32 v[224:225], v[224:225], v[234:235] op_sel_hi:[1,0]
    v_pk_mul_f32 v[226:227], v[226:227], v[234:235] op_sel_hi:[1,0]
    v_pk_mul_f32 v[228:229], v[228:229], v[234:235] op_sel_hi:[1,0]
    v_pk_mul_f32 v[230:231], v[230:231], v[234:235] op_sel_hi:[1,0]
    s_lshl_b32 s3, s6, 7
    s_add_u32 s49, s3, s48
Lw_18:
    buffer_load_dword v6, v5, s[8:11], s49 offen offset:0 sc1
    s_waitcnt vmcnt(0)
    v_cmp_eq_u32 vcc, 0, v6
    s_cbranch_vccz Lwd_19
    s_sleep 1
    s_sub_u32 s98, s98, 1
    s_cbranch_scc1 L_end
    s_branch Lw_18
Lwd_19:
    s_mul_i32 s35, s32, 16640
    s_add_u32 s35, s35, 20971520
    s_lshl_b32 s3, s6, 12
    s_add_u32 s35, s35, s3
    s_add_u32 s37, s3, 0
    s_mov_b32 m0, s37
    s_nop 0
    buffer_load_dwordx4 v2, s[8:11], s35 offen offset:0 sc1 lds
    buffer_load_dwordx4 v2, s[8:11], s35 offen offset:1024 sc1 lds
    buffer_load_dwordx4 v2, s[8:11], s35 offen offset:2048 sc1 lds
    buffer_load_dwordx4 v2, s[8:11], s35 offen offset:3072 sc1 lds
    v_lshl_add_u32 v6, v1, 3, s37
    v_mul_u32_u24 v7, 1040, v3
    v_lshl_add_u32 v7, v4, 3, v7
    s_lshl_b32 s3, s6, 8
    v_add_u32 v7, s3, v7
    s_waitcnt vmcnt(0)
    ds_read_b64_tr_b16 v[10:11], v6 offset:0
    ds_read_b64_tr_b16 v[12:13], v6 offset:512
    ds_read_b64_tr_b16 v[14:15], v6 offset:1024
    ds_read_b64_tr_b16 v[16:17], v6 offset:1536
    ds_read_b64_tr_b16 v[18:19], v6 offset:2048
    ds_read_b64_tr_b16 v[20:21], v6 offset:2560
    ds_read_b64_tr_b16 v[22:23], v6 offset:3072
    ds_read_b64_tr_b16 v[24:25], v6 offset:3584
    s_waitcnt lgkmcnt(7)
    ds_write_b64 v7, v[10:11] offset:18432
    s_waitcnt lgkmcnt(7)
    ds_write_b64 v7, v[12:13] offset:18464
    s_waitcnt lgkmcnt(7)
    ds_write_b64 v7, v[14:15] offset:18496
    s_waitcnt lgkmcnt(7)
    ds_write_b64 v7, v[16:17] offset:18528
    s_waitcnt lgkmcnt(7)
    ds_write_b64 v7, v[18:19] offset:18560
    s_waitcnt lgkmcnt(7)
    ds_write_b64 v7, v[20:21] offset:18592
    s_waitcnt lgkmcnt(7)
    ds_write_b64 v7, v[22:23] offset:18624
    s_waitcnt lgkmcnt(7)
    ds_write_b64 v7, v[24:25] offset:18656
    s_waitcnt lgkmcnt(0)
    s_barrier
    s_mul_i32 s3, s6, 4160
    v_add_u32 v7, s3, v2
    ds_read_b128 v[140:143], v7 offset:18432
    ds_read_b128 v[172:175], v7 offset:19472
    ds_read_b128 v[204:207], v7 offset:20512
    ds_read_b128 v[236:239], v7 offset:21552
    s_waitcnt lgkmcnt(0)
    s_add_u32 s35, s47, 3145728
    buffer_store_dwordx4 v[140:143], v2, s[8:11], s35 offen offset:0 sc1
    v_lshlrev_b32 v40, 16, v140
    v_and_b32 v41, 0xffff0000, v140
    v_lshlrev_b32 v42, 16, v141
    v_and_b32 v43, 0xffff0000, v141
    v_lshlrev_b32 v44, 16, v142
    v_and_b32 v45, 0xffff0000, v142
    v_lshlrev_b32 v46, 16, v143
    v_and_b32 v47, 0xffff0000, v143
    buffer_store_dwordx4 v[172:175], v2, s[8:11], s35 offen offset:1024 sc1
    v_lshlrev_b32 v48, 16, v172
    v_and_b32 v49, 0xffff0000, v172
    v_lshlrev_b32 v50, 16, v173
    v_and_b32 v51, 0xffff0000, v173
    v_lshlrev_b32 v52, 16, v174
    v_and_b32 v53, 0xffff0000, v174
    v_lshlrev_b32 v54, 16, v175
    v_and_b32 v55, 0xffff0000, v175
    buffer_store_dwordx4 v[204:207], v2, s[8:11], s35 offen offset:2048 sc1
    v_lshlrev_b32 v56, 16, v204
    v_and_b32 v57, 0xffff0000, v204
    v_lshlrev_b32 v58, 16, v205
    v_and_b32 v59, 0xffff0000, v205
    v_lshlrev_b32 v60, 16, v206
    v_and_b32 v61, 0xffff0000, v206
    v_lshlrev_b32 v62, 16, v207
    v_and_b32 v63, 0xffff0000, v207
    buffer_store_dwordx4 v[236:239], v2, s[8:11], s35 offen offset:3072 sc1
    v_lshlrev_b32 v64, 16, v236
    v_and_b32 v65, 0xffff0000, v236
    v_lshlrev_b32 v66, 16, v237
    v_and_b32 v67, 0xffff0000, v237
    v_lshlrev_b32 v68, 16, v238
    v_and_b32 v69, 0xffff0000, v238
    v_lshlrev_b32 v70, 16, v239
    v_and_b32 v71, 0xffff0000, v239
    s_add_u32 s35, s47, 5242880
    s_add_u32 s36, s47, 9437184
    v_pk_fma_f32 v[120:121], v[128:129], v[40:41], v[120:121]
    v_pk_fma_f32 v[122:123], v[130:131], v[42:43], v[122:123]
    v_pk_fma_f32 v[124:125], v[132:133], v[44:45], v[124:125]
    v_pk_fma_f32 v[126:127], v[134:135], v[46:47], v[126:127]
    v_cvt_pk_bf16_f32 v144, v120, v121
    v_cvt_pk_bf16_f32 v145, v122, v123
    v_cvt_pk_bf16_f32 v146, v124, v125
    v_cvt_pk_bf16_f32 v147, v126, v127
    v_lshlrev_b32 v120, 16, v144
    v_and_b32 v121, 0xffff0000, v144
    v_lshlrev_b32 v122, 16, v145
    v_and_b32 v123, 0xffff0000, v145
    v_lshlrev_b32 v124, 16, v146
    v_and_b32 v125, 0xffff0000, v146
    v_lshlrev_b32 v126, 16, v147
    v_and_b32 v127, 0xffff0000, v147
    v_pk_fma_f32 v[152:153], v[160:161], v[48:49], v[152:153]
    v_pk_fma_f32 v[154:155], v[162:163], v[50:51], v[154:155]
    v_pk_fma_f32 v[156:157], v[164:165], v[52:53], v[156:157]
    v_pk_fma_f32 v[158:159], v[166:167], v[54:55], v[158:159]
    v_cvt_pk_bf16_f32 v176, v152, v153
    v_cvt_pk_bf16_f32 v177, v154, v155
    v_cvt_pk_bf16_f32 v178, v156, v157
    v_cvt_pk_bf16_f32 v179, v158, v159
    v_lshlrev_b32 v152, 16, v176
    v_and_b32 v153, 0xffff0000, v176
    v_lshlrev_b32 v154, 16, v177
    v_and_b32 v155, 0xffff0000, v177
    v_lshlrev_b32 v156, 16, v178
    v_and_b32 v157, 0xffff0000, v178
    v_lshlrev_b32 v158, 16, v179
    v_and_b32 v159, 0xffff0000, v179
    v_pk_fma_f32 v[184:185], v[192:193], v[56:57], v[184:185]
    v_pk_fma_f32 v[186:187], v[194:195], v[58:59], v[186:187]
    v_pk_fma_f32 v[188:189], v[196:197], v[60:61], v[188:189]
    v_pk_fma_f32 v[190:191], v[198:199], v[62:63], v[190:191]
    v_cvt_pk_bf16_f32 v208, v184, v185
    v_cvt_pk_bf16_f32 v209, v186, v187
    v_cvt_pk_bf16_f32 v210, v188, v189
    v_cvt_pk_bf16_f32 v211, v190, v191
    v_lshlrev_b32 v184, 16, v208
    v_and_b32 v185, 0xffff0000, v208
    v_lshlrev_b32 v186, 16, v209
    v_and_b32 v187, 0xffff0000, v209
    v_lshlrev_b32 v188, 16, v210
    v_and_b32 v189, 0xffff0000, v210
    v_lshlrev_b32 v190, 16, v211
    v_and_b32 v191, 0xffff0000, v211
    v_pk_fma_f32 v[216:217], v[224:225], v[64:65], v[216:217]
    v_pk_fma_f32 v[218:219], v[226:227], v[66:67], v[218:219]
    v_pk_fma_f32 v[220:221], v[228:229], v[68:69], v[220:221]
    v_pk_fma_f32 v[222:223], v[230:231], v[70:71], v[222:223]
    v_cvt_pk_bf16_f32 v240, v216, v217
    v_cvt_pk_bf16_f32 v241, v218, v219
    v_cvt_pk_bf16_f32 v242, v220, v221
    v_cvt_pk_bf16_f32 v243, v222, v223
    v_lshlrev_b32 v216, 16, v240
    v_and_b32 v217, 0xffff0000, v240
    v_lshlrev_b32 v218, 16, v241
    v_and_b32 v219, 0xffff0000, v241
    v_lshlrev_b32 v220, 16, v242
    v_and_b32 v221, 0xffff0000, v242
    v_lshlrev_b32 v222, 16, v243
    v_and_b32 v223, 0xffff0000, v243
    buffer_store_dwordx4 v[144:147], v2, s[8:11], s35 offen offset:0 sc1
    buffer_store_dwordx4 v[176:179], v2, s[8:11], s35 offen offset:1024 sc1
    buffer_store_dwordx4 v[208:211], v2, s[8:11], s35 offen offset:2048 sc1
    buffer_store_dwordx4 v[240:243], v2, s[8:11], s35 offen offset:3072 sc1
    v_pk_add_f32 v[136:137], v[120:121], v[122:123]
    v_pk_add_f32 v[138:139], v[124:125], v[126:127]
    v_pk_add_f32 v[136:137], v[136:137], v[138:139]
    v_add_f32 v136, v136, v137
    v_pk_add_f32 v[168:169], v[152:153], v[154:155]
    v_pk_add_f32 v[170:171], v[156:157], v[158:159]
    v_pk_add_f32 v[168:169], v[168:169], v[170:171]
    v_add_f32 v168, v168, v169
    v_pk_add_f32 v[200:201], v[184:185], v[186:187]
    v_pk_add_f32 v[202:203], v[188:189], v[190:191]
    v_pk_add_f32 v[200:201], v[200:201], v[202:203]
    v_add_f32 v200, v200, v201
    v_pk_add_f32 v[232:233], v[216:217], v[218:219]
    v_pk_add_f32 v[234:235], v[220:221], v[222:223]
    v_pk_add_f32 v[232:233], v[232:233], v[234:235]
    v_add_f32 v232, v232, v233
    v_add_f32_dpp v136, v136, v136 quad_perm:[1,0,3,2] row_mask:0xf bank_mask:0xf
    v_add_f32_dpp v168, v168, v168 quad_perm:[1,0,3,2] row_mask:0xf bank_mask:0xf
    v_add_f32_dpp v200, v200, v200 quad_perm:[1,0,3,2] row_mask:0xf bank_mask:0xf
    v_add_f32_dpp v232, v232, v232 quad_perm:[1,0,3,2] row_mask:0xf bank_mask:0xf
    v_add_f32_dpp v136, v136, v136 quad_perm:[2,3,0,1] row_mask:0xf bank_mask:0xf
    v_add_f32_dpp v168, v168, v168 quad_perm:[2,3,0,1] row_mask:0xf bank_mask:0xf
    v_add_f32_dpp v200, v200, v200 quad_perm:[2,3,0,1] row_mask:0xf bank_mask:0xf
    v_add_f32_dpp v232, v232, v232 quad_perm:[2,3,0,1] row_mask:0xf bank_mask:0xf
    v_add_f32_dpp v136, v136, v136 row_half_mirror row_mask:0xf bank_mask:0xf
    v_add_f32_dpp v168, v168, v168 row_half_mirror row_mask:0xf bank_mask:0xf
    v_add_f32_dpp v200, v200, v200 row_half_mirror row_mask:0xf bank_mask:0xf
    v_add_f32_dpp v232, v232, v232 row_half_mirror row_mask:0xf bank_mask:0xf
    v_add_f32_dpp v136, v136, v136 row_mirror row_mask:0xf bank_mask:0xf
    v_add_f32_dpp v168, v168, v168 row_mirror row_mask:0xf bank_mask:0xf
    v_add_f32_dpp v200, v200, v200 row_mirror row_mask:0xf bank_mask:0xf
    v_add_f32_dpp v232, v232, v232 row_mirror row_mask:0xf bank_mask:0xf
    v_mov_b32 v137, v136
    v_mov_b32 v169, v168
    v_mov_b32 v201, v200
    v_mov_b32 v233, v232
    v_permlane16_swap_b32 v137, v136
    v_permlane16_swap_b32 v169, v168
    v_permlane16_swap_b32 v201, v200
    v_permlane16_swap_b32 v233, v232
    v_add_f32 v136, v136, v137
    v_add_f32 v168, v168, v169
    v_add_f32 v200, v200, v201
    v_add_f32 v232, v232, v233
    v_mov_b32 v137, v136
    v_mov_b32 v169, v168
    v_mov_b32 v201, v200
    v_mov_b32 v233, v232
    v_permlane32_swap_b32 v137, v136
    v_permlane32_swap_b32 v169, v168
    v_permlane32_swap_b32 v201, v200
    v_permlane32_swap_b32 v233, v232
    v_add_f32 v136, v136, v137
    v_add_f32 v168, v168, v169
    v_add_f32 v200, v200, v201
    v_add_f32 v232, v232, v233
    v_mul_f32 v136, 0x3b000000, v136
    v_pk_add_f32 v[128:129], v[120:121], v[136:137] op_sel_hi:[1,0] neg_lo:[0,1] neg_hi:[0,1]
    v_pk_add_f32 v[130:131], v[122:123], v[136:137] op_sel_hi:[1,0] neg_lo:[0,1] neg_hi:[0,1]
    v_pk_add_f32 v[132:133], v[124:125], v[136:137] op_sel_hi:[1,0] neg_lo:[0,1] neg_hi:[0,1]
    v_pk_add_f32 v[134:135], v[126:127], v[136:137] op_sel_hi:[1,0] neg_lo:[0,1] neg_hi:[0,1]
    v_pk_mul_f32 v[138:139], v[128:129], v[128:129]
    v_pk_fma_f32 v[138:139], v[130:131], v[130:131], v[138:139]
    v_pk_fma_f32 v[138:139], v[132:133], v[132:133], v[138:139]
    v_pk_fma_f32 v[138:139], v[134:135], v[134:135], v[138:139]
    v_add_f32 v138, v138, v139
    v_mul_f32 v168, 0x3b000000, v168
    v_pk_add_f32 v[160:161], v[152:153], v[168:169] op_sel_hi:[1,0] neg_lo:[0,1] neg_hi:[0,1]
    v_pk_add_f32 v[162:163], v[154:155], v[168:169] op_sel_hi:[1,0] neg_lo:[0,1] neg_hi:[0,1]
    v_pk_add_f32 v[164:165], v[156:157], v[168:169] op_sel_hi:[1,0] neg_lo:[0,1] neg_hi:[0,1]
    v_pk_add_f32 v[166:167], v[158:159], v[168:169] op_sel_hi:[1,0] neg_lo:[0,1] neg_hi:[0,1]
    v_pk_mul_f32 v[170:171], v[160:161], v[160:161]
    v_pk_fma_f32 v[170:171], v[162:163], v[162:163], v[170:171]
    v_pk_fma_f32 v[170:171], v[164:165], v[164:165], v[170:171]
    v_pk_fma_f32 v[170:171], v[166:167], v[166:167], v[170:171]
    v_add_f32 v170, v170, v171
    v_mul_f32 v200, 0x3b000000, v200
    v_pk_add_f32 v[192:193], v[184:185], v[200:201] op_sel_hi:[1,0] neg_lo:[0,1] neg_hi:[0,1]
    v_pk_add_f32 v[194:195], v[186:187], v[200:201] op_sel_hi:[1,0] neg_lo:[0,1] neg_hi:[0,1]
    v_pk_add_f32 v[196:197], v[188:189], v[200:201] op_sel_hi:[1,0] neg_lo:[0,1] neg_hi:[0,1]
    v_pk_add_f32 v[198:199], v[190:191], v[200:201] op_sel_hi:[1,0] neg_lo:[0,1] neg_hi:[0,1]
    v_pk_mul_f32 v[202:203], v[192:193], v[192:193]
    v_pk_fma_f32 v[202:203], v[194:195], v[194:195], v[202:203]
    v_pk_fma_f32 v[202:203], v[196:197], v[196:197], v[202:203]
    v_pk_fma_f32 v[202:203], v[198:199], v[198:199], v[202:203]
    v_add_f32 v202, v202, v203
    v_mul_f32 v232, 0x3b000000, v232
    v_pk_add_f32 v[224:225], v[216:217], v[232:233] op_sel_hi:[1,0] neg_lo:[0,1] neg_hi:[0,1]
    v_pk_add_f32 v[226:227], v[218:219], v[232:233] op_sel_hi:[1,0] neg_lo:[0,1] neg_hi:[0,1]
    v_pk_add_f32 v[228:229], v[220:221], v[232:233] op_sel_hi:[1,0] neg_lo:[0,1] neg_hi:[0,1]
    v_pk_add_f32 v[230:231], v[222:223], v[232:233] op_sel_hi:[1,0] neg_lo:[0,1] neg_hi:[0,1]
    v_pk_mul_f32 v[234:235], v[224:225], v[224:225]
    v_pk_fma_f32 v[234:235], v[226:227], v[226:227], v[234:235]
    v_pk_fma_f32 v[234:235], v[228:229], v[228:229], v[234:235]
    v_pk_fma_f32 v[234:235], v[230:231], v[230:231], v[234:235]
    v_add_f32 v234, v234, v235
    v_cvt_pk_bf16_f32 v136, v136, v136
    v_and_b32 v136, 0xffff0000, v136
    v_pk_add_f32 v[128:129], v[120:121], v[136:137] op_sel_hi:[1,0] neg_lo:[0,1] neg_hi:[0,1]
    v_pk_add_f32 v[130:131], v[122:123], v[136:137] op_sel_hi:[1,0] neg_lo:[0,1] neg_hi:[0,1]
    v_pk_add_f32 v[132:133], v[124:125], v[136:137] op_sel_hi:[1,0] neg_lo:[0,1] neg_hi:[0,1]
    v_pk_add_f32 v[134:135], v[126:127], v[136:137] op_sel_hi:[1,0] neg_lo:[0,1] neg_hi:[0,1]
    v_cvt_pk_bf16_f32 v129, v128, v129
    v_lshlrev_b32 v128, 16, v129
    v_and_b32 v129, 0xffff0000, v129
    v_cvt_pk_bf16_f32 v131, v130, v131
    v_lshlrev_b32 v130, 16, v131
    v_and_b32 v131, 0xffff0000, v131
    v_add_f32_dpp v138, v138, v138 quad_perm:[1,0,3,2] row_mask:0xf bank_mask:0xf
    v_add_f32_dpp v170, v170, v170 quad_perm:[1,0,3,2] row_mask:0xf bank_mask:0xf
    v_add_f32_dpp v202, v202, v202 quad_perm:[1,0,3,2] row_mask:0xf bank_mask:0xf
    v_add_f32_dpp v234, v234, v234 quad_perm:[1,0,3,2] row_mask:0xf bank_mask:0xf
    v_cvt_pk_bf16_f32 v133, v132, v133
    v_lshlrev_b32 v132, 16, v133
    v_and_b32 v133, 0xffff0000, v133
    v_cvt_pk_bf16_f32 v135, v134, v135
    v_lshlrev_b32 v134, 16, v135
    v_and_b32 v135, 0xffff0000, v135
    v_cvt_pk_bf16_f32 v168, v168, v168
    v_and_b32 v168, 0xffff0000, v168
    v_pk_add_f32 v[160:161], v[152:153], v[168:169] op_sel_hi:[1,0] neg_lo:[0,1] neg_hi:[0,1]
    v_pk_add_f32 v[162:163], v[154:155], v[168:169] op_sel_hi:[1,0] neg_lo:[0,1] neg_hi:[0,1]
    v_pk_add_f32 v[164:165], v[156:157], v[168:169] op_sel_hi:[1,0] neg_lo:[0,1] neg_hi:[0,1]
    v_pk_add_f32 v[166:167], v[158:159], v[168:169] op_sel_hi:[1,0] neg_lo:[0,1] neg_hi:[0,1]
    v_add_f32_dpp v138, v138, v138 quad_perm:[2,3,0,1] row_mask:0xf bank_mask:0xf
    v_add_f32_dpp v170, v170, v170 quad_perm:[2,3,0,1] row_mask:0xf bank_mask:0xf
    v_add_f32_dpp v202, v202, v202 quad_perm:[2,3,0,1] row_mask:0xf bank_mask:0xf
    v_add_f32_dpp v234, v234, v234 quad_perm:[2,3,0,1] row_mask:0xf bank_mask:0xf
    v_cvt_pk_bf16_f32 v161, v160, v161
    v_lshlrev_b32 v160, 16, v161
    v_and_b32 v161, 0xffff0000, v161
    v_cvt_pk_bf16_f32 v163, v162, v163
    v_lshlrev_b32 v162, 16, v163
    v_and_b32 v163, 0xffff0000, v163
    v_cvt_pk_bf16_f32 v165, v164, v165
    v_lshlrev_b32 v164, 16, v165
    v_and_b32 v165, 0xffff0000, v165
    v_cvt_pk_bf16_f32 v167, v166, v167
    v_lshlrev_b32 v166, 16, v167
    v_and_b32 v167, 0xffff0000, v167
    v_add_f32_dpp v138, v138, v138 row_half_mirror row_mask:0xf bank_mask:0xf
    v_add_f32_dpp v170, v170, v170 row_half_mirror row_mask:0xf bank_mask:0xf
    v_add_f32_dpp v202, v202, v202 row_half_mirror row_mask:0xf bank_mask:0xf
    v_add_f32_dpp v234, v234, v234 row_half_mirror row_mask:0xf bank_mask:0xf
    v_cvt_pk_bf16_f32 v200, v200, v200
    v_and_b32 v200, 0xffff0000, v200
    v_pk_add_f32 v[192:193], v[184:185], v[200:201] op_sel_hi:[1,0] neg_lo:[0,1] neg_hi:[0,1]
    v_pk_add_f32 v[194:195], v[186:187], v[200:201] op_sel_hi:[1,0] neg_lo:[0,1] neg_hi:[0,1]
    v_pk_add_f32 v[196:197], v[188:189], v[200:201] op_sel_hi:[1,0] neg_lo:[0,1] neg_hi:[0,1]
    v_pk_add_f32 v[198:199], v[190:191], v[200:201] op_sel_hi:[1,0] neg_lo:[0,1] neg_hi:[0,1]
    v_cvt_pk_bf16_f32 v193, v192, v193
    v_lshlrev_b32 v192, 16, v193
    v_and_b32 v193, 0xffff0000, v193
    v_cvt_pk_bf16_f32 v195, v194, v195
    v_lshlrev_b32 v194, 16, v195
    v_and_b32 v195, 0xffff0000, v195
    v_add_f32_dpp v138, v138, v138 row_mirror row_mask:0xf bank_mask:0xf
    v_add_f32_dpp v170, v170, v170 row_mirror row_mask:0xf bank_mask:0xf
    v_add_f32_dpp v202, v202, v202 row_mirror row_mask:0xf bank_mask:0xf
    v_add_f32_dpp v234, v234, v234 row_mirror row_mask:0xf bank_mask:0xf
    v_mov_b32 v139, v138
    v_mov_b32 v171, v170
    v_mov_b32 v203, v202
    v_mov_b32 v235, v234
    v_cvt_pk_bf16_f32 v197, v196, v197
    v_lshlrev_b32 v196, 16, v197
    v_and_b32 v197, 0xffff0000, v197
    v_cvt_pk_bf16_f32 v199, v198, v199
    v_lshlrev_b32 v198, 16, v199
    v_and_b32 v199, 0xffff0000, v199
    v_cvt_pk_bf16_f32 v232, v232, v232
    v_and_b32 v232, 0xffff0000, v232
    v_pk_add_f32 v[224:225], v[216:217], v[232:233] op_sel_hi:[1,0] neg_lo:[0,1] neg_hi:[0,1]
    v_pk_add_f32 v[226:227], v[218:219], v[232:233] op_sel_hi:[1,0] neg_lo:[0,1] neg_hi:[0,1]
    v_pk_add_f32 v[228:229], v[220:221], v[232:233] op_sel_hi:[1,0] neg_lo:[0,1] neg_hi:[0,1]
    v_pk_add_f32 v[230:231], v[222:223], v[232:233] op_sel_hi:[1,0] neg_lo:[0,1] neg_hi:[0,1]
    v_permlane16_swap_b32 v139, v138
    v_permlane16_swap_b32 v171, v170
    v_permlane16_swap_b32 v203, v202
    v_permlane16_swap_b32 v235, v234
    v_add_f32 v138, v138, v139
    v_add_f32 v170, v170, v171
    v_add_f32 v202, v202, v203
    v_add_f32 v234, v234, v235
    v_mov_b32 v139, v138
    v_mov_b32 v171, v170
    v_mov_b32 v203, v202
    v_mov_b32 v235, v234
    v_cvt_pk_bf16_f32 v225, v224, v225
    v_lshlrev_b32 v224, 16, v225
    v_and_b32 v225, 0xffff0000, v225
    v_cvt_pk_bf16_f32 v227, v226, v227
    v_lshlrev_b32 v226, 16, v227
    v_and_b32 v227, 0xffff0000, v227
    v_cvt_pk_bf16_f32 v229, v228, v229
    v_lshlrev_b32 v228, 16, v229
    v_and_b32 v229, 0xffff0000, v229
    v_cvt_pk_bf16_f32 v231, v230, v231
    v_lshlrev_b32 v230, 16, v231
    v_and_b32 v231, 0xffff0000, v231
    v_permlane32_swap_b32 v139, v138
    v_permlane32_swap_b32 v171, v170
    v_permlane32_swap_b32 v203, v202
    v_permlane32_swap_b32 v235, v234
    v_add_f32 v138, v138, v139
    v_add_f32 v170, v170, v171
    v_add_f32 v202, v202, v203
    v_add_f32 v234, v234, v235
    v_mul_f32 v138, 0x3b000000, v138
    v_cvt_pk_bf16_f32 v138, v138, v138
    v_and_b32 v138, 0xffff0000, v138
    v_add_f32 v138, 0x3727c5ac, v138
    v_cvt_pk_bf16_f32 v138, v138, v138
    v_and_b32 v138, 0xffff0000, v138
    v_sqrt_f32 v138, v138
    s_nop 0
    v_cvt_pk_bf16_f32 v138, v138, v138
    v_and_b32 v138, 0xffff0000, v138
    v_rcp_f32 v138, v138
    s_nop 0
    v_pk_mul_f32 v[128:129], v[128:129], v[138:139] op_sel_hi:[1,0]
    v_pk_mul_f32 v[130:131], v[130:131], v[138:139] op_sel_hi:[1,0]
    v_pk_mul_f32 v[132:133], v[132:133], v[138:139] op_sel_hi:[1,0]
    v_pk_mul_f32 v[134:135], v[134:135], v[138:139] op_sel_hi:[1,0]
    v_cvt_pk_bf16_f32 v148, v128, v129
    v_cvt_pk_bf16_f32 v149, v130, v131
    v_cvt_pk_bf16_f32 v150, v132, v133
    v_cvt_pk_bf16_f32 v151, v134, v135
    v_mul_f32 v170, 0x3b000000, v170
    v_cvt_pk_bf16_f32 v170, v170, v170
    v_and_b32 v170, 0xffff0000, v170
    v_add_f32 v170, 0x3727c5ac, v170
    v_cvt_pk_bf16_f32 v170, v170, v170
    v_and_b32 v170, 0xffff0000, v170
    v_sqrt_f32 v170, v170
    s_nop 0
    v_cvt_pk_bf16_f32 v170, v170, v170
    v_and_b32 v170, 0xffff0000, v170
    v_rcp_f32 v170, v170
    s_nop 0
    v_pk_mul_f32 v[160:161], v[160:161], v[170:171] op_sel_hi:[1,0]
    v_pk_mul_f32 v[162:163], v[162:163], v[170:171] op_sel_hi:[1,0]
    v_pk_mul_f32 v[164:165], v[164:165], v[170:171] op_sel_hi:[1,0]
    v_pk_mul_f32 v[166:167], v[166:167], v[170:171] op_sel_hi:[1,0]
    v_cvt_pk_bf16_f32 v180, v160, v161
    v_cvt_pk_bf16_f32 v181, v162, v163
    v_cvt_pk_bf16_f32 v182, v164, v165
    v_cvt_pk_bf16_f32 v183, v166, v167
    v_mul_f32 v202, 0x3b000000, v202
    v_cvt_pk_bf16_f32 v202, v202, v202
    v_and_b32 v202, 0xffff0000, v202
    v_add_f32 v202, 0x3727c5ac, v202
    v_cvt_pk_bf16_f32 v202, v202, v202
    v_and_b32 v202, 0xffff0000, v202
    v_sqrt_f32 v202, v202
    s_nop 0
    v_cvt_pk_bf16_f32 v202, v202, v202
    v_and_b32 v202, 0xffff0000, v202
    v_rcp_f32 v202, v202
    s_nop 0
    v_pk_mul_f32 v[192:193], v[192:193], v[202:203] op_sel_hi:[1,0]
    v_pk_mul_f32 v[194:195], v[194:195], v[202:203] op_sel_hi:[1,0]
    v_pk_mul_f32 v[196:197], v[196:197], v[202:203] op_sel_hi:[1,0]
    v_pk_mul_f32 v[198:199], v[198:199], v[202:203] op_sel_hi:[1,0]
    v_cvt_pk_bf16_f32 v212, v192, v193
    v_cvt_pk_bf16_f32 v213, v194, v195
    v_cvt_pk_bf16_f32 v214, v196, v197
    v_cvt_pk_bf16_f32 v215, v198, v199
    v_mul_f32 v234, 0x3b000000, v234
    v_cvt_pk_bf16_f32 v234, v234, v234
    v_and_b32 v234, 0xffff0000, v234
    v_add_f32 v234, 0x3727c5ac, v234
    v_cvt_pk_bf16_f32 v234, v234, v234
    v_and_b32 v234, 0xffff0000, v234
    v_sqrt_f32 v234, v234
    s_nop 0
    v_cvt_pk_bf16_f32 v234, v234, v234
    v_and_b32 v234, 0xffff0000, v234
    v_rcp_f32 v234, v234
    s_nop 0
    v_pk_mul_f32 v[224:225], v[224:225], v[234:235] op_sel_hi:[1,0]
    v_pk_mul_f32 v[226:227], v[226:227], v[234:235] op_sel_hi:[1,0]
    v_pk_mul_f32 v[228:229], v[228:229], v[234:235] op_sel_hi:[1,0]
    v_pk_mul_f32 v[230:231], v[230:231], v[234:235] op_sel_hi:[1,0]
    v_cvt_pk_bf16_f32 v244, v224, v225
    v_cvt_pk_bf16_f32 v245, v226, v227
    v_cvt_pk_bf16_f32 v246, v228, v229
    v_cvt_pk_bf16_f32 v247, v230, v231
    s_add_u32 s3, s46, 0
    s_and_b32 s3, s3, 15
    s_lshl_b32 s3, s3, 4
    v_xor_b32 v10, s3, v2
    buffer_store_dwordx4 v[148:151], v10, s[8:11], s36 offen offset:0 sc1
    s_add_u32 s3, s46, 1
    s_and_b32 s3, s3, 15
    s_lshl_b32 s3, s3, 4
    v_xor_b32 v11, s3, v2
    buffer_store_dwordx4 v[180:183], v11, s[8:11], s36 offen offset:1024 sc1
    s_add_u32 s3, s46, 2
    s_and_b32 s3, s3, 15
    s_lshl_b32 s3, s3, 4
    v_xor_b32 v12, s3, v2
    buffer_store_dwordx4 v[212:215], v12, s[8:11], s36 offen offset:2048 sc1
    s_add_u32 s3, s46, 3
    s_and_b32 s3, s3, 15
    s_lshl_b32 s3, s3, 4
    v_xor_b32 v13, s3, v2
    buffer_store_dwordx4 v[244:247], v13, s[8:11], s36 offen offset:3072 sc1
    s_lshl_b32 s35, s32, 6
    s_add_u32 s35, s35, 524288
    s_lshl_b32 s3, s6, 29
    s_add_u32 s35, s35, s3
    v_mov_b32 v16, 1
    v_lshlrev_b32 v17, 2, v3
    s_waitcnt vmcnt(0)
    s_barrier
    buffer_store_dword v16, v17, s[8:11], s35 offen sc1
    s_mov_b32 s48, 575488
    s_mov_b32 s3, s32
    s_cmp_lt_u32 s3, 16
    s_cselect_b32 s37, 112, 32
    s_add_u32 s32, s32, s37
    s_cmp_lt_u32 s3, 80
    s_cbranch_scc1 L_pre_x
L_pre_end:
    s_mov_b32 s3, s4
    s_cmp_lt_u32 s3, 4
    s_cbranch_scc1 L_main
    s_cmp_eq_u32 s3, 7
    s_cbranch_scc1 L_main
    s_cmp_eq_u32 s3, 6
    s_cselect_b32 s49, 0, 5
    s_lshl_b32 s49, s49, 12
    s_lshl_b32 s3, s5, 7
    s_add_u32 s49, s49, s3
Lw_20:
    buffer_load_dword v6, v5, s[8:11], s49 offen offset:0 sc1
    s_waitcnt vmcnt(0)
    v_cmp_eq_u32 vcc, 0, v6
    s_cbranch_vccz Lwd_21
    s_sleep 8
    s_sub_u32 s98, s98, 1
    s_cbranch_scc1 L_end
    s_branch Lw_20
Lwd_21:
L_main:
    s_lshr_b32 s7, s4, 2
    s_lshr_b32 s3, s5, 4
    s_and_b32 s40, s4, 3
    s_cmp_eq_u32 s40, 3
    s_cselect_b32 s7, s3, s7
    s_lshl_b32 s3, s7, 3
    s_add_u32 s3, s3, s4
    s_cmp_eq_u32 s4, 0
    s_cbranch_scc1 L_chain
    s_cmp_eq_u32 s4, 1
    s_cbranch_scc1 L_ao
    s_cmp_eq_u32 s3, 7
    s_cbranch_scc1 L_ao
    s_cmp_eq_u32 s4, 2
    s_cbranch_scc1 L_qkv
    s_cmp_eq_u32 s3, 3
    s_cbranch_scc1 L_qkv
    s_cmp_eq_u32 s4, 4
    s_cbranch_scc1 L_chain
    s_cmp_eq_u32 s4, 5
    s_cbranch_scc1 L_ao
    s_cmp_eq_u32 s3, 15
    s_cbranch_scc1 L_ao
    s_cmp_eq_u32 s4, 6
    s_cbranch_scc1 L_qkv
    s_cmp_eq_u32 s3, 11
    s_cbranch_scc1 L_qkv
L_end:
    s_endpgm
L_qkv:
    s_and_b32 s56, s4, 1
    s_lshl_b32 s57, s5, s56
    s_and_b32 s57, s57, 31
    s_lshl_b32 s58, s56, 8
    s_cmp_lg_u32 s56, 0
    s_cselect_b64 s[12:13], s[80:81], s[82:83]
    s_cselect_b64 s[16:17], s[80:81], s[84:85]
    s_mov_b32 s12, s12
    s_and_b32 s13, s13, 0xffff
    s_mov_b32 s14, 0x400000
    s_mov_b32 s15, 0x20000
    s_mov_b32 s16, s16
    s_and_b32 s17, s17, 0xffff
    s_mov_b32 s18, 0x400000
    s_mov_b32 s19, 0x20000
    v_and_b32 v1, 63, v0
    v_lshlrev_b32 v1, 4, v1
    v_mov_b32 v2, 0
    v_mov_b32 v3, 1
    v_and_b32 v5, 31, v0
    v_lshlrev_b32 v5, 2, v5
    v_bfe_u32 v8, v0, 4, 2
    v_lshlrev_b32 v8, 11, v8
    v_bfe_u32 v9, v0, 2, 2
    v_lshl_add_u32 v8, v9, 6, v8
    s_lshl_b32 s3, s6, 8
    v_add_u32 v8, s3, v8
    v_and_b32 v9, 1, v0
    v_lshl_add_u32 v8, v9, 3, v8
    v_and_b32 v9, 2, v0
    v_lshl_add_u32 v16, v9, 4, v8
    v_add_u32 v17, 0x10000, v16
    s_add_u32 s3, s56, 3
    v_lshlrev_b32 v9, s3, v9
    v_add_u32 v18, v8, v9
    s_lshr_b32 s3, 32, s56
    v_add_u32 v19, 0x10000, v18
    v_add_u32 v20, s3, v18
    v_add_u32 v21, s3, v19
Lc_22:
    buffer_load_dword v4, v2, s[28:31], 0 offen offset:0 sc1
    s_waitcnt vmcnt(0)
    v_cmp_gt_u32 vcc, 32, v4
    s_cbranch_vccz Lcd_23
    s_sleep 2
    s_sub_u32 s98, s98, 1
    s_cbranch_scc1 L_end
    s_branch Lc_22
Lcd_23:
    v_bfe_u32 v10, v0, 2, 2
    v_lshlrev_b32 v10, 13, v10
    v_bfe_u32 v11, v0, 4, 2
    v_lshl_add_u32 v10, v11, 6, v10
    v_and_b32 v11, 3, v0
    v_lshl_add_u32 v10, v11, 4, v10
    s_lshl_b32 s40, s57, 8
    v_add_u32 v10, s40, v10
    s_lshl_b32 s40, s6, 17
    s_lshl_b32 s41, s6, 12
    s_add_u32 m0, s41, 0
    s_add_u32 s42, s40, 0
    buffer_load_dwordx4 v10, s[12:15], s42 offen lds
    s_add_u32 m0, s41, 1024
    s_add_u32 s42, s40, 32768
    buffer_load_dwordx4 v10, s[12:15], s42 offen lds
    s_add_u32 m0, s41, 2048
    s_add_u32 s42, s40, 65536
    buffer_load_dwordx4 v10, s[12:15], s42 offen lds
    s_add_u32 m0, s41, 3072
    s_add_u32 s42, s40, 98304
    buffer_load_dwordx4 v10, s[12:15], s42 offen lds
    s_add_u32 m0, s41, 16384
    s_add_u32 s42, s40, 524288
    buffer_load_dwordx4 v10, s[12:15], s42 offen lds
    s_add_u32 m0, s41, 17408
    s_add_u32 s42, s40, 557056
    buffer_load_dwordx4 v10, s[12:15], s42 offen lds
    s_add_u32 m0, s41, 18432
    s_add_u32 s42, s40, 589824
    buffer_load_dwordx4 v10, s[12:15], s42 offen lds
    s_add_u32 m0, s41, 19456
    s_add_u32 s42, s40, 622592
    buffer_load_dwordx4 v10, s[12:15], s42 offen lds
    s_add_u32 m0, s41, 32768
    s_add_u32 s42, s40, 1048576
    buffer_load_dwordx4 v10, s[12:15], s42 offen lds
    s_add_u32 m0, s41, 33792
    s_add_u32 s42, s40, 1081344
    buffer_load_dwordx4 v10, s[12:15], s42 offen lds
    s_add_u32 m0, s41, 34816
    s_add_u32 s42, s40, 1114112
    buffer_load_dwordx4 v10, s[12:15], s42 offen lds
    s_add_u32 m0, s41, 35840
    s_add_u32 s42, s40, 1146880
    buffer_load_dwordx4 v10, s[12:15], s42 offen lds
    s_add_u32 m0, s41, 49152
    s_add_u32 s42, s40, 1572864
    buffer_load_dwordx4 v10, s[12:15], s42 offen lds
    s_add_u32 m0, s41, 50176
    s_add_u32 s42, s40, 1605632
    buffer_load_dwordx4 v10, s[12:15], s42 offen lds
    s_add_u32 m0, s41, 51200
    s_add_u32 s42, s40, 1638400
    buffer_load_dwordx4 v10, s[12:15], s42 offen lds
    s_add_u32 m0, s41, 52224
    s_add_u32 s42, s40, 1671168
    buffer_load_dwordx4 v10, s[12:15], s42 offen lds
    s_add_u32 m0, s41, 65536
    s_add_u32 s42, s40, 2097152
    buffer_load_dwordx4 v10, s[12:15], s42 offen lds
    s_add_u32 m0, s41, 66560
    s_add_u32 s42, s40, 2129920
    buffer_load_dwordx4 v10, s[12:15], s42 offen lds
    s_add_u32 m0, s41, 67584
    s_add_u32 s42, s40, 2162688
    buffer_load_dwordx4 v10, s[12:15], s42 offen lds
    s_add_u32 m0, s41, 68608
    s_add_u32 s42, s40, 2195456
    buffer_load_dwordx4 v10, s[12:15], s42 offen lds
    s_add_u32 m0, s41, 81920
    s_add_u32 s42, s40, 2621440
    buffer_load_dwordx4 v10, s[12:15], s42 offen lds
    s_add_u32 m0, s41, 82944
    s_add_u32 s42, s40, 2654208
    buffer_load_dwordx4 v10, s[12:15], s42 offen lds
    s_add_u32 m0, s41, 83968
    s_add_u32 s42, s40, 2686976
    buffer_load_dwordx4 v10, s[12:15], s42 offen lds
    s_add_u32 m0, s41, 84992
    s_add_u32 s42, s40, 2719744
    buffer_load_dwordx4 v10, s[12:15], s42 offen lds
    s_add_u32 m0, s41, 98304
    s_add_u32 s42, s40, 3145728
    buffer_load_dwordx4 v10, s[12:15], s42 offen lds
    s_add_u32 m0, s41, 99328
    s_add_u32 s42, s40, 3178496
    buffer_load_dwordx4 v10, s[12:15], s42 offen lds
    s_add_u32 m0, s41, 100352
    s_add_u32 s42, s40, 3211264
    buffer_load_dwordx4 v10, s[12:15], s42 offen lds
    s_add_u32 m0, s41, 101376
    s_add_u32 s42, s40, 3244032
    buffer_load_dwordx4 v10, s[12:15], s42 offen lds
    s_add_u32 m0, s41, 114688
    s_add_u32 s42, s40, 3670016
    buffer_load_dwordx4 v10, s[12:15], s42 offen lds
    s_add_u32 m0, s41, 115712
    s_add_u32 s42, s40, 3702784
    buffer_load_dwordx4 v10, s[12:15], s42 offen lds
    s_add_u32 m0, s41, 116736
    s_add_u32 s42, s40, 3735552
    buffer_load_dwordx4 v10, s[12:15], s42 offen lds
    s_add_u32 m0, s41, 117760
    s_add_u32 s42, s40, 3768320
    buffer_load_dwordx4 v10, s[12:15], s42 offen lds
    s_waitcnt vmcnt(28)
    s_barrier
    ds_read_b64_tr_b16 a[0:1], v16 offset:0
    ds_read_b64_tr_b16 a[2:3], v16 offset:1024
    ds_read_b64_tr_b16 a[4:5], v16 offset:16
    ds_read_b64_tr_b16 a[6:7], v16 offset:1040
    ds_read_b64_tr_b16 a[8:9], v16 offset:8192
    ds_read_b64_tr_b16 a[10:11], v16 offset:9216
    ds_read_b64_tr_b16 a[12:13], v16 offset:8208
    ds_read_b64_tr_b16 a[14:15], v16 offset:9232
    s_waitcnt lgkmcnt(0)
    s_waitcnt vmcnt(24)
    s_barrier
    ds_read_b64_tr_b16 a[16:17], v16 offset:16384
    ds_read_b64_tr_b16 a[18:19], v16 offset:17408
    ds_read_b64_tr_b16 a[20:21], v16 offset:16400
    ds_read_b64_tr_b16 a[22:23], v16 offset:17424
    ds_read_b64_tr_b16 a[24:25], v16 offset:24576
    ds_read_b64_tr_b16 a[26:27], v16 offset:25600
    ds_read_b64_tr_b16 a[28:29], v16 offset:24592
    ds_read_b64_tr_b16 a[30:31], v16 offset:25616
    s_add_u32 s40, s40, s58
    s_add_u32 m0, s41, 0
    s_add_u32 s42, s40, 0
    buffer_load_dwordx4 v10, s[16:19], s42 offen lds
    s_add_u32 m0, s41, 1024
    s_add_u32 s42, s40, 32768
    buffer_load_dwordx4 v10, s[16:19], s42 offen lds
    s_add_u32 m0, s41, 2048
    s_add_u32 s42, s40, 65536
    buffer_load_dwordx4 v10, s[16:19], s42 offen lds
    s_add_u32 m0, s41, 3072
    s_add_u32 s42, s40, 98304
    buffer_load_dwordx4 v10, s[16:19], s42 offen lds
    s_waitcnt lgkmcnt(0)
    s_waitcnt vmcnt(24)
    s_barrier
    ds_read_b64_tr_b16 a[32:33], v16 offset:32768
    ds_read_b64_tr_b16 a[34:35], v16 offset:33792
    ds_read_b64_tr_b16 a[36:37], v16 offset:32784
    ds_read_b64_tr_b16 a[38:39], v16 offset:33808
    ds_read_b64_tr_b16 a[40:41], v16 offset:40960
    ds_read_b64_tr_b16 a[42:43], v16 offset:41984
    ds_read_b64_tr_b16 a[44:45], v16 offset:40976
    ds_read_b64_tr_b16 a[46:47], v16 offset:42000
    s_add_u32 m0, s41, 16384
    s_add_u32 s42, s40, 524288
    buffer_load_dwordx4 v10, s[16:19], s42 offen lds
    s_add_u32 m0, s41, 17408
    s_add_u32 s42, s40, 557056
    buffer_load_dwordx4 v10, s[16:19], s42 offen lds
    s_add_u32 m0, s41, 18432
    s_add_u32 s42, s40, 589824
    buffer_load_dwordx4 v10, s[16:19], s42 offen lds
    s_add_u32 m0, s41, 19456
    s_add_u32 s42, s40, 622592
    buffer_load_dwordx4 v10, s[16:19], s42 offen lds
    s_waitcnt lgkmcnt(0)
    s_waitcnt vmcnt(24)
    s_barrier
    ds_read_b64_tr_b16 a[48:49], v16 offset:49152
    ds_read_b64_tr_b16 a[50:51], v16 offset:50176
    ds_read_b64_tr_b16 a[52:53], v16 offset:49168
    ds_read_b64_tr_b16 a[54:55], v16 offset:50192
    ds_read_b64_tr_b16 a[56:57], v16 offset:57344
    ds_read_b64_tr_b16 a[58:59], v16 offset:58368
    ds_read_b64_tr_b16 a[60:61], v16 offset:57360
    ds_read_b64_tr_b16 a[62:63], v16 offset:58384
    s_add_u32 m0, s41, 32768
    s_add_u32 s42, s40, 1048576
    buffer_load_dwordx4 v10, s[16:19], s42 offen lds
    s_add_u32 m0, s41, 33792
    s_add_u32 s42, s40, 1081344
    buffer_load_dwordx4 v10, s[16:19], s42 offen lds
    s_add_u32 m0, s41, 34816
    s_add_u32 s42, s40, 1114112
    buffer_load_dwordx4 v10, s[16:19], s42 offen lds
    s_add_u32 m0, s41, 35840
    s_add_u32 s42, s40, 1146880
    buffer_load_dwordx4 v10, s[16:19], s42 offen lds
    s_waitcnt lgkmcnt(0)
    s_waitcnt vmcnt(24)
    s_barrier
    ds_read_b64_tr_b16 a[64:65], v17 offset:0
    ds_read_b64_tr_b16 a[66:67], v17 offset:1024
    ds_read_b64_tr_b16 a[68:69], v17 offset:16
    ds_read_b64_tr_b16 a[70:71], v17 offset:1040
    ds_read_b64_tr_b16 a[72:73], v17 offset:8192
    ds_read_b64_tr_b16 a[74:75], v17 offset:9216
    ds_read_b64_tr_b16 a[76:77], v17 offset:8208
    ds_read_b64_tr_b16 a[78:79], v17 offset:9232
    s_add_u32 m0, s41, 49152
    s_add_u32 s42, s40, 1572864
    buffer_load_dwordx4 v10, s[16:19], s42 offen lds
    s_add_u32 m0, s41, 50176
    s_add_u32 s42, s40, 1605632
    buffer_load_dwordx4 v10, s[16:19], s42 offen lds
    s_add_u32 m0, s41, 51200
    s_add_u32 s42, s40, 1638400
    buffer_load_dwordx4 v10, s[16:19], s42 offen lds
    s_add_u32 m0, s41, 52224
    s_add_u32 s42, s40, 1671168
    buffer_load_dwordx4 v10, s[16:19], s42 offen lds
    s_waitcnt lgkmcnt(0)
    s_waitcnt vmcnt(24)
    s_barrier
    ds_read_b64_tr_b16 a[80:81], v17 offset:16384
    ds_read_b64_tr_b16 a[82:83], v17 offset:17408
    ds_read_b64_tr_b16 a[84:85], v17 offset:16400
    ds_read_b64_tr_b16 a[86:87], v17 offset:17424
    ds_read_b64_tr_b16 a[88:89], v17 offset:24576
    ds_read_b64_tr_b16 a[90:91], v17 offset:25600
    ds_read_b64_tr_b16 a[92:93], v17 offset:24592
    ds_read_b64_tr_b16 a[94:95], v17 offset:25616
    s_add_u32 m0, s41, 65536
    s_add_u32 s42, s40, 2097152
    buffer_load_dwordx4 v10, s[16:19], s42 offen lds
    s_add_u32 m0, s41, 66560
    s_add_u32 s42, s40, 2129920
    buffer_load_dwordx4 v10, s[16:19], s42 offen lds
    s_add_u32 m0, s41, 67584
    s_add_u32 s42, s40, 2162688
    buffer_load_dwordx4 v10, s[16:19], s42 offen lds
    s_add_u32 m0, s41, 68608
    s_add_u32 s42, s40, 2195456
    buffer_load_dwordx4 v10, s[16:19], s42 offen lds
    s_waitcnt lgkmcnt(0)
    s_waitcnt vmcnt(24)
    s_barrier
    ds_read_b64_tr_b16 a[96:97], v17 offset:32768
    ds_read_b64_tr_b16 a[98:99], v17 offset:33792
    ds_read_b64_tr_b16 a[100:101], v17 offset:32784
    ds_read_b64_tr_b16 a[102:103], v17 offset:33808
    ds_read_b64_tr_b16 a[104:105], v17 offset:40960
    ds_read_b64_tr_b16 a[106:107], v17 offset:41984
    ds_read_b64_tr_b16 a[108:109], v17 offset:40976
    ds_read_b64_tr_b16 a[110:111], v17 offset:42000
    s_add_u32 m0, s41, 81920
    s_add_u32 s42, s40, 2621440
    buffer_load_dwordx4 v10, s[16:19], s42 offen lds
    s_add_u32 m0, s41, 82944
    s_add_u32 s42, s40, 2654208
    buffer_load_dwordx4 v10, s[16:19], s42 offen lds
    s_add_u32 m0, s41, 83968
    s_add_u32 s42, s40, 2686976
    buffer_load_dwordx4 v10, s[16:19], s42 offen lds
    s_add_u32 m0, s41, 84992
    s_add_u32 s42, s40, 2719744
    buffer_load_dwordx4 v10, s[16:19], s42 offen lds
    s_waitcnt lgkmcnt(0)
    s_waitcnt vmcnt(24)
    s_barrier
    ds_read_b64_tr_b16 a[112:113], v17 offset:49152
    ds_read_b64_tr_b16 a[114:115], v17 offset:50176
    ds_read_b64_tr_b16 a[116:117], v17 offset:49168
    ds_read_b64_tr_b16 a[118:119], v17 offset:50192
    ds_read_b64_tr_b16 a[120:121], v17 offset:57344
    ds_read_b64_tr_b16 a[122:123], v17 offset:58368
    ds_read_b64_tr_b16 a[124:125], v17 offset:57360
    ds_read_b64_tr_b16 a[126:127], v17 offset:58384
    s_add_u32 m0, s41, 98304
    s_add_u32 s42, s40, 3145728
    buffer_load_dwordx4 v10, s[16:19], s42 offen lds
    s_add_u32 m0, s41, 99328
    s_add_u32 s42, s40, 3178496
    buffer_load_dwordx4 v10, s[16:19], s42 offen lds
    s_add_u32 m0, s41, 100352
    s_add_u32 s42, s40, 3211264
    buffer_load_dwordx4 v10, s[16:19], s42 offen lds
    s_add_u32 m0, s41, 101376
    s_add_u32 s42, s40, 3244032
    buffer_load_dwordx4 v10, s[16:19], s42 offen lds
    s_waitcnt lgkmcnt(0)
    s_waitcnt vmcnt(24)
    s_barrier
    ds_read_b64_tr_b16 a[128:129], v18 offset:0
    ds_read_b64_tr_b16 a[130:131], v18 offset:1024
    ds_read_b64_tr_b16 a[132:133], v20 offset:0
    ds_read_b64_tr_b16 a[134:135], v20 offset:1024
    ds_read_b64_tr_b16 a[136:137], v18 offset:8192
    ds_read_b64_tr_b16 a[138:139], v18 offset:9216
    ds_read_b64_tr_b16 a[140:141], v20 offset:8192
    ds_read_b64_tr_b16 a[142:143], v20 offset:9216
    s_add_u32 m0, s41, 114688
    s_add_u32 s42, s40, 3670016
    buffer_load_dwordx4 v10, s[16:19], s42 offen lds
    s_add_u32 m0, s41, 115712
    s_add_u32 s42, s40, 3702784
    buffer_load_dwordx4 v10, s[16:19], s42 offen lds
    s_add_u32 m0, s41, 116736
    s_add_u32 s42, s40, 3735552
    buffer_load_dwordx4 v10, s[16:19], s42 offen lds
    s_add_u32 m0, s41, 117760
    s_add_u32 s42, s40, 3768320
    buffer_load_dwordx4 v10, s[16:19], s42 offen lds
    s_waitcnt lgkmcnt(0)
    s_waitcnt vmcnt(24)
    s_barrier
    ds_read_b64_tr_b16 a[144:145], v18 offset:16384
    ds_read_b64_tr_b16 a[146:147], v18 offset:17408
    ds_read_b64_tr_b16 a[148:149], v20 offset:16384
    ds_read_b64_tr_b16 a[150:151], v20 offset:17408
    ds_read_b64_tr_b16 a[152:153], v18 offset:24576
    ds_read_b64_tr_b16 a[154:155], v18 offset:25600
    ds_read_b64_tr_b16 a[156:157], v20 offset:24576
    ds_read_b64_tr_b16 a[158:159], v20 offset:25600
    s_waitcnt lgkmcnt(0)
    s_waitcnt vmcnt(20)
    s_barrier
    ds_read_b64_tr_b16 a[160:161], v18 offset:32768
    ds_read_b64_tr_b16 a[162:163], v18 offset:33792
    ds_read_b64_tr_b16 a[164:165], v20 offset:32768
    ds_read_b64_tr_b16 a[166:167], v20 offset:33792
    ds_read_b64_tr_b16 a[168:169], v18 offset:40960
    ds_read_b64_tr_b16 a[170:171], v18 offset:41984
    ds_read_b64_tr_b16 a[172:173], v20 offset:40960
    ds_read_b64_tr_b16 a[174:175], v20 offset:41984
    s_waitcnt lgkmcnt(0)
    s_waitcnt vmcnt(16)
    s_barrier
    ds_read_b64_tr_b16 a[176:177], v18 offset:49152
    ds_read_b64_tr_b16 a[178:179], v18 offset:50176
    ds_read_b64_tr_b16 a[180:181], v20 offset:49152
    ds_read_b64_tr_b16 a[182:183], v20 offset:50176
    ds_read_b64_tr_b16 a[184:185], v18 offset:57344
    ds_read_b64_tr_b16 a[186:187], v18 offset:58368
    ds_read_b64_tr_b16 a[188:189], v20 offset:57344
    ds_read_b64_tr_b16 a[190:191], v20 offset:58368
    s_waitcnt lgkmcnt(0)
    s_waitcnt vmcnt(12)
    s_barrier
    ds_read_b64_tr_b16 a[192:193], v19 offset:0
    ds_read_b64_tr_b16 a[194:195], v19 offset:1024
    ds_read_b64_tr_b16 a[196:197], v21 offset:0
    ds_read_b64_tr_b16 a[198:199], v21 offset:1024
    ds_read_b64_tr_b16 a[200:201], v19 offset:8192
    ds_read_b64_tr_b16 a[202:203], v19 offset:9216
    ds_read_b64_tr_b16 a[204:205], v21 offset:8192
    ds_read_b64_tr_b16 a[206:207], v21 offset:9216
    s_waitcnt lgkmcnt(0)
    s_waitcnt vmcnt(8)
    s_barrier
    ds_read_b64_tr_b16 a[208:209], v19 offset:16384
    ds_read_b64_tr_b16 a[210:211], v19 offset:17408
    ds_read_b64_tr_b16 a[212:213], v21 offset:16384
    ds_read_b64_tr_b16 a[214:215], v21 offset:17408
    ds_read_b64_tr_b16 a[216:217], v19 offset:24576
    ds_read_b64_tr_b16 a[218:219], v19 offset:25600
    ds_read_b64_tr_b16 a[220:221], v21 offset:24576
    ds_read_b64_tr_b16 a[222:223], v21 offset:25600
    s_waitcnt lgkmcnt(0)
    s_waitcnt vmcnt(4)
    s_barrier
    ds_read_b64_tr_b16 a[224:225], v19 offset:32768
    ds_read_b64_tr_b16 a[226:227], v19 offset:33792
    ds_read_b64_tr_b16 a[228:229], v21 offset:32768
    ds_read_b64_tr_b16 a[230:231], v21 offset:33792
    ds_read_b64_tr_b16 a[232:233], v19 offset:40960
    ds_read_b64_tr_b16 a[234:235], v19 offset:41984
    ds_read_b64_tr_b16 a[236:237], v21 offset:40960
    ds_read_b64_tr_b16 a[238:239], v21 offset:41984
    s_waitcnt lgkmcnt(0)
    s_waitcnt vmcnt(0)
    s_barrier
    ds_read_b64_tr_b16 a[240:241], v19 offset:49152
    ds_read_b64_tr_b16 a[242:243], v19 offset:50176
    ds_read_b64_tr_b16 a[244:245], v21 offset:49152
    ds_read_b64_tr_b16 a[246:247], v21 offset:50176
    ds_read_b64_tr_b16 a[248:249], v19 offset:57344
    ds_read_b64_tr_b16 a[250:251], v19 offset:58368
    ds_read_b64_tr_b16 a[252:253], v21 offset:57344
    ds_read_b64_tr_b16 a[254:255], v21 offset:58368
    s_waitcnt lgkmcnt(0)
    s_barrier
    v_bfe_u32 v9, v0, 4, 2
    v_and_b32 v10, 15, v0
    v_lshlrev_b32 v13, 9, v9
    v_lshl_add_u32 v13, v10, 4, v13
    v_xor_b32 v9, v9, v10
    v_lshlrev_b32 v9, 4, v9
    v_lshl_add_u32 v8, v10, 10, v9
    v_xor_b32 v104, 0, v8
    v_xor_b32 v105, 64, v8
    v_xor_b32 v106, 128, v8
    v_xor_b32 v107, 192, v8
    v_mov_b32 v6, 0x3e0293ee
    v_and_b32 v7, 1, v0
    v_lshlrev_b32 v7, 7, v7
    v_mul_u32_u24 v7, s56, v7
    s_lshl_b32 s3, s7, 6
    s_mov_b32 s44, 0
    s_lshl_b32 s45, s3, 7
    s_add_u32 s45, s45, 524288
    s_lshl_b32 s46, s3, 15
    s_add_u32 s46, s46, 9437184
    s_lshl_b32 s53, s6, 13
    s_add_u32 s46, s46, s53
    s_lshl_b32 s3, s3, 5
    s_add_u32 s3, s3, s57
    s_lshl_b32 s50, s3, 7
    s_lshl_b32 s47, s56, 2
    s_add_u32 s50, s50, s47
    s_lshl_b32 s3, s7, 5
    s_add_u32 s3, s3, s57
    s_mul_i32 s47, s3, 2099328
    s_add_u32 s47, s47, 50331648
    s_lshl_b32 s3, s6, 11
    s_add_u32 s47, s47, s3
    s_lshl_b32 s3, s56, 14
    s_add_u32 s47, s47, s3
    s_mul_i32 s3, s56, 2091136
    s_add_u32 s48, s47, 8192
    s_add_u32 s48, s48, s3
    s_lshl_b32 s3, s6, 10
    s_sub_u32 s49, 24576, s3
    v_mov_b32 v48, 0xff81ff81
    v_mov_b32 v49, 0xff81ff81
    v_mov_b32 v50, 0xff81ff81
    v_mov_b32 v51, 0xff81ff81
    s_mov_b32 s63, 0x20000000
    v_mov_b32 v12, 0x10000
    v_mov_b32 v11, 0
    ds_write2_b32 v12, v2, v2 offset1:1
    s_waitcnt lgkmcnt(0)
    v_mov_b32 v4, 0
    s_cmp_lg_u32 s56, 0
    s_cbranch_scc1 L_qq1W
    s_branch L_kv1W
L_kv0A:
    ds_read_b128 v[76:79], v105 offset:16384
    s_waitcnt lgkmcnt(3)
    v_mfma_f32_16x16x32_bf16 v[16:19], a[0:3], v[64:67], 0
    s_add_u32 m0, s53, 32768
    s_add_u32 s3, s46, 4096
    buffer_load_dwordx4 v1, s[8:11], s46 offen offset:0 sc1 lds
    v_mfma_f32_16x16x32_bf16 v[20:23], a[4:7], v[64:67], 0
    v_mfma_f32_16x16x32_bf16 v[32:35], v[64:67], a[128:131], 0
    buffer_load_dwordx4 v1, s[8:11], s46 offen offset:1024 sc1 lds
    v_mfma_f32_16x16x32_bf16 v[36:39], v[64:67], a[132:135], 0
    ds_read_b128 v[64:67], v106 offset:0
    s_waitcnt lgkmcnt(3)
    v_mfma_f32_16x16x32_bf16 v[24:27], a[0:3], v[68:71], 0
    buffer_load_dwordx4 v1, s[8:11], s46 offen offset:2048 sc1 lds
    v_mfma_f32_16x16x32_bf16 v[28:31], a[4:7], v[68:71], 0
    v_mfma_f32_16x16x32_bf16 v[40:43], v[68:71], a[128:131], 0
    buffer_load_dwordx4 v1, s[8:11], s46 offen offset:3072 sc1 lds
    v_mfma_f32_16x16x32_bf16 v[44:47], v[68:71], a[132:135], 0
    ds_read_b128 v[68:71], v106 offset:16384
    s_waitcnt lgkmcnt(3)
    v_mfma_f32_16x16x32_bf16 v[16:19], a[8:11], v[72:75], v[16:19]
    s_add_u32 m0, s53, 36864
    s_add_u32 s45, s45, 128
    buffer_load_dwordx4 v1, s[8:11], s3 offen offset:0 sc1 lds
    v_mfma_f32_16x16x32_bf16 v[20:23], a[12:15], v[72:75], v[20:23]
    v_mfma_f32_16x16x32_bf16 v[32:35], v[72:75], a[136:139], v[32:35]
    buffer_load_dwordx4 v1, s[8:11], s3 offen offset:1024 sc1 lds
    v_mfma_f32_16x16x32_bf16 v[36:39], v[72:75], a[140:143], v[36:39]
    ds_read_b128 v[72:75], v107 offset:0
    s_waitcnt lgkmcnt(3)
    v_mfma_f32_16x16x32_bf16 v[24:27], a[8:11], v[76:79], v[24:27]
    buffer_load_dwordx4 v1, s[8:11], s3 offen offset:2048 sc1 lds
    v_mfma_f32_16x16x32_bf16 v[28:31], a[12:15], v[76:79], v[28:31]
    v_mfma_f32_16x16x32_bf16 v[40:43], v[76:79], a[136:139], v[40:43]
    buffer_load_dwordx4 v1, s[8:11], s3 offen offset:3072 sc1 lds
    s_add_u32 s46, s46, 32768
    v_mfma_f32_16x16x32_bf16 v[44:47], v[76:79], a[140:143], v[44:47]
    ds_read_b128 v[76:79], v107 offset:16384
    s_waitcnt lgkmcnt(3)
    v_mfma_f32_16x16x32_bf16 v[16:19], a[16:19], v[64:67], v[16:19]
    buffer_load_dword v4, v5, s[8:11], s45 offen sc1
    v_mfma_f32_16x16x32_bf16 v[20:23], a[20:23], v[64:67], v[20:23]
    v_mfma_f32_16x16x32_bf16 v[32:35], v[64:67], a[144:147], v[32:35]
    v_cvt_pk_bf16_f32 v88, v112, v116
    v_cvt_pk_bf16_f32 v89, v113, v117
    v_mfma_f32_16x16x32_bf16 v[36:39], v[64:67], a[148:151], v[36:39]
    v_cvt_pk_bf16_f32 v90, v114, v118
    v_cvt_pk_bf16_f32 v91, v115, v119
    ds_read_b128 v[64:67], v104 offset:256
    s_waitcnt lgkmcnt(3)
    v_mfma_f32_16x16x32_bf16 v[24:27], a[16:19], v[68:71], v[24:27]
    buffer_store_dwordx4 v[88:91], v13, s[8:11], s60 offen offset:0 sc1
    v_mfma_f32_16x16x32_bf16 v[28:31], a[20:23], v[68:71], v[28:31]
    v_mfma_f32_16x16x32_bf16 v[40:43], v[68:71], a[144:147], v[40:43]
    v_cvt_pk_bf16_f32 v92, v120, v124
    v_cvt_pk_bf16_f32 v93, v121, v125
    v_mfma_f32_16x16x32_bf16 v[44:47], v[68:71], a[148:151], v[44:47]
    v_cvt_pk_bf16_f32 v94, v122, v126
    v_cvt_pk_bf16_f32 v95, v123, v127
    ds_read_b128 v[68:71], v104 offset:16640
    s_waitcnt lgkmcnt(3)
    v_mfma_f32_16x16x32_bf16 v[16:19], a[24:27], v[72:75], v[16:19]
    buffer_store_dwordx4 v[92:95], v13, s[8:11], s60 offen offset:256 sc1
    v_mfma_f32_16x16x32_bf16 v[20:23], a[28:31], v[72:75], v[20:23]
    v_mfma_f32_16x16x32_bf16 v[32:35], v[72:75], a[152:155], v[32:35]
    v_cvt_pk_bf16_f32 v96, v128, v129
    v_cvt_pk_bf16_f32 v97, v130, v131
    v_mfma_f32_16x16x32_bf16 v[36:39], v[72:75], a[156:159], v[36:39]
    v_cvt_pk_bf16_f32 v98, v136, v137
    v_cvt_pk_bf16_f32 v99, v138, v139
    ds_read_b128 v[72:75], v105 offset:256
    s_waitcnt lgkmcnt(3)
    v_mfma_f32_16x16x32_bf16 v[24:27], a[24:27], v[76:79], v[24:27]
    buffer_store_dwordx4 v[96:99], v13, s[8:11], s61 offen offset:0 sc1
    v_mfma_f32_16x16x32_bf16 v[28:31], a[28:31], v[76:79], v[28:31]
    v_mfma_f32_16x16x32_bf16 v[40:43], v[76:79], a[152:155], v[40:43]
    v_cvt_pk_bf16_f32 v100, v132, v133
    v_cvt_pk_bf16_f32 v101, v134, v135
    v_mfma_f32_16x16x32_bf16 v[44:47], v[76:79], a[156:159], v[44:47]
    v_cvt_pk_bf16_f32 v102, v140, v141
    v_cvt_pk_bf16_f32 v103, v142, v143
    ds_read_b128 v[76:79], v105 offset:16640
    s_waitcnt lgkmcnt(3)
    v_mfma_f32_16x16x32_bf16 v[16:19], a[32:35], v[64:67], v[16:19]
    buffer_store_dwordx4 v[100:103], v13, s[8:11], s61 offen offset:256 sc1
    v_mfma_f32_16x16x32_bf16 v[20:23], a[36:39], v[64:67], v[20:23]
    v_mfma_f32_16x16x32_bf16 v[32:35], v[64:67], a[160:163], v[32:35]
    s_add_u32 s3, s60, s49
    buffer_store_dwordx4 v[48:51], v1, s[8:11], s3 offen sc1
    v_mfma_f32_16x16x32_bf16 v[36:39], v[64:67], a[164:167], v[36:39]
    ds_read_b128 v[64:67], v106 offset:256
    s_waitcnt lgkmcnt(3)
    v_mfma_f32_16x16x32_bf16 v[24:27], a[32:35], v[68:71], v[24:27]
    v_mfma_f32_16x16x32_bf16 v[28:31], a[36:39], v[68:71], v[28:31]
    v_mfma_f32_16x16x32_bf16 v[40:43], v[68:71], a[160:163], v[40:43]
    v_mfma_f32_16x16x32_bf16 v[44:47], v[68:71], a[164:167], v[44:47]
    ds_read_b128 v[68:71], v106 offset:16640
    s_waitcnt lgkmcnt(3)
    v_mfma_f32_16x16x32_bf16 v[16:19], a[40:43], v[72:75], v[16:19]
    v_mfma_f32_16x16x32_bf16 v[20:23], a[44:47], v[72:75], v[20:23]
    v_mfma_f32_16x16x32_bf16 v[32:35], v[72:75], a[168:171], v[32:35]
    v_mfma_f32_16x16x32_bf16 v[36:39], v[72:75], a[172:175], v[36:39]
    ds_read_b128 v[72:75], v107 offset:256
    s_waitcnt lgkmcnt(3)
    v_mfma_f32_16x16x32_bf16 v[24:27], a[40:43], v[76:79], v[24:27]
    v_mfma_f32_16x16x32_bf16 v[28:31], a[44:47], v[76:79], v[28:31]
    v_mfma_f32_16x16x32_bf16 v[40:43], v[76:79], a[168:171], v[40:43]
    v_mfma_f32_16x16x32_bf16 v[44:47], v[76:79], a[172:175], v[44:47]
    ds_read_b128 v[76:79], v107 offset:16640
    s_waitcnt lgkmcnt(3)
    v_mfma_f32_16x16x32_bf16 v[16:19], a[48:51], v[64:67], v[16:19]
    v_mfma_f32_16x16x32_bf16 v[20:23], a[52:55], v[64:67], v[20:23]
    v_mfma_f32_16x16x32_bf16 v[32:35], v[64:67], a[176:179], v[32:35]
    v_mfma_f32_16x16x32_bf16 v[36:39], v[64:67], a[180:183], v[36:39]
    ds_read_b128 v[64:67], v104 offset:512
    s_waitcnt lgkmcnt(3)
    v_mfma_f32_16x16x32_bf16 v[24:27], a[48:51], v[68:71], v[24:27]
    v_mfma_f32_16x16x32_bf16 v[28:31], a[52:55], v[68:71], v[28:31]
    v_mfma_f32_16x16x32_bf16 v[40:43], v[68:71], a[176:179], v[40:43]
    v_mfma_f32_16x16x32_bf16 v[44:47], v[68:71], a[180:183], v[44:47]
    ds_read_b128 v[68:71], v104 offset:16896
    s_waitcnt lgkmcnt(3)
    v_mfma_f32_16x16x32_bf16 v[16:19], a[56:59], v[72:75], v[16:19]
    v_mfma_f32_16x16x32_bf16 v[20:23], a[60:63], v[72:75], v[20:23]
    v_mfma_f32_16x16x32_bf16 v[32:35], v[72:75], a[184:187], v[32:35]
    v_mfma_f32_16x16x32_bf16 v[36:39], v[72:75], a[188:191], v[36:39]
    ds_read_b128 v[72:75], v105 offset:512
    s_waitcnt lgkmcnt(3)
    v_mfma_f32_16x16x32_bf16 v[24:27], a[56:59], v[76:79], v[24:27]
    v_mfma_f32_16x16x32_bf16 v[28:31], a[60:63], v[76:79], v[28:31]
    v_mfma_f32_16x16x32_bf16 v[40:43], v[76:79], a[184:187], v[40:43]
    v_mfma_f32_16x16x32_bf16 v[44:47], v[76:79], a[188:191], v[44:47]
    ds_read_b128 v[76:79], v105 offset:16896
    s_waitcnt lgkmcnt(3)
    v_mfma_f32_16x16x32_bf16 v[16:19], a[64:67], v[64:67], v[16:19]
    v_mfma_f32_16x16x32_bf16 v[20:23], a[68:71], v[64:67], v[20:23]
    v_mfma_f32_16x16x32_bf16 v[32:35], v[64:67], a[192:195], v[32:35]
    v_mfma_f32_16x16x32_bf16 v[36:39], v[64:67], a[196:199], v[36:39]
    ds_read_b128 v[64:67], v106 offset:512
    s_waitcnt lgkmcnt(3)
    v_mfma_f32_16x16x32_bf16 v[24:27], a[64:67], v[68:71], v[24:27]
    v_mfma_f32_16x16x32_bf16 v[28:31], a[68:71], v[68:71], v[28:31]
    v_mfma_f32_16x16x32_bf16 v[40:43], v[68:71], a[192:195], v[40:43]
    v_mfma_f32_16x16x32_bf16 v[44:47], v[68:71], a[196:199], v[44:47]
    ds_read_b128 v[68:71], v106 offset:16896
    s_waitcnt lgkmcnt(3)
    v_mfma_f32_16x16x32_bf16 v[16:19], a[72:75], v[72:75], v[16:19]
    v_mfma_f32_16x16x32_bf16 v[20:23], a[76:79], v[72:75], v[20:23]
    v_mfma_f32_16x16x32_bf16 v[32:35], v[72:75], a[200:203], v[32:35]
    v_mfma_f32_16x16x32_bf16 v[36:39], v[72:75], a[204:207], v[36:39]
    ds_read_b128 v[72:75], v107 offset:512
    s_waitcnt lgkmcnt(3)
    v_mfma_f32_16x16x32_bf16 v[24:27], a[72:75], v[76:79], v[24:27]
    v_mfma_f32_16x16x32_bf16 v[28:31], a[76:79], v[76:79], v[28:31]
    v_mfma_f32_16x16x32_bf16 v[40:43], v[76:79], a[200:203], v[40:43]
    v_mfma_f32_16x16x32_bf16 v[44:47], v[76:79], a[204:207], v[44:47]
    ds_read_b128 v[76:79], v107 offset:16896
    s_waitcnt lgkmcnt(3)
    v_mfma_f32_16x16x32_bf16 v[16:19], a[80:83], v[64:67], v[16:19]
    v_mfma_f32_16x16x32_bf16 v[20:23], a[84:87], v[64:67], v[20:23]
    v_mfma_f32_16x16x32_bf16 v[32:35], v[64:67], a[208:211], v[32:35]
    v_mfma_f32_16x16x32_bf16 v[36:39], v[64:67], a[212:215], v[36:39]
    ds_read_b128 v[64:67], v104 offset:768
    s_waitcnt lgkmcnt(3)
    v_mfma_f32_16x16x32_bf16 v[24:27], a[80:83], v[68:71], v[24:27]
    v_mfma_f32_16x16x32_bf16 v[28:31], a[84:87], v[68:71], v[28:31]
    v_mfma_f32_16x16x32_bf16 v[40:43], v[68:71], a[208:211], v[40:43]
    v_mfma_f32_16x16x32_bf16 v[44:47], v[68:71], a[212:215], v[44:47]
    ds_read_b128 v[68:71], v104 offset:17152
    s_waitcnt lgkmcnt(3)
    v_mfma_f32_16x16x32_bf16 v[16:19], a[88:91], v[72:75], v[16:19]
    v_mfma_f32_16x16x32_bf16 v[20:23], a[92:95], v[72:75], v[20:23]
    v_mfma_f32_16x16x32_bf16 v[32:35], v[72:75], a[216:219], v[32:35]
    v_mfma_f32_16x16x32_bf16 v[36:39], v[72:75], a[220:223], v[36:39]
    ds_read_b128 v[72:75], v105 offset:768
    s_waitcnt lgkmcnt(3)
    v_mfma_f32_16x16x32_bf16 v[24:27], a[88:91], v[76:79], v[24:27]
    v_mfma_f32_16x16x32_bf16 v[28:31], a[92:95], v[76:79], v[28:31]
    v_mfma_f32_16x16x32_bf16 v[40:43], v[76:79], a[216:219], v[40:43]
    v_mfma_f32_16x16x32_bf16 v[44:47], v[76:79], a[220:223], v[44:47]
    ds_read_b128 v[76:79], v105 offset:17152
    s_waitcnt lgkmcnt(3)
    v_mfma_f32_16x16x32_bf16 v[16:19], a[96:99], v[64:67], v[16:19]
    v_mfma_f32_16x16x32_bf16 v[20:23], a[100:103], v[64:67], v[20:23]
    v_mfma_f32_16x16x32_bf16 v[32:35], v[64:67], a[224:227], v[32:35]
    v_mfma_f32_16x16x32_bf16 v[36:39], v[64:67], a[228:231], v[36:39]
    ds_read_b128 v[64:67], v106 offset:768
    s_waitcnt lgkmcnt(3)
    v_mfma_f32_16x16x32_bf16 v[24:27], a[96:99], v[68:71], v[24:27]
    s_mov_b32 s60, s47
    s_mov_b32 s61, s48
    s_mov_b32 s51, s50
    v_mfma_f32_16x16x32_bf16 v[28:31], a[100:103], v[68:71], v[28:31]
    v_mfma_f32_16x16x32_bf16 v[40:43], v[68:71], a[224:227], v[40:43]
    s_add_u32 s47, s47, 28672
    s_add_u32 s48, s48, 28672
    v_mfma_f32_16x16x32_bf16 v[44:47], v[68:71], a[228:231], v[44:47]
    ds_read_b128 v[68:71], v106 offset:17152
    s_waitcnt lgkmcnt(3)
    v_mfma_f32_16x16x32_bf16 v[16:19], a[104:107], v[72:75], v[16:19]
    v_mfma_f32_16x16x32_bf16 v[20:23], a[108:111], v[72:75], v[20:23]
    v_mfma_f32_16x16x32_bf16 v[32:35], v[72:75], a[232:235], v[32:35]
    s_add_u32 s50, s50, 4096
    s_add_u32 s44, s44, 1
    v_mfma_f32_16x16x32_bf16 v[36:39], v[72:75], a[236:239], v[36:39]
    ds_read_b128 v[72:75], v107 offset:768
    s_waitcnt lgkmcnt(3)
    v_mfma_f32_16x16x32_bf16 v[24:27], a[104:107], v[76:79], v[24:27]
    v_mfma_f32_16x16x32_bf16 v[28:31], a[108:111], v[76:79], v[28:31]
    v_mfma_f32_16x16x32_bf16 v[40:43], v[76:79], a[232:235], v[40:43]
    s_waitcnt vmcnt(0)
    v_mfma_f32_16x16x32_bf16 v[44:47], v[76:79], a[236:239], v[44:47]
    s_mov_b64 exec, s[54:55]
    ds_add_rtn_u32 v11, v12, v3 offset:4
    s_mov_b64 exec, -1
    ds_read_b128 v[76:79], v107 offset:17152
    s_waitcnt lgkmcnt(3)
    v_mfma_f32_16x16x32_bf16 v[16:19], a[112:115], v[64:67], v[16:19]
    v_mfma_f32_16x16x32_bf16 v[20:23], a[116:119], v[64:67], v[20:23]
    v_mfma_f32_16x16x32_bf16 v[32:35], v[64:67], a[240:243], v[32:35]
    v_mfma_f32_16x16x32_bf16 v[36:39], v[64:67], a[244:247], v[36:39]
    s_waitcnt vmcnt(0) lgkmcnt(0)
    s_barrier
    ds_read_b128 v[64:67], v104 offset:32768
    v_mfma_f32_16x16x32_bf16 v[24:27], a[112:115], v[68:71], v[24:27]
    v_readfirstlane_b32 s3, v11
    s_and_b32 s3, s3, 3
    s_cmp_eq_u32 s3, 3
    s_cselect_b32 s3, s62, s63
    s_nop 1
    buffer_store_dword v3, v7, s[8:11], s3 offen sc1
    v_mfma_f32_16x16x32_bf16 v[28:31], a[116:119], v[68:71], v[28:31]
    v_mfma_f32_16x16x32_bf16 v[40:43], v[68:71], a[240:243], v[40:43]
    v_mfma_f32_16x16x32_bf16 v[44:47], v[68:71], a[244:247], v[44:47]
    ds_read_b128 v[68:71], v104 offset:49152
    v_mfma_f32_16x16x32_bf16 v[16:19], a[120:123], v[72:75], v[16:19]
    s_mov_b32 s62, s51
    s_mov_b64 s[54:55], 1
    v_mfma_f32_16x16x32_bf16 v[20:23], a[124:127], v[72:75], v[20:23]
    v_mfma_f32_16x16x32_bf16 v[32:35], v[72:75], a[248:251], v[32:35]
    v_mfma_f32_16x16x32_bf16 v[36:39], v[72:75], a[252:255], v[36:39]
    ds_read_b128 v[72:75], v105 offset:32768
    v_mfma_f32_16x16x32_bf16 v[24:27], a[120:123], v[76:79], v[24:27]
    v_mfma_f32_16x16x32_bf16 v[28:31], a[124:127], v[76:79], v[28:31]
    v_mfma_f32_16x16x32_bf16 v[40:43], v[76:79], a[248:251], v[40:43]
    v_mfma_f32_16x16x32_bf16 v[44:47], v[76:79], a[252:255], v[44:47]
    v_cmp_eq_u32 vcc, 0, v4
    s_cmp_ge_u32 s44, 63
    s_cbranch_scc1 L_kv1B
    s_cbranch_vccnz L_kv1B
    s_branch L_kv1A
L_kv0B:
    ds_read_b128 v[76:79], v105 offset:16384
    s_waitcnt lgkmcnt(3)
    v_mfma_f32_16x16x32_bf16 v[16:19], a[0:3], v[64:67], 0
    v_mfma_f32_16x16x32_bf16 v[20:23], a[4:7], v[64:67], 0
    v_mfma_f32_16x16x32_bf16 v[32:35], v[64:67], a[128:131], 0
    buffer_load_dword v4, v5, s[8:11], s45 offen sc1
    v_mfma_f32_16x16x32_bf16 v[36:39], v[64:67], a[132:135], 0
    s_mov_b32 s52, 0
    ds_read_b128 v[64:67], v106 offset:0
    s_waitcnt lgkmcnt(3)
    v_mfma_f32_16x16x32_bf16 v[24:27], a[0:3], v[68:71], 0
    v_mfma_f32_16x16x32_bf16 v[28:31], a[4:7], v[68:71], 0
    v_mfma_f32_16x16x32_bf16 v[40:43], v[68:71], a[128:131], 0
    v_mfma_f32_16x16x32_bf16 v[44:47], v[68:71], a[132:135], 0
    ds_read_b128 v[68:71], v106 offset:16384
    s_waitcnt lgkmcnt(3)
    v_mfma_f32_16x16x32_bf16 v[16:19], a[8:11], v[72:75], v[16:19]
    v_cvt_pk_bf16_f32 v88, v112, v116
    v_cvt_pk_bf16_f32 v89, v113, v117
    v_mfma_f32_16x16x32_bf16 v[20:23], a[12:15], v[72:75], v[20:23]
    v_cvt_pk_bf16_f32 v90, v114, v118
    v_cvt_pk_bf16_f32 v91, v115, v119
    v_mfma_f32_16x16x32_bf16 v[32:35], v[72:75], a[136:139], v[32:35]
    buffer_store_dwordx4 v[88:91], v13, s[8:11], s60 offen offset:0 sc1
    v_mfma_f32_16x16x32_bf16 v[36:39], v[72:75], a[140:143], v[36:39]
    ds_read_b128 v[72:75], v107 offset:0
    s_waitcnt lgkmcnt(3)
    v_mfma_f32_16x16x32_bf16 v[24:27], a[8:11], v[76:79], v[24:27]
    v_cvt_pk_bf16_f32 v92, v120, v124
    v_cvt_pk_bf16_f32 v93, v121, v125
    v_mfma_f32_16x16x32_bf16 v[28:31], a[12:15], v[76:79], v[28:31]
    v_cvt_pk_bf16_f32 v94, v122, v126
    v_cvt_pk_bf16_f32 v95, v123, v127
    v_mfma_f32_16x16x32_bf16 v[40:43], v[76:79], a[136:139], v[40:43]
    buffer_store_dwordx4 v[92:95], v13, s[8:11], s60 offen offset:256 sc1
    v_mfma_f32_16x16x32_bf16 v[44:47], v[76:79], a[140:143], v[44:47]
    ds_read_b128 v[76:79], v107 offset:16384
    s_waitcnt lgkmcnt(3)
    v_mfma_f32_16x16x32_bf16 v[16:19], a[16:19], v[64:67], v[16:19]
    v_cvt_pk_bf16_f32 v96, v128, v129
    v_cvt_pk_bf16_f32 v97, v130, v131
    v_mfma_f32_16x16x32_bf16 v[20:23], a[20:23], v[64:67], v[20:23]
    v_cvt_pk_bf16_f32 v98, v136, v137
    v_cvt_pk_bf16_f32 v99, v138, v139
    v_mfma_f32_16x16x32_bf16 v[32:35], v[64:67], a[144:147], v[32:35]
    buffer_store_dwordx4 v[96:99], v13, s[8:11], s61 offen offset:0 sc1
    v_mfma_f32_16x16x32_bf16 v[36:39], v[64:67], a[148:151], v[36:39]
    ds_read_b128 v[64:67], v104 offset:256
    s_waitcnt lgkmcnt(3)
    v_mfma_f32_16x16x32_bf16 v[24:27], a[16:19], v[68:71], v[24:27]
    v_cvt_pk_bf16_f32 v100, v132, v133
    v_cvt_pk_bf16_f32 v101, v134, v135
    v_mfma_f32_16x16x32_bf16 v[28:31], a[20:23], v[68:71], v[28:31]
    v_cvt_pk_bf16_f32 v102, v140, v141
    v_cvt_pk_bf16_f32 v103, v142, v143
    v_mfma_f32_16x16x32_bf16 v[40:43], v[68:71], a[144:147], v[40:43]
    buffer_store_dwordx4 v[100:103], v13, s[8:11], s61 offen offset:256 sc1
    v_mfma_f32_16x16x32_bf16 v[44:47], v[68:71], a[148:151], v[44:47]
    ds_read_b128 v[68:71], v104 offset:16640
    s_waitcnt lgkmcnt(3)
    v_mfma_f32_16x16x32_bf16 v[16:19], a[24:27], v[72:75], v[16:19]
    s_add_u32 s3, s60, s49
    buffer_store_dwordx4 v[48:51], v1, s[8:11], s3 offen sc1
    v_mfma_f32_16x16x32_bf16 v[20:23], a[28:31], v[72:75], v[20:23]
    v_mfma_f32_16x16x32_bf16 v[32:35], v[72:75], a[152:155], v[32:35]
    v_mfma_f32_16x16x32_bf16 v[36:39], v[72:75], a[156:159], v[36:39]
    ds_read_b128 v[72:75], v105 offset:256
    s_waitcnt lgkmcnt(3)
    v_mfma_f32_16x16x32_bf16 v[24:27], a[24:27], v[76:79], v[24:27]
    v_mfma_f32_16x16x32_bf16 v[28:31], a[28:31], v[76:79], v[28:31]
    v_mfma_f32_16x16x32_bf16 v[40:43], v[76:79], a[152:155], v[40:43]
    v_mfma_f32_16x16x32_bf16 v[44:47], v[76:79], a[156:159], v[44:47]
    ds_read_b128 v[76:79], v105 offset:16640
    s_waitcnt lgkmcnt(3)
    v_mfma_f32_16x16x32_bf16 v[16:19], a[32:35], v[64:67], v[16:19]
    v_mfma_f32_16x16x32_bf16 v[20:23], a[36:39], v[64:67], v[20:23]
    v_mfma_f32_16x16x32_bf16 v[32:35], v[64:67], a[160:163], v[32:35]
    v_mfma_f32_16x16x32_bf16 v[36:39], v[64:67], a[164:167], v[36:39]
    ds_read_b128 v[64:67], v106 offset:256
    s_waitcnt lgkmcnt(3)
    v_mfma_f32_16x16x32_bf16 v[24:27], a[32:35], v[68:71], v[24:27]
    v_mfma_f32_16x16x32_bf16 v[28:31], a[36:39], v[68:71], v[28:31]
    v_mfma_f32_16x16x32_bf16 v[40:43], v[68:71], a[160:163], v[40:43]
    v_mfma_f32_16x16x32_bf16 v[44:47], v[68:71], a[164:167], v[44:47]
    ds_read_b128 v[68:71], v106 offset:16640
    s_waitcnt lgkmcnt(3)
    v_mfma_f32_16x16x32_bf16 v[16:19], a[40:43], v[72:75], v[16:19]
    v_mfma_f32_16x16x32_bf16 v[20:23], a[44:47], v[72:75], v[20:23]
    v_mfma_f32_16x16x32_bf16 v[32:35], v[72:75], a[168:171], v[32:35]
    v_mfma_f32_16x16x32_bf16 v[36:39], v[72:75], a[172:175], v[36:39]
    ds_read_b128 v[72:75], v107 offset:256
    s_waitcnt lgkmcnt(3)
    v_mfma_f32_16x16x32_bf16 v[24:27], a[40:43], v[76:79], v[24:27]
    v_mfma_f32_16x16x32_bf16 v[28:31], a[44:47], v[76:79], v[28:31]
    v_mfma_f32_16x16x32_bf16 v[40:43], v[76:79], a[168:171], v[40:43]
    v_mfma_f32_16x16x32_bf16 v[44:47], v[76:79], a[172:175], v[44:47]
    s_waitcnt vmcnt(5)
    v_cmp_eq_u32 vcc, 0, v4
    s_cmp_ge_u32 s44, 63
    s_cbranch_scc1 Lq_24
    s_cbranch_vccnz Lq_24
    s_add_u32 m0, s53, 32768
    s_add_u32 s3, s46, 4096
    buffer_load_dwordx4 v1, s[8:11], s46 offen offset:0 sc1 lds
    buffer_load_dwordx4 v1, s[8:11], s46 offen offset:1024 sc1 lds
    buffer_load_dwordx4 v1, s[8:11], s46 offen offset:2048 sc1 lds
    buffer_load_dwordx4 v1, s[8:11], s46 offen offset:3072 sc1 lds
    s_add_u32 m0, s53, 36864
    s_add_u32 s45, s45, 128
    buffer_load_dwordx4 v1, s[8:11], s3 offen offset:0 sc1 lds
    buffer_load_dwordx4 v1, s[8:11], s3 offen offset:1024 sc1 lds
    buffer_load_dwordx4 v1, s[8:11], s3 offen offset:2048 sc1 lds
    buffer_load_dwordx4 v1, s[8:11], s3 offen offset:3072 sc1 lds
    s_add_u32 s46, s46, 32768
    s_mov_b32 s52, 1
Lq_24:
Lq_24x:
    ds_read_b128 v[76:79], v107 offset:16640
    s_waitcnt lgkmcnt(3)
    v_mfma_f32_16x16x32_bf16 v[16:19], a[48:51], v[64:67], v[16:19]
    v_mfma_f32_16x16x32_bf16 v[20:23], a[52:55], v[64:67], v[20:23]
    v_mfma_f32_16x16x32_bf16 v[32:35], v[64:67], a[176:179], v[32:35]
    v_mfma_f32_16x16x32_bf16 v[36:39], v[64:67], a[180:183], v[36:39]
    ds_read_b128 v[64:67], v104 offset:512
    s_waitcnt lgkmcnt(3)
    v_mfma_f32_16x16x32_bf16 v[24:27], a[48:51], v[68:71], v[24:27]
    v_mfma_f32_16x16x32_bf16 v[28:31], a[52:55], v[68:71], v[28:31]
    v_mfma_f32_16x16x32_bf16 v[40:43], v[68:71], a[176:179], v[40:43]
    v_mfma_f32_16x16x32_bf16 v[44:47], v[68:71], a[180:183], v[44:47]
    ds_read_b128 v[68:71], v104 offset:16896
    s_waitcnt lgkmcnt(3)
    v_mfma_f32_16x16x32_bf16 v[16:19], a[56:59], v[72:75], v[16:19]
    v_mfma_f32_16x16x32_bf16 v[20:23], a[60:63], v[72:75], v[20:23]
    v_mfma_f32_16x16x32_bf16 v[32:35], v[72:75], a[184:187], v[32:35]
    v_mfma_f32_16x16x32_bf16 v[36:39], v[72:75], a[188:191], v[36:39]
    ds_read_b128 v[72:75], v105 offset:512
    s_waitcnt lgkmcnt(3)
    v_mfma_f32_16x16x32_bf16 v[24:27], a[56:59], v[76:79], v[24:27]
    v_mfma_f32_16x16x32_bf16 v[28:31], a[60:63], v[76:79], v[28:31]
    v_mfma_f32_16x16x32_bf16 v[40:43], v[76:79], a[184:187], v[40:43]
    v_mfma_f32_16x16x32_bf16 v[44:47], v[76:79], a[188:191], v[44:47]
    ds_read_b128 v[76:79], v105 offset:16896
    s_waitcnt lgkmcnt(3)
    v_mfma_f32_16x16x32_bf16 v[16:19], a[64:67], v[64:67], v[16:19]
    v_mfma_f32_16x16x32_bf16 v[20:23], a[68:71], v[64:67], v[20:23]
    v_mfma_f32_16x16x32_bf16 v[32:35], v[64:67], a[192:195], v[32:35]
    v_mfma_f32_16x16x32_bf16 v[36:39], v[64:67], a[196:199], v[36:39]
    ds_read_b128 v[64:67], v106 offset:512
    s_waitcnt lgkmcnt(3)
    v_mfma_f32_16x16x32_bf16 v[24:27], a[64:67], v[68:71], v[24:27]
    v_mfma_f32_16x16x32_bf16 v[28:31], a[68:71], v[68:71], v[28:31]
    v_mfma_f32_16x16x32_bf16 v[40:43], v[68:71], a[192:195], v[40:43]
    v_mfma_f32_16x16x32_bf16 v[44:47], v[68:71], a[196:199], v[44:47]
    ds_read_b128 v[68:71], v106 offset:16896
    s_waitcnt lgkmcnt(3)
    v_mfma_f32_16x16x32_bf16 v[16:19], a[72:75], v[72:75], v[16:19]
    v_mfma_f32_16x16x32_bf16 v[20:23], a[76:79], v[72:75], v[20:23]
    v_mfma_f32_16x16x32_bf16 v[32:35], v[72:75], a[200:203], v[32:35]
    v_mfma_f32_16x16x32_bf16 v[36:39], v[72:75], a[204:207], v[36:39]
    ds_read_b128 v[72:75], v107 offset:512
    s_waitcnt lgkmcnt(3)
    v_mfma_f32_16x16x32_bf16 v[24:27], a[72:75], v[76:79], v[24:27]
    buffer_load_dword v4, v5, s[8:11], s45 offen sc1
    v_mfma_f32_16x16x32_bf16 v[28:31], a[76:79], v[76:79], v[28:31]
    v_mfma_f32_16x16x32_bf16 v[40:43], v[76:79], a[200:203], v[40:43]
    v_mfma_f32_16x16x32_bf16 v[44:47], v[76:79], a[204:207], v[44:47]
    ds_read_b128 v[76:79], v107 offset:16896
    s_waitcnt lgkmcnt(3)
    v_mfma_f32_16x16x32_bf16 v[16:19], a[80:83], v[64:67], v[16:19]
    v_mfma_f32_16x16x32_bf16 v[20:23], a[84:87], v[64:67], v[20:23]
    v_mfma_f32_16x16x32_bf16 v[32:35], v[64:67], a[208:211], v[32:35]
    v_mfma_f32_16x16x32_bf16 v[36:39], v[64:67], a[212:215], v[36:39]
    ds_read_b128 v[64:67], v104 offset:768
    s_waitcnt lgkmcnt(3)
    v_mfma_f32_16x16x32_bf16 v[24:27], a[80:83], v[68:71], v[24:27]
    v_mfma_f32_16x16x32_bf16 v[28:31], a[84:87], v[68:71], v[28:31]
    v_mfma_f32_16x16x32_bf16 v[40:43], v[68:71], a[208:211], v[40:43]
    v_mfma_f32_16x16x32_bf16 v[44:47], v[68:71], a[212:215], v[44:47]
    ds_read_b128 v[68:71], v104 offset:17152
    s_waitcnt lgkmcnt(3)
    v_mfma_f32_16x16x32_bf16 v[16:19], a[88:91], v[72:75], v[16:19]
    v_mfma_f32_16x16x32_bf16 v[20:23], a[92:95], v[72:75], v[20:23]
    v_mfma_f32_16x16x32_bf16 v[32:35], v[72:75], a[216:219], v[32:35]
    v_mfma_f32_16x16x32_bf16 v[36:39], v[72:75], a[220:223], v[36:39]
    ds_read_b128 v[72:75], v105 offset:768
    s_waitcnt lgkmcnt(3)
    v_mfma_f32_16x16x32_bf16 v[24:27], a[88:91], v[76:79], v[24:27]
    v_mfma_f32_16x16x32_bf16 v[28:31], a[92:95], v[76:79], v[28:31]
    v_mfma_f32_16x16x32_bf16 v[40:43], v[76:79], a[216:219], v[40:43]
    v_mfma_f32_16x16x32_bf16 v[44:47], v[76:79], a[220:223], v[44:47]
    ds_read_b128 v[76:79], v105 offset:17152
    s_waitcnt lgkmcnt(3)
    v_mfma_f32_16x16x32_bf16 v[16:19], a[96:99], v[64:67], v[16:19]
    v_mfma_f32_16x16x32_bf16 v[20:23], a[100:103], v[64:67], v[20:23]
    v_mfma_f32_16x16x32_bf16 v[32:35], v[64:67], a[224:227], v[32:35]
    v_mfma_f32_16x16x32_bf16 v[36:39], v[64:67], a[228:231], v[36:39]
    s_cmp_lg_u32 s52, 0
    s_cbranch_scc0 Lq_25a
    s_waitcnt vmcnt(9)
    s_mov_b64 exec, s[54:55]
    ds_add_rtn_u32 v11, v12, v3 offset:4
    s_mov_b64 exec, -1
    s_branch Lq_25x
Lq_25a:
    s_waitcnt vmcnt(0)
    s_mov_b64 exec, s[54:55]
    ds_add_rtn_u32 v11, v12, v3 offset:4
    s_mov_b64 exec, -1
    v_cmp_eq_u32 vcc, 0, v4
    s_cmp_ge_u32 s44, 63
    s_cbranch_scc1 Lq_25
    s_cbranch_vccnz Lq_25
    s_add_u32 m0, s53, 32768
    s_add_u32 s3, s46, 4096
    buffer_load_dwordx4 v1, s[8:11], s46 offen offset:0 sc1 lds
    buffer_load_dwordx4 v1, s[8:11], s46 offen offset:1024 sc1 lds
    buffer_load_dwordx4 v1, s[8:11], s46 offen offset:2048 sc1 lds
    buffer_load_dwordx4 v1, s[8:11], s46 offen offset:3072 sc1 lds
    s_add_u32 m0, s53, 36864
    s_add_u32 s45, s45, 128
    buffer_load_dwordx4 v1, s[8:11], s3 offen offset:0 sc1 lds
    buffer_load_dwordx4 v1, s[8:11], s3 offen offset:1024 sc1 lds
    buffer_load_dwordx4 v1, s[8:11], s3 offen offset:2048 sc1 lds
    buffer_load_dwordx4 v1, s[8:11], s3 offen offset:3072 sc1 lds
    s_add_u32 s46, s46, 32768
    s_mov_b32 s52, 2
Lq_25:
Lq_25x:
    ds_read_b128 v[64:67], v106 offset:768
    s_waitcnt lgkmcnt(3)
    v_mfma_f32_16x16x32_bf16 v[24:27], a[96:99], v[68:71], v[24:27]
    s_mov_b32 s60, s47
    s_mov_b32 s61, s48
    s_mov_b32 s51, s50
    v_mfma_f32_16x16x32_bf16 v[28:31], a[100:103], v[68:71], v[28:31]
    v_mfma_f32_16x16x32_bf16 v[40:43], v[68:71], a[224:227], v[40:43]
    s_add_u32 s47, s47, 28672
    s_add_u32 s48, s48, 28672
    v_mfma_f32_16x16x32_bf16 v[44:47], v[68:71], a[228:231], v[44:47]
    ds_read_b128 v[68:71], v106 offset:17152
    s_waitcnt lgkmcnt(3)
    v_mfma_f32_16x16x32_bf16 v[16:19], a[104:107], v[72:75], v[16:19]
    v_mfma_f32_16x16x32_bf16 v[20:23], a[108:111], v[72:75], v[20:23]
    v_mfma_f32_16x16x32_bf16 v[32:35], v[72:75], a[232:235], v[32:35]
    s_add_u32 s50, s50, 4096
    s_add_u32 s44, s44, 1
    v_mfma_f32_16x16x32_bf16 v[36:39], v[72:75], a[236:239], v[36:39]
    ds_read_b128 v[72:75], v107 offset:768
    s_waitcnt lgkmcnt(3)
    v_mfma_f32_16x16x32_bf16 v[24:27], a[104:107], v[76:79], v[24:27]
    v_mfma_f32_16x16x32_bf16 v[28:31], a[108:111], v[76:79], v[28:31]
    v_mfma_f32_16x16x32_bf16 v[40:43], v[76:79], a[232:235], v[40:43]
    v_mfma_f32_16x16x32_bf16 v[44:47], v[76:79], a[236:239], v[44:47]
    ds_read_b128 v[76:79], v107 offset:17152
    s_waitcnt lgkmcnt(3)
    v_mfma_f32_16x16x32_bf16 v[16:19], a[112:115], v[64:67], v[16:19]
    v_readfirstlane_b32 s3, v11
    s_and_b32 s3, s3, 3
    s_cmp_eq_u32 s3, 3
    s_cselect_b32 s3, s62, s63
    s_nop 1
    buffer_store_dword v3, v7, s[8:11], s3 offen sc1
    v_mfma_f32_16x16x32_bf16 v[20:23], a[116:119], v[64:67], v[20:23]
    v_mfma_f32_16x16x32_bf16 v[32:35], v[64:67], a[240:243], v[32:35]
    s_mov_b32 s62, s51
    s_mov_b64 s[54:55], 1
    v_mfma_f32_16x16x32_bf16 v[36:39], v[64:67], a[244:247], v[36:39]
    s_cmp_lg_u32 s52, 1
    s_cbranch_scc1 L_kv0T
    s_waitcnt vmcnt(1) lgkmcnt(0)
    s_barrier
    ds_read_b128 v[64:67], v104 offset:32768
    v_mfma_f32_16x16x32_bf16 v[24:27], a[112:115], v[68:71], v[24:27]
    v_mfma_f32_16x16x32_bf16 v[28:31], a[116:119], v[68:71], v[28:31]
    v_mfma_f32_16x16x32_bf16 v[40:43], v[68:71], a[240:243], v[40:43]
    v_mfma_f32_16x16x32_bf16 v[44:47], v[68:71], a[244:247], v[44:47]
    ds_read_b128 v[68:71], v104 offset:49152
    v_mfma_f32_16x16x32_bf16 v[16:19], a[120:123], v[72:75], v[16:19]
    v_mfma_f32_16x16x32_bf16 v[20:23], a[124:127], v[72:75], v[20:23]
    v_mfma_f32_16x16x32_bf16 v[32:35], v[72:75], a[248:251], v[32:35]
    v_mfma_f32_16x16x32_bf16 v[36:39], v[72:75], a[252:255], v[36:39]
    ds_read_b128 v[72:75], v105 offset:32768
    v_mfma_f32_16x16x32_bf16 v[24:27], a[120:123], v[76:79], v[24:27]
    v_mfma_f32_16x16x32_bf16 v[28:31], a[124:127], v[76:79], v[28:31]
    v_mfma_f32_16x16x32_bf16 v[40:43], v[76:79], a[248:251], v[40:43]
    v_mfma_f32_16x16x32_bf16 v[44:47], v[76:79], a[252:255], v[44:47]
    v_cmp_eq_u32 vcc, 0, v4
    s_cmp_ge_u32 s44, 63
    s_cbranch_scc1 L_kv1B
    s_cbranch_vccnz L_kv1B
    s_branch L_kv1A
L_kv0T:
    s_waitcnt lgkmcnt(0)
    buffer_load_dword v4, v5, s[8:11], s45 offen sc1
    v_mfma_f32_16x16x32_bf16 v[24:27], a[112:115], v[68:71], v[24:27]
    v_mfma_f32_16x16x32_bf16 v[28:31], a[116:119], v[68:71], v[28:31]
    v_mfma_f32_16x16x32_bf16 v[40:43], v[68:71], a[240:243], v[40:43]
    v_mfma_f32_16x16x32_bf16 v[44:47], v[68:71], a[244:247], v[44:47]
    v_mfma_f32_16x16x32_bf16 v[16:19], a[120:123], v[72:75], v[16:19]
    v_mfma_f32_16x16x32_bf16 v[20:23], a[124:127], v[72:75], v[20:23]
    v_mfma_f32_16x16x32_bf16 v[32:35], v[72:75], a[248:251], v[32:35]
    v_mfma_f32_16x16x32_bf16 v[36:39], v[72:75], a[252:255], v[36:39]
    v_mfma_f32_16x16x32_bf16 v[24:27], a[120:123], v[76:79], v[24:27]
    v_mfma_f32_16x16x32_bf16 v[28:31], a[124:127], v[76:79], v[28:31]
    v_mfma_f32_16x16x32_bf16 v[40:43], v[76:79], a[248:251], v[40:43]
    v_mfma_f32_16x16x32_bf16 v[44:47], v[76:79], a[252:255], v[44:47]
    s_nop 1
    v_cvt_pk_bf16_f32 v88, v16, v20
    v_cvt_pk_bf16_f32 v89, v17, v21
    v_cvt_pk_bf16_f32 v90, v18, v22
    v_cvt_pk_bf16_f32 v91, v19, v23
    buffer_store_dwordx4 v[88:91], v13, s[8:11], s60 offen offset:0 sc1
    v_cvt_pk_bf16_f32 v92, v24, v28
    v_cvt_pk_bf16_f32 v93, v25, v29
    v_cvt_pk_bf16_f32 v94, v26, v30
    v_cvt_pk_bf16_f32 v95, v27, v31
    buffer_store_dwordx4 v[92:95], v13, s[8:11], s60 offen offset:256 sc1
    v_cvt_pk_bf16_f32 v96, v32, v33
    v_cvt_pk_bf16_f32 v97, v34, v35
    v_cvt_pk_bf16_f32 v98, v40, v41
    v_cvt_pk_bf16_f32 v99, v42, v43
    buffer_store_dwordx4 v[96:99], v13, s[8:11], s61 offen offset:0 sc1
    v_cvt_pk_bf16_f32 v100, v36, v37
    v_cvt_pk_bf16_f32 v101, v38, v39
    v_cvt_pk_bf16_f32 v102, v44, v45
    v_cvt_pk_bf16_f32 v103, v46, v47
    buffer_store_dwordx4 v[100:103], v13, s[8:11], s61 offen offset:256 sc1
    s_add_u32 s3, s60, s49
    buffer_store_dwordx4 v[48:51], v1, s[8:11], s3 offen sc1
    s_cmp_eq_u32 s52, 2
    s_cbranch_scc0 L_kv0X
    s_waitcnt vmcnt(0)
    s_branch L_kv0Y
L_kv0X:
    s_waitcnt vmcnt(5)
    v_cmp_eq_u32 vcc, 0, v4
    s_cmp_ge_u32 s44, 64
    s_cbranch_scc1 L_kv0U
    s_cbranch_vccnz L_kv0U
    s_add_u32 m0, s53, 32768
    s_add_u32 s3, s46, 4096
    buffer_load_dwordx4 v1, s[8:11], s46 offen offset:0 sc1 lds
    buffer_load_dwordx4 v1, s[8:11], s46 offen offset:1024 sc1 lds
    buffer_load_dwordx4 v1, s[8:11], s46 offen offset:2048 sc1 lds
    buffer_load_dwordx4 v1, s[8:11], s46 offen offset:3072 sc1 lds
    s_add_u32 m0, s53, 36864
    s_add_u32 s45, s45, 128
    buffer_load_dwordx4 v1, s[8:11], s3 offen offset:0 sc1 lds
    buffer_load_dwordx4 v1, s[8:11], s3 offen offset:1024 sc1 lds
    buffer_load_dwordx4 v1, s[8:11], s3 offen offset:2048 sc1 lds
    buffer_load_dwordx4 v1, s[8:11], s3 offen offset:3072 sc1 lds
    s_add_u32 s46, s46, 32768
    buffer_load_dword v4, v5, s[8:11], s45 offen sc1
    s_waitcnt vmcnt(9)
L_kv0Y:
    s_mov_b64 exec, s[54:55]
    ds_add_rtn_u32 v11, v12, v3 offset:0
    s_mov_b64 exec, -1
    s_waitcnt lgkmcnt(0)
    v_readfirstlane_b32 s3, v11
    s_and_b32 s3, s3, 3
    s_cmp_eq_u32 s3, 3
    s_cselect_b32 s3, s62, s63
    s_nop 1
    buffer_store_dword v3, v7, s[8:11], s3 offen sc1
    s_mov_b32 s60, s63
    s_mov_b32 s61, s63
    s_mov_b32 s62, s63
    s_mov_b64 s[54:55], 0
    s_waitcnt vmcnt(1)
    s_branch L_kv0V
L_kv0U:
    s_waitcnt vmcnt(0)
    buffer_load_dword v4, v5, s[8:11], s45 offen sc1
    s_mov_b64 exec, s[54:55]
    ds_add_rtn_u32 v11, v12, v3 offset:0
    s_mov_b64 exec, -1
    s_waitcnt lgkmcnt(0)
    v_readfirstlane_b32 s3, v11
    s_and_b32 s3, s3, 3
    s_cmp_eq_u32 s3, 3
    s_cselect_b32 s3, s62, s63
    s_nop 1
    buffer_store_dword v3, v7, s[8:11], s3 offen sc1
    s_cmp_ge_u32 s44, 64
    s_cbranch_scc1 L_end
    s_waitcnt vmcnt(1)
L_kv0W:
    s_mov_b32 s60, s63
    s_mov_b32 s61, s63
    s_mov_b32 s62, s63
    s_mov_b64 s[54:55], 0
    v_cmp_eq_u32 vcc, 0, v4
    s_cbranch_vccz Lq_26
Lw_27:
    buffer_load_dword v4, v5, s[8:11], s45 offen offset:0 sc1
    s_waitcnt vmcnt(0)
    v_cmp_eq_u32 vcc, 0, v4
    s_cbranch_vccz Lwd_28
    s_sleep 1
    s_sub_u32 s98, s98, 1
    s_cbranch_scc1 L_end
    s_branch Lw_27
Lwd_28:
Lq_26:
    s_add_u32 m0, s53, 32768
    s_add_u32 s3, s46, 4096
    buffer_load_dwordx4 v1, s[8:11], s46 offen offset:0 sc1 lds
    buffer_load_dwordx4 v1, s[8:11], s46 offen offset:1024 sc1 lds
    buffer_load_dwordx4 v1, s[8:11], s46 offen offset:2048 sc1 lds
    buffer_load_dwordx4 v1, s[8:11], s46 offen offset:3072 sc1 lds
    s_add_u32 m0, s53, 36864
    s_add_u32 s45, s45, 128
    buffer_load_dwordx4 v1, s[8:11], s3 offen offset:0 sc1 lds
    buffer_load_dwordx4 v1, s[8:11], s3 offen offset:1024 sc1 lds
    buffer_load_dwordx4 v1, s[8:11], s3 offen offset:2048 sc1 lds
    buffer_load_dwordx4 v1, s[8:11], s3 offen offset:3072 sc1 lds
    s_add_u32 s46, s46, 32768
    buffer_load_dword v4, v5, s[8:11], s45 offen sc1
    s_waitcnt vmcnt(0)
L_kv0V:
    s_barrier
    ds_read_b128 v[64:67], v104 offset:32768
    ds_read_b128 v[68:71], v104 offset:49152
    ds_read_b128 v[72:75], v105 offset:32768
    v_cmp_eq_u32 vcc, 0, v4
    s_cmp_ge_u32 s44, 63
    s_cbranch_scc1 L_kv1B
    s_cbranch_vccnz L_kv1B
    s_branch L_kv1A
L_kv1A:
    ds_read_b128 v[76:79], v105 offset:49152
    s_waitcnt lgkmcnt(3)
    v_mfma_f32_16x16x32_bf16 v[112:115], a[0:3], v[64:67], 0
    s_add_u32 m0, s53, 0
    s_add_u32 s3, s46, 4096
    buffer_load_dwordx4 v1, s[8:11], s46 offen offset:0 sc1 lds
    v_mfma_f32_16x16x32_bf16 v[116:119], a[4:7], v[64:67], 0
    v_mfma_f32_16x16x32_bf16 v[128:131], v[64:67], a[128:131], 0
    buffer_load_dwordx4 v1, s[8:11], s46 offen offset:1024 sc1 lds
    v_mfma_f32_16x16x32_bf16 v[132:135], v[64:67], a[132:135], 0
    ds_read_b128 v[64:67], v106 offset:32768
    s_waitcnt lgkmcnt(3)
    v_mfma_f32_16x16x32_bf16 v[120:123], a[0:3], v[68:71], 0
    buffer_load_dwordx4 v1, s[8:11], s46 offen offset:2048 sc1 lds
    v_mfma_f32_16x16x32_bf16 v[124:127], a[4:7], v[68:71], 0
    v_mfma_f32_16x16x32_bf16 v[136:139], v[68:71], a[128:131], 0
    buffer_load_dwordx4 v1, s[8:11], s46 offen offset:3072 sc1 lds
    v_mfma_f32_16x16x32_bf16 v[140:143], v[68:71], a[132:135], 0
    ds_read_b128 v[68:71], v106 offset:49152
    s_waitcnt lgkmcnt(3)
    v_mfma_f32_16x16x32_bf16 v[112:115], a[8:11], v[72:75], v[112:115]
    s_add_u32 m0, s53, 4096
    s_add_u32 s45, s45, 128
    buffer_load_dwordx4 v1, s[8:11], s3 offen offset:0 sc1 lds
    v_mfma_f32_16x16x32_bf16 v[116:119], a[12:15], v[72:75], v[116:119]
    v_mfma_f32_16x16x32_bf16 v[128:131], v[72:75], a[136:139], v[128:131]
    buffer_load_dwordx4 v1, s[8:11], s3 offen offset:1024 sc1 lds
    v_mfma_f32_16x16x32_bf16 v[132:135], v[72:75], a[140:143], v[132:135]
    ds_read_b128 v[72:75], v107 offset:32768
    s_waitcnt lgkmcnt(3)
    v_mfma_f32_16x16x32_bf16 v[120:123], a[8:11], v[76:79], v[120:123]
    buffer_load_dwordx4 v1, s[8:11], s3 offen offset:2048 sc1 lds
    v_mfma_f32_16x16x32_bf16 v[124:127], a[12:15], v[76:79], v[124:127]
    v_mfma_f32_16x16x32_bf16 v[136:139], v[76:79], a[136:139], v[136:139]
    buffer_load_dwordx4 v1, s[8:11], s3 offen offset:3072 sc1 lds
    s_add_u32 s46, s46, 32768
    v_mfma_f32_16x16x32_bf16 v[140:143], v[76:79], a[140:143], v[140:143]
    ds_read_b128 v[76:79], v107 offset:49152
    s_waitcnt lgkmcnt(3)
    v_mfma_f32_16x16x32_bf16 v[112:115], a[16:19], v[64:67], v[112:115]
    buffer_load_dword v4, v5, s[8:11], s45 offen sc1
    v_mfma_f32_16x16x32_bf16 v[116:119], a[20:23], v[64:67], v[116:119]
    v_mfma_f32_16x16x32_bf16 v[128:131], v[64:67], a[144:147], v[128:131]
    v_cvt_pk_bf16_f32 v88, v16, v20
    v_cvt_pk_bf16_f32 v89, v17, v21
    v_mfma_f32_16x16x32_bf16 v[132:135], v[64:67], a[148:151], v[132:135]
    v_cvt_pk_bf16_f32 v90, v18, v22
    v_cvt_pk_bf16_f32 v91, v19, v23
    ds_read_b128 v[64:67], v104 offset:33024
    s_waitcnt lgkmcnt(3)
    v_mfma_f32_16x16x32_bf16 v[120:123], a[16:19], v[68:71], v[120:123]
    buffer_store_dwordx4 v[88:91], v13, s[8:11], s60 offen offset:0 sc1
    v_mfma_f32_16x16x32_bf16 v[124:127], a[20:23], v[68:71], v[124:127]
    v_mfma_f32_16x16x32_bf16 v[136:139], v[68:71], a[144:147], v[136:139]
    v_cvt_pk_bf16_f32 v92, v24, v28
    v_cvt_pk_bf16_f32 v93, v25, v29
    v_mfma_f32_16x16x32_bf16 v[140:143], v[68:71], a[148:151], v[140:143]
    v_cvt_pk_bf16_f32 v94, v26, v30
    v_cvt_pk_bf16_f32 v95, v27, v31
    ds_read_b128 v[68:71], v104 offset:49408
    s_waitcnt lgkmcnt(3)
    v_mfma_f32_16x16x32_bf16 v[112:115], a[24:27], v[72:75], v[112:115]
    buffer_store_dwordx4 v[92:95], v13, s[8:11], s60 offen offset:256 sc1
    v_mfma_f32_16x16x32_bf16 v[116:119], a[28:31], v[72:75], v[116:119]
    v_mfma_f32_16x16x32_bf16 v[128:131], v[72:75], a[152:155], v[128:131]
    v_cvt_pk_bf16_f32 v96, v32, v33
    v_cvt_pk_bf16_f32 v97, v34, v35
    v_mfma_f32_16x16x32_bf16 v[132:135], v[72:75], a[156:159], v[132:135]
    v_cvt_pk_bf16_f32 v98, v40, v41
    v_cvt_pk_bf16_f32 v99, v42, v43
    ds_read_b128 v[72:75], v105 offset:33024
    s_waitcnt lgkmcnt(3)
    v_mfma_f32_16x16x32_bf16 v[120:123], a[24:27], v[76:79], v[120:123]
    buffer_store_dwordx4 v[96:99], v13, s[8:11], s61 offen offset:0 sc1
    v_mfma_f32_16x16x32_bf16 v[124:127], a[28:31], v[76:79], v[124:127]
    v_mfma_f32_16x16x32_bf16 v[136:139], v[76:79], a[152:155], v[136:139]
    v_cvt_pk_bf16_f32 v100, v36, v37
    v_cvt_pk_bf16_f32 v101, v38, v39
    v_mfma_f32_16x16x32_bf16 v[140:143], v[76:79], a[156:159], v[140:143]
    v_cvt_pk_bf16_f32 v102, v44, v45
    v_cvt_pk_bf16_f32 v103, v46, v47
    ds_read_b128 v[76:79], v105 offset:49408
    s_waitcnt lgkmcnt(3)
    v_mfma_f32_16x16x32_bf16 v[112:115], a[32:35], v[64:67], v[112:115]
    buffer_store_dwordx4 v[100:103], v13, s[8:11], s61 offen offset:256 sc1
    v_mfma_f32_16x16x32_bf16 v[116:119], a[36:39], v[64:67], v[116:119]
    v_mfma_f32_16x16x32_bf16 v[128:131], v[64:67], a[160:163], v[128:131]
    s_add_u32 s3, s60, s49
    buffer_store_dwordx4 v[48:51], v1, s[8:11], s3 offen sc1
    v_mfma_f32_16x16x32_bf16 v[132:135], v[64:67], a[164:167], v[132:135]
    ds_read_b128 v[64:67], v106 offset:33024
    s_waitcnt lgkmcnt(3)
    v_mfma_f32_16x16x32_bf16 v[120:123], a[32:35], v[68:71], v[120:123]
    v_mfma_f32_16x16x32_bf16 v[124:127], a[36:39], v[68:71], v[124:127]
    v_mfma_f32_16x16x32_bf16 v[136:139], v[68:71], a[160:163], v[136:139]
    v_mfma_f32_16x16x32_bf16 v[140:143], v[68:71], a[164:167], v[140:143]
    ds_read_b128 v[68:71], v106 offset:49408
    s_waitcnt lgkmcnt(3)
    v_mfma_f32_16x16x32_bf16 v[112:115], a[40:43], v[72:75], v[112:115]
    v_mfma_f32_16x16x32_bf16 v[116:119], a[44:47], v[72:75], v[116:119]
    v_mfma_f32_16x16x32_bf16 v[128:131], v[72:75], a[168:171], v[128:131]
    v_mfma_f32_16x16x32_bf16 v[132:135], v[72:75], a[172:175], v[132:135]
    ds_read_b128 v[72:75], v107 offset:33024
    s_waitcnt lgkmcnt(3)
    v_mfma_f32_16x16x32_bf16 v[120:123], a[40:43], v[76:79], v[120:123]
    v_mfma_f32_16x16x32_bf16 v[124:127], a[44:47], v[76:79], v[124:127]
    v_mfma_f32_16x16x32_bf16 v[136:139], v[76:79], a[168:171], v[136:139]
    v_mfma_f32_16x16x32_bf16 v[140:143], v[76:79], a[172:175], v[140:143]
    ds_read_b128 v[76:79], v107 offset:49408
    s_waitcnt lgkmcnt(3)
    v_mfma_f32_16x16x32_bf16 v[112:115], a[48:51], v[64:67], v[112:115]
    v_mfma_f32_16x16x32_bf16 v[116:119], a[52:55], v[64:67], v[116:119]
    v_mfma_f32_16x16x32_bf16 v[128:131], v[64:67], a[176:179], v[128:131]
    v_mfma_f32_16x16x32_bf16 v[132:135], v[64:67], a[180:183], v[132:135]
    ds_read_b128 v[64:67], v104 offset:33280
    s_waitcnt lgkmcnt(3)
    v_mfma_f32_16x16x32_bf16 v[120:123], a[48:51], v[68:71], v[120:123]
    v_mfma_f32_16x16x32_bf16 v[124:127], a[52:55], v[68:71], v[124:127]
    v_mfma_f32_16x16x32_bf16 v[136:139], v[68:71], a[176:179], v[136:139]
    v_mfma_f32_16x16x32_bf16 v[140:143], v[68:71], a[180:183], v[140:143]
    ds_read_b128 v[68:71], v104 offset:49664
    s_waitcnt lgkmcnt(3)
    v_mfma_f32_16x16x32_bf16 v[112:115], a[56:59], v[72:75], v[112:115]
    v_mfma_f32_16x16x32_bf16 v[116:119], a[60:63], v[72:75], v[116:119]
    v_mfma_f32_16x16x32_bf16 v[128:131], v[72:75], a[184:187], v[128:131]
    v_mfma_f32_16x16x32_bf16 v[132:135], v[72:75], a[188:191], v[132:135]
    ds_read_b128 v[72:75], v105 offset:33280
    s_waitcnt lgkmcnt(3)
    v_mfma_f32_16x16x32_bf16 v[120:123], a[56:59], v[76:79], v[120:123]
    v_mfma_f32_16x16x32_bf16 v[124:127], a[60:63], v[76:79], v[124:127]
    v_mfma_f32_16x16x32_bf16 v[136:139], v[76:79], a[184:187], v[136:139]
    v_mfma_f32_16x16x32_bf16 v[140:143], v[76:79], a[188:191], v[140:143]
    ds_read_b128 v[76:79], v105 offset:49664
    s_waitcnt lgkmcnt(3)
    v_mfma_f32_16x16x32_bf16 v[112:115], a[64:67], v[64:67], v[112:115]
    v_mfma_f32_16x16x32_bf16 v[116:119], a[68:71], v[64:67], v[116:119]
    v_mfma_f32_16x16x32_bf16 v[128:131], v[64:67], a[192:195], v[128:131]
    v_mfma_f32_16x16x32_bf16 v[132:135], v[64:67], a[196:199], v[132:135]
    ds_read_b128 v[64:67], v106 offset:33280
    s_waitcnt lgkmcnt(3)
    v_mfma_f32_16x16x32_bf16 v[120:123], a[64:67], v[68:71], v[120:123]
    v_mfma_f32_16x16x32_bf16 v[124:127], a[68:71], v[68:71], v[124:127]
    v_mfma_f32_16x16x32_bf16 v[136:139], v[68:71], a[192:195], v[136:139]
    v_mfma_f32_16x16x32_bf16 v[140:143], v[68:71], a[196:199], v[140:143]
    ds_read_b128 v[68:71], v106 offset:49664
    s_waitcnt lgkmcnt(3)
    v_mfma_f32_16x16x32_bf16 v[112:115], a[72:75], v[72:75], v[112:115]
    v_mfma_f32_16x16x32_bf16 v[116:119], a[76:79], v[72:75], v[116:119]
    v_mfma_f32_16x16x32_bf16 v[128:131], v[72:75], a[200:203], v[128:131]
    v_mfma_f32_16x16x32_bf16 v[132:135], v[72:75], a[204:207], v[132:135]
    ds_read_b128 v[72:75], v107 offset:33280
    s_waitcnt lgkmcnt(3)
    v_mfma_f32_16x16x32_bf16 v[120:123], a[72:75], v[76:79], v[120:123]
    v_mfma_f32_16x16x32_bf16 v[124:127], a[76:79], v[76:79], v[124:127]
    v_mfma_f32_16x16x32_bf16 v[136:139], v[76:79], a[200:203], v[136:139]
    v_mfma_f32_16x16x32_bf16 v[140:143], v[76:79], a[204:207], v[140:143]
    ds_read_b128 v[76:79], v107 offset:49664
    s_waitcnt lgkmcnt(3)
    v_mfma_f32_16x16x32_bf16 v[112:115], a[80:83], v[64:67], v[112:115]
    v_mfma_f32_16x16x32_bf16 v[116:119], a[84:87], v[64:67], v[116:119]
    v_mfma_f32_16x16x32_bf16 v[128:131], v[64:67], a[208:211], v[128:131]
    v_mfma_f32_16x16x32_bf16 v[132:135], v[64:67], a[212:215], v[132:135]
    ds_read_b128 v[64:67], v104 offset:33536
    s_waitcnt lgkmcnt(3)
    v_mfma_f32_16x16x32_bf16 v[120:123], a[80:83], v[68:71], v[120:123]
    v_mfma_f32_16x16x32_bf16 v[124:127], a[84:87], v[68:71], v[124:127]
    v_mfma_f32_16x16x32_bf16 v[136:139], v[68:71], a[208:211], v[136:139]
    v_mfma_f32_16x16x32_bf16 v[140:143], v[68:71], a[212:215], v[140:143]
    ds_read_b128 v[68:71], v104 offset:49920
    s_waitcnt lgkmcnt(3)
    v_mfma_f32_16x16x32_bf16 v[112:115], a[88:91], v[72:75], v[112:115]
    v_mfma_f32_16x16x32_bf16 v[116:119], a[92:95], v[72:75], v[116:119]
    v_mfma_f32_16x16x32_bf16 v[128:131], v[72:75], a[216:219], v[128:131]
    v_mfma_f32_16x16x32_bf16 v[132:135], v[72:75], a[220:223], v[132:135]
    ds_read_b128 v[72:75], v105 offset:33536
    s_waitcnt lgkmcnt(3)
    v_mfma_f32_16x16x32_bf16 v[120:123], a[88:91], v[76:79], v[120:123]
    v_mfma_f32_16x16x32_bf16 v[124:127], a[92:95], v[76:79], v[124:127]
    v_mfma_f32_16x16x32_bf16 v[136:139], v[76:79], a[216:219], v[136:139]
    v_mfma_f32_16x16x32_bf16 v[140:143], v[76:79], a[220:223], v[140:143]
    ds_read_b128 v[76:79], v105 offset:49920
    s_waitcnt lgkmcnt(3)
    v_mfma_f32_16x16x32_bf16 v[112:115], a[96:99], v[64:67], v[112:115]
    v_mfma_f32_16x16x32_bf16 v[116:119], a[100:103], v[64:67], v[116:119]
    v_mfma_f32_16x16x32_bf16 v[128:131], v[64:67], a[224:227], v[128:131]
    v_mfma_f32_16x16x32_bf16 v[132:135], v[64:67], a[228:231], v[132:135]
    ds_read_b128 v[64:67], v106 offset:33536
    s_waitcnt lgkmcnt(3)
    v_mfma_f32_16x16x32_bf16 v[120:123], a[96:99], v[68:71], v[120:123]
    s_mov_b32 s60, s47
    s_mov_b32 s61, s48
    s_mov_b32 s51, s50
    v_mfma_f32_16x16x32_bf16 v[124:127], a[100:103], v[68:71], v[124:127]
    v_mfma_f32_16x16x32_bf16 v[136:139], v[68:71], a[224:227], v[136:139]
    s_add_u32 s47, s47, 28672
    s_add_u32 s48, s48, 28672
    v_mfma_f32_16x16x32_bf16 v[140:143], v[68:71], a[228:231], v[140:143]
    ds_read_b128 v[68:71], v106 offset:49920
    s_waitcnt lgkmcnt(3)
    v_mfma_f32_16x16x32_bf16 v[112:115], a[104:107], v[72:75], v[112:115]
    v_mfma_f32_16x16x32_bf16 v[116:119], a[108:111], v[72:75], v[116:119]
    v_mfma_f32_16x16x32_bf16 v[128:131], v[72:75], a[232:235], v[128:131]
    s_add_u32 s50, s50, 4096
    s_add_u32 s44, s44, 1
    v_mfma_f32_16x16x32_bf16 v[132:135], v[72:75], a[236:239], v[132:135]
    ds_read_b128 v[72:75], v107 offset:33536
    s_waitcnt lgkmcnt(3)
    v_mfma_f32_16x16x32_bf16 v[120:123], a[104:107], v[76:79], v[120:123]
    v_mfma_f32_16x16x32_bf16 v[124:127], a[108:111], v[76:79], v[124:127]
    v_mfma_f32_16x16x32_bf16 v[136:139], v[76:79], a[232:235], v[136:139]
    s_waitcnt vmcnt(0)
    v_mfma_f32_16x16x32_bf16 v[140:143], v[76:79], a[236:239], v[140:143]
    s_mov_b64 exec, s[54:55]
    ds_add_rtn_u32 v11, v12, v3 offset:0
    s_mov_b64 exec, -1
    ds_read_b128 v[76:79], v107 offset:49920
    s_waitcnt lgkmcnt(3)
    v_mfma_f32_16x16x32_bf16 v[112:115], a[112:115], v[64:67], v[112:115]
    v_mfma_f32_16x16x32_bf16 v[116:119], a[116:119], v[64:67], v[116:119]
    v_mfma_f32_16x16x32_bf16 v[128:131], v[64:67], a[240:243], v[128:131]
    v_mfma_f32_16x16x32_bf16 v[132:135], v[64:67], a[244:247], v[132:135]
    s_waitcnt vmcnt(0) lgkmcnt(0)
    s_barrier
    ds_read_b128 v[64:67], v104 offset:0
    v_mfma_f32_16x16x32_bf16 v[120:123], a[112:115], v[68:71], v[120:123]
    v_readfirstlane_b32 s3, v11
    s_and_b32 s3, s3, 3
    s_cmp_eq_u32 s3, 3
    s_cselect_b32 s3, s62, s63
    s_nop 1
    buffer_store_dword v3, v7, s[8:11], s3 offen sc1
    v_mfma_f32_16x16x32_bf16 v[124:127], a[116:119], v[68:71], v[124:127]
    v_mfma_f32_16x16x32_bf16 v[136:139], v[68:71], a[240:243], v[136:139]
    v_mfma_f32_16x16x32_bf16 v[140:143], v[68:71], a[244:247], v[140:143]
    ds_read_b128 v[68:71], v104 offset:16384
    v_mfma_f32_16x16x32_bf16 v[112:115], a[120:123], v[72:75], v[112:115]
    s_mov_b32 s62, s51
    s_mov_b64 s[54:55], 1
    v_mfma_f32_16x16x32_bf16 v[116:119], a[124:127], v[72:75], v[116:119]
    v_mfma_f32_16x16x32_bf16 v[128:131], v[72:75], a[248:251], v[128:131]
    v_mfma_f32_16x16x32_bf16 v[132:135], v[72:75], a[252:255], v[132:135]
    ds_read_b128 v[72:75], v105 offset:0
    v_mfma_f32_16x16x32_bf16 v[120:123], a[120:123], v[76:79], v[120:123]
    v_mfma_f32_16x16x32_bf16 v[124:127], a[124:127], v[76:79], v[124:127]
    v_mfma_f32_16x16x32_bf16 v[136:139], v[76:79], a[248:251], v[136:139]
    v_mfma_f32_16x16x32_bf16 v[140:143], v[76:79], a[252:255], v[140:143]
    v_cmp_eq_u32 vcc, 0, v4
    s_cmp_ge_u32 s44, 63
    s_cbranch_scc1 L_kv0B
    s_cbranch_vccnz L_kv0B
    s_branch L_kv0A
L_kv1B:
    ds_read_b128 v[76:79], v105 offset:49152
    s_waitcnt lgkmcnt(3)
    v_mfma_f32_16x16x32_bf16 v[112:115], a[0:3], v[64:67], 0
    v_mfma_f32_16x16x32_bf16 v[116:119], a[4:7], v[64:67], 0
    v_mfma_f32_16x16x32_bf16 v[128:131], v[64:67], a[128:131], 0
    buffer_load_dword v4, v5, s[8:11], s45 offen sc1
    v_mfma_f32_16x16x32_bf16 v[132:135], v[64:67], a[132:135], 0
    s_mov_b32 s52, 0
    ds_read_b128 v[64:67], v106 offset:32768
    s_waitcnt lgkmcnt(3)
    v_mfma_f32_16x16x32_bf16 v[120:123], a[0:3], v[68:71], 0
    v_mfma_f32_16x16x32_bf16 v[124:127], a[4:7], v[68:71], 0
    v_mfma_f32_16x16x32_bf16 v[136:139], v[68:71], a[128:131], 0
    v_mfma_f32_16x16x32_bf16 v[140:143], v[68:71], a[132:135], 0
    ds_read_b128 v[68:71], v106 offset:49152
    s_waitcnt lgkmcnt(3)
    v_mfma_f32_16x16x32_bf16 v[112:115], a[8:11], v[72:75], v[112:115]
    v_cvt_pk_bf16_f32 v88, v16, v20
    v_cvt_pk_bf16_f32 v89, v17, v21
    v_mfma_f32_16x16x32_bf16 v[116:119], a[12:15], v[72:75], v[116:119]
    v_cvt_pk_bf16_f32 v90, v18, v22
    v_cvt_pk_bf16_f32 v91, v19, v23
    v_mfma_f32_16x16x32_bf16 v[128:131], v[72:75], a[136:139], v[128:131]
    buffer_store_dwordx4 v[88:91], v13, s[8:11], s60 offen offset:0 sc1
    v_mfma_f32_16x16x32_bf16 v[132:135], v[72:75], a[140:143], v[132:135]
    ds_read_b128 v[72:75], v107 offset:32768
    s_waitcnt lgkmcnt(3)
    v_mfma_f32_16x16x32_bf16 v[120:123], a[8:11], v[76:79], v[120:123]
    v_cvt_pk_bf16_f32 v92, v24, v28
    v_cvt_pk_bf16_f32 v93, v25, v29
    v_mfma_f32_16x16x32_bf16 v[124:127], a[12:15], v[76:79], v[124:127]
    v_cvt_pk_bf16_f32 v94, v26, v30
    v_cvt_pk_bf16_f32 v95, v27, v31
    v_mfma_f32_16x16x32_bf16 v[136:139], v[76:79], a[136:139], v[136:139]
    buffer_store_dwordx4 v[92:95], v13, s[8:11], s60 offen offset:256 sc1
    v_mfma_f32_16x16x32_bf16 v[140:143], v[76:79], a[140:143], v[140:143]
    ds_read_b128 v[76:79], v107 offset:49152
    s_waitcnt lgkmcnt(3)
    v_mfma_f32_16x16x32_bf16 v[112:115], a[16:19], v[64:67], v[112:115]
    v_cvt_pk_bf16_f32 v96, v32, v33
    v_cvt_pk_bf16_f32 v97, v34, v35
    v_mfma_f32_16x16x32_bf16 v[116:119], a[20:23], v[64:67], v[116:119]
    v_cvt_pk_bf16_f32 v98, v40, v41
    v_cvt_pk_bf16_f32 v99, v42, v43
    v_mfma_f32_16x16x32_bf16 v[128:131], v[64:67], a[144:147], v[128:131]
    buffer_store_dwordx4 v[96:99], v13, s[8:11], s61 offen offset:0 sc1
    v_mfma_f32_16x16x32_bf16 v[132:135], v[64:67], a[148:151], v[132:135]
    ds_read_b128 v[64:67], v104 offset:33024
    s_waitcnt lgkmcnt(3)
    v_mfma_f32_16x16x32_bf16 v[120:123], a[16:19], v[68:71], v[120:123]
    v_cvt_pk_bf16_f32 v100, v36, v37
    v_cvt_pk_bf16_f32 v101, v38, v39
    v_mfma_f32_16x16x32_bf16 v[124:127], a[20:23], v[68:71], v[124:127]
    v_cvt_pk_bf16_f32 v102, v44, v45
    v_cvt_pk_bf16_f32 v103, v46, v47
    v_mfma_f32_16x16x32_bf16 v[136:139], v[68:71], a[144:147], v[136:139]
    buffer_store_dwordx4 v[100:103], v13, s[8:11], s61 offen offset:256 sc1
    v_mfma_f32_16x16x32_bf16 v[140:143], v[68:71], a[148:151], v[140:143]
    ds_read_b128 v[68:71], v104 offset:49408
    s_waitcnt lgkmcnt(3)
    v_mfma_f32_16x16x32_bf16 v[112:115], a[24:27], v[72:75], v[112:115]
    s_add_u32 s3, s60, s49
    buffer_store_dwordx4 v[48:51], v1, s[8:11], s3 offen sc1
    v_mfma_f32_16x16x32_bf16 v[116:119], a[28:31], v[72:75], v[116:119]
    v_mfma_f32_16x16x32_bf16 v[128:131], v[72:75], a[152:155], v[128:131]
    v_mfma_f32_16x16x32_bf16 v[132:135], v[72:75], a[156:159], v[132:135]
    ds_read_b128 v[72:75], v105 offset:33024
    s_waitcnt lgkmcnt(3)
    v_mfma_f32_16x16x32_bf16 v[120:123], a[24:27], v[76:79], v[120:123]
    v_mfma_f32_16x16x32_bf16 v[124:127], a[28:31], v[76:79], v[124:127]
    v_mfma_f32_16x16x32_bf16 v[136:139], v[76:79], a[152:155], v[136:139]
    v_mfma_f32_16x16x32_bf16 v[140:143], v[76:79], a[156:159], v[140:143]
    ds_read_b128 v[76:79], v105 offset:49408
    s_waitcnt lgkmcnt(3)
    v_mfma_f32_16x16x32_bf16 v[112:115], a[32:35], v[64:67], v[112:115]
    v_mfma_f32_16x16x32_bf16 v[116:119], a[36:39], v[64:67], v[116:119]
    v_mfma_f32_16x16x32_bf16 v[128:131], v[64:67], a[160:163], v[128:131]
    v_mfma_f32_16x16x32_bf16 v[132:135], v[64:67], a[164:167], v[132:135]
    ds_read_b128 v[64:67], v106 offset:33024
    s_waitcnt lgkmcnt(3)
    v_mfma_f32_16x16x32_bf16 v[120:123], a[32:35], v[68:71], v[120:123]
    v_mfma_f32_16x16x32_bf16 v[124:127], a[36:39], v[68:71], v[124:127]
    v_mfma_f32_16x16x32_bf16 v[136:139], v[68:71], a[160:163], v[136:139]
    v_mfma_f32_16x16x32_bf16 v[140:143], v[68:71], a[164:167], v[140:143]
    ds_read_b128 v[68:71], v106 offset:49408
    s_waitcnt lgkmcnt(3)
    v_mfma_f32_16x16x32_bf16 v[112:115], a[40:43], v[72:75], v[112:115]
    v_mfma_f32_16x16x32_bf16 v[116:119], a[44:47], v[72:75], v[116:119]
    v_mfma_f32_16x16x32_bf16 v[128:131], v[72:75], a[168:171], v[128:131]
    v_mfma_f32_16x16x32_bf16 v[132:135], v[72:75], a[172:175], v[132:135]
    ds_read_b128 v[72:75], v107 offset:33024
    s_waitcnt lgkmcnt(3)
    v_mfma_f32_16x16x32_bf16 v[120:123], a[40:43], v[76:79], v[120:123]
    v_mfma_f32_16x16x32_bf16 v[124:127], a[44:47], v[76:79], v[124:127]
    v_mfma_f32_16x16x32_bf16 v[136:139], v[76:79], a[168:171], v[136:139]
    v_mfma_f32_16x16x32_bf16 v[140:143], v[76:79], a[172:175], v[140:143]
    s_waitcnt vmcnt(5)
    v_cmp_eq_u32 vcc, 0, v4
    s_cmp_ge_u32 s44, 63
    s_cbranch_scc1 Lq_29
    s_cbranch_vccnz Lq_29
    s_add_u32 m0, s53, 0
    s_add_u32 s3, s46, 4096
    buffer_load_dwordx4 v1, s[8:11], s46 offen offset:0 sc1 lds
    buffer_load_dwordx4 v1, s[8:11], s46 offen offset:1024 sc1 lds
    buffer_load_dwordx4 v1, s[8:11], s46 offen offset:2048 sc1 lds
    buffer_load_dwordx4 v1, s[8:11], s46 offen offset:3072 sc1 lds
    s_add_u32 m0, s53, 4096
    s_add_u32 s45, s45, 128
    buffer_load_dwordx4 v1, s[8:11], s3 offen offset:0 sc1 lds
    buffer_load_dwordx4 v1, s[8:11], s3 offen offset:1024 sc1 lds
    buffer_load_dwordx4 v1, s[8:11], s3 offen offset:2048 sc1 lds
    buffer_load_dwordx4 v1, s[8:11], s3 offen offset:3072 sc1 lds
    s_add_u32 s46, s46, 32768
    s_mov_b32 s52, 1
Lq_29:
Lq_29x:
    ds_read_b128 v[76:79], v107 offset:49408
    s_waitcnt lgkmcnt(3)
    v_mfma_f32_16x16x32_bf16 v[112:115], a[48:51], v[64:67], v[112:115]
    v_mfma_f32_16x16x32_bf16 v[116:119], a[52:55], v[64:67], v[116:119]
    v_mfma_f32_16x16x32_bf16 v[128:131], v[64:67], a[176:179], v[128:131]
    v_mfma_f32_16x16x32_bf16 v[132:135], v[64:67], a[180:183], v[132:135]
    ds_read_b128 v[64:67], v104 offset:33280
    s_waitcnt lgkmcnt(3)
    v_mfma_f32_16x16x32_bf16 v[120:123], a[48:51], v[68:71], v[120:123]
    v_mfma_f32_16x16x32_bf16 v[124:127], a[52:55], v[68:71], v[124:127]
    v_mfma_f32_16x16x32_bf16 v[136:139], v[68:71], a[176:179], v[136:139]
    v_mfma_f32_16x16x32_bf16 v[140:143], v[68:71], a[180:183], v[140:143]
    ds_read_b128 v[68:71], v104 offset:49664
    s_waitcnt lgkmcnt(3)
    v_mfma_f32_16x16x32_bf16 v[112:115], a[56:59], v[72:75], v[112:115]
    v_mfma_f32_16x16x32_bf16 v[116:119], a[60:63], v[72:75], v[116:119]
    v_mfma_f32_16x16x32_bf16 v[128:131], v[72:75], a[184:187], v[128:131]
    v_mfma_f32_16x16x32_bf16 v[132:135], v[72:75], a[188:191], v[132:135]
    ds_read_b128 v[72:75], v105 offset:33280
    s_waitcnt lgkmcnt(3)
    v_mfma_f32_16x16x32_bf16 v[120:123], a[56:59], v[76:79], v[120:123]
    v_mfma_f32_16x16x32_bf16 v[124:127], a[60:63], v[76:79], v[124:127]
    v_mfma_f32_16x16x32_bf16 v[136:139], v[76:79], a[184:187], v[136:139]
    v_mfma_f32_16x16x32_bf16 v[140:143], v[76:79], a[188:191], v[140:143]
    ds_read_b128 v[76:79], v105 offset:49664
    s_waitcnt lgkmcnt(3)
    v_mfma_f32_16x16x32_bf16 v[112:115], a[64:67], v[64:67], v[112:115]
    v_mfma_f32_16x16x32_bf16 v[116:119], a[68:71], v[64:67], v[116:119]
    v_mfma_f32_16x16x32_bf16 v[128:131], v[64:67], a[192:195], v[128:131]
    v_mfma_f32_16x16x32_bf16 v[132:135], v[64:67], a[196:199], v[132:135]
    ds_read_b128 v[64:67], v106 offset:33280
    s_waitcnt lgkmcnt(3)
    v_mfma_f32_16x16x32_bf16 v[120:123], a[64:67], v[68:71], v[120:123]
    v_mfma_f32_16x16x32_bf16 v[124:127], a[68:71], v[68:71], v[124:127]
    v_mfma_f32_16x16x32_bf16 v[136:139], v[68:71], a[192:195], v[136:139]
    v_mfma_f32_16x16x32_bf16 v[140:143], v[68:71], a[196:199], v[140:143]
    ds_read_b128 v[68:71], v106 offset:49664
    s_waitcnt lgkmcnt(3)
    v_mfma_f32_16x16x32_bf16 v[112:115], a[72:75], v[72:75], v[112:115]
    v_mfma_f32_16x16x32_bf16 v[116:119], a[76:79], v[72:75], v[116:119]
    v_mfma_f32_16x16x32_bf16 v[128:131], v[72:75], a[200:203], v[128:131]
    v_mfma_f32_16x16x32_bf16 v[132:135], v[72:75], a[204:207], v[132:135]
    ds_read_b128 v[72:75], v107 offset:33280
    s_waitcnt lgkmcnt(3)
    v_mfma_f32_16x16x32_bf16 v[120:123], a[72:75], v[76:79], v[120:123]
    buffer_load_dword v4, v5, s[8:11], s45 offen sc1
    v_mfma_f32_16x16x32_bf16 v[124:127], a[76:79], v[76:79], v[124:127]
    v_mfma_f32_16x16x32_bf16 v[136:139], v[76:79], a[200:203], v[136:139]
    v_mfma_f32_16x16x32_bf16 v[140:143], v[76:79], a[204:207], v[140:143]
    ds_read_b128 v[76:79], v107 offset:49664
    s_waitcnt lgkmcnt(3)
    v_mfma_f32_16x16x32_bf16 v[112:115], a[80:83], v[64:67], v[112:115]
    v_mfma_f32_16x16x32_bf16 v[116:119], a[84:87], v[64:67], v[116:119]
    v_mfma_f32_16x16x32_bf16 v[128:131], v[64:67], a[208:211], v[128:131]
    v_mfma_f32_16x16x32_bf16 v[132:135], v[64:67], a[212:215], v[132:135]
    ds_read_b128 v[64:67], v104 offset:33536
    s_waitcnt lgkmcnt(3)
    v_mfma_f32_16x16x32_bf16 v[120:123], a[80:83], v[68:71], v[120:123]
    v_mfma_f32_16x16x32_bf16 v[124:127], a[84:87], v[68:71], v[124:127]
    v_mfma_f32_16x16x32_bf16 v[136:139], v[68:71], a[208:211], v[136:139]
    v_mfma_f32_16x16x32_bf16 v[140:143], v[68:71], a[212:215], v[140:143]
    ds_read_b128 v[68:71], v104 offset:49920
    s_waitcnt lgkmcnt(3)
    v_mfma_f32_16x16x32_bf16 v[112:115], a[88:91], v[72:75], v[112:115]
    v_mfma_f32_16x16x32_bf16 v[116:119], a[92:95], v[72:75], v[116:119]
    v_mfma_f32_16x16x32_bf16 v[128:131], v[72:75], a[216:219], v[128:131]
    v_mfma_f32_16x16x32_bf16 v[132:135], v[72:75], a[220:223], v[132:135]
    ds_read_b128 v[72:75], v105 offset:33536
    s_waitcnt lgkmcnt(3)
    v_mfma_f32_16x16x32_bf16 v[120:123], a[88:91], v[76:79], v[120:123]
    v_mfma_f32_16x16x32_bf16 v[124:127], a[92:95], v[76:79], v[124:127]
    v_mfma_f32_16x16x32_bf16 v[136:139], v[76:79], a[216:219], v[136:139]
    v_mfma_f32_16x16x32_bf16 v[140:143], v[76:79], a[220:223], v[140:143]
    ds_read_b128 v[76:79], v105 offset:49920
    s_waitcnt lgkmcnt(3)
    v_mfma_f32_16x16x32_bf16 v[112:115], a[96:99], v[64:67], v[112:115]
    v_mfma_f32_16x16x32_bf16 v[116:119], a[100:103], v[64:67], v[116:119]
    v_mfma_f32_16x16x32_bf16 v[128:131], v[64:67], a[224:227], v[128:131]
    v_mfma_f32_16x16x32_bf16 v[132:135], v[64:67], a[228:231], v[132:135]
    s_cmp_lg_u32 s52, 0
    s_cbranch_scc0 Lq_30a
    s_waitcnt vmcnt(9)
    s_mov_b64 exec, s[54:55]
    ds_add_rtn_u32 v11, v12, v3 offset:0
    s_mov_b64 exec, -1
    s_branch Lq_30x
Lq_30a:
    s_waitcnt vmcnt(0)
    s_mov_b64 exec, s[54:55]
    ds_add_rtn_u32 v11, v12, v3 offset:0
    s_mov_b64 exec, -1
    v_cmp_eq_u32 vcc, 0, v4
    s_cmp_ge_u32 s44, 63
    s_cbranch_scc1 Lq_30
    s_cbranch_vccnz Lq_30
    s_add_u32 m0, s53, 0
    s_add_u32 s3, s46, 4096
    buffer_load_dwordx4 v1, s[8:11], s46 offen offset:0 sc1 lds
    buffer_load_dwordx4 v1, s[8:11], s46 offen offset:1024 sc1 lds
    buffer_load_dwordx4 v1, s[8:11], s46 offen offset:2048 sc1 lds
    buffer_load_dwordx4 v1, s[8:11], s46 offen offset:3072 sc1 lds
    s_add_u32 m0, s53, 4096
    s_add_u32 s45, s45, 128
    buffer_load_dwordx4 v1, s[8:11], s3 offen offset:0 sc1 lds
    buffer_load_dwordx4 v1, s[8:11], s3 offen offset:1024 sc1 lds
    buffer_load_dwordx4 v1, s[8:11], s3 offen offset:2048 sc1 lds
    buffer_load_dwordx4 v1, s[8:11], s3 offen offset:3072 sc1 lds
    s_add_u32 s46, s46, 32768
    s_mov_b32 s52, 2
Lq_30:
Lq_30x:
    ds_read_b128 v[64:67], v106 offset:33536
    s_waitcnt lgkmcnt(3)
    v_mfma_f32_16x16x32_bf16 v[120:123], a[96:99], v[68:71], v[120:123]
    s_mov_b32 s60, s47
    s_mov_b32 s61, s48
    s_mov_b32 s51, s50
    v_mfma_f32_16x16x32_bf16 v[124:127], a[100:103], v[68:71], v[124:127]
    v_mfma_f32_16x16x32_bf16 v[136:139], v[68:71], a[224:227], v[136:139]
    s_add_u32 s47, s47, 28672
    s_add_u32 s48, s48, 28672
    v_mfma_f32_16x16x32_bf16 v[140:143], v[68:71], a[228:231], v[140:143]
    ds_read_b128 v[68:71], v106 offset:49920
    s_waitcnt lgkmcnt(3)
    v_mfma_f32_16x16x32_bf16 v[112:115], a[104:107], v[72:75], v[112:115]
    v_mfma_f32_16x16x32_bf16 v[116:119], a[108:111], v[72:75], v[116:119]
    v_mfma_f32_16x16x32_bf16 v[128:131], v[72:75], a[232:235], v[128:131]
    s_add_u32 s50, s50, 4096
    s_add_u32 s44, s44, 1
    v_mfma_f32_16x16x32_bf16 v[132:135], v[72:75], a[236:239], v[132:135]
    ds_read_b128 v[72:75], v107 offset:33536
    s_waitcnt lgkmcnt(3)
    v_mfma_f32_16x16x32_bf16 v[120:123], a[104:107], v[76:79], v[120:123]
    v_mfma_f32_16x16x32_bf16 v[124:127], a[108:111], v[76:79], v[124:127]
    v_mfma_f32_16x16x32_bf16 v[136:139], v[76:79], a[232:235], v[136:139]
    v_mfma_f32_16x16x32_bf16 v[140:143], v[76:79], a[236:239], v[140:143]
    ds_read_b128 v[76:79], v107 offset:49920
    s_waitcnt lgkmcnt(3)
    v_mfma_f32_16x16x32_bf16 v[112:115], a[112:115], v[64:67], v[112:115]
    v_readfirstlane_b32 s3, v11
    s_and_b32 s3, s3, 3
    s_cmp_eq_u32 s3, 3
    s_cselect_b32 s3, s62, s63
    s_nop 1
    buffer_store_dword v3, v7, s[8:11], s3 offen sc1
    v_mfma_f32_16x16x32_bf16 v[116:119], a[116:119], v[64:67], v[116:119]
    v_mfma_f32_16x16x32_bf16 v[128:131], v[64:67], a[240:243], v[128:131]
    s_mov_b32 s62, s51
    s_mov_b64 s[54:55], 1
    v_mfma_f32_16x16x32_bf16 v[132:135], v[64:67], a[244:247], v[132:135]
    s_cmp_lg_u32 s52, 1
    s_cbranch_scc1 L_kv1T
    s_waitcnt vmcnt(1) lgkmcnt(0)
    s_barrier
    ds_read_b128 v[64:67], v104 offset:0
    v_mfma_f32_16x16x32_bf16 v[120:123], a[112:115], v[68:71], v[120:123]
    v_mfma_f32_16x16x32_bf16 v[124:127], a[116:119], v[68:71], v[124:127]
    v_mfma_f32_16x16x32_bf16 v[136:139], v[68:71], a[240:243], v[136:139]
    v_mfma_f32_16x16x32_bf16 v[140:143], v[68:71], a[244:247], v[140:143]
    ds_read_b128 v[68:71], v104 offset:16384
    v_mfma_f32_16x16x32_bf16 v[112:115], a[120:123], v[72:75], v[112:115]
    v_mfma_f32_16x16x32_bf16 v[116:119], a[124:127], v[72:75], v[116:119]
    v_mfma_f32_16x16x32_bf16 v[128:131], v[72:75], a[248:251], v[128:131]
    v_mfma_f32_16x16x32_bf16 v[132:135], v[72:75], a[252:255], v[132:135]
    ds_read_b128 v[72:75], v105 offset:0
    v_mfma_f32_16x16x32_bf16 v[120:123], a[120:123], v[76:79], v[120:123]
    v_mfma_f32_16x16x32_bf16 v[124:127], a[124:127], v[76:79], v[124:127]
    v_mfma_f32_16x16x32_bf16 v[136:139], v[76:79], a[248:251], v[136:139]
    v_mfma_f32_16x16x32_bf16 v[140:143], v[76:79], a[252:255], v[140:143]
    v_cmp_eq_u32 vcc, 0, v4
    s_cmp_ge_u32 s44, 63
    s_cbranch_scc1 L_kv0B
    s_cbranch_vccnz L_kv0B
    s_branch L_kv0A
L_kv1T:
    s_waitcnt lgkmcnt(0)
    buffer_load_dword v4, v5, s[8:11], s45 offen sc1
    v_mfma_f32_16x16x32_bf16 v[120:123], a[112:115], v[68:71], v[120:123]
    v_mfma_f32_16x16x32_bf16 v[124:127], a[116:119], v[68:71], v[124:127]
    v_mfma_f32_16x16x32_bf16 v[136:139], v[68:71], a[240:243], v[136:139]
    v_mfma_f32_16x16x32_bf16 v[140:143], v[68:71], a[244:247], v[140:143]
    v_mfma_f32_16x16x32_bf16 v[112:115], a[120:123], v[72:75], v[112:115]
    v_mfma_f32_16x16x32_bf16 v[116:119], a[124:127], v[72:75], v[116:119]
    v_mfma_f32_16x16x32_bf16 v[128:131], v[72:75], a[248:251], v[128:131]
    v_mfma_f32_16x16x32_bf16 v[132:135], v[72:75], a[252:255], v[132:135]
    v_mfma_f32_16x16x32_bf16 v[120:123], a[120:123], v[76:79], v[120:123]
    v_mfma_f32_16x16x32_bf16 v[124:127], a[124:127], v[76:79], v[124:127]
    v_mfma_f32_16x16x32_bf16 v[136:139], v[76:79], a[248:251], v[136:139]
    v_mfma_f32_16x16x32_bf16 v[140:143], v[76:79], a[252:255], v[140:143]
    s_nop 1
    v_cvt_pk_bf16_f32 v88, v112, v116
    v_cvt_pk_bf16_f32 v89, v113, v117
    v_cvt_pk_bf16_f32 v90, v114, v118
    v_cvt_pk_bf16_f32 v91, v115, v119
    buffer_store_dwordx4 v[88:91], v13, s[8:11], s60 offen offset:0 sc1
    v_cvt_pk_bf16_f32 v92, v120, v124
    v_cvt_pk_bf16_f32 v93, v121, v125
    v_cvt_pk_bf16_f32 v94, v122, v126
    v_cvt_pk_bf16_f32 v95, v123, v127
    buffer_store_dwordx4 v[92:95], v13, s[8:11], s60 offen offset:256 sc1
    v_cvt_pk_bf16_f32 v96, v128, v129
    v_cvt_pk_bf16_f32 v97, v130, v131
    v_cvt_pk_bf16_f32 v98, v136, v137
    v_cvt_pk_bf16_f32 v99, v138, v139
    buffer_store_dwordx4 v[96:99], v13, s[8:11], s61 offen offset:0 sc1
    v_cvt_pk_bf16_f32 v100, v132, v133
    v_cvt_pk_bf16_f32 v101, v134, v135
    v_cvt_pk_bf16_f32 v102, v140, v141
    v_cvt_pk_bf16_f32 v103, v142, v143
    buffer_store_dwordx4 v[100:103], v13, s[8:11], s61 offen offset:256 sc1
    s_add_u32 s3, s60, s49
    buffer_store_dwordx4 v[48:51], v1, s[8:11], s3 offen sc1
    s_cmp_eq_u32 s52, 2
    s_cbranch_scc0 L_kv1X
    s_waitcnt vmcnt(0)
    s_branch L_kv1Y
L_kv1X:
    s_waitcnt vmcnt(5)
    v_cmp_eq_u32 vcc, 0, v4
    s_cmp_ge_u32 s44, 64
    s_cbranch_scc1 L_kv1U
    s_cbranch_vccnz L_kv1U
    s_add_u32 m0, s53, 0
    s_add_u32 s3, s46, 4096
    buffer_load_dwordx4 v1, s[8:11], s46 offen offset:0 sc1 lds
    buffer_load_dwordx4 v1, s[8:11], s46 offen offset:1024 sc1 lds
    buffer_load_dwordx4 v1, s[8:11], s46 offen offset:2048 sc1 lds
    buffer_load_dwordx4 v1, s[8:11], s46 offen offset:3072 sc1 lds
    s_add_u32 m0, s53, 4096
    s_add_u32 s45, s45, 128
    buffer_load_dwordx4 v1, s[8:11], s3 offen offset:0 sc1 lds
    buffer_load_dwordx4 v1, s[8:11], s3 offen offset:1024 sc1 lds
    buffer_load_dwordx4 v1, s[8:11], s3 offen offset:2048 sc1 lds
    buffer_load_dwordx4 v1, s[8:11], s3 offen offset:3072 sc1 lds
    s_add_u32 s46, s46, 32768
    buffer_load_dword v4, v5, s[8:11], s45 offen sc1
    s_waitcnt vmcnt(9)
L_kv1Y:
    s_mov_b64 exec, s[54:55]
    ds_add_rtn_u32 v11, v12, v3 offset:4
    s_mov_b64 exec, -1
    s_waitcnt lgkmcnt(0)
    v_readfirstlane_b32 s3, v11
    s_and_b32 s3, s3, 3
    s_cmp_eq_u32 s3, 3
    s_cselect_b32 s3, s62, s63
    s_nop 1
    buffer_store_dword v3, v7, s[8:11], s3 offen sc1
    s_mov_b32 s60, s63
    s_mov_b32 s61, s63
    s_mov_b32 s62, s63
    s_mov_b64 s[54:55], 0
    s_waitcnt vmcnt(1)
    s_branch L_kv1V
L_kv1U:
    s_waitcnt vmcnt(0)
    buffer_load_dword v4, v5, s[8:11], s45 offen sc1
    s_mov_b64 exec, s[54:55]
    ds_add_rtn_u32 v11, v12, v3 offset:4
    s_mov_b64 exec, -1
    s_waitcnt lgkmcnt(0)
    v_readfirstlane_b32 s3, v11
    s_and_b32 s3, s3, 3
    s_cmp_eq_u32 s3, 3
    s_cselect_b32 s3, s62, s63
    s_nop 1
    buffer_store_dword v3, v7, s[8:11], s3 offen sc1
    s_cmp_ge_u32 s44, 64
    s_cbranch_scc1 L_end
    s_waitcnt vmcnt(1)
L_kv1W:
    s_mov_b32 s60, s63
    s_mov_b32 s61, s63
    s_mov_b32 s62, s63
    s_mov_b64 s[54:55], 0
    v_cmp_eq_u32 vcc, 0, v4
    s_cbranch_vccz Lq_31
Lw_32:
    buffer_load_dword v4, v5, s[8:11], s45 offen offset:0 sc1
    s_waitcnt vmcnt(0)
    v_cmp_eq_u32 vcc, 0, v4
    s_cbranch_vccz Lwd_33
    s_sleep 1
    s_sub_u32 s98, s98, 1
    s_cbranch_scc1 L_end
    s_branch Lw_32
Lwd_33:
Lq_31:
    s_add_u32 m0, s53, 0
    s_add_u32 s3, s46, 4096
    buffer_load_dwordx4 v1, s[8:11], s46 offen offset:0 sc1 lds
    buffer_load_dwordx4 v1, s[8:11], s46 offen offset:1024 sc1 lds
    buffer_load_dwordx4 v1, s[8:11], s46 offen offset:2048 sc1 lds
    buffer_load_dwordx4 v1, s[8:11], s46 offen offset:3072 sc1 lds
    s_add_u32 m0, s53, 4096
    s_add_u32 s45, s45, 128
    buffer_load_dwordx4 v1, s[8:11], s3 offen offset:0 sc1 lds
    buffer_load_dwordx4 v1, s[8:11], s3 offen offset:1024 sc1 lds
    buffer_load_dwordx4 v1, s[8:11], s3 offen offset:2048 sc1 lds
    buffer_load_dwordx4 v1, s[8:11], s3 offen offset:3072 sc1 lds
    s_add_u32 s46, s46, 32768
    buffer_load_dword v4, v5, s[8:11], s45 offen sc1
    s_waitcnt vmcnt(0)
L_kv1V:
    s_barrier
    ds_read_b128 v[64:67], v104 offset:0
    ds_read_b128 v[68:71], v104 offset:16384
    ds_read_b128 v[72:75], v105 offset:0
    v_cmp_eq_u32 vcc, 0, v4
    s_cmp_ge_u32 s44, 63
    s_cbranch_scc1 L_kv0B
    s_cbranch_vccnz L_kv0B
    s_branch L_kv0A
L_qq0A:
    ds_read_b128 v[76:79], v105 offset:16384
    s_waitcnt lgkmcnt(3)
    v_mfma_f32_16x16x32_bf16 v[16:19], a[0:3], v[64:67], 0
    s_add_u32 m0, s53, 32768
    s_add_u32 s3, s46, 4096
    buffer_load_dwordx4 v1, s[8:11], s46 offen offset:0 sc1 lds
    v_mfma_f32_16x16x32_bf16 v[20:23], a[4:7], v[64:67], 0
    v_mfma_f32_16x16x32_bf16 v[32:35], a[128:131], v[64:67], 0
    buffer_load_dwordx4 v1, s[8:11], s46 offen offset:1024 sc1 lds
    v_mfma_f32_16x16x32_bf16 v[36:39], a[132:135], v[64:67], 0
    ds_read_b128 v[64:67], v106 offset:0
    s_waitcnt lgkmcnt(3)
    v_mfma_f32_16x16x32_bf16 v[24:27], a[0:3], v[68:71], 0
    buffer_load_dwordx4 v1, s[8:11], s46 offen offset:2048 sc1 lds
    v_mfma_f32_16x16x32_bf16 v[28:31], a[4:7], v[68:71], 0
    v_mfma_f32_16x16x32_bf16 v[40:43], a[128:131], v[68:71], 0
    buffer_load_dwordx4 v1, s[8:11], s46 offen offset:3072 sc1 lds
    v_mfma_f32_16x16x32_bf16 v[44:47], a[132:135], v[68:71], 0
    ds_read_b128 v[68:71], v106 offset:16384
    s_waitcnt lgkmcnt(3)
    v_mfma_f32_16x16x32_bf16 v[16:19], a[8:11], v[72:75], v[16:19]
    s_add_u32 m0, s53, 36864
    s_add_u32 s45, s45, 128
    buffer_load_dwordx4 v1, s[8:11], s3 offen offset:0 sc1 lds
    v_mfma_f32_16x16x32_bf16 v[20:23], a[12:15], v[72:75], v[20:23]
    v_mfma_f32_16x16x32_bf16 v[32:35], a[136:139], v[72:75], v[32:35]
    buffer_load_dwordx4 v1, s[8:11], s3 offen offset:1024 sc1 lds
    v_mfma_f32_16x16x32_bf16 v[36:39], a[140:143], v[72:75], v[36:39]
    ds_read_b128 v[72:75], v107 offset:0
    s_waitcnt lgkmcnt(3)
    v_mfma_f32_16x16x32_bf16 v[24:27], a[8:11], v[76:79], v[24:27]
    buffer_load_dwordx4 v1, s[8:11], s3 offen offset:2048 sc1 lds
    v_mfma_f32_16x16x32_bf16 v[28:31], a[12:15], v[76:79], v[28:31]
    v_mfma_f32_16x16x32_bf16 v[40:43], a[136:139], v[76:79], v[40:43]
    buffer_load_dwordx4 v1, s[8:11], s3 offen offset:3072 sc1 lds
    s_add_u32 s46, s46, 32768
    v_mfma_f32_16x16x32_bf16 v[44:47], a[140:143], v[76:79], v[44:47]
    ds_read_b128 v[76:79], v107 offset:16384
    s_waitcnt lgkmcnt(3)
    v_mfma_f32_16x16x32_bf16 v[16:19], a[16:19], v[64:67], v[16:19]
    buffer_load_dword v4, v5, s[8:11], s45 offen sc1
    v_mfma_f32_16x16x32_bf16 v[20:23], a[20:23], v[64:67], v[20:23]
    v_mfma_f32_16x16x32_bf16 v[32:35], a[144:147], v[64:67], v[32:35]
    v_mul_f32 v112, v6, v112
    v_mul_f32 v116, v6, v116
    v_mfma_f32_16x16x32_bf16 v[36:39], a[148:151], v[64:67], v[36:39]
    v_cvt_pk_bf16_f32 v88, v112, v116
    v_mul_f32 v113, v6, v113
    ds_read_b128 v[64:67], v104 offset:256
    s_waitcnt lgkmcnt(3)
    v_mfma_f32_16x16x32_bf16 v[24:27], a[16:19], v[68:71], v[24:27]
    v_mul_f32 v117, v6, v117
    v_cvt_pk_bf16_f32 v89, v113, v117
    v_mfma_f32_16x16x32_bf16 v[28:31], a[20:23], v[68:71], v[28:31]
    v_mul_f32 v114, v6, v114
    v_mul_f32 v118, v6, v118
    v_mfma_f32_16x16x32_bf16 v[40:43], a[144:147], v[68:71], v[40:43]
    v_cvt_pk_bf16_f32 v90, v114, v118
    v_mul_f32 v115, v6, v115
    v_mfma_f32_16x16x32_bf16 v[44:47], a[148:151], v[68:71], v[44:47]
    v_mul_f32 v119, v6, v119
    v_cvt_pk_bf16_f32 v91, v115, v119
    ds_read_b128 v[68:71], v104 offset:16640
    s_waitcnt lgkmcnt(3)
    v_mfma_f32_16x16x32_bf16 v[16:19], a[24:27], v[72:75], v[16:19]
    buffer_store_dwordx4 v[88:91], v13, s[8:11], s60 offen offset:0 sc1
    v_mfma_f32_16x16x32_bf16 v[20:23], a[28:31], v[72:75], v[20:23]
    v_mfma_f32_16x16x32_bf16 v[32:35], a[152:155], v[72:75], v[32:35]
    v_mul_f32 v120, v6, v120
    v_mul_f32 v124, v6, v124
    v_mfma_f32_16x16x32_bf16 v[36:39], a[156:159], v[72:75], v[36:39]
    v_cvt_pk_bf16_f32 v92, v120, v124
    v_mul_f32 v121, v6, v121
    ds_read_b128 v[72:75], v105 offset:256
    s_waitcnt lgkmcnt(3)
    v_mfma_f32_16x16x32_bf16 v[24:27], a[24:27], v[76:79], v[24:27]
    v_mul_f32 v125, v6, v125
    v_cvt_pk_bf16_f32 v93, v121, v125
    v_mfma_f32_16x16x32_bf16 v[28:31], a[28:31], v[76:79], v[28:31]
    v_mul_f32 v122, v6, v122
    v_mul_f32 v126, v6, v126
    v_mfma_f32_16x16x32_bf16 v[40:43], a[152:155], v[76:79], v[40:43]
    v_cvt_pk_bf16_f32 v94, v122, v126
    v_mul_f32 v123, v6, v123
    v_mfma_f32_16x16x32_bf16 v[44:47], a[156:159], v[76:79], v[44:47]
    v_mul_f32 v127, v6, v127
    v_cvt_pk_bf16_f32 v95, v123, v127
    ds_read_b128 v[76:79], v105 offset:16640
    s_waitcnt lgkmcnt(3)
    v_mfma_f32_16x16x32_bf16 v[16:19], a[32:35], v[64:67], v[16:19]
    buffer_store_dwordx4 v[92:95], v13, s[8:11], s60 offen offset:256 sc1
    v_mfma_f32_16x16x32_bf16 v[20:23], a[36:39], v[64:67], v[20:23]
    v_mfma_f32_16x16x32_bf16 v[32:35], a[160:163], v[64:67], v[32:35]
    v_mul_f32 v128, v6, v128
    v_mul_f32 v132, v6, v132
    v_mfma_f32_16x16x32_bf16 v[36:39], a[164:167], v[64:67], v[36:39]
    v_cvt_pk_bf16_f32 v96, v128, v132
    v_mul_f32 v129, v6, v129
    ds_read_b128 v[64:67], v106 offset:256
    s_waitcnt lgkmcnt(3)
    v_mfma_f32_16x16x32_bf16 v[24:27], a[32:35], v[68:71], v[24:27]
    v_mul_f32 v133, v6, v133
    v_cvt_pk_bf16_f32 v97, v129, v133
    v_mfma_f32_16x16x32_bf16 v[28:31], a[36:39], v[68:71], v[28:31]
    v_mul_f32 v130, v6, v130
    v_mul_f32 v134, v6, v134
    v_mfma_f32_16x16x32_bf16 v[40:43], a[160:163], v[68:71], v[40:43]
    v_cvt_pk_bf16_f32 v98, v130, v134
    v_mul_f32 v131, v6, v131
    v_mfma_f32_16x16x32_bf16 v[44:47], a[164:167], v[68:71], v[44:47]
    v_mul_f32 v135, v6, v135
    v_cvt_pk_bf16_f32 v99, v131, v135
    ds_read_b128 v[68:71], v106 offset:16640
    s_waitcnt lgkmcnt(3)
    v_mfma_f32_16x16x32_bf16 v[16:19], a[40:43], v[72:75], v[16:19]
    buffer_store_dwordx4 v[96:99], v13, s[8:11], s61 offen offset:0 sc1
    v_mfma_f32_16x16x32_bf16 v[20:23], a[44:47], v[72:75], v[20:23]
    v_mfma_f32_16x16x32_bf16 v[32:35], a[168:171], v[72:75], v[32:35]
    v_mul_f32 v136, v6, v136
    v_mul_f32 v140, v6, v140
    v_mfma_f32_16x16x32_bf16 v[36:39], a[172:175], v[72:75], v[36:39]
    v_cvt_pk_bf16_f32 v100, v136, v140
    v_mul_f32 v137, v6, v137
    ds_read_b128 v[72:75], v107 offset:256
    s_waitcnt lgkmcnt(3)
    v_mfma_f32_16x16x32_bf16 v[24:27], a[40:43], v[76:79], v[24:27]
    v_mul_f32 v141, v6, v141
    v_cvt_pk_bf16_f32 v101, v137, v141
    v_mfma_f32_16x16x32_bf16 v[28:31], a[44:47], v[76:79], v[28:31]
    v_mul_f32 v138, v6, v138
    v_mul_f32 v142, v6, v142
    v_mfma_f32_16x16x32_bf16 v[40:43], a[168:171], v[76:79], v[40:43]
    v_cvt_pk_bf16_f32 v102, v138, v142
    v_mul_f32 v139, v6, v139
    v_mfma_f32_16x16x32_bf16 v[44:47], a[172:175], v[76:79], v[44:47]
    v_mul_f32 v143, v6, v143
    v_cvt_pk_bf16_f32 v103, v139, v143
    ds_read_b128 v[76:79], v107 offset:16640
    s_waitcnt lgkmcnt(3)
    v_mfma_f32_16x16x32_bf16 v[16:19], a[48:51], v[64:67], v[16:19]
    buffer_store_dwordx4 v[100:103], v13, s[8:11], s61 offen offset:256 sc1
    v_mfma_f32_16x16x32_bf16 v[20:23], a[52:55], v[64:67], v[20:23]
    v_mfma_f32_16x16x32_bf16 v[32:35], a[176:179], v[64:67], v[32:35]
    v_mfma_f32_16x16x32_bf16 v[36:39], a[180:183], v[64:67], v[36:39]
    ds_read_b128 v[64:67], v104 offset:512
    s_waitcnt lgkmcnt(3)
    v_mfma_f32_16x16x32_bf16 v[24:27], a[48:51], v[68:71], v[24:27]
    v_mfma_f32_16x16x32_bf16 v[28:31], a[52:55], v[68:71], v[28:31]
    v_mfma_f32_16x16x32_bf16 v[40:43], a[176:179], v[68:71], v[40:43]
    v_mfma_f32_16x16x32_bf16 v[44:47], a[180:183], v[68:71], v[44:47]
    ds_read_b128 v[68:71], v104 offset:16896
    s_waitcnt lgkmcnt(3)
    v_mfma_f32_16x16x32_bf16 v[16:19], a[56:59], v[72:75], v[16:19]
    v_mfma_f32_16x16x32_bf16 v[20:23], a[60:63], v[72:75], v[20:23]
    v_mfma_f32_16x16x32_bf16 v[32:35], a[184:187], v[72:75], v[32:35]
    v_mfma_f32_16x16x32_bf16 v[36:39], a[188:191], v[72:75], v[36:39]
    ds_read_b128 v[72:75], v105 offset:512
    s_waitcnt lgkmcnt(3)
    v_mfma_f32_16x16x32_bf16 v[24:27], a[56:59], v[76:79], v[24:27]
    v_mfma_f32_16x16x32_bf16 v[28:31], a[60:63], v[76:79], v[28:31]
    v_mfma_f32_16x16x32_bf16 v[40:43], a[184:187], v[76:79], v[40:43]
    v_mfma_f32_16x16x32_bf16 v[44:47], a[188:191], v[76:79], v[44:47]
    ds_read_b128 v[76:79], v105 offset:16896
    s_waitcnt lgkmcnt(3)
    v_mfma_f32_16x16x32_bf16 v[16:19], a[64:67], v[64:67], v[16:19]
    v_mfma_f32_16x16x32_bf16 v[20:23], a[68:71], v[64:67], v[20:23]
    v_mfma_f32_16x16x32_bf16 v[32:35], a[192:195], v[64:67], v[32:35]
    v_mfma_f32_16x16x32_bf16 v[36:39], a[196:199], v[64:67], v[36:39]
    ds_read_b128 v[64:67], v106 offset:512
    s_waitcnt lgkmcnt(3)
    v_mfma_f32_16x16x32_bf16 v[24:27], a[64:67], v[68:71], v[24:27]
    v_mfma_f32_16x16x32_bf16 v[28:31], a[68:71], v[68:71], v[28:31]
    v_mfma_f32_16x16x32_bf16 v[40:43], a[192:195], v[68:71], v[40:43]
    v_mfma_f32_16x16x32_bf16 v[44:47], a[196:199], v[68:71], v[44:47]
    ds_read_b128 v[68:71], v106 offset:16896
    s_waitcnt lgkmcnt(3)
    v_mfma_f32_16x16x32_bf16 v[16:19], a[72:75], v[72:75], v[16:19]
    v_mfma_f32_16x16x32_bf16 v[20:23], a[76:79], v[72:75], v[20:23]
    v_mfma_f32_16x16x32_bf16 v[32:35], a[200:203], v[72:75], v[32:35]
    v_mfma_f32_16x16x32_bf16 v[36:39], a[204:207], v[72:75], v[36:39]
    ds_read_b128 v[72:75], v107 offset:512
    s_waitcnt lgkmcnt(3)
    v_mfma_f32_16x16x32_bf16 v[24:27], a[72:75], v[76:79], v[24:27]
    v_mfma_f32_16x16x32_bf16 v[28:31], a[76:79], v[76:79], v[28:31]
    v_mfma_f32_16x16x32_bf16 v[40:43], a[200:203], v[76:79], v[40:43]
    v_mfma_f32_16x16x32_bf16 v[44:47], a[204:207], v[76:79], v[44:47]
    ds_read_b128 v[76:79], v107 offset:16896
    s_waitcnt lgkmcnt(3)
    v_mfma_f32_16x16x32_bf16 v[16:19], a[80:83], v[64:67], v[16:19]
    v_mfma_f32_16x16x32_bf16 v[20:23], a[84:87], v[64:67], v[20:23]
    v_mfma_f32_16x16x32_bf16 v[32:35], a[208:211], v[64:67], v[32:35]
    v_mfma_f32_16x16x32_bf16 v[36:39], a[212:215], v[64:67], v[36:39]
    ds_read_b128 v[64:67], v104 offset:768
    s_waitcnt lgkmcnt(3)
    v_mfma_f32_16x16x32_bf16 v[24:27], a[80:83], v[68:71], v[24:27]
    v_mfma_f32_16x16x32_bf16 v[28:31], a[84:87], v[68:71], v[28:31]
    v_mfma_f32_16x16x32_bf16 v[40:43], a[208:211], v[68:71], v[40:43]
    v_mfma_f32_16x16x32_bf16 v[44:47], a[212:215], v[68:71], v[44:47]
    ds_read_b128 v[68:71], v104 offset:17152
    s_waitcnt lgkmcnt(3)
    v_mfma_f32_16x16x32_bf16 v[16:19], a[88:91], v[72:75], v[16:19]
    v_mfma_f32_16x16x32_bf16 v[20:23], a[92:95], v[72:75], v[20:23]
    v_mfma_f32_16x16x32_bf16 v[32:35], a[216:219], v[72:75], v[32:35]
    v_mfma_f32_16x16x32_bf16 v[36:39], a[220:223], v[72:75], v[36:39]
    ds_read_b128 v[72:75], v105 offset:768
    s_waitcnt lgkmcnt(3)
    v_mfma_f32_16x16x32_bf16 v[24:27], a[88:91], v[76:79], v[24:27]
    v_mfma_f32_16x16x32_bf16 v[28:31], a[92:95], v[76:79], v[28:31]
    v_mfma_f32_16x16x32_bf16 v[40:43], a[216:219], v[76:79], v[40:43]
    v_mfma_f32_16x16x32_bf16 v[44:47], a[220:223], v[76:79], v[44:47]
    ds_read_b128 v[76:79], v105 offset:17152
    s_waitcnt lgkmcnt(3)
    v_mfma_f32_16x16x32_bf16 v[16:19], a[96:99], v[64:67], v[16:19]
    v_mfma_f32_16x16x32_bf16 v[20:23], a[100:103], v[64:67], v[20:23]
    v_mfma_f32_16x16x32_bf16 v[32:35], a[224:227], v[64:67], v[32:35]
    v_mfma_f32_16x16x32_bf16 v[36:39], a[228:231], v[64:67], v[36:39]
    ds_read_b128 v[64:67], v106 offset:768
    s_waitcnt lgkmcnt(3)
    v_mfma_f32_16x16x32_bf16 v[24:27], a[96:99], v[68:71], v[24:27]
    s_mov_b32 s60, s47
    s_mov_b32 s61, s48
    s_mov_b32 s51, s50
    v_mfma_f32_16x16x32_bf16 v[28:31], a[100:103], v[68:71], v[28:31]
    v_mfma_f32_16x16x32_bf16 v[40:43], a[224:227], v[68:71], v[40:43]
    s_add_u32 s47, s47, 28672
    s_add_u32 s48, s48, 28672
    v_mfma_f32_16x16x32_bf16 v[44:47], a[228:231], v[68:71], v[44:47]
    ds_read_b128 v[68:71], v106 offset:17152
    s_waitcnt lgkmcnt(3)
    v_mfma_f32_16x16x32_bf16 v[16:19], a[104:107], v[72:75], v[16:19]
    v_mfma_f32_16x16x32_bf16 v[20:23], a[108:111], v[72:75], v[20:23]
    v_mfma_f32_16x16x32_bf16 v[32:35], a[232:235], v[72:75], v[32:35]
    s_add_u32 s50, s50, 4096
    s_add_u32 s44, s44, 1
    v_mfma_f32_16x16x32_bf16 v[36:39], a[236:239], v[72:75], v[36:39]
    ds_read_b128 v[72:75], v107 offset:768
    s_waitcnt lgkmcnt(3)
    v_mfma_f32_16x16x32_bf16 v[24:27], a[104:107], v[76:79], v[24:27]
    v_mfma_f32_16x16x32_bf16 v[28:31], a[108:111], v[76:79], v[28:31]
    v_mfma_f32_16x16x32_bf16 v[40:43], a[232:235], v[76:79], v[40:43]
    s_waitcnt vmcnt(0)
    v_mfma_f32_16x16x32_bf16 v[44:47], a[236:239], v[76:79], v[44:47]
    s_mov_b64 exec, s[54:55]
    ds_add_rtn_u32 v11, v12, v3 offset:4
    s_mov_b64 exec, -1
    ds_read_b128 v[76:79], v107 offset:17152
    s_waitcnt lgkmcnt(3)
    v_mfma_f32_16x16x32_bf16 v[16:19], a[112:115], v[64:67], v[16:19]
    v_mfma_f32_16x16x32_bf16 v[20:23], a[116:119], v[64:67], v[20:23]
    v_mfma_f32_16x16x32_bf16 v[32:35], a[240:243], v[64:67], v[32:35]
    v_mfma_f32_16x16x32_bf16 v[36:39], a[244:247], v[64:67], v[36:39]
    s_waitcnt vmcnt(0) lgkmcnt(0)
    s_barrier
    ds_read_b128 v[64:67], v104 offset:32768
    v_mfma_f32_16x16x32_bf16 v[24:27], a[112:115], v[68:71], v[24:27]
    v_readfirstlane_b32 s3, v11
    s_and_b32 s3, s3, 3
    s_cmp_eq_u32 s3, 3
    s_cselect_b32 s3, s62, s63
    s_nop 1
    buffer_store_dword v3, v7, s[8:11], s3 offen sc1
    v_mfma_f32_16x16x32_bf16 v[28:31], a[116:119], v[68:71], v[28:31]
    v_mfma_f32_16x16x32_bf16 v[40:43], a[240:243], v[68:71], v[40:43]
    v_mfma_f32_16x16x32_bf16 v[44:47], a[244:247], v[68:71], v[44:47]
    ds_read_b128 v[68:71], v104 offset:49152
    v_mfma_f32_16x16x32_bf16 v[16:19], a[120:123], v[72:75], v[16:19]
    s_mov_b32 s62, s51
    s_mov_b64 s[54:55], 1
    v_mfma_f32_16x16x32_bf16 v[20:23], a[124:127], v[72:75], v[20:23]
    v_mfma_f32_16x16x32_bf16 v[32:35], a[248:251], v[72:75], v[32:35]
    v_mfma_f32_16x16x32_bf16 v[36:39], a[252:255], v[72:75], v[36:39]
    ds_read_b128 v[72:75], v105 offset:32768
    v_mfma_f32_16x16x32_bf16 v[24:27], a[120:123], v[76:79], v[24:27]
    v_mfma_f32_16x16x32_bf16 v[28:31], a[124:127], v[76:79], v[28:31]
    v_mfma_f32_16x16x32_bf16 v[40:43], a[248:251], v[76:79], v[40:43]
    v_mfma_f32_16x16x32_bf16 v[44:47], a[252:255], v[76:79], v[44:47]
    v_cmp_eq_u32 vcc, 0, v4
    s_cmp_ge_u32 s44, 63
    s_cbranch_scc1 L_qq1B
    s_cbranch_vccnz L_qq1B
    s_branch L_qq1A
L_qq0B:
    ds_read_b128 v[76:79], v105 offset:16384
    s_waitcnt lgkmcnt(3)
    v_mfma_f32_16x16x32_bf16 v[16:19], a[0:3], v[64:67], 0
    v_mfma_f32_16x16x32_bf16 v[20:23], a[4:7], v[64:67], 0
    v_mfma_f32_16x16x32_bf16 v[32:35], a[128:131], v[64:67], 0
    buffer_load_dword v4, v5, s[8:11], s45 offen sc1
    v_mfma_f32_16x16x32_bf16 v[36:39], a[132:135], v[64:67], 0
    s_mov_b32 s52, 0
    ds_read_b128 v[64:67], v106 offset:0
    s_waitcnt lgkmcnt(3)
    v_mfma_f32_16x16x32_bf16 v[24:27], a[0:3], v[68:71], 0
    v_mfma_f32_16x16x32_bf16 v[28:31], a[4:7], v[68:71], 0
    v_mfma_f32_16x16x32_bf16 v[40:43], a[128:131], v[68:71], 0
    v_mfma_f32_16x16x32_bf16 v[44:47], a[132:135], v[68:71], 0
    ds_read_b128 v[68:71], v106 offset:16384
    s_waitcnt lgkmcnt(3)
    v_mfma_f32_16x16x32_bf16 v[16:19], a[8:11], v[72:75], v[16:19]
    v_mul_f32 v112, v6, v112
    v_mul_f32 v116, v6, v116
    v_mfma_f32_16x16x32_bf16 v[20:23], a[12:15], v[72:75], v[20:23]
    v_cvt_pk_bf16_f32 v88, v112, v116
    v_mul_f32 v113, v6, v113
    v_mfma_f32_16x16x32_bf16 v[32:35], a[136:139], v[72:75], v[32:35]
    v_mul_f32 v117, v6, v117
    v_cvt_pk_bf16_f32 v89, v113, v117
    v_mfma_f32_16x16x32_bf16 v[36:39], a[140:143], v[72:75], v[36:39]
    v_mul_f32 v114, v6, v114
    v_mul_f32 v118, v6, v118
    ds_read_b128 v[72:75], v107 offset:0
    s_waitcnt lgkmcnt(3)
    v_mfma_f32_16x16x32_bf16 v[24:27], a[8:11], v[76:79], v[24:27]
    v_cvt_pk_bf16_f32 v90, v114, v118
    v_mul_f32 v115, v6, v115
    v_mfma_f32_16x16x32_bf16 v[28:31], a[12:15], v[76:79], v[28:31]
    v_mul_f32 v119, v6, v119
    v_cvt_pk_bf16_f32 v91, v115, v119
    v_mfma_f32_16x16x32_bf16 v[40:43], a[136:139], v[76:79], v[40:43]
    buffer_store_dwordx4 v[88:91], v13, s[8:11], s60 offen offset:0 sc1
    v_mfma_f32_16x16x32_bf16 v[44:47], a[140:143], v[76:79], v[44:47]
    ds_read_b128 v[76:79], v107 offset:16384
    s_waitcnt lgkmcnt(3)
    v_mfma_f32_16x16x32_bf16 v[16:19], a[16:19], v[64:67], v[16:19]
    v_mul_f32 v120, v6, v120
    v_mul_f32 v124, v6, v124
    v_mfma_f32_16x16x32_bf16 v[20:23], a[20:23], v[64:67], v[20:23]
    v_cvt_pk_bf16_f32 v92, v120, v124
    v_mul_f32 v121, v6, v121
    v_mfma_f32_16x16x32_bf16 v[32:35], a[144:147], v[64:67], v[32:35]
    v_mul_f32 v125, v6, v125
    v_cvt_pk_bf16_f32 v93, v121, v125
    v_mfma_f32_16x16x32_bf16 v[36:39], a[148:151], v[64:67], v[36:39]
    v_mul_f32 v122, v6, v122
    v_mul_f32 v126, v6, v126
    ds_read_b128 v[64:67], v104 offset:256
    s_waitcnt lgkmcnt(3)
    v_mfma_f32_16x16x32_bf16 v[24:27], a[16:19], v[68:71], v[24:27]
    v_cvt_pk_bf16_f32 v94, v122, v126
    v_mul_f32 v123, v6, v123
    v_mfma_f32_16x16x32_bf16 v[28:31], a[20:23], v[68:71], v[28:31]
    v_mul_f32 v127, v6, v127
    v_cvt_pk_bf16_f32 v95, v123, v127
    v_mfma_f32_16x16x32_bf16 v[40:43], a[144:147], v[68:71], v[40:43]
    buffer_store_dwordx4 v[92:95], v13, s[8:11], s60 offen offset:256 sc1
    v_mfma_f32_16x16x32_bf16 v[44:47], a[148:151], v[68:71], v[44:47]
    ds_read_b128 v[68:71], v104 offset:16640
    s_waitcnt lgkmcnt(3)
    v_mfma_f32_16x16x32_bf16 v[16:19], a[24:27], v[72:75], v[16:19]
    v_mul_f32 v128, v6, v128
    v_mul_f32 v132, v6, v132
    v_mfma_f32_16x16x32_bf16 v[20:23], a[28:31], v[72:75], v[20:23]
    v_cvt_pk_bf16_f32 v96, v128, v132
    v_mul_f32 v129, v6, v129
    v_mfma_f32_16x16x32_bf16 v[32:35], a[152:155], v[72:75], v[32:35]
    v_mul_f32 v133, v6, v133
    v_cvt_pk_bf16_f32 v97, v129, v133
    v_mfma_f32_16x16x32_bf16 v[36:39], a[156:159], v[72:75], v[36:39]
    v_mul_f32 v130, v6, v130
    v_mul_f32 v134, v6, v134
    ds_read_b128 v[72:75], v105 offset:256
    s_waitcnt lgkmcnt(3)
    v_mfma_f32_16x16x32_bf16 v[24:27], a[24:27], v[76:79], v[24:27]
    v_cvt_pk_bf16_f32 v98, v130, v134
    v_mul_f32 v131, v6, v131
    v_mfma_f32_16x16x32_bf16 v[28:31], a[28:31], v[76:79], v[28:31]
    v_mul_f32 v135, v6, v135
    v_cvt_pk_bf16_f32 v99, v131, v135
    v_mfma_f32_16x16x32_bf16 v[40:43], a[152:155], v[76:79], v[40:43]
    buffer_store_dwordx4 v[96:99], v13, s[8:11], s61 offen offset:0 sc1
    v_mfma_f32_16x16x32_bf16 v[44:47], a[156:159], v[76:79], v[44:47]
    ds_read_b128 v[76:79], v105 offset:16640
    s_waitcnt lgkmcnt(3)
    v_mfma_f32_16x16x32_bf16 v[16:19], a[32:35], v[64:67], v[16:19]
    v_mul_f32 v136, v6, v136
    v_mul_f32 v140, v6, v140
    v_mfma_f32_16x16x32_bf16 v[20:23], a[36:39], v[64:67], v[20:23]
    v_cvt_pk_bf16_f32 v100, v136, v140
    v_mul_f32 v137, v6, v137
    v_mfma_f32_16x16x32_bf16 v[32:35], a[160:163], v[64:67], v[32:35]
    v_mul_f32 v141, v6, v141
    v_cvt_pk_bf16_f32 v101, v137, v141
    v_mfma_f32_16x16x32_bf16 v[36:39], a[164:167], v[64:67], v[36:39]
    v_mul_f32 v138, v6, v138
    v_mul_f32 v142, v6, v142
    ds_read_b128 v[64:67], v106 offset:256
    s_waitcnt lgkmcnt(3)
    v_mfma_f32_16x16x32_bf16 v[24:27], a[32:35], v[68:71], v[24:27]
    v_cvt_pk_bf16_f32 v102, v138, v142
    v_mul_f32 v139, v6, v139
    v_mfma_f32_16x16x32_bf16 v[28:31], a[36:39], v[68:71], v[28:31]
    v_mul_f32 v143, v6, v143
    v_cvt_pk_bf16_f32 v103, v139, v143
    v_mfma_f32_16x16x32_bf16 v[40:43], a[160:163], v[68:71], v[40:43]
    buffer_store_dwordx4 v[100:103], v13, s[8:11], s61 offen offset:256 sc1
    v_mfma_f32_16x16x32_bf16 v[44:47], a[164:167], v[68:71], v[44:47]
    ds_read_b128 v[68:71], v106 offset:16640
    s_waitcnt lgkmcnt(3)
    v_mfma_f32_16x16x32_bf16 v[16:19], a[40:43], v[72:75], v[16:19]
    v_mfma_f32_16x16x32_bf16 v[20:23], a[44:47], v[72:75], v[20:23]
    v_mfma_f32_16x16x32_bf16 v[32:35], a[168:171], v[72:75], v[32:35]
    v_mfma_f32_16x16x32_bf16 v[36:39], a[172:175], v[72:75], v[36:39]
    ds_read_b128 v[72:75], v107 offset:256
    s_waitcnt lgkmcnt(3)
    v_mfma_f32_16x16x32_bf16 v[24:27], a[40:43], v[76:79], v[24:27]
    v_mfma_f32_16x16x32_bf16 v[28:31], a[44:47], v[76:79], v[28:31]
    v_mfma_f32_16x16x32_bf16 v[40:43], a[168:171], v[76:79], v[40:43]
    v_mfma_f32_16x16x32_bf16 v[44:47], a[172:175], v[76:79], v[44:47]
    s_waitcnt vmcnt(4)
    v_cmp_eq_u32 vcc, 0, v4
    s_cmp_ge_u32 s44, 63
    s_cbranch_scc1 Lq_34
    s_cbranch_vccnz Lq_34
    s_add_u32 m0, s53, 32768
    s_add_u32 s3, s46, 4096
    buffer_load_dwordx4 v1, s[8:11], s46 offen offset:0 sc1 lds
    buffer_load_dwordx4 v1, s[8:11], s46 offen offset:1024 sc1 lds
    buffer_load_dwordx4 v1, s[8:11], s46 offen offset:2048 sc1 lds
    buffer_load_dwordx4 v1, s[8:11], s46 offen offset:3072 sc1 lds
    s_add_u32 m0, s53, 36864
    s_add_u32 s45, s45, 128
    buffer_load_dwordx4 v1, s[8:11], s3 offen offset:0 sc1 lds
    buffer_load_dwordx4 v1, s[8:11], s3 offen offset:1024 sc1 lds
    buffer_load_dwordx4 v1, s[8:11], s3 offen offset:2048 sc1 lds
    buffer_load_dwordx4 v1, s[8:11], s3 offen offset:3072 sc1 lds
    s_add_u32 s46, s46, 32768
    s_mov_b32 s52, 1
Lq_34:
Lq_34x:
    ds_read_b128 v[76:79], v107 offset:16640
    s_waitcnt lgkmcnt(3)
    v_mfma_f32_16x16x32_bf16 v[16:19], a[48:51], v[64:67], v[16:19]
    v_mfma_f32_16x16x32_bf16 v[20:23], a[52:55], v[64:67], v[20:23]
    v_mfma_f32_16x16x32_bf16 v[32:35], a[176:179], v[64:67], v[32:35]
    v_mfma_f32_16x16x32_bf16 v[36:39], a[180:183], v[64:67], v[36:39]
    ds_read_b128 v[64:67], v104 offset:512
    s_waitcnt lgkmcnt(3)
    v_mfma_f32_16x16x32_bf16 v[24:27], a[48:51], v[68:71], v[24:27]
    v_mfma_f32_16x16x32_bf16 v[28:31], a[52:55], v[68:71], v[28:31]
    v_mfma_f32_16x16x32_bf16 v[40:43], a[176:179], v[68:71], v[40:43]
    v_mfma_f32_16x16x32_bf16 v[44:47], a[180:183], v[68:71], v[44:47]
    ds_read_b128 v[68:71], v104 offset:16896
    s_waitcnt lgkmcnt(3)
    v_mfma_f32_16x16x32_bf16 v[16:19], a[56:59], v[72:75], v[16:19]
    v_mfma_f32_16x16x32_bf16 v[20:23], a[60:63], v[72:75], v[20:23]
    v_mfma_f32_16x16x32_bf16 v[32:35], a[184:187], v[72:75], v[32:35]
    v_mfma_f32_16x16x32_bf16 v[36:39], a[188:191], v[72:75], v[36:39]
    ds_read_b128 v[72:75], v105 offset:512
    s_waitcnt lgkmcnt(3)
    v_mfma_f32_16x16x32_bf16 v[24:27], a[56:59], v[76:79], v[24:27]
    v_mfma_f32_16x16x32_bf16 v[28:31], a[60:63], v[76:79], v[28:31]
    v_mfma_f32_16x16x32_bf16 v[40:43], a[184:187], v[76:79], v[40:43]
    v_mfma_f32_16x16x32_bf16 v[44:47], a[188:191], v[76:79], v[44:47]
    ds_read_b128 v[76:79], v105 offset:16896
    s_waitcnt lgkmcnt(3)
    v_mfma_f32_16x16x32_bf16 v[16:19], a[64:67], v[64:67], v[16:19]
    v_mfma_f32_16x16x32_bf16 v[20:23], a[68:71], v[64:67], v[20:23]
    v_mfma_f32_16x16x32_bf16 v[32:35], a[192:195], v[64:67], v[32:35]
    v_mfma_f32_16x16x32_bf16 v[36:39], a[196:199], v[64:67], v[36:39]
    ds_read_b128 v[64:67], v106 offset:512
    s_waitcnt lgkmcnt(3)
    v_mfma_f32_16x16x32_bf16 v[24:27], a[64:67], v[68:71], v[24:27]
    v_mfma_f32_16x16x32_bf16 v[28:31], a[68:71], v[68:71], v[28:31]
    v_mfma_f32_16x16x32_bf16 v[40:43], a[192:195], v[68:71], v[40:43]
    v_mfma_f32_16x16x32_bf16 v[44:47], a[196:199], v[68:71], v[44:47]
    ds_read_b128 v[68:71], v106 offset:16896
    s_waitcnt lgkmcnt(3)
    v_mfma_f32_16x16x32_bf16 v[16:19], a[72:75], v[72:75], v[16:19]
    v_mfma_f32_16x16x32_bf16 v[20:23], a[76:79], v[72:75], v[20:23]
    v_mfma_f32_16x16x32_bf16 v[32:35], a[200:203], v[72:75], v[32:35]
    v_mfma_f32_16x16x32_bf16 v[36:39], a[204:207], v[72:75], v[36:39]
    ds_read_b128 v[72:75], v107 offset:512
    s_waitcnt lgkmcnt(3)
    v_mfma_f32_16x16x32_bf16 v[24:27], a[72:75], v[76:79], v[24:27]
    buffer_load_dword v4, v5, s[8:11], s45 offen sc1
    v_mfma_f32_16x16x32_bf16 v[28:31], a[76:79], v[76:79], v[28:31]
    v_mfma_f32_16x16x32_bf16 v[40:43], a[200:203], v[76:79], v[40:43]
    v_mfma_f32_16x16x32_bf16 v[44:47], a[204:207], v[76:79], v[44:47]
    ds_read_b128 v[76:79], v107 offset:16896
    s_waitcnt lgkmcnt(3)
    v_mfma_f32_16x16x32_bf16 v[16:19], a[80:83], v[64:67], v[16:19]
    v_mfma_f32_16x16x32_bf16 v[20:23], a[84:87], v[64:67], v[20:23]
    v_mfma_f32_16x16x32_bf16 v[32:35], a[208:211], v[64:67], v[32:35]
    v_mfma_f32_16x16x32_bf16 v[36:39], a[212:215], v[64:67], v[36:39]
    ds_read_b128 v[64:67], v104 offset:768
    s_waitcnt lgkmcnt(3)
    v_mfma_f32_16x16x32_bf16 v[24:27], a[80:83], v[68:71], v[24:27]
    v_mfma_f32_16x16x32_bf16 v[28:31], a[84:87], v[68:71], v[28:31]
    v_mfma_f32_16x16x32_bf16 v[40:43], a[208:211], v[68:71], v[40:43]
    v_mfma_f32_16x16x32_bf16 v[44:47], a[212:215], v[68:71], v[44:47]
    ds_read_b128 v[68:71], v104 offset:17152
    s_waitcnt lgkmcnt(3)
    v_mfma_f32_16x16x32_bf16 v[16:19], a[88:91], v[72:75], v[16:19]
    v_mfma_f32_16x16x32_bf16 v[20:23], a[92:95], v[72:75], v[20:23]
    v_mfma_f32_16x16x32_bf16 v[32:35], a[216:219], v[72:75], v[32:35]
    v_mfma_f32_16x16x32_bf16 v[36:39], a[220:223], v[72:75], v[36:39]
    ds_read_b128 v[72:75], v105 offset:768
    s_waitcnt lgkmcnt(3)
    v_mfma_f32_16x16x32_bf16 v[24:27], a[88:91], v[76:79], v[24:27]
    v_mfma_f32_16x16x32_bf16 v[28:31], a[92:95], v[76:79], v[28:31]
    v_mfma_f32_16x16x32_bf16 v[40:43], a[216:219], v[76:79], v[40:43]
    v_mfma_f32_16x16x32_bf16 v[44:47], a[220:223], v[76:79], v[44:47]
    ds_read_b128 v[76:79], v105 offset:17152
    s_waitcnt lgkmcnt(3)
    v_mfma_f32_16x16x32_bf16 v[16:19], a[96:99], v[64:67], v[16:19]
    v_mfma_f32_16x16x32_bf16 v[20:23], a[100:103], v[64:67], v[20:23]
    v_mfma_f32_16x16x32_bf16 v[32:35], a[224:227], v[64:67], v[32:35]
    v_mfma_f32_16x16x32_bf16 v[36:39], a[228:231], v[64:67], v[36:39]
    s_cmp_lg_u32 s52, 0
    s_cbranch_scc0 Lq_35a
    s_waitcnt vmcnt(9)
    s_mov_b64 exec, s[54:55]
    ds_add_rtn_u32 v11, v12, v3 offset:4
    s_mov_b64 exec, -1
    s_branch Lq_35x
Lq_35a:
    s_waitcnt vmcnt(0)
    s_mov_b64 exec, s[54:55]
    ds_add_rtn_u32 v11, v12, v3 offset:4
    s_mov_b64 exec, -1
    v_cmp_eq_u32 vcc, 0, v4
    s_cmp_ge_u32 s44, 63
    s_cbranch_scc1 Lq_35
    s_cbranch_vccnz Lq_35
    s_add_u32 m0, s53, 32768
    s_add_u32 s3, s46, 4096
    buffer_load_dwordx4 v1, s[8:11], s46 offen offset:0 sc1 lds
    buffer_load_dwordx4 v1, s[8:11], s46 offen offset:1024 sc1 lds
    buffer_load_dwordx4 v1, s[8:11], s46 offen offset:2048 sc1 lds
    buffer_load_dwordx4 v1, s[8:11], s46 offen offset:3072 sc1 lds
    s_add_u32 m0, s53, 36864
    s_add_u32 s45, s45, 128
    buffer_load_dwordx4 v1, s[8:11], s3 offen offset:0 sc1 lds
    buffer_load_dwordx4 v1, s[8:11], s3 offen offset:1024 sc1 lds
    buffer_load_dwordx4 v1, s[8:11], s3 offen offset:2048 sc1 lds
    buffer_load_dwordx4 v1, s[8:11], s3 offen offset:3072 sc1 lds
    s_add_u32 s46, s46, 32768
    s_mov_b32 s52, 2
Lq_35:
Lq_35x:
    ds_read_b128 v[64:67], v106 offset:768
    s_waitcnt lgkmcnt(3)
    v_mfma_f32_16x16x32_bf16 v[24:27], a[96:99], v[68:71], v[24:27]
    s_mov_b32 s60, s47
    s_mov_b32 s61, s48
    s_mov_b32 s51, s50
    v_mfma_f32_16x16x32_bf16 v[28:31], a[100:103], v[68:71], v[28:31]
    v_mfma_f32_16x16x32_bf16 v[40:43], a[224:227], v[68:71], v[40:43]
    s_add_u32 s47, s47, 28672
    s_add_u32 s48, s48, 28672
    v_mfma_f32_16x16x32_bf16 v[44:47], a[228:231], v[68:71], v[44:47]
    ds_read_b128 v[68:71], v106 offset:17152
    s_waitcnt lgkmcnt(3)
    v_mfma_f32_16x16x32_bf16 v[16:19], a[104:107], v[72:75], v[16:19]
    v_mfma_f32_16x16x32_bf16 v[20:23], a[108:111], v[72:75], v[20:23]
    v_mfma_f32_16x16x32_bf16 v[32:35], a[232:235], v[72:75], v[32:35]
    s_add_u32 s50, s50, 4096
    s_add_u32 s44, s44, 1
    v_mfma_f32_16x16x32_bf16 v[36:39], a[236:239], v[72:75], v[36:39]
    ds_read_b128 v[72:75], v107 offset:768
    s_waitcnt lgkmcnt(3)
    v_mfma_f32_16x16x32_bf16 v[24:27], a[104:107], v[76:79], v[24:27]
    v_mfma_f32_16x16x32_bf16 v[28:31], a[108:111], v[76:79], v[28:31]
    v_mfma_f32_16x16x32_bf16 v[40:43], a[232:235], v[76:79], v[40:43]
    v_mfma_f32_16x16x32_bf16 v[44:47], a[236:239], v[76:79], v[44:47]
    ds_read_b128 v[76:79], v107 offset:17152
    s_waitcnt lgkmcnt(3)
    v_mfma_f32_16x16x32_bf16 v[16:19], a[112:115], v[64:67], v[16:19]
    v_readfirstlane_b32 s3, v11
    s_and_b32 s3, s3, 3
    s_cmp_eq_u32 s3, 3
    s_cselect_b32 s3, s62, s63
    s_nop 1
    buffer_store_dword v3, v7, s[8:11], s3 offen sc1
    v_mfma_f32_16x16x32_bf16 v[20:23], a[116:119], v[64:67], v[20:23]
    v_mfma_f32_16x16x32_bf16 v[32:35], a[240:243], v[64:67], v[32:35]
    s_mov_b32 s62, s51
    s_mov_b64 s[54:55], 1
    v_mfma_f32_16x16x32_bf16 v[36:39], a[244:247], v[64:67], v[36:39]
    s_cmp_lg_u32 s52, 1
    s_cbranch_scc1 L_qq0T
    s_waitcnt vmcnt(1) lgkmcnt(0)
    s_barrier
    ds_read_b128 v[64:67], v104 offset:32768
    v_mfma_f32_16x16x32_bf16 v[24:27], a[112:115], v[68:71], v[24:27]
    v_mfma_f32_16x16x32_bf16 v[28:31], a[116:119], v[68:71], v[28:31]
    v_mfma_f32_16x16x32_bf16 v[40:43], a[240:243], v[68:71], v[40:43]
    v_mfma_f32_16x16x32_bf16 v[44:47], a[244:247], v[68:71], v[44:47]
    ds_read_b128 v[68:71], v104 offset:49152
    v_mfma_f32_16x16x32_bf16 v[16:19], a[120:123], v[72:75], v[16:19]
    v_mfma_f32_16x16x32_bf16 v[20:23], a[124:127], v[72:75], v[20:23]
    v_mfma_f32_16x16x32_bf16 v[32:35], a[248:251], v[72:75], v[32:35]
    v_mfma_f32_16x16x32_bf16 v[36:39], a[252:255], v[72:75], v[36:39]
    ds_read_b128 v[72:75], v105 offset:32768
    v_mfma_f32_16x16x32_bf16 v[24:27], a[120:123], v[76:79], v[24:27]
    v_mfma_f32_16x16x32_bf16 v[28:31], a[124:127], v[76:79], v[28:31]
    v_mfma_f32_16x16x32_bf16 v[40:43], a[248:251], v[76:79], v[40:43]
    v_mfma_f32_16x16x32_bf16 v[44:47], a[252:255], v[76:79], v[44:47]
    v_cmp_eq_u32 vcc, 0, v4
    s_cmp_ge_u32 s44, 63
    s_cbranch_scc1 L_qq1B
    s_cbranch_vccnz L_qq1B
    s_branch L_qq1A
L_qq0T:
    s_waitcnt lgkmcnt(0)
    buffer_load_dword v4, v5, s[8:11], s45 offen sc1
    v_mfma_f32_16x16x32_bf16 v[24:27], a[112:115], v[68:71], v[24:27]
    v_mfma_f32_16x16x32_bf16 v[28:31], a[116:119], v[68:71], v[28:31]
    v_mfma_f32_16x16x32_bf16 v[40:43], a[240:243], v[68:71], v[40:43]
    v_mfma_f32_16x16x32_bf16 v[44:47], a[244:247], v[68:71], v[44:47]
    v_mfma_f32_16x16x32_bf16 v[16:19], a[120:123], v[72:75], v[16:19]
    v_mfma_f32_16x16x32_bf16 v[20:23], a[124:127], v[72:75], v[20:23]
    v_mfma_f32_16x16x32_bf16 v[32:35], a[248:251], v[72:75], v[32:35]
    v_mfma_f32_16x16x32_bf16 v[36:39], a[252:255], v[72:75], v[36:39]
    v_mfma_f32_16x16x32_bf16 v[24:27], a[120:123], v[76:79], v[24:27]
    v_mfma_f32_16x16x32_bf16 v[28:31], a[124:127], v[76:79], v[28:31]
    v_mfma_f32_16x16x32_bf16 v[40:43], a[248:251], v[76:79], v[40:43]
    v_mfma_f32_16x16x32_bf16 v[44:47], a[252:255], v[76:79], v[44:47]
    s_nop 0
    v_mul_f32 v16, v6, v16
    v_mul_f32 v20, v6, v20
    v_cvt_pk_bf16_f32 v88, v16, v20
    v_mul_f32 v17, v6, v17
    v_mul_f32 v21, v6, v21
    v_cvt_pk_bf16_f32 v89, v17, v21
    v_mul_f32 v18, v6, v18
    v_mul_f32 v22, v6, v22
    v_cvt_pk_bf16_f32 v90, v18, v22
    v_mul_f32 v19, v6, v19
    v_mul_f32 v23, v6, v23
    v_cvt_pk_bf16_f32 v91, v19, v23
    buffer_store_dwordx4 v[88:91], v13, s[8:11], s60 offen offset:0 sc1
    v_mul_f32 v24, v6, v24
    v_mul_f32 v28, v6, v28
    v_cvt_pk_bf16_f32 v92, v24, v28
    v_mul_f32 v25, v6, v25
    v_mul_f32 v29, v6, v29
    v_cvt_pk_bf16_f32 v93, v25, v29
    v_mul_f32 v26, v6, v26
    v_mul_f32 v30, v6, v30
    v_cvt_pk_bf16_f32 v94, v26, v30
    v_mul_f32 v27, v6, v27
    v_mul_f32 v31, v6, v31
    v_cvt_pk_bf16_f32 v95, v27, v31
    buffer_store_dwordx4 v[92:95], v13, s[8:11], s60 offen offset:256 sc1
    v_mul_f32 v32, v6, v32
    v_mul_f32 v36, v6, v36
    v_cvt_pk_bf16_f32 v96, v32, v36
    v_mul_f32 v33, v6, v33
    v_mul_f32 v37, v6, v37
    v_cvt_pk_bf16_f32 v97, v33, v37
    v_mul_f32 v34, v6, v34
    v_mul_f32 v38, v6, v38
    v_cvt_pk_bf16_f32 v98, v34, v38
    v_mul_f32 v35, v6, v35
    v_mul_f32 v39, v6, v39
    v_cvt_pk_bf16_f32 v99, v35, v39
    buffer_store_dwordx4 v[96:99], v13, s[8:11], s61 offen offset:0 sc1
    v_mul_f32 v40, v6, v40
    v_mul_f32 v44, v6, v44
    v_cvt_pk_bf16_f32 v100, v40, v44
    v_mul_f32 v41, v6, v41
    v_mul_f32 v45, v6, v45
    v_cvt_pk_bf16_f32 v101, v41, v45
    v_mul_f32 v42, v6, v42
    v_mul_f32 v46, v6, v46
    v_cvt_pk_bf16_f32 v102, v42, v46
    v_mul_f32 v43, v6, v43
    v_mul_f32 v47, v6, v47
    v_cvt_pk_bf16_f32 v103, v43, v47
    buffer_store_dwordx4 v[100:103], v13, s[8:11], s61 offen offset:256 sc1
    s_cmp_eq_u32 s52, 2
    s_cbranch_scc0 L_qq0X
    s_waitcnt vmcnt(0)
    s_branch L_qq0Y
L_qq0X:
    s_waitcnt vmcnt(4)
    v_cmp_eq_u32 vcc, 0, v4
    s_cmp_ge_u32 s44, 64
    s_cbranch_scc1 L_qq0U
    s_cbranch_vccnz L_qq0U
    s_add_u32 m0, s53, 32768
    s_add_u32 s3, s46, 4096
    buffer_load_dwordx4 v1, s[8:11], s46 offen offset:0 sc1 lds
    buffer_load_dwordx4 v1, s[8:11], s46 offen offset:1024 sc1 lds
    buffer_load_dwordx4 v1, s[8:11], s46 offen offset:2048 sc1 lds
    buffer_load_dwordx4 v1, s[8:11], s46 offen offset:3072 sc1 lds
    s_add_u32 m0, s53, 36864
    s_add_u32 s45, s45, 128
    buffer_load_dwordx4 v1, s[8:11], s3 offen offset:0 sc1 lds
    buffer_load_dwordx4 v1, s[8:11], s3 offen offset:1024 sc1 lds
    buffer_load_dwordx4 v1, s[8:11], s3 offen offset:2048 sc1 lds
    buffer_load_dwordx4 v1, s[8:11], s3 offen offset:3072 sc1 lds
    s_add_u32 s46, s46, 32768
    buffer_load_dword v4, v5, s[8:11], s45 offen sc1
    s_waitcnt vmcnt(9)
L_qq0Y:
    s_mov_b64 exec, s[54:55]
    ds_add_rtn_u32 v11, v12, v3 offset:0
    s_mov_b64 exec, -1
    s_waitcnt lgkmcnt(0)
    v_readfirstlane_b32 s3, v11
    s_and_b32 s3, s3, 3
    s_cmp_eq_u32 s3, 3
    s_cselect_b32 s3, s62, s63
    s_nop 1
    buffer_store_dword v3, v7, s[8:11], s3 offen sc1
    s_mov_b32 s60, s63
    s_mov_b32 s61, s63
    s_mov_b32 s62, s63
    s_mov_b64 s[54:55], 0
    s_waitcnt vmcnt(1)
    s_branch L_qq0V
L_qq0U:
    s_waitcnt vmcnt(0)
    buffer_load_dword v4, v5, s[8:11], s45 offen sc1
    s_mov_b64 exec, s[54:55]
    ds_add_rtn_u32 v11, v12, v3 offset:0
    s_mov_b64 exec, -1
    s_waitcnt lgkmcnt(0)
    v_readfirstlane_b32 s3, v11
    s_and_b32 s3, s3, 3
    s_cmp_eq_u32 s3, 3
    s_cselect_b32 s3, s62, s63
    s_nop 1
    buffer_store_dword v3, v7, s[8:11], s3 offen sc1
    s_cmp_ge_u32 s44, 64
    s_cbranch_scc1 L_end
    s_waitcnt vmcnt(1)
L_qq0W:
    s_mov_b32 s60, s63
    s_mov_b32 s61, s63
    s_mov_b32 s62, s63
    s_mov_b64 s[54:55], 0
    v_cmp_eq_u32 vcc, 0, v4
    s_cbranch_vccz Lq_36
Lw_37:
    buffer_load_dword v4, v5, s[8:11], s45 offen offset:0 sc1
    s_waitcnt vmcnt(0)
    v_cmp_eq_u32 vcc, 0, v4
    s_cbranch_vccz Lwd_38
    s_sleep 1
    s_sub_u32 s98, s98, 1
    s_cbranch_scc1 L_end
    s_branch Lw_37
Lwd_38:
Lq_36:
    s_add_u32 m0, s53, 32768
    s_add_u32 s3, s46, 4096
    buffer_load_dwordx4 v1, s[8:11], s46 offen offset:0 sc1 lds
    buffer_load_dwordx4 v1, s[8:11], s46 offen offset:1024 sc1 lds
    buffer_load_dwordx4 v1, s[8:11], s46 offen offset:2048 sc1 lds
    buffer_load_dwordx4 v1, s[8:11], s46 offen offset:3072 sc1 lds
    s_add_u32 m0, s53, 36864
    s_add_u32 s45, s45, 128
    buffer_load_dwordx4 v1, s[8:11], s3 offen offset:0 sc1 lds
    buffer_load_dwordx4 v1, s[8:11], s3 offen offset:1024 sc1 lds
    buffer_load_dwordx4 v1, s[8:11], s3 offen offset:2048 sc1 lds
    buffer_load_dwordx4 v1, s[8:11], s3 offen offset:3072 sc1 lds
    s_add_u32 s46, s46, 32768
    buffer_load_dword v4, v5, s[8:11], s45 offen sc1
    s_waitcnt vmcnt(0)
L_qq0V:
    s_barrier
    ds_read_b128 v[64:67], v104 offset:32768
    ds_read_b128 v[68:71], v104 offset:49152
    ds_read_b128 v[72:75], v105 offset:32768
    v_cmp_eq_u32 vcc, 0, v4
    s_cmp_ge_u32 s44, 63
    s_cbranch_scc1 L_qq1B
    s_cbranch_vccnz L_qq1B
    s_branch L_qq1A
L_qq1A:
    ds_read_b128 v[76:79], v105 offset:49152
    s_waitcnt lgkmcnt(3)
    v_mfma_f32_16x16x32_bf16 v[112:115], a[0:3], v[64:67], 0
    s_add_u32 m0, s53, 0
    s_add_u32 s3, s46, 4096
    buffer_load_dwordx4 v1, s[8:11], s46 offen offset:0 sc1 lds
    v_mfma_f32_16x16x32_bf16 v[116:119], a[4:7], v[64:67], 0
    v_mfma_f32_16x16x32_bf16 v[128:131], a[128:131], v[64:67], 0
    buffer_load_dwordx4 v1, s[8:11], s46 offen offset:1024 sc1 lds
    v_mfma_f32_16x16x32_bf16 v[132:135], a[132:135], v[64:67], 0
    ds_read_b128 v[64:67], v106 offset:32768
    s_waitcnt lgkmcnt(3)
    v_mfma_f32_16x16x32_bf16 v[120:123], a[0:3], v[68:71], 0
    buffer_load_dwordx4 v1, s[8:11], s46 offen offset:2048 sc1 lds
    v_mfma_f32_16x16x32_bf16 v[124:127], a[4:7], v[68:71], 0
    v_mfma_f32_16x16x32_bf16 v[136:139], a[128:131], v[68:71], 0
    buffer_load_dwordx4 v1, s[8:11], s46 offen offset:3072 sc1 lds
    v_mfma_f32_16x16x32_bf16 v[140:143], a[132:135], v[68:71], 0
    ds_read_b128 v[68:71], v106 offset:49152
    s_waitcnt lgkmcnt(3)
    v_mfma_f32_16x16x32_bf16 v[112:115], a[8:11], v[72:75], v[112:115]
    s_add_u32 m0, s53, 4096
    s_add_u32 s45, s45, 128
    buffer_load_dwordx4 v1, s[8:11], s3 offen offset:0 sc1 lds
    v_mfma_f32_16x16x32_bf16 v[116:119], a[12:15], v[72:75], v[116:119]
    v_mfma_f32_16x16x32_bf16 v[128:131], a[136:139], v[72:75], v[128:131]
    buffer_load_dwordx4 v1, s[8:11], s3 offen offset:1024 sc1 lds
    v_mfma_f32_16x16x32_bf16 v[132:135], a[140:143], v[72:75], v[132:135]
    ds_read_b128 v[72:75], v107 offset:32768
    s_waitcnt lgkmcnt(3)
    v_mfma_f32_16x16x32_bf16 v[120:123], a[8:11], v[76:79], v[120:123]
    buffer_load_dwordx4 v1, s[8:11], s3 offen offset:2048 sc1 lds
    v_mfma_f32_16x16x32_bf16 v[124:127], a[12:15], v[76:79], v[124:127]
    v_mfma_f32_16x16x32_bf16 v[136:139], a[136:139], v[76:79], v[136:139]
    buffer_load_dwordx4 v1, s[8:11], s3 offen offset:3072 sc1 lds
    s_add_u32 s46, s46, 32768
    v_mfma_f32_16x16x32_bf16 v[140:143], a[140:143], v[76:79], v[140:143]
    ds_read_b128 v[76:79], v107 offset:49152
    s_waitcnt lgkmcnt(3)
    v_mfma_f32_16x16x32_bf16 v[112:115], a[16:19], v[64:67], v[112:115]
    buffer_load_dword v4, v5, s[8:11], s45 offen sc1
    v_mfma_f32_16x16x32_bf16 v[116:119], a[20:23], v[64:67], v[116:119]
    v_mfma_f32_16x16x32_bf16 v[128:131], a[144:147], v[64:67], v[128:131]
    v_mul_f32 v16, v6, v16
    v_mul_f32 v20, v6, v20
    v_mfma_f32_16x16x32_bf16 v[132:135], a[148:151], v[64:67], v[132:135]
    v_cvt_pk_bf16_f32 v88, v16, v20
    v_mul_f32 v17, v6, v17
    ds_read_b128 v[64:67], v104 offset:33024
    s_waitcnt lgkmcnt(3)
    v_mfma_f32_16x16x32_bf16 v[120:123], a[16:19], v[68:71], v[120:123]
    v_mul_f32 v21, v6, v21
    v_cvt_pk_bf16_f32 v89, v17, v21
    v_mfma_f32_16x16x32_bf16 v[124:127], a[20:23], v[68:71], v[124:127]
    v_mul_f32 v18, v6, v18
    v_mul_f32 v22, v6, v22
    v_mfma_f32_16x16x32_bf16 v[136:139], a[144:147], v[68:71], v[136:139]
    v_cvt_pk_bf16_f32 v90, v18, v22
    v_mul_f32 v19, v6, v19
    v_mfma_f32_16x16x32_bf16 v[140:143], a[148:151], v[68:71], v[140:143]
    v_mul_f32 v23, v6, v23
    v_cvt_pk_bf16_f32 v91, v19, v23
    ds_read_b128 v[68:71], v104 offset:49408
    s_waitcnt lgkmcnt(3)
    v_mfma_f32_16x16x32_bf16 v[112:115], a[24:27], v[72:75], v[112:115]
    buffer_store_dwordx4 v[88:91], v13, s[8:11], s60 offen offset:0 sc1
    v_mfma_f32_16x16x32_bf16 v[116:119], a[28:31], v[72:75], v[116:119]
    v_mfma_f32_16x16x32_bf16 v[128:131], a[152:155], v[72:75], v[128:131]
    v_mul_f32 v24, v6, v24
    v_mul_f32 v28, v6, v28
    v_mfma_f32_16x16x32_bf16 v[132:135], a[156:159], v[72:75], v[132:135]
    v_cvt_pk_bf16_f32 v92, v24, v28
    v_mul_f32 v25, v6, v25
    ds_read_b128 v[72:75], v105 offset:33024
    s_waitcnt lgkmcnt(3)
    v_mfma_f32_16x16x32_bf16 v[120:123], a[24:27], v[76:79], v[120:123]
    v_mul_f32 v29, v6, v29
    v_cvt_pk_bf16_f32 v93, v25, v29
    v_mfma_f32_16x16x32_bf16 v[124:127], a[28:31], v[76:79], v[124:127]
    v_mul_f32 v26, v6, v26
    v_mul_f32 v30, v6, v30
    v_mfma_f32_16x16x32_bf16 v[136:139], a[152:155], v[76:79], v[136:139]
    v_cvt_pk_bf16_f32 v94, v26, v30
    v_mul_f32 v27, v6, v27
    v_mfma_f32_16x16x32_bf16 v[140:143], a[156:159], v[76:79], v[140:143]
    v_mul_f32 v31, v6, v31
    v_cvt_pk_bf16_f32 v95, v27, v31
    ds_read_b128 v[76:79], v105 offset:49408
    s_waitcnt lgkmcnt(3)
    v_mfma_f32_16x16x32_bf16 v[112:115], a[32:35], v[64:67], v[112:115]
    buffer_store_dwordx4 v[92:95], v13, s[8:11], s60 offen offset:256 sc1
    v_mfma_f32_16x16x32_bf16 v[116:119], a[36:39], v[64:67], v[116:119]
    v_mfma_f32_16x16x32_bf16 v[128:131], a[160:163], v[64:67], v[128:131]
    v_mul_f32 v32, v6, v32
    v_mul_f32 v36, v6, v36
    v_mfma_f32_16x16x32_bf16 v[132:135], a[164:167], v[64:67], v[132:135]
    v_cvt_pk_bf16_f32 v96, v32, v36
    v_mul_f32 v33, v6, v33
    ds_read_b128 v[64:67], v106 offset:33024
    s_waitcnt lgkmcnt(3)
    v_mfma_f32_16x16x32_bf16 v[120:123], a[32:35], v[68:71], v[120:123]
    v_mul_f32 v37, v6, v37
    v_cvt_pk_bf16_f32 v97, v33, v37
    v_mfma_f32_16x16x32_bf16 v[124:127], a[36:39], v[68:71], v[124:127]
    v_mul_f32 v34, v6, v34
    v_mul_f32 v38, v6, v38
    v_mfma_f32_16x16x32_bf16 v[136:139], a[160:163], v[68:71], v[136:139]
    v_cvt_pk_bf16_f32 v98, v34, v38
    v_mul_f32 v35, v6, v35
    v_mfma_f32_16x16x32_bf16 v[140:143], a[164:167], v[68:71], v[140:143]
    v_mul_f32 v39, v6, v39
    v_cvt_pk_bf16_f32 v99, v35, v39
    ds_read_b128 v[68:71], v106 offset:49408
    s_waitcnt lgkmcnt(3)
    v_mfma_f32_16x16x32_bf16 v[112:115], a[40:43], v[72:75], v[112:115]
    buffer_store_dwordx4 v[96:99], v13, s[8:11], s61 offen offset:0 sc1
    v_mfma_f32_16x16x32_bf16 v[116:119], a[44:47], v[72:75], v[116:119]
    v_mfma_f32_16x16x32_bf16 v[128:131], a[168:171], v[72:75], v[128:131]
    v_mul_f32 v40, v6, v40
    v_mul_f32 v44, v6, v44
    v_mfma_f32_16x16x32_bf16 v[132:135], a[172:175], v[72:75], v[132:135]
    v_cvt_pk_bf16_f32 v100, v40, v44
    v_mul_f32 v41, v6, v41
    ds_read_b128 v[72:75], v107 offset:33024
    s_waitcnt lgkmcnt(3)
    v_mfma_f32_16x16x32_bf16 v[120:123], a[40:43], v[76:79], v[120:123]
    v_mul_f32 v45, v6, v45
    v_cvt_pk_bf16_f32 v101, v41, v45
    v_mfma_f32_16x16x32_bf16 v[124:127], a[44:47], v[76:79], v[124:127]
    v_mul_f32 v42, v6, v42
    v_mul_f32 v46, v6, v46
    v_mfma_f32_16x16x32_bf16 v[136:139], a[168:171], v[76:79], v[136:139]
    v_cvt_pk_bf16_f32 v102, v42, v46
    v_mul_f32 v43, v6, v43
    v_mfma_f32_16x16x32_bf16 v[140:143], a[172:175], v[76:79], v[140:143]
    v_mul_f32 v47, v6, v47
    v_cvt_pk_bf16_f32 v103, v43, v47
    ds_read_b128 v[76:79], v107 offset:49408
    s_waitcnt lgkmcnt(3)
    v_mfma_f32_16x16x32_bf16 v[112:115], a[48:51], v[64:67], v[112:115]
    buffer_store_dwordx4 v[100:103], v13, s[8:11], s61 offen offset:256 sc1
    v_mfma_f32_16x16x32_bf16 v[116:119], a[52:55], v[64:67], v[116:119]
    v_mfma_f32_16x16x32_bf16 v[128:131], a[176:179], v[64:67], v[128:131]
    v_mfma_f32_16x16x32_bf16 v[132:135], a[180:183], v[64:67], v[132:135]
    ds_read_b128 v[64:67], v104 offset:33280
    s_waitcnt lgkmcnt(3)
    v_mfma_f32_16x16x32_bf16 v[120:123], a[48:51], v[68:71], v[120:123]
    v_mfma_f32_16x16x32_bf16 v[124:127], a[52:55], v[68:71], v[124:127]
    v_mfma_f32_16x16x32_bf16 v[136:139], a[176:179], v[68:71], v[136:139]
    v_mfma_f32_16x16x32_bf16 v[140:143], a[180:183], v[68:71], v[140:143]
    ds_read_b128 v[68:71], v104 offset:49664
    s_waitcnt lgkmcnt(3)
    v_mfma_f32_16x16x32_bf16 v[112:115], a[56:59], v[72:75], v[112:115]
    v_mfma_f32_16x16x32_bf16 v[116:119], a[60:63], v[72:75], v[116:119]
    v_mfma_f32_16x16x32_bf16 v[128:131], a[184:187], v[72:75], v[128:131]
    v_mfma_f32_16x16x32_bf16 v[132:135], a[188:191], v[72:75], v[132:135]
    ds_read_b128 v[72:75], v105 offset:33280
    s_waitcnt lgkmcnt(3)
    v_mfma_f32_16x16x32_bf16 v[120:123], a[56:59], v[76:79], v[120:123]
    v_mfma_f32_16x16x32_bf16 v[124:127], a[60:63], v[76:79], v[124:127]
    v_mfma_f32_16x16x32_bf16 v[136:139], a[184:187], v[76:79], v[136:139]
    v_mfma_f32_16x16x32_bf16 v[140:143], a[188:191], v[76:79], v[140:143]
    ds_read_b128 v[76:79], v105 offset:49664
    s_waitcnt lgkmcnt(3)
    v_mfma_f32_16x16x32_bf16 v[112:115], a[64:67], v[64:67], v[112:115]
    v_mfma_f32_16x16x32_bf16 v[116:119], a[68:71], v[64:67], v[116:119]
    v_mfma_f32_16x16x32_bf16 v[128:131], a[192:195], v[64:67], v[128:131]
    v_mfma_f32_16x16x32_bf16 v[132:135], a[196:199], v[64:67], v[132:135]
    ds_read_b128 v[64:67], v106 offset:33280
    s_waitcnt lgkmcnt(3)
    v_mfma_f32_16x16x32_bf16 v[120:123], a[64:67], v[68:71], v[120:123]
    v_mfma_f32_16x16x32_bf16 v[124:127], a[68:71], v[68:71], v[124:127]
    v_mfma_f32_16x16x32_bf16 v[136:139], a[192:195], v[68:71], v[136:139]
    v_mfma_f32_16x16x32_bf16 v[140:143], a[196:199], v[68:71], v[140:143]
    ds_read_b128 v[68:71], v106 offset:49664
    s_waitcnt lgkmcnt(3)
    v_mfma_f32_16x16x32_bf16 v[112:115], a[72:75], v[72:75], v[112:115]
    v_mfma_f32_16x16x32_bf16 v[116:119], a[76:79], v[72:75], v[116:119]
    v_mfma_f32_16x16x32_bf16 v[128:131], a[200:203], v[72:75], v[128:131]
    v_mfma_f32_16x16x32_bf16 v[132:135], a[204:207], v[72:75], v[132:135]
    ds_read_b128 v[72:75], v107 offset:33280
    s_waitcnt lgkmcnt(3)
    v_mfma_f32_16x16x32_bf16 v[120:123], a[72:75], v[76:79], v[120:123]
    v_mfma_f32_16x16x32_bf16 v[124:127], a[76:79], v[76:79], v[124:127]
    v_mfma_f32_16x16x32_bf16 v[136:139], a[200:203], v[76:79], v[136:139]
    v_mfma_f32_16x16x32_bf16 v[140:143], a[204:207], v[76:79], v[140:143]
    ds_read_b128 v[76:79], v107 offset:49664
    s_waitcnt lgkmcnt(3)
    v_mfma_f32_16x16x32_bf16 v[112:115], a[80:83], v[64:67], v[112:115]
    v_mfma_f32_16x16x32_bf16 v[116:119], a[84:87], v[64:67], v[116:119]
    v_mfma_f32_16x16x32_bf16 v[128:131], a[208:211], v[64:67], v[128:131]
    v_mfma_f32_16x16x32_bf16 v[132:135], a[212:215], v[64:67], v[132:135]
    ds_read_b128 v[64:67], v104 offset:33536
    s_waitcnt lgkmcnt(3)
    v_mfma_f32_16x16x32_bf16 v[120:123], a[80:83], v[68:71], v[120:123]
    v_mfma_f32_16x16x32_bf16 v[124:127], a[84:87], v[68:71], v[124:127]
    v_mfma_f32_16x16x32_bf16 v[136:139], a[208:211], v[68:71], v[136:139]
    v_mfma_f32_16x16x32_bf16 v[140:143], a[212:215], v[68:71], v[140:143]
    ds_read_b128 v[68:71], v104 offset:49920
    s_waitcnt lgkmcnt(3)
    v_mfma_f32_16x16x32_bf16 v[112:115], a[88:91], v[72:75], v[112:115]
    v_mfma_f32_16x16x32_bf16 v[116:119], a[92:95], v[72:75], v[116:119]
    v_mfma_f32_16x16x32_bf16 v[128:131], a[216:219], v[72:75], v[128:131]
    v_mfma_f32_16x16x32_bf16 v[132:135], a[220:223], v[72:75], v[132:135]
    ds_read_b128 v[72:75], v105 offset:33536
    s_waitcnt lgkmcnt(3)
    v_mfma_f32_16x16x32_bf16 v[120:123], a[88:91], v[76:79], v[120:123]
    v_mfma_f32_16x16x32_bf16 v[124:127], a[92:95], v[76:79], v[124:127]
    v_mfma_f32_16x16x32_bf16 v[136:139], a[216:219], v[76:79], v[136:139]
    v_mfma_f32_16x16x32_bf16 v[140:143], a[220:223], v[76:79], v[140:143]
    ds_read_b128 v[76:79], v105 offset:49920
    s_waitcnt lgkmcnt(3)
    v_mfma_f32_16x16x32_bf16 v[112:115], a[96:99], v[64:67], v[112:115]
    v_mfma_f32_16x16x32_bf16 v[116:119], a[100:103], v[64:67], v[116:119]
    v_mfma_f32_16x16x32_bf16 v[128:131], a[224:227], v[64:67], v[128:131]
    v_mfma_f32_16x16x32_bf16 v[132:135], a[228:231], v[64:67], v[132:135]
    ds_read_b128 v[64:67], v106 offset:33536
    s_waitcnt lgkmcnt(3)
    v_mfma_f32_16x16x32_bf16 v[120:123], a[96:99], v[68:71], v[120:123]
    s_mov_b32 s60, s47
    s_mov_b32 s61, s48
    s_mov_b32 s51, s50
    v_mfma_f32_16x16x32_bf16 v[124:127], a[100:103], v[68:71], v[124:127]
    v_mfma_f32_16x16x32_bf16 v[136:139], a[224:227], v[68:71], v[136:139]
    s_add_u32 s47, s47, 28672
    s_add_u32 s48, s48, 28672
    v_mfma_f32_16x16x32_bf16 v[140:143], a[228:231], v[68:71], v[140:143]
    ds_read_b128 v[68:71], v106 offset:49920
    s_waitcnt lgkmcnt(3)
    v_mfma_f32_16x16x32_bf16 v[112:115], a[104:107], v[72:75], v[112:115]
    v_mfma_f32_16x16x32_bf16 v[116:119], a[108:111], v[72:75], v[116:119]
    v_mfma_f32_16x16x32_bf16 v[128:131], a[232:235], v[72:75], v[128:131]
    s_add_u32 s50, s50, 4096
    s_add_u32 s44, s44, 1
    v_mfma_f32_16x16x32_bf16 v[132:135], a[236:239], v[72:75], v[132:135]
    ds_read_b128 v[72:75], v107 offset:33536
    s_waitcnt lgkmcnt(3)
    v_mfma_f32_16x16x32_bf16 v[120:123], a[104:107], v[76:79], v[120:123]
    v_mfma_f32_16x16x32_bf16 v[124:127], a[108:111], v[76:79], v[124:127]
    v_mfma_f32_16x16x32_bf16 v[136:139], a[232:235], v[76:79], v[136:139]
    s_waitcnt vmcnt(0)
    v_mfma_f32_16x16x32_bf16 v[140:143], a[236:239], v[76:79], v[140:143]
    s_mov_b64 exec, s[54:55]
    ds_add_rtn_u32 v11, v12, v3 offset:0
    s_mov_b64 exec, -1
    ds_read_b128 v[76:79], v107 offset:49920
    s_waitcnt lgkmcnt(3)
    v_mfma_f32_16x16x32_bf16 v[112:115], a[112:115], v[64:67], v[112:115]
    v_mfma_f32_16x16x32_bf16 v[116:119], a[116:119], v[64:67], v[116:119]
    v_mfma_f32_16x16x32_bf16 v[128:131], a[240:243], v[64:67], v[128:131]
    v_mfma_f32_16x16x32_bf16 v[132:135], a[244:247], v[64:67], v[132:135]
    s_waitcnt vmcnt(0) lgkmcnt(0)
    s_barrier
    ds_read_b128 v[64:67], v104 offset:0
    v_mfma_f32_16x16x32_bf16 v[120:123], a[112:115], v[68:71], v[120:123]
    v_readfirstlane_b32 s3, v11
    s_and_b32 s3, s3, 3
    s_cmp_eq_u32 s3, 3
    s_cselect_b32 s3, s62, s63
    s_nop 1
    buffer_store_dword v3, v7, s[8:11], s3 offen sc1
    v_mfma_f32_16x16x32_bf16 v[124:127], a[116:119], v[68:71], v[124:127]
    v_mfma_f32_16x16x32_bf16 v[136:139], a[240:243], v[68:71], v[136:139]
    v_mfma_f32_16x16x32_bf16 v[140:143], a[244:247], v[68:71], v[140:143]
    ds_read_b128 v[68:71], v104 offset:16384
    v_mfma_f32_16x16x32_bf16 v[112:115], a[120:123], v[72:75], v[112:115]
    s_mov_b32 s62, s51
    s_mov_b64 s[54:55], 1
    v_mfma_f32_16x16x32_bf16 v[116:119], a[124:127], v[72:75], v[116:119]
    v_mfma_f32_16x16x32_bf16 v[128:131], a[248:251], v[72:75], v[128:131]
    v_mfma_f32_16x16x32_bf16 v[132:135], a[252:255], v[72:75], v[132:135]
    ds_read_b128 v[72:75], v105 offset:0
    v_mfma_f32_16x16x32_bf16 v[120:123], a[120:123], v[76:79], v[120:123]
    v_mfma_f32_16x16x32_bf16 v[124:127], a[124:127], v[76:79], v[124:127]
    v_mfma_f32_16x16x32_bf16 v[136:139], a[248:251], v[76:79], v[136:139]
    v_mfma_f32_16x16x32_bf16 v[140:143], a[252:255], v[76:79], v[140:143]
    v_cmp_eq_u32 vcc, 0, v4
    s_cmp_ge_u32 s44, 63
    s_cbranch_scc1 L_qq0B
    s_cbranch_vccnz L_qq0B
    s_branch L_qq0A
L_qq1B:
    ds_read_b128 v[76:79], v105 offset:49152
    s_waitcnt lgkmcnt(3)
    v_mfma_f32_16x16x32_bf16 v[112:115], a[0:3], v[64:67], 0
    v_mfma_f32_16x16x32_bf16 v[116:119], a[4:7], v[64:67], 0
    v_mfma_f32_16x16x32_bf16 v[128:131], a[128:131], v[64:67], 0
    buffer_load_dword v4, v5, s[8:11], s45 offen sc1
    v_mfma_f32_16x16x32_bf16 v[132:135], a[132:135], v[64:67], 0
    s_mov_b32 s52, 0
    ds_read_b128 v[64:67], v106 offset:32768
    s_waitcnt lgkmcnt(3)
    v_mfma_f32_16x16x32_bf16 v[120:123], a[0:3], v[68:71], 0
    v_mfma_f32_16x16x32_bf16 v[124:127], a[4:7], v[68:71], 0
    v_mfma_f32_16x16x32_bf16 v[136:139], a[128:131], v[68:71], 0
    v_mfma_f32_16x16x32_bf16 v[140:143], a[132:135], v[68:71], 0
    ds_read_b128 v[68:71], v106 offset:49152
    s_waitcnt lgkmcnt(3)
    v_mfma_f32_16x16x32_bf16 v[112:115], a[8:11], v[72:75], v[112:115]
    v_mul_f32 v16, v6, v16
    v_mul_f32 v20, v6, v20
    v_mfma_f32_16x16x32_bf16 v[116:119], a[12:15], v[72:75], v[116:119]
    v_cvt_pk_bf16_f32 v88, v16, v20
    v_mul_f32 v17, v6, v17
    v_mfma_f32_16x16x32_bf16 v[128:131], a[136:139], v[72:75], v[128:131]
    v_mul_f32 v21, v6, v21
    v_cvt_pk_bf16_f32 v89, v17, v21
    v_mfma_f32_16x16x32_bf16 v[132:135], a[140:143], v[72:75], v[132:135]
    v_mul_f32 v18, v6, v18
    v_mul_f32 v22, v6, v22
    ds_read_b128 v[72:75], v107 offset:32768
    s_waitcnt lgkmcnt(3)
    v_mfma_f32_16x16x32_bf16 v[120:123], a[8:11], v[76:79], v[120:123]
    v_cvt_pk_bf16_f32 v90, v18, v22
    v_mul_f32 v19, v6, v19
    v_mfma_f32_16x16x32_bf16 v[124:127], a[12:15], v[76:79], v[124:127]
    v_mul_f32 v23, v6, v23
    v_cvt_pk_bf16_f32 v91, v19, v23
    v_mfma_f32_16x16x32_bf16 v[136:139], a[136:139], v[76:79], v[136:139]
    buffer_store_dwordx4 v[88:91], v13, s[8:11], s60 offen offset:0 sc1
    v_mfma_f32_16x16x32_bf16 v[140:143], a[140:143], v[76:79], v[140:143]
    ds_read_b128 v[76:79], v107 offset:49152
    s_waitcnt lgkmcnt(3)
    v_mfma_f32_16x16x32_bf16 v[112:115], a[16:19], v[64:67], v[112:115]
    v_mul_f32 v24, v6, v24
    v_mul_f32 v28, v6, v28
    v_mfma_f32_16x16x32_bf16 v[116:119], a[20:23], v[64:67], v[116:119]
    v_cvt_pk_bf16_f32 v92, v24, v28
    v_mul_f32 v25, v6, v25
    v_mfma_f32_16x16x32_bf16 v[128:131], a[144:147], v[64:67], v[128:131]
    v_mul_f32 v29, v6, v29
    v_cvt_pk_bf16_f32 v93, v25, v29
    v_mfma_f32_16x16x32_bf16 v[132:135], a[148:151], v[64:67], v[132:135]
    v_mul_f32 v26, v6, v26
    v_mul_f32 v30, v6, v30
    ds_read_b128 v[64:67], v104 offset:33024
    s_waitcnt lgkmcnt(3)
    v_mfma_f32_16x16x32_bf16 v[120:123], a[16:19], v[68:71], v[120:123]
    v_cvt_pk_bf16_f32 v94, v26, v30
    v_mul_f32 v27, v6, v27
    v_mfma_f32_16x16x32_bf16 v[124:127], a[20:23], v[68:71], v[124:127]
    v_mul_f32 v31, v6, v31
    v_cvt_pk_bf16_f32 v95, v27, v31
    v_mfma_f32_16x16x32_bf16 v[136:139], a[144:147], v[68:71], v[136:139]
    buffer_store_dwordx4 v[92:95], v13, s[8:11], s60 offen offset:256 sc1
    v_mfma_f32_16x16x32_bf16 v[140:143], a[148:151], v[68:71], v[140:143]
    ds_read_b128 v[68:71], v104 offset:49408
    s_waitcnt lgkmcnt(3)
    v_mfma_f32_16x16x32_bf16 v[112:115], a[24:27], v[72:75], v[112:115]
    v_mul_f32 v32, v6, v32
    v_mul_f32 v36, v6, v36
    v_mfma_f32_16x16x32_bf16 v[116:119], a[28:31], v[72:75], v[116:119]
    v_cvt_pk_bf16_f32 v96, v32, v36
    v_mul_f32 v33, v6, v33
    v_mfma_f32_16x16x32_bf16 v[128:131], a[152:155], v[72:75], v[128:131]
    v_mul_f32 v37, v6, v37
    v_cvt_pk_bf16_f32 v97, v33, v37
    v_mfma_f32_16x16x32_bf16 v[132:135], a[156:159], v[72:75], v[132:135]
    v_mul_f32 v34, v6, v34
    v_mul_f32 v38, v6, v38
    ds_read_b128 v[72:75], v105 offset:33024
    s_waitcnt lgkmcnt(3)
    v_mfma_f32_16x16x32_bf16 v[120:123], a[24:27], v[76:79], v[120:123]
    v_cvt_pk_bf16_f32 v98, v34, v38
    v_mul_f32 v35, v6, v35
    v_mfma_f32_16x16x32_bf16 v[124:127], a[28:31], v[76:79], v[124:127]
    v_mul_f32 v39, v6, v39
    v_cvt_pk_bf16_f32 v99, v35, v39
    v_mfma_f32_16x16x32_bf16 v[136:139], a[152:155], v[76:79], v[136:139]
    buffer_store_dwordx4 v[96:99], v13, s[8:11], s61 offen offset:0 sc1
    v_mfma_f32_16x16x32_bf16 v[140:143], a[156:159], v[76:79], v[140:143]
    ds_read_b128 v[76:79], v105 offset:49408
    s_waitcnt lgkmcnt(3)
    v_mfma_f32_16x16x32_bf16 v[112:115], a[32:35], v[64:67], v[112:115]
    v_mul_f32 v40, v6, v40
    v_mul_f32 v44, v6, v44
    v_mfma_f32_16x16x32_bf16 v[116:119], a[36:39], v[64:67], v[116:119]
    v_cvt_pk_bf16_f32 v100, v40, v44
    v_mul_f32 v41, v6, v41
    v_mfma_f32_16x16x32_bf16 v[128:131], a[160:163], v[64:67], v[128:131]
    v_mul_f32 v45, v6, v45
    v_cvt_pk_bf16_f32 v101, v41, v45
    v_mfma_f32_16x16x32_bf16 v[132:135], a[164:167], v[64:67], v[132:135]
    v_mul_f32 v42, v6, v42
    v_mul_f32 v46, v6, v46
    ds_read_b128 v[64:67], v106 offset:33024
    s_waitcnt lgkmcnt(3)
    v_mfma_f32_16x16x32_bf16 v[120:123], a[32:35], v[68:71], v[120:123]
    v_cvt_pk_bf16_f32 v102, v42, v46
    v_mul_f32 v43, v6, v43
    v_mfma_f32_16x16x32_bf16 v[124:127], a[36:39], v[68:71], v[124:127]
    v_mul_f32 v47, v6, v47
    v_cvt_pk_bf16_f32 v103, v43, v47
    v_mfma_f32_16x16x32_bf16 v[136:139], a[160:163], v[68:71], v[136:139]
    buffer_store_dwordx4 v[100:103], v13, s[8:11], s61 offen offset:256 sc1
    v_mfma_f32_16x16x32_bf16 v[140:143], a[164:167], v[68:71], v[140:143]
    ds_read_b128 v[68:71], v106 offset:49408
    s_waitcnt lgkmcnt(3)
    v_mfma_f32_16x16x32_bf16 v[112:115], a[40:43], v[72:75], v[112:115]
    v_mfma_f32_16x16x32_bf16 v[116:119], a[44:47], v[72:75], v[116:119]
    v_mfma_f32_16x16x32_bf16 v[128:131], a[168:171], v[72:75], v[128:131]
    v_mfma_f32_16x16x32_bf16 v[132:135], a[172:175], v[72:75], v[132:135]
    ds_read_b128 v[72:75], v107 offset:33024
    s_waitcnt lgkmcnt(3)
    v_mfma_f32_16x16x32_bf16 v[120:123], a[40:43], v[76:79], v[120:123]
    v_mfma_f32_16x16x32_bf16 v[124:127], a[44:47], v[76:79], v[124:127]
    v_mfma_f32_16x16x32_bf16 v[136:139], a[168:171], v[76:79], v[136:139]
    v_mfma_f32_16x16x32_bf16 v[140:143], a[172:175], v[76:79], v[140:143]
    s_waitcnt vmcnt(4)
    v_cmp_eq_u32 vcc, 0, v4
    s_cmp_ge_u32 s44, 63
    s_cbranch_scc1 Lq_39
    s_cbranch_vccnz Lq_39
    s_add_u32 m0, s53, 0
    s_add_u32 s3, s46, 4096
    buffer_load_dwordx4 v1, s[8:11], s46 offen offset:0 sc1 lds
    buffer_load_dwordx4 v1, s[8:11], s46 offen offset:1024 sc1 lds
    buffer_load_dwordx4 v1, s[8:11], s46 offen offset:2048 sc1 lds
    buffer_load_dwordx4 v1, s[8:11], s46 offen offset:3072 sc1 lds
    s_add_u32 m0, s53, 4096
    s_add_u32 s45, s45, 128
    buffer_load_dwordx4 v1, s[8:11], s3 offen offset:0 sc1 lds
    buffer_load_dwordx4 v1, s[8:11], s3 offen offset:1024 sc1 lds
    buffer_load_dwordx4 v1, s[8:11], s3 offen offset:2048 sc1 lds
    buffer_load_dwordx4 v1, s[8:11], s3 offen offset:3072 sc1 lds
    s_add_u32 s46, s46, 32768
    s_mov_b32 s52, 1
Lq_39:
Lq_39x:
    ds_read_b128 v[76:79], v107 offset:49408
    s_waitcnt lgkmcnt(3)
    v_mfma_f32_16x16x32_bf16 v[112:115], a[48:51], v[64:67], v[112:115]
    v_mfma_f32_16x16x32_bf16 v[116:119], a[52:55], v[64:67], v[116:119]
    v_mfma_f32_16x16x32_bf16 v[128:131], a[176:179], v[64:67], v[128:131]
    v_mfma_f32_16x16x32_bf16 v[132:135], a[180:183], v[64:67], v[132:135]
    ds_read_b128 v[64:67], v104 offset:33280
    s_waitcnt lgkmcnt(3)
    v_mfma_f32_16x16x32_bf16 v[120:123], a[48:51], v[68:71], v[120:123]
    v_mfma_f32_16x16x32_bf16 v[124:127], a[52:55], v[68:71], v[124:127]
    v_mfma_f32_16x16x32_bf16 v[136:139], a[176:179], v[68:71], v[136:139]
    v_mfma_f32_16x16x32_bf16 v[140:143], a[180:183], v[68:71], v[140:143]
    ds_read_b128 v[68:71], v104 offset:49664
    s_waitcnt lgkmcnt(3)
    v_mfma_f32_16x16x32_bf16 v[112:115], a[56:59], v[72:75], v[112:115]
    v_mfma_f32_16x16x32_bf16 v[116:119], a[60:63], v[72:75], v[116:119]
    v_mfma_f32_16x16x32_bf16 v[128:131], a[184:187], v[72:75], v[128:131]
    v_mfma_f32_16x16x32_bf16 v[132:135], a[188:191], v[72:75], v[132:135]
    ds_read_b128 v[72:75], v105 offset:33280
    s_waitcnt lgkmcnt(3)
    v_mfma_f32_16x16x32_bf16 v[120:123], a[56:59], v[76:79], v[120:123]
    v_mfma_f32_16x16x32_bf16 v[124:127], a[60:63], v[76:79], v[124:127]
    v_mfma_f32_16x16x32_bf16 v[136:139], a[184:187], v[76:79], v[136:139]
    v_mfma_f32_16x16x32_bf16 v[140:143], a[188:191], v[76:79], v[140:143]
    ds_read_b128 v[76:79], v105 offset:49664
    s_waitcnt lgkmcnt(3)
    v_mfma_f32_16x16x32_bf16 v[112:115], a[64:67], v[64:67], v[112:115]
    v_mfma_f32_16x16x32_bf16 v[116:119], a[68:71], v[64:67], v[116:119]
    v_mfma_f32_16x16x32_bf16 v[128:131], a[192:195], v[64:67], v[128:131]
    v_mfma_f32_16x16x32_bf16 v[132:135], a[196:199], v[64:67], v[132:135]
    ds_read_b128 v[64:67], v106 offset:33280
    s_waitcnt lgkmcnt(3)
    v_mfma_f32_16x16x32_bf16 v[120:123], a[64:67], v[68:71], v[120:123]
    v_mfma_f32_16x16x32_bf16 v[124:127], a[68:71], v[68:71], v[124:127]
    v_mfma_f32_16x16x32_bf16 v[136:139], a[192:195], v[68:71], v[136:139]
    v_mfma_f32_16x16x32_bf16 v[140:143], a[196:199], v[68:71], v[140:143]
    ds_read_b128 v[68:71], v106 offset:49664
    s_waitcnt lgkmcnt(3)
    v_mfma_f32_16x16x32_bf16 v[112:115], a[72:75], v[72:75], v[112:115]
    v_mfma_f32_16x16x32_bf16 v[116:119], a[76:79], v[72:75], v[116:119]
    v_mfma_f32_16x16x32_bf16 v[128:131], a[200:203], v[72:75], v[128:131]
    v_mfma_f32_16x16x32_bf16 v[132:135], a[204:207], v[72:75], v[132:135]
    ds_read_b128 v[72:75], v107 offset:33280
    s_waitcnt lgkmcnt(3)
    v_mfma_f32_16x16x32_bf16 v[120:123], a[72:75], v[76:79], v[120:123]
    buffer_load_dword v4, v5, s[8:11], s45 offen sc1
    v_mfma_f32_16x16x32_bf16 v[124:127], a[76:79], v[76:79], v[124:127]
    v_mfma_f32_16x16x32_bf16 v[136:139], a[200:203], v[76:79], v[136:139]
    v_mfma_f32_16x16x32_bf16 v[140:143], a[204:207], v[76:79], v[140:143]
    ds_read_b128 v[76:79], v107 offset:49664
    s_waitcnt lgkmcnt(3)
    v_mfma_f32_16x16x32_bf16 v[112:115], a[80:83], v[64:67], v[112:115]
    v_mfma_f32_16x16x32_bf16 v[116:119], a[84:87], v[64:67], v[116:119]
    v_mfma_f32_16x16x32_bf16 v[128:131], a[208:211], v[64:67], v[128:131]
    v_mfma_f32_16x16x32_bf16 v[132:135], a[212:215], v[64:67], v[132:135]
    ds_read_b128 v[64:67], v104 offset:33536
    s_waitcnt lgkmcnt(3)
    v_mfma_f32_16x16x32_bf16 v[120:123], a[80:83], v[68:71], v[120:123]
    v_mfma_f32_16x16x32_bf16 v[124:127], a[84:87], v[68:71], v[124:127]
    v_mfma_f32_16x16x32_bf16 v[136:139], a[208:211], v[68:71], v[136:139]
    v_mfma_f32_16x16x32_bf16 v[140:143], a[212:215], v[68:71], v[140:143]
    ds_read_b128 v[68:71], v104 offset:49920
    s_waitcnt lgkmcnt(3)
    v_mfma_f32_16x16x32_bf16 v[112:115], a[88:91], v[72:75], v[112:115]
    v_mfma_f32_16x16x32_bf16 v[116:119], a[92:95], v[72:75], v[116:119]
    v_mfma_f32_16x16x32_bf16 v[128:131], a[216:219], v[72:75], v[128:131]
    v_mfma_f32_16x16x32_bf16 v[132:135], a[220:223], v[72:75], v[132:135]
    ds_read_b128 v[72:75], v105 offset:33536
    s_waitcnt lgkmcnt(3)
    v_mfma_f32_16x16x32_bf16 v[120:123], a[88:91], v[76:79], v[120:123]
    v_mfma_f32_16x16x32_bf16 v[124:127], a[92:95], v[76:79], v[124:127]
    v_mfma_f32_16x16x32_bf16 v[136:139], a[216:219], v[76:79], v[136:139]
    v_mfma_f32_16x16x32_bf16 v[140:143], a[220:223], v[76:79], v[140:143]
    ds_read_b128 v[76:79], v105 offset:49920
    s_waitcnt lgkmcnt(3)
    v_mfma_f32_16x16x32_bf16 v[112:115], a[96:99], v[64:67], v[112:115]
    v_mfma_f32_16x16x32_bf16 v[116:119], a[100:103], v[64:67], v[116:119]
    v_mfma_f32_16x16x32_bf16 v[128:131], a[224:227], v[64:67], v[128:131]
    v_mfma_f32_16x16x32_bf16 v[132:135], a[228:231], v[64:67], v[132:135]
    s_cmp_lg_u32 s52, 0
    s_cbranch_scc0 Lq_40a
    s_waitcnt vmcnt(9)
    s_mov_b64 exec, s[54:55]
    ds_add_rtn_u32 v11, v12, v3 offset:0
    s_mov_b64 exec, -1
    s_branch Lq_40x
Lq_40a:
    s_waitcnt vmcnt(0)
    s_mov_b64 exec, s[54:55]
    ds_add_rtn_u32 v11, v12, v3 offset:0
    s_mov_b64 exec, -1
    v_cmp_eq_u32 vcc, 0, v4
    s_cmp_ge_u32 s44, 63
    s_cbranch_scc1 Lq_40
    s_cbranch_vccnz Lq_40
    s_add_u32 m0, s53, 0
    s_add_u32 s3, s46, 4096
    buffer_load_dwordx4 v1, s[8:11], s46 offen offset:0 sc1 lds
    buffer_load_dwordx4 v1, s[8:11], s46 offen offset:1024 sc1 lds
    buffer_load_dwordx4 v1, s[8:11], s46 offen offset:2048 sc1 lds
    buffer_load_dwordx4 v1, s[8:11], s46 offen offset:3072 sc1 lds
    s_add_u32 m0, s53, 4096
    s_add_u32 s45, s45, 128
    buffer_load_dwordx4 v1, s[8:11], s3 offen offset:0 sc1 lds
    buffer_load_dwordx4 v1, s[8:11], s3 offen offset:1024 sc1 lds
    buffer_load_dwordx4 v1, s[8:11], s3 offen offset:2048 sc1 lds
    buffer_load_dwordx4 v1, s[8:11], s3 offen offset:3072 sc1 lds
    s_add_u32 s46, s46, 32768
    s_mov_b32 s52, 2
Lq_40:
Lq_40x:
    ds_read_b128 v[64:67], v106 offset:33536
    s_waitcnt lgkmcnt(3)
    v_mfma_f32_16x16x32_bf16 v[120:123], a[96:99], v[68:71], v[120:123]
    s_mov_b32 s60, s47
    s_mov_b32 s61, s48
    s_mov_b32 s51, s50
    v_mfma_f32_16x16x32_bf16 v[124:127], a[100:103], v[68:71], v[124:127]
    v_mfma_f32_16x16x32_bf16 v[136:139], a[224:227], v[68:71], v[136:139]
    s_add_u32 s47, s47, 28672
    s_add_u32 s48, s48, 28672
    v_mfma_f32_16x16x32_bf16 v[140:143], a[228:231], v[68:71], v[140:143]
    ds_read_b128 v[68:71], v106 offset:49920
    s_waitcnt lgkmcnt(3)
    v_mfma_f32_16x16x32_bf16 v[112:115], a[104:107], v[72:75], v[112:115]
    v_mfma_f32_16x16x32_bf16 v[116:119], a[108:111], v[72:75], v[116:119]
    v_mfma_f32_16x16x32_bf16 v[128:131], a[232:235], v[72:75], v[128:131]
    s_add_u32 s50, s50, 4096
    s_add_u32 s44, s44, 1
    v_mfma_f32_16x16x32_bf16 v[132:135], a[236:239], v[72:75], v[132:135]
    ds_read_b128 v[72:75], v107 offset:33536
    s_waitcnt lgkmcnt(3)
    v_mfma_f32_16x16x32_bf16 v[120:123], a[104:107], v[76:79], v[120:123]
    v_mfma_f32_16x16x32_bf16 v[124:127], a[108:111], v[76:79], v[124:127]
    v_mfma_f32_16x16x32_bf16 v[136:139], a[232:235], v[76:79], v[136:139]
    v_mfma_f32_16x16x32_bf16 v[140:143], a[236:239], v[76:79], v[140:143]
    ds_read_b128 v[76:79], v107 offset:49920
    s_waitcnt lgkmcnt(3)
    v_mfma_f32_16x16x32_bf16 v[112:115], a[112:115], v[64:67], v[112:115]
    v_readfirstlane_b32 s3, v11
    s_and_b32 s3, s3, 3
    s_cmp_eq_u32 s3, 3
    s_cselect_b32 s3, s62, s63
    s_nop 1
    buffer_store_dword v3, v7, s[8:11], s3 offen sc1
    v_mfma_f32_16x16x32_bf16 v[116:119], a[116:119], v[64:67], v[116:119]
    v_mfma_f32_16x16x32_bf16 v[128:131], a[240:243], v[64:67], v[128:131]
    s_mov_b32 s62, s51
    s_mov_b64 s[54:55], 1
    v_mfma_f32_16x16x32_bf16 v[132:135], a[244:247], v[64:67], v[132:135]
    s_cmp_lg_u32 s52, 1
    s_cbranch_scc1 L_qq1T
    s_waitcnt vmcnt(1) lgkmcnt(0)
    s_barrier
    ds_read_b128 v[64:67], v104 offset:0
    v_mfma_f32_16x16x32_bf16 v[120:123], a[112:115], v[68:71], v[120:123]
    v_mfma_f32_16x16x32_bf16 v[124:127], a[116:119], v[68:71], v[124:127]
    v_mfma_f32_16x16x32_bf16 v[136:139], a[240:243], v[68:71], v[136:139]
    v_mfma_f32_16x16x32_bf16 v[140:143], a[244:247], v[68:71], v[140:143]
    ds_read_b128 v[68:71], v104 offset:16384
    v_mfma_f32_16x16x32_bf16 v[112:115], a[120:123], v[72:75], v[112:115]
    v_mfma_f32_16x16x32_bf16 v[116:119], a[124:127], v[72:75], v[116:119]
    v_mfma_f32_16x16x32_bf16 v[128:131], a[248:251], v[72:75], v[128:131]
    v_mfma_f32_16x16x32_bf16 v[132:135], a[252:255], v[72:75], v[132:135]
    ds_read_b128 v[72:75], v105 offset:0
    v_mfma_f32_16x16x32_bf16 v[120:123], a[120:123], v[76:79], v[120:123]
    v_mfma_f32_16x16x32_bf16 v[124:127], a[124:127], v[76:79], v[124:127]
    v_mfma_f32_16x16x32_bf16 v[136:139], a[248:251], v[76:79], v[136:139]
    v_mfma_f32_16x16x32_bf16 v[140:143], a[252:255], v[76:79], v[140:143]
    v_cmp_eq_u32 vcc, 0, v4
    s_cmp_ge_u32 s44, 63
    s_cbranch_scc1 L_qq0B
    s_cbranch_vccnz L_qq0B
    s_branch L_qq0A
L_qq1T:
    s_waitcnt lgkmcnt(0)
    buffer_load_dword v4, v5, s[8:11], s45 offen sc1
    v_mfma_f32_16x16x32_bf16 v[120:123], a[112:115], v[68:71], v[120:123]
    v_mfma_f32_16x16x32_bf16 v[124:127], a[116:119], v[68:71], v[124:127]
    v_mfma_f32_16x16x32_bf16 v[136:139], a[240:243], v[68:71], v[136:139]
    v_mfma_f32_16x16x32_bf16 v[140:143], a[244:247], v[68:71], v[140:143]
    v_mfma_f32_16x16x32_bf16 v[112:115], a[120:123], v[72:75], v[112:115]
    v_mfma_f32_16x16x32_bf16 v[116:119], a[124:127], v[72:75], v[116:119]
    v_mfma_f32_16x16x32_bf16 v[128:131], a[248:251], v[72:75], v[128:131]
    v_mfma_f32_16x16x32_bf16 v[132:135], a[252:255], v[72:75], v[132:135]
    v_mfma_f32_16x16x32_bf16 v[120:123], a[120:123], v[76:79], v[120:123]
    v_mfma_f32_16x16x32_bf16 v[124:127], a[124:127], v[76:79], v[124:127]
    v_mfma_f32_16x16x32_bf16 v[136:139], a[248:251], v[76:79], v[136:139]
    v_mfma_f32_16x16x32_bf16 v[140:143], a[252:255], v[76:79], v[140:143]
    s_nop 0
    v_mul_f32 v112, v6, v112
    v_mul_f32 v116, v6, v116
    v_cvt_pk_bf16_f32 v88, v112, v116
    v_mul_f32 v113, v6, v113
    v_mul_f32 v117, v6, v117
    v_cvt_pk_bf16_f32 v89, v113, v117
    v_mul_f32 v114, v6, v114
    v_mul_f32 v118, v6, v118
    v_cvt_pk_bf16_f32 v90, v114, v118
    v_mul_f32 v115, v6, v115
    v_mul_f32 v119, v6, v119
    v_cvt_pk_bf16_f32 v91, v115, v119
    buffer_store_dwordx4 v[88:91], v13, s[8:11], s60 offen offset:0 sc1
    v_mul_f32 v120, v6, v120
    v_mul_f32 v124, v6, v124
    v_cvt_pk_bf16_f32 v92, v120, v124
    v_mul_f32 v121, v6, v121
    v_mul_f32 v125, v6, v125
    v_cvt_pk_bf16_f32 v93, v121, v125
    v_mul_f32 v122, v6, v122
    v_mul_f32 v126, v6, v126
    v_cvt_pk_bf16_f32 v94, v122, v126
    v_mul_f32 v123, v6, v123
    v_mul_f32 v127, v6, v127
    v_cvt_pk_bf16_f32 v95, v123, v127
    buffer_store_dwordx4 v[92:95], v13, s[8:11], s60 offen offset:256 sc1
    v_mul_f32 v128, v6, v128
    v_mul_f32 v132, v6, v132
    v_cvt_pk_bf16_f32 v96, v128, v132
    v_mul_f32 v129, v6, v129
    v_mul_f32 v133, v6, v133
    v_cvt_pk_bf16_f32 v97, v129, v133
    v_mul_f32 v130, v6, v130
    v_mul_f32 v134, v6, v134
    v_cvt_pk_bf16_f32 v98, v130, v134
    v_mul_f32 v131, v6, v131
    v_mul_f32 v135, v6, v135
    v_cvt_pk_bf16_f32 v99, v131, v135
    buffer_store_dwordx4 v[96:99], v13, s[8:11], s61 offen offset:0 sc1
    v_mul_f32 v136, v6, v136
    v_mul_f32 v140, v6, v140
    v_cvt_pk_bf16_f32 v100, v136, v140
    v_mul_f32 v137, v6, v137
    v_mul_f32 v141, v6, v141
    v_cvt_pk_bf16_f32 v101, v137, v141
    v_mul_f32 v138, v6, v138
    v_mul_f32 v142, v6, v142
    v_cvt_pk_bf16_f32 v102, v138, v142
    v_mul_f32 v139, v6, v139
    v_mul_f32 v143, v6, v143
    v_cvt_pk_bf16_f32 v103, v139, v143
    buffer_store_dwordx4 v[100:103], v13, s[8:11], s61 offen offset:256 sc1
    s_cmp_eq_u32 s52, 2
    s_cbranch_scc0 L_qq1X
    s_waitcnt vmcnt(0)
    s_branch L_qq1Y
L_qq1X:
    s_waitcnt vmcnt(4)
    v_cmp_eq_u32 vcc, 0, v4
    s_cmp_ge_u32 s44, 64
    s_cbranch_scc1 L_qq1U
    s_cbranch_vccnz L_qq1U
    s_add_u32 m0, s53, 0
    s_add_u32 s3, s46, 4096
    buffer_load_dwordx4 v1, s[8:11], s46 offen offset:0 sc1 lds
    buffer_load_dwordx4 v1, s[8:11], s46 offen offset:1024 sc1 lds
    buffer_load_dwordx4 v1, s[8:11], s46 offen offset:2048 sc1 lds
    buffer_load_dwordx4 v1, s[8:11], s46 offen offset:3072 sc1 lds
    s_add_u32 m0, s53, 4096
    s_add_u32 s45, s45, 128
    buffer_load_dwordx4 v1, s[8:11], s3 offen offset:0 sc1 lds
    buffer_load_dwordx4 v1, s[8:11], s3 offen offset:1024 sc1 lds
    buffer_load_dwordx4 v1, s[8:11], s3 offen offset:2048 sc1 lds
    buffer_load_dwordx4 v1, s[8:11], s3 offen offset:3072 sc1 lds
    s_add_u32 s46, s46, 32768
    buffer_load_dword v4, v5, s[8:11], s45 offen sc1
    s_waitcnt vmcnt(9)
L_qq1Y:
    s_mov_b64 exec, s[54:55]
    ds_add_rtn_u32 v11, v12, v3 offset:4
    s_mov_b64 exec, -1
    s_waitcnt lgkmcnt(0)
    v_readfirstlane_b32 s3, v11
    s_and_b32 s3, s3, 3
    s_cmp_eq_u32 s3, 3
    s_cselect_b32 s3, s62, s63
    s_nop 1
    buffer_store_dword v3, v7, s[8:11], s3 offen sc1
    s_mov_b32 s60, s63
    s_mov_b32 s61, s63
    s_mov_b32 s62, s63
    s_mov_b64 s[54:55], 0
    s_waitcnt vmcnt(1)
    s_branch L_qq1V
L_qq1U:
    s_waitcnt vmcnt(0)
    buffer_load_dword v4, v5, s[8:11], s45 offen sc1
    s_mov_b64 exec, s[54:55]
    ds_add_rtn_u32 v11, v12, v3 offset:4
    s_mov_b64 exec, -1
    s_waitcnt lgkmcnt(0)
    v_readfirstlane_b32 s3, v11
    s_and_b32 s3, s3, 3
    s_cmp_eq_u32 s3, 3
    s_cselect_b32 s3, s62, s63
    s_nop 1
    buffer_store_dword v3, v7, s[8:11], s3 offen sc1
    s_cmp_ge_u32 s44, 64
    s_cbranch_scc1 L_end
    s_waitcnt vmcnt(1)
L_qq1W:
    s_mov_b32 s60, s63
    s_mov_b32 s61, s63
    s_mov_b32 s62, s63
    s_mov_b64 s[54:55], 0
    v_cmp_eq_u32 vcc, 0, v4
    s_cbranch_vccz Lq_41
Lw_42:
    buffer_load_dword v4, v5, s[8:11], s45 offen offset:0 sc1
    s_waitcnt vmcnt(0)
    v_cmp_eq_u32 vcc, 0, v4
    s_cbranch_vccz Lwd_43
    s_sleep 1
    s_sub_u32 s98, s98, 1
    s_cbranch_scc1 L_end
    s_branch Lw_42
Lwd_43:
Lq_41:
    s_add_u32 m0, s53, 0
    s_add_u32 s3, s46, 4096
    buffer_load_dwordx4 v1, s[8:11], s46 offen offset:0 sc1 lds
    buffer_load_dwordx4 v1, s[8:11], s46 offen offset:1024 sc1 lds
    buffer_load_dwordx4 v1, s[8:11], s46 offen offset:2048 sc1 lds
    buffer_load_dwordx4 v1, s[8:11], s46 offen offset:3072 sc1 lds
    s_add_u32 m0, s53, 4096
    s_add_u32 s45, s45, 128
    buffer_load_dwordx4 v1, s[8:11], s3 offen offset:0 sc1 lds
    buffer_load_dwordx4 v1, s[8:11], s3 offen offset:1024 sc1 lds
    buffer_load_dwordx4 v1, s[8:11], s3 offen offset:2048 sc1 lds
    buffer_load_dwordx4 v1, s[8:11], s3 offen offset:3072 sc1 lds
    s_add_u32 s46, s46, 32768
    buffer_load_dword v4, v5, s[8:11], s45 offen sc1
    s_waitcnt vmcnt(0)
L_qq1V:
    s_barrier
    ds_read_b128 v[64:67], v104 offset:0
    ds_read_b128 v[68:71], v104 offset:16384
    ds_read_b128 v[72:75], v105 offset:0
    v_cmp_eq_u32 vcc, 0, v4
    s_cmp_ge_u32 s44, 63
    s_cbranch_scc1 L_qq0B
    s_cbranch_vccnz L_qq0B
    s_branch L_qq0A
    s_endpgm
L_ao:
    s_mov_b32 s24, s86
    s_and_b32 s25, s87, 0xffff
    s_mov_b32 s26, 0x400000
    s_mov_b32 s27, 0x20000
    s_mov_b32 s12, s90
    s_and_b32 s13, s91, 0xffff
    s_mov_b32 s14, 0x200000
    s_mov_b32 s15, 0x20000
    v_and_b32 v40, 63, v0
    v_lshlrev_b32 v1, 4, v40
    v_lshlrev_b32 v5, 2, v40
    v_mov_b32 v2, 0
    v_mov_b32 v3, 1
    v_and_b32 v41, 15, v0
    v_bfe_u32 v42, v0, 4, 1
    v_bfe_u32 v43, v0, 5, 1
    v_and_b32 v44, 31, v0
    s_and_b32 s56, s5, 15
    s_lshr_b32 s57, s5, 4
    s_add_u32 s57, s57, 1
    s_bitcmp1_b32 s4, 1
    s_cselect_b32 s57, 0, s57
Lc_44:
    buffer_load_dword v4, v2, s[28:31], 0 offen offset:0 sc1
    s_waitcnt vmcnt(0)
    v_cmp_gt_u32 vcc, 32, v4
    s_cbranch_vccz Lcd_45
    s_sleep 2
    s_sub_u32 s98, s98, 1
    s_cbranch_scc1 L_end
    s_branch Lc_44
Lcd_45:
    s_cmp_lg_u32 s6, 0
    s_cbranch_scc1 Ltp_46
    s_getreg_b32 s3, hwreg(HW_REG_XCC_ID)
    s_and_b32 s3, s3, 15
    s_add_u32 s3, s3, 1
    v_mov_b32 v4, s3
    s_lshl_b32 s3, s4, 5
    s_add_u32 s3, s3, s5
    s_lshl_b32 s3, s3, 2
    s_add_u32 s3, s3, 573440
    s_mov_b64 exec, 1
    buffer_store_dword v4, v2, s[8:11], s3 offen offset:0 sc1
    s_mov_b64 exec, -1
Ltp_46:
    v_lshlrev_b32 v45, 12, v43
    v_lshl_add_u32 v45, v44, 3, v45
    s_mov_b32 s60, 0x05040100
    s_mov_b32 s61, 0x07060302
    s_lshl_b32 s41, s56, 18
    s_lshl_b32 s3, s6, 8
    s_add_u32 s41, s41, s3
    s_add_u32 s3, s41, 0
    s_add_u32 s40, s3, 8192
    buffer_load_dwordx2 v[80:81], v45, s[24:27], s3 offen offset:0
    buffer_load_dwordx2 v[82:83], v45, s[24:27], s3 offen offset:1024
    buffer_load_dwordx2 v[84:85], v45, s[24:27], s3 offen offset:2048
    buffer_load_dwordx2 v[86:87], v45, s[24:27], s3 offen offset:3072
    buffer_load_dwordx2 v[88:89], v45, s[24:27], s40 offen offset:0
    buffer_load_dwordx2 v[90:91], v45, s[24:27], s40 offen offset:1024
    buffer_load_dwordx2 v[92:93], v45, s[24:27], s40 offen offset:2048
    buffer_load_dwordx2 v[94:95], v45, s[24:27], s40 offen offset:3072
    s_add_u32 s3, s41, 16384
    s_add_u32 s40, s3, 8192
    buffer_load_dwordx2 v[96:97], v45, s[24:27], s3 offen offset:0
    buffer_load_dwordx2 v[98:99], v45, s[24:27], s3 offen offset:1024
    buffer_load_dwordx2 v[100:101], v45, s[24:27], s3 offen offset:2048
    buffer_load_dwordx2 v[102:103], v45, s[24:27], s3 offen offset:3072
    buffer_load_dwordx2 v[104:105], v45, s[24:27], s40 offen offset:0
    buffer_load_dwordx2 v[106:107], v45, s[24:27], s40 offen offset:1024
    buffer_load_dwordx2 v[108:109], v45, s[24:27], s40 offen offset:2048
    buffer_load_dwordx2 v[110:111], v45, s[24:27], s40 offen offset:3072
    s_add_u32 s3, s41, 32768
    s_add_u32 s40, s3, 8192
    buffer_load_dwordx2 v[112:113], v45, s[24:27], s3 offen offset:0
    buffer_load_dwordx2 v[114:115], v45, s[24:27], s3 offen offset:1024
    buffer_load_dwordx2 v[116:117], v45, s[24:27], s3 offen offset:2048
    buffer_load_dwordx2 v[118:119], v45, s[24:27], s3 offen offset:3072
    buffer_load_dwordx2 v[120:121], v45, s[24:27], s40 offen offset:0
    buffer_load_dwordx2 v[122:123], v45, s[24:27], s40 offen offset:1024
    buffer_load_dwordx2 v[124:125], v45, s[24:27], s40 offen offset:2048
    buffer_load_dwordx2 v[126:127], v45, s[24:27], s40 offen offset:3072
    s_add_u32 s3, s41, 49152
    s_add_u32 s40, s3, 8192
    buffer_load_dwordx2 v[128:129], v45, s[24:27], s3 offen offset:0
    buffer_load_dwordx2 v[130:131], v45, s[24:27], s3 offen offset:1024
    buffer_load_dwordx2 v[132:133], v45, s[24:27], s3 offen offset:2048
    buffer_load_dwordx2 v[134:135], v45, s[24:27], s3 offen offset:3072
    buffer_load_dwordx2 v[136:137], v45, s[24:27], s40 offen offset:0
    buffer_load_dwordx2 v[138:139], v45, s[24:27], s40 offen offset:1024
    buffer_load_dwordx2 v[140:141], v45, s[24:27], s40 offen offset:2048
    buffer_load_dwordx2 v[142:143], v45, s[24:27], s40 offen offset:3072
    s_add_u32 s3, s41, 65536
    s_add_u32 s40, s3, 8192
    buffer_load_dwordx2 v[144:145], v45, s[24:27], s3 offen offset:0
    buffer_load_dwordx2 v[146:147], v45, s[24:27], s3 offen offset:1024
    buffer_load_dwordx2 v[148:149], v45, s[24:27], s3 offen offset:2048
    buffer_load_dwordx2 v[150:151], v45, s[24:27], s3 offen offset:3072
    buffer_load_dwordx2 v[152:153], v45, s[24:27], s40 offen offset:0
    buffer_load_dwordx2 v[154:155], v45, s[24:27], s40 offen offset:1024
    buffer_load_dwordx2 v[156:157], v45, s[24:27], s40 offen offset:2048
    buffer_load_dwordx2 v[158:159], v45, s[24:27], s40 offen offset:3072
    s_add_u32 s3, s41, 81920
    s_add_u32 s40, s3, 8192
    buffer_load_dwordx2 v[160:161], v45, s[24:27], s3 offen offset:0
    buffer_load_dwordx2 v[162:163], v45, s[24:27], s3 offen offset:1024
    buffer_load_dwordx2 v[164:165], v45, s[24:27], s3 offen offset:2048
    buffer_load_dwordx2 v[166:167], v45, s[24:27], s3 offen offset:3072
    buffer_load_dwordx2 v[168:169], v45, s[24:27], s40 offen offset:0
    buffer_load_dwordx2 v[170:171], v45, s[24:27], s40 offen offset:1024
    buffer_load_dwordx2 v[172:173], v45, s[24:27], s40 offen offset:2048
    buffer_load_dwordx2 v[174:175], v45, s[24:27], s40 offen offset:3072
    s_add_u32 s3, s41, 98304
    s_add_u32 s40, s3, 8192
    buffer_load_dwordx2 v[176:177], v45, s[24:27], s3 offen offset:0
    buffer_load_dwordx2 v[178:179], v45, s[24:27], s3 offen offset:1024
    buffer_load_dwordx2 v[180:181], v45, s[24:27], s3 offen offset:2048
    buffer_load_dwordx2 v[182:183], v45, s[24:27], s3 offen offset:3072
    buffer_load_dwordx2 v[184:185], v45, s[24:27], s40 offen offset:0
    buffer_load_dwordx2 v[186:187], v45, s[24:27], s40 offen offset:1024
    buffer_load_dwordx2 v[188:189], v45, s[24:27], s40 offen offset:2048
    buffer_load_dwordx2 v[190:191], v45, s[24:27], s40 offen offset:3072
    s_waitcnt vmcnt(48)
    s_add_u32 s3, s41, 114688
    s_add_u32 s40, s3, 8192
    buffer_load_dwordx2 v[192:193], v45, s[24:27], s3 offen offset:0
    buffer_load_dwordx2 v[194:195], v45, s[24:27], s3 offen offset:1024
    buffer_load_dwordx2 v[196:197], v45, s[24:27], s3 offen offset:2048
    buffer_load_dwordx2 v[198:199], v45, s[24:27], s3 offen offset:3072
    buffer_load_dwordx2 v[200:201], v45, s[24:27], s40 offen offset:0
    buffer_load_dwordx2 v[202:203], v45, s[24:27], s40 offen offset:1024
    buffer_load_dwordx2 v[204:205], v45, s[24:27], s40 offen offset:2048
    buffer_load_dwordx2 v[206:207], v45, s[24:27], s40 offen offset:3072
    v_perm_b32 v48, v82, v80, s60
    v_perm_b32 v49, v86, v84, s60
    v_perm_b32 v50, v90, v88, s60
    v_perm_b32 v51, v94, v92, s60
    v_perm_b32 v52, v82, v80, s61
    v_perm_b32 v53, v86, v84, s61
    v_perm_b32 v54, v90, v88, s61
    v_perm_b32 v55, v94, v92, s61
    v_perm_b32 v56, v83, v81, s60
    v_perm_b32 v57, v87, v85, s60
    v_perm_b32 v58, v91, v89, s60
    v_perm_b32 v59, v95, v93, s60
    v_perm_b32 v60, v83, v81, s61
    v_perm_b32 v61, v87, v85, s61
    v_perm_b32 v62, v91, v89, s61
    v_perm_b32 v63, v95, v93, s61
    v_accvgpr_write_b32 a0, v48
    v_accvgpr_write_b32 a1, v49
    v_accvgpr_write_b32 a2, v50
    v_accvgpr_write_b32 a3, v51
    v_accvgpr_write_b32 a4, v52
    v_accvgpr_write_b32 a5, v53
    v_accvgpr_write_b32 a6, v54
    v_accvgpr_write_b32 a7, v55
    v_accvgpr_write_b32 a8, v56
    v_accvgpr_write_b32 a9, v57
    v_accvgpr_write_b32 a10, v58
    v_accvgpr_write_b32 a11, v59
    v_accvgpr_write_b32 a12, v60
    v_accvgpr_write_b32 a13, v61
    v_accvgpr_write_b32 a14, v62
    v_accvgpr_write_b32 a15, v63
    s_waitcnt vmcnt(48)
    s_add_u32 s3, s41, 131072
    s_add_u32 s40, s3, 8192
    buffer_load_dwordx2 v[80:81], v45, s[24:27], s3 offen offset:0
    buffer_load_dwordx2 v[82:83], v45, s[24:27], s3 offen offset:1024
    buffer_load_dwordx2 v[84:85], v45, s[24:27], s3 offen offset:2048
    buffer_load_dwordx2 v[86:87], v45, s[24:27], s3 offen offset:3072
    buffer_load_dwordx2 v[88:89], v45, s[24:27], s40 offen offset:0
    buffer_load_dwordx2 v[90:91], v45, s[24:27], s40 offen offset:1024
    buffer_load_dwordx2 v[92:93], v45, s[24:27], s40 offen offset:2048
    buffer_load_dwordx2 v[94:95], v45, s[24:27], s40 offen offset:3072
    v_perm_b32 v48, v98, v96, s60
    v_perm_b32 v49, v102, v100, s60
    v_perm_b32 v50, v106, v104, s60
    v_perm_b32 v51, v110, v108, s60
    v_perm_b32 v52, v98, v96, s61
    v_perm_b32 v53, v102, v100, s61
    v_perm_b32 v54, v106, v104, s61
    v_perm_b32 v55, v110, v108, s61
    v_perm_b32 v56, v99, v97, s60
    v_perm_b32 v57, v103, v101, s60
    v_perm_b32 v58, v107, v105, s60
    v_perm_b32 v59, v111, v109, s60
    v_perm_b32 v60, v99, v97, s61
    v_perm_b32 v61, v103, v101, s61
    v_perm_b32 v62, v107, v105, s61
    v_perm_b32 v63, v111, v109, s61
    v_accvgpr_write_b32 a16, v48
    v_accvgpr_write_b32 a17, v49
    v_accvgpr_write_b32 a18, v50
    v_accvgpr_write_b32 a19, v51
    v_accvgpr_write_b32 a20, v52
    v_accvgpr_write_b32 a21, v53
    v_accvgpr_write_b32 a22, v54
    v_accvgpr_write_b32 a23, v55
    v_accvgpr_write_b32 a24, v56
    v_accvgpr_write_b32 a25, v57
    v_accvgpr_write_b32 a26, v58
    v_accvgpr_write_b32 a27, v59
    v_accvgpr_write_b32 a28, v60
    v_accvgpr_write_b32 a29, v61
    v_accvgpr_write_b32 a30, v62
    v_accvgpr_write_b32 a31, v63
    s_waitcnt vmcnt(48)
    s_add_u32 s3, s41, 147456
    s_add_u32 s40, s3, 8192
    buffer_load_dwordx2 v[96:97], v45, s[24:27], s3 offen offset:0
    buffer_load_dwordx2 v[98:99], v45, s[24:27], s3 offen offset:1024
    buffer_load_dwordx2 v[100:101], v45, s[24:27], s3 offen offset:2048
    buffer_load_dwordx2 v[102:103], v45, s[24:27], s3 offen offset:3072
    buffer_load_dwordx2 v[104:105], v45, s[24:27], s40 offen offset:0
    buffer_load_dwordx2 v[106:107], v45, s[24:27], s40 offen offset:1024
    buffer_load_dwordx2 v[108:109], v45, s[24:27], s40 offen offset:2048
    buffer_load_dwordx2 v[110:111], v45, s[24:27], s40 offen offset:3072
    v_perm_b32 v48, v114, v112, s60
    v_perm_b32 v49, v118, v116, s60
    v_perm_b32 v50, v122, v120, s60
    v_perm_b32 v51, v126, v124, s60
    v_perm_b32 v52, v114, v112, s61
    v_perm_b32 v53, v118, v116, s61
    v_perm_b32 v54, v122, v120, s61
    v_perm_b32 v55, v126, v124, s61
    v_perm_b32 v56, v115, v113, s60
    v_perm_b32 v57, v119, v117, s60
    v_perm_b32 v58, v123, v121, s60
    v_perm_b32 v59, v127, v125, s60
    v_perm_b32 v60, v115, v113, s61
    v_perm_b32 v61, v119, v117, s61
    v_perm_b32 v62, v123, v121, s61
    v_perm_b32 v63, v127, v125, s61
    v_accvgpr_write_b32 a32, v48
    v_accvgpr_write_b32 a33, v49
    v_accvgpr_write_b32 a34, v50
    v_accvgpr_write_b32 a35, v51
    v_accvgpr_write_b32 a36, v52
    v_accvgpr_write_b32 a37, v53
    v_accvgpr_write_b32 a38, v54
    v_accvgpr_write_b32 a39, v55
    v_accvgpr_write_b32 a40, v56
    v_accvgpr_write_b32 a41, v57
    v_accvgpr_write_b32 a42, v58
    v_accvgpr_write_b32 a43, v59
    v_accvgpr_write_b32 a44, v60
    v_accvgpr_write_b32 a45, v61
    v_accvgpr_write_b32 a46, v62
    v_accvgpr_write_b32 a47, v63
    s_waitcnt vmcnt(48)
    s_add_u32 s3, s41, 163840
    s_add_u32 s40, s3, 8192
    buffer_load_dwordx2 v[112:113], v45, s[24:27], s3 offen offset:0
    buffer_load_dwordx2 v[114:115], v45, s[24:27], s3 offen offset:1024
    buffer_load_dwordx2 v[116:117], v45, s[24:27], s3 offen offset:2048
    buffer_load_dwordx2 v[118:119], v45, s[24:27], s3 offen offset:3072
    buffer_load_dwordx2 v[120:121], v45, s[24:27], s40 offen offset:0
    buffer_load_dwordx2 v[122:123], v45, s[24:27], s40 offen offset:1024
    buffer_load_dwordx2 v[124:125], v45, s[24:27], s40 offen offset:2048
    buffer_load_dwordx2 v[126:127], v45, s[24:27], s40 offen offset:3072
    v_perm_b32 v48, v130, v128, s60
    v_perm_b32 v49, v134, v132, s60
    v_perm_b32 v50, v138, v136, s60
    v_perm_b32 v51, v142, v140, s60
    v_perm_b32 v52, v130, v128, s61
    v_perm_b32 v53, v134, v132, s61
    v_perm_b32 v54, v138, v136, s61
    v_perm_b32 v55, v142, v140, s61
    v_perm_b32 v56, v131, v129, s60
    v_perm_b32 v57, v135, v133, s60
    v_perm_b32 v58, v139, v137, s60
    v_perm_b32 v59, v143, v141, s60
    v_perm_b32 v60, v131, v129, s61
    v_perm_b32 v61, v135, v133, s61
    v_perm_b32 v62, v139, v137, s61
    v_perm_b32 v63, v143, v141, s61
    v_accvgpr_write_b32 a48, v48
    v_accvgpr_write_b32 a49, v49
    v_accvgpr_write_b32 a50, v50
    v_accvgpr_write_b32 a51, v51
    v_accvgpr_write_b32 a52, v52
    v_accvgpr_write_b32 a53, v53
    v_accvgpr_write_b32 a54, v54
    v_accvgpr_write_b32 a55, v55
    v_accvgpr_write_b32 a56, v56
    v_accvgpr_write_b32 a57, v57
    v_accvgpr_write_b32 a58, v58
    v_accvgpr_write_b32 a59, v59
    v_accvgpr_write_b32 a60, v60
    v_accvgpr_write_b32 a61, v61
    v_accvgpr_write_b32 a62, v62
    v_accvgpr_write_b32 a63, v63
    s_waitcnt vmcnt(48)
    s_add_u32 s3, s41, 180224
    s_add_u32 s40, s3, 8192
    buffer_load_dwordx2 v[128:129], v45, s[24:27], s3 offen offset:0
    buffer_load_dwordx2 v[130:131], v45, s[24:27], s3 offen offset:1024
    buffer_load_dwordx2 v[132:133], v45, s[24:27], s3 offen offset:2048
    buffer_load_dwordx2 v[134:135], v45, s[24:27], s3 offen offset:3072
    buffer_load_dwordx2 v[136:137], v45, s[24:27], s40 offen offset:0
    buffer_load_dwordx2 v[138:139], v45, s[24:27], s40 offen offset:1024
    buffer_load_dwordx2 v[140:141], v45, s[24:27], s40 offen offset:2048
    buffer_load_dwordx2 v[142:143], v45, s[24:27], s40 offen offset:3072
    v_perm_b32 v48, v146, v144, s60
    v_perm_b32 v49, v150, v148, s60
    v_perm_b32 v50, v154, v152, s60
    v_perm_b32 v51, v158, v156, s60
    v_perm_b32 v52, v146, v144, s61
    v_perm_b32 v53, v150, v148, s61
    v_perm_b32 v54, v154, v152, s61
    v_perm_b32 v55, v158, v156, s61
    v_perm_b32 v56, v147, v145, s60
    v_perm_b32 v57, v151, v149, s60
    v_perm_b32 v58, v155, v153, s60
    v_perm_b32 v59, v159, v157, s60
    v_perm_b32 v60, v147, v145, s61
    v_perm_b32 v61, v151, v149, s61
    v_perm_b32 v62, v155, v153, s61
    v_perm_b32 v63, v159, v157, s61
    v_accvgpr_write_b32 a64, v48
    v_accvgpr_write_b32 a65, v49
    v_accvgpr_write_b32 a66, v50
    v_accvgpr_write_b32 a67, v51
    v_accvgpr_write_b32 a68, v52
    v_accvgpr_write_b32 a69, v53
    v_accvgpr_write_b32 a70, v54
    v_accvgpr_write_b32 a71, v55
    v_accvgpr_write_b32 a72, v56
    v_accvgpr_write_b32 a73, v57
    v_accvgpr_write_b32 a74, v58
    v_accvgpr_write_b32 a75, v59
    v_accvgpr_write_b32 a76, v60
    v_accvgpr_write_b32 a77, v61
    v_accvgpr_write_b32 a78, v62
    v_accvgpr_write_b32 a79, v63
    s_waitcnt vmcnt(48)
    s_add_u32 s3, s41, 196608
    s_add_u32 s40, s3, 8192
    buffer_load_dwordx2 v[144:145], v45, s[24:27], s3 offen offset:0
    buffer_load_dwordx2 v[146:147], v45, s[24:27], s3 offen offset:1024
    buffer_load_dwordx2 v[148:149], v45, s[24:27], s3 offen offset:2048
    buffer_load_dwordx2 v[150:151], v45, s[24:27], s3 offen offset:3072
    buffer_load_dwordx2 v[152:153], v45, s[24:27], s40 offen offset:0
    buffer_load_dwordx2 v[154:155], v45, s[24:27], s40 offen offset:1024
    buffer_load_dwordx2 v[156:157], v45, s[24:27], s40 offen offset:2048
    buffer_load_dwordx2 v[158:159], v45, s[24:27], s40 offen offset:3072
    v_perm_b32 v48, v162, v160, s60
    v_perm_b32 v49, v166, v164, s60
    v_perm_b32 v50, v170, v168, s60
    v_perm_b32 v51, v174, v172, s60
    v_perm_b32 v52, v162, v160, s61
    v_perm_b32 v53, v166, v164, s61
    v_perm_b32 v54, v170, v168, s61
    v_perm_b32 v55, v174, v172, s61
    v_perm_b32 v56, v163, v161, s60
    v_perm_b32 v57, v167, v165, s60
    v_perm_b32 v58, v171, v169, s60
    v_perm_b32 v59, v175, v173, s60
    v_perm_b32 v60, v163, v161, s61
    v_perm_b32 v61, v167, v165, s61
    v_perm_b32 v62, v171, v169, s61
    v_perm_b32 v63, v175, v173, s61
    v_accvgpr_write_b32 a80, v48
    v_accvgpr_write_b32 a81, v49
    v_accvgpr_write_b32 a82, v50
    v_accvgpr_write_b32 a83, v51
    v_accvgpr_write_b32 a84, v52
    v_accvgpr_write_b32 a85, v53
    v_accvgpr_write_b32 a86, v54
    v_accvgpr_write_b32 a87, v55
    v_accvgpr_write_b32 a88, v56
    v_accvgpr_write_b32 a89, v57
    v_accvgpr_write_b32 a90, v58
    v_accvgpr_write_b32 a91, v59
    v_accvgpr_write_b32 a92, v60
    v_accvgpr_write_b32 a93, v61
    v_accvgpr_write_b32 a94, v62
    v_accvgpr_write_b32 a95, v63
    s_waitcnt vmcnt(48)
    s_add_u32 s3, s41, 212992
    s_add_u32 s40, s3, 8192
    buffer_load_dwordx2 v[160:161], v45, s[24:27], s3 offen offset:0
    buffer_load_dwordx2 v[162:163], v45, s[24:27], s3 offen offset:1024
    buffer_load_dwordx2 v[164:165], v45, s[24:27], s3 offen offset:2048
    buffer_load_dwordx2 v[166:167], v45, s[24:27], s3 offen offset:3072
    buffer_load_dwordx2 v[168:169], v45, s[24:27], s40 offen offset:0
    buffer_load_dwordx2 v[170:171], v45, s[24:27], s40 offen offset:1024
    buffer_load_dwordx2 v[172:173], v45, s[24:27], s40 offen offset:2048
    buffer_load_dwordx2 v[174:175], v45, s[24:27], s40 offen offset:3072
    v_perm_b32 v48, v178, v176, s60
    v_perm_b32 v49, v182, v180, s60
    v_perm_b32 v50, v186, v184, s60
    v_perm_b32 v51, v190, v188, s60
    v_perm_b32 v52, v178, v176, s61
    v_perm_b32 v53, v182, v180, s61
    v_perm_b32 v54, v186, v184, s61
    v_perm_b32 v55, v190, v188, s61
    v_perm_b32 v56, v179, v177, s60
    v_perm_b32 v57, v183, v181, s60
    v_perm_b32 v58, v187, v185, s60
    v_perm_b32 v59, v191, v189, s60
    v_perm_b32 v60, v179, v177, s61
    v_perm_b32 v61, v183, v181, s61
    v_perm_b32 v62, v187, v185, s61
    v_perm_b32 v63, v191, v189, s61
    v_accvgpr_write_b32 a96, v48
    v_accvgpr_write_b32 a97, v49
    v_accvgpr_write_b32 a98, v50
    v_accvgpr_write_b32 a99, v51
    v_accvgpr_write_b32 a100, v52
    v_accvgpr_write_b32 a101, v53
    v_accvgpr_write_b32 a102, v54
    v_accvgpr_write_b32 a103, v55
    v_accvgpr_write_b32 a104, v56
    v_accvgpr_write_b32 a105, v57
    v_accvgpr_write_b32 a106, v58
    v_accvgpr_write_b32 a107, v59
    v_accvgpr_write_b32 a108, v60
    v_accvgpr_write_b32 a109, v61
    v_accvgpr_write_b32 a110, v62
    v_accvgpr_write_b32 a111, v63
    s_waitcnt vmcnt(48)
    s_add_u32 s3, s41, 229376
    s_add_u32 s40, s3, 8192
    buffer_load_dwordx2 v[176:177], v45, s[24:27], s3 offen offset:0
    buffer_load_dwordx2 v[178:179], v45, s[24:27], s3 offen offset:1024
    buffer_load_dwordx2 v[180:181], v45, s[24:27], s3 offen offset:2048
    buffer_load_dwordx2 v[182:183], v45, s[24:27], s3 offen offset:3072
    buffer_load_dwordx2 v[184:185], v45, s[24:27], s40 offen offset:0
    buffer_load_dwordx2 v[186:187], v45, s[24:27], s40 offen offset:1024
    buffer_load_dwordx2 v[188:189], v45, s[24:27], s40 offen offset:2048
    buffer_load_dwordx2 v[190:191], v45, s[24:27], s40 offen offset:3072
    v_perm_b32 v48, v194, v192, s60
    v_perm_b32 v49, v198, v196, s60
    v_perm_b32 v50, v202, v200, s60
    v_perm_b32 v51, v206, v204, s60
    v_perm_b32 v52, v194, v192, s61
    v_perm_b32 v53, v198, v196, s61
    v_perm_b32 v54, v202, v200, s61
    v_perm_b32 v55, v206, v204, s61
    v_perm_b32 v56, v195, v193, s60
    v_perm_b32 v57, v199, v197, s60
    v_perm_b32 v58, v203, v201, s60
    v_perm_b32 v59, v207, v205, s60
    v_perm_b32 v60, v195, v193, s61
    v_perm_b32 v61, v199, v197, s61
    v_perm_b32 v62, v203, v201, s61
    v_perm_b32 v63, v207, v205, s61
    v_accvgpr_write_b32 a112, v48
    v_accvgpr_write_b32 a113, v49
    v_accvgpr_write_b32 a114, v50
    v_accvgpr_write_b32 a115, v51
    v_accvgpr_write_b32 a116, v52
    v_accvgpr_write_b32 a117, v53
    v_accvgpr_write_b32 a118, v54
    v_accvgpr_write_b32 a119, v55
    v_accvgpr_write_b32 a120, v56
    v_accvgpr_write_b32 a121, v57
    v_accvgpr_write_b32 a122, v58
    v_accvgpr_write_b32 a123, v59
    v_accvgpr_write_b32 a124, v60
    v_accvgpr_write_b32 a125, v61
    v_accvgpr_write_b32 a126, v62
    v_accvgpr_write_b32 a127, v63
    s_waitcnt vmcnt(48)
    s_add_u32 s3, s41, 245760
    s_add_u32 s40, s3, 8192
    buffer_load_dwordx2 v[192:193], v45, s[24:27], s3 offen offset:0
    buffer_load_dwordx2 v[194:195], v45, s[24:27], s3 offen offset:1024
    buffer_load_dwordx2 v[196:197], v45, s[24:27], s3 offen offset:2048
    buffer_load_dwordx2 v[198:199], v45, s[24:27], s3 offen offset:3072
    buffer_load_dwordx2 v[200:201], v45, s[24:27], s40 offen offset:0
    buffer_load_dwordx2 v[202:203], v45, s[24:27], s40 offen offset:1024
    buffer_load_dwordx2 v[204:205], v45, s[24:27], s40 offen offset:2048
    buffer_load_dwordx2 v[206:207], v45, s[24:27], s40 offen offset:3072
    v_perm_b32 v48, v82, v80, s60
    v_perm_b32 v49, v86, v84, s60
    v_perm_b32 v50, v90, v88, s60
    v_perm_b32 v51, v94, v92, s60
    v_perm_b32 v52, v82, v80, s61
    v_perm_b32 v53, v86, v84, s61
    v_perm_b32 v54, v90, v88, s61
    v_perm_b32 v55, v94, v92, s61
    v_perm_b32 v56, v83, v81, s60
    v_perm_b32 v57, v87, v85, s60
    v_perm_b32 v58, v91, v89, s60
    v_perm_b32 v59, v95, v93, s60
    v_perm_b32 v60, v83, v81, s61
    v_perm_b32 v61, v87, v85, s61
    v_perm_b32 v62, v91, v89, s61
    v_perm_b32 v63, v95, v93, s61
    v_accvgpr_write_b32 a128, v48
    v_accvgpr_write_b32 a129, v49
    v_accvgpr_write_b32 a130, v50
    v_accvgpr_write_b32 a131, v51
    v_accvgpr_write_b32 a132, v52
    v_accvgpr_write_b32 a133, v53
    v_accvgpr_write_b32 a134, v54
    v_accvgpr_write_b32 a135, v55
    v_accvgpr_write_b32 a136, v56
    v_accvgpr_write_b32 a137, v57
    v_accvgpr_write_b32 a138, v58
    v_accvgpr_write_b32 a139, v59
    v_accvgpr_write_b32 a140, v60
    v_accvgpr_write_b32 a141, v61
    v_accvgpr_write_b32 a142, v62
    v_accvgpr_write_b32 a143, v63
    s_waitcnt vmcnt(48)
    v_perm_b32 v48, v98, v96, s60
    v_perm_b32 v49, v102, v100, s60
    v_perm_b32 v50, v106, v104, s60
    v_perm_b32 v51, v110, v108, s60
    v_perm_b32 v52, v98, v96, s61
    v_perm_b32 v53, v102, v100, s61
    v_perm_b32 v54, v106, v104, s61
    v_perm_b32 v55, v110, v108, s61
    v_perm_b32 v56, v99, v97, s60
    v_perm_b32 v57, v103, v101, s60
    v_perm_b32 v58, v107, v105, s60
    v_perm_b32 v59, v111, v109, s60
    v_perm_b32 v60, v99, v97, s61
    v_perm_b32 v61, v103, v101, s61
    v_perm_b32 v62, v107, v105, s61
    v_perm_b32 v63, v111, v109, s61
    v_accvgpr_write_b32 a144, v48
    v_accvgpr_write_b32 a145, v49
    v_accvgpr_write_b32 a146, v50
    v_accvgpr_write_b32 a147, v51
    v_accvgpr_write_b32 a148, v52
    v_accvgpr_write_b32 a149, v53
    v_accvgpr_write_b32 a150, v54
    v_accvgpr_write_b32 a151, v55
    v_accvgpr_write_b32 a152, v56
    v_accvgpr_write_b32 a153, v57
    v_accvgpr_write_b32 a154, v58
    v_accvgpr_write_b32 a155, v59
    v_accvgpr_write_b32 a156, v60
    v_accvgpr_write_b32 a157, v61
    v_accvgpr_write_b32 a158, v62
    v_accvgpr_write_b32 a159, v63
    s_waitcnt vmcnt(40)
    v_perm_b32 v48, v114, v112, s60
    v_perm_b32 v49, v118, v116, s60
    v_perm_b32 v50, v122, v120, s60
    v_perm_b32 v51, v126, v124, s60
    v_perm_b32 v52, v114, v112, s61
    v_perm_b32 v53, v118, v116, s61
    v_perm_b32 v54, v122, v120, s61
    v_perm_b32 v55, v126, v124, s61
    v_perm_b32 v56, v115, v113, s60
    v_perm_b32 v57, v119, v117, s60
    v_perm_b32 v58, v123, v121, s60
    v_perm_b32 v59, v127, v125, s60
    v_perm_b32 v60, v115, v113, s61
    v_perm_b32 v61, v119, v117, s61
    v_perm_b32 v62, v123, v121, s61
    v_perm_b32 v63, v127, v125, s61
    v_accvgpr_write_b32 a160, v48
    v_accvgpr_write_b32 a161, v49
    v_accvgpr_write_b32 a162, v50
    v_accvgpr_write_b32 a163, v51
    v_accvgpr_write_b32 a164, v52
    v_accvgpr_write_b32 a165, v53
    v_accvgpr_write_b32 a166, v54
    v_accvgpr_write_b32 a167, v55
    v_accvgpr_write_b32 a168, v56
    v_accvgpr_write_b32 a169, v57
    v_accvgpr_write_b32 a170, v58
    v_accvgpr_write_b32 a171, v59
    v_accvgpr_write_b32 a172, v60
    v_accvgpr_write_b32 a173, v61
    v_accvgpr_write_b32 a174, v62
    v_accvgpr_write_b32 a175, v63
    s_waitcnt vmcnt(32)
    v_perm_b32 v48, v130, v128, s60
    v_perm_b32 v49, v134, v132, s60
    v_perm_b32 v50, v138, v136, s60
    v_perm_b32 v51, v142, v140, s60
    v_perm_b32 v52, v130, v128, s61
    v_perm_b32 v53, v134, v132, s61
    v_perm_b32 v54, v138, v136, s61
    v_perm_b32 v55, v142, v140, s61
    v_perm_b32 v56, v131, v129, s60
    v_perm_b32 v57, v135, v133, s60
    v_perm_b32 v58, v139, v137, s60
    v_perm_b32 v59, v143, v141, s60
    v_perm_b32 v60, v131, v129, s61
    v_perm_b32 v61, v135, v133, s61
    v_perm_b32 v62, v139, v137, s61
    v_perm_b32 v63, v143, v141, s61
    v_accvgpr_write_b32 a176, v48
    v_accvgpr_write_b32 a177, v49
    v_accvgpr_write_b32 a178, v50
    v_accvgpr_write_b32 a179, v51
    v_accvgpr_write_b32 a180, v52
    v_accvgpr_write_b32 a181, v53
    v_accvgpr_write_b32 a182, v54
    v_accvgpr_write_b32 a183, v55
    v_accvgpr_write_b32 a184, v56
    v_accvgpr_write_b32 a185, v57
    v_accvgpr_write_b32 a186, v58
    v_accvgpr_write_b32 a187, v59
    v_accvgpr_write_b32 a188, v60
    v_accvgpr_write_b32 a189, v61
    v_accvgpr_write_b32 a190, v62
    v_accvgpr_write_b32 a191, v63
    s_waitcnt vmcnt(24)
    v_perm_b32 v48, v146, v144, s60
    v_perm_b32 v49, v150, v148, s60
    v_perm_b32 v50, v154, v152, s60
    v_perm_b32 v51, v158, v156, s60
    v_perm_b32 v52, v146, v144, s61
    v_perm_b32 v53, v150, v148, s61
    v_perm_b32 v54, v154, v152, s61
    v_perm_b32 v55, v158, v156, s61
    v_perm_b32 v56, v147, v145, s60
    v_perm_b32 v57, v151, v149, s60
    v_perm_b32 v58, v155, v153, s60
    v_perm_b32 v59, v159, v157, s60
    v_perm_b32 v60, v147, v145, s61
    v_perm_b32 v61, v151, v149, s61
    v_perm_b32 v62, v155, v153, s61
    v_perm_b32 v63, v159, v157, s61
    v_accvgpr_write_b32 a192, v48
    v_accvgpr_write_b32 a193, v49
    v_accvgpr_write_b32 a194, v50
    v_accvgpr_write_b32 a195, v51
    v_accvgpr_write_b32 a196, v52
    v_accvgpr_write_b32 a197, v53
    v_accvgpr_write_b32 a198, v54
    v_accvgpr_write_b32 a199, v55
    v_accvgpr_write_b32 a200, v56
    v_accvgpr_write_b32 a201, v57
    v_accvgpr_write_b32 a202, v58
    v_accvgpr_write_b32 a203, v59
    v_accvgpr_write_b32 a204, v60
    v_accvgpr_write_b32 a205, v61
    v_accvgpr_write_b32 a206, v62
    v_accvgpr_write_b32 a207, v63
    s_waitcnt vmcnt(16)
    v_perm_b32 v48, v162, v160, s60
    v_perm_b32 v49, v166, v164, s60
    v_perm_b32 v50, v170, v168, s60
    v_perm_b32 v51, v174, v172, s60
    v_perm_b32 v52, v162, v160, s61
    v_perm_b32 v53, v166, v164, s61
    v_perm_b32 v54, v170, v168, s61
    v_perm_b32 v55, v174, v172, s61
    v_perm_b32 v56, v163, v161, s60
    v_perm_b32 v57, v167, v165, s60
    v_perm_b32 v58, v171, v169, s60
    v_perm_b32 v59, v175, v173, s60
    v_perm_b32 v60, v163, v161, s61
    v_perm_b32 v61, v167, v165, s61
    v_perm_b32 v62, v171, v169, s61
    v_perm_b32 v63, v175, v173, s61
    v_accvgpr_write_b32 a208, v48
    v_accvgpr_write_b32 a209, v49
    v_accvgpr_write_b32 a210, v50
    v_accvgpr_write_b32 a211, v51
    v_accvgpr_write_b32 a212, v52
    v_accvgpr_write_b32 a213, v53
    v_accvgpr_write_b32 a214, v54
    v_accvgpr_write_b32 a215, v55
    v_accvgpr_write_b32 a216, v56
    v_accvgpr_write_b32 a217, v57
    v_accvgpr_write_b32 a218, v58
    v_accvgpr_write_b32 a219, v59
    v_accvgpr_write_b32 a220, v60
    v_accvgpr_write_b32 a221, v61
    v_accvgpr_write_b32 a222, v62
    v_accvgpr_write_b32 a223, v63
    s_waitcnt vmcnt(8)
    v_perm_b32 v48, v178, v176, s60
    v_perm_b32 v49, v182, v180, s60
    v_perm_b32 v50, v186, v184, s60
    v_perm_b32 v51, v190, v188, s60
    v_perm_b32 v52, v178, v176, s61
    v_perm_b32 v53, v182, v180, s61
    v_perm_b32 v54, v186, v184, s61
    v_perm_b32 v55, v190, v188, s61
    v_perm_b32 v56, v179, v177, s60
    v_perm_b32 v57, v183, v181, s60
    v_perm_b32 v58, v187, v185, s60
    v_perm_b32 v59, v191, v189, s60
    v_perm_b32 v60, v179, v177, s61
    v_perm_b32 v61, v183, v181, s61
    v_perm_b32 v62, v187, v185, s61
    v_perm_b32 v63, v191, v189, s61
    v_accvgpr_write_b32 a224, v48
    v_accvgpr_write_b32 a225, v49
    v_accvgpr_write_b32 a226, v50
    v_accvgpr_write_b32 a227, v51
    v_accvgpr_write_b32 a228, v52
    v_accvgpr_write_b32 a229, v53
    v_accvgpr_write_b32 a230, v54
    v_accvgpr_write_b32 a231, v55
    v_accvgpr_write_b32 a232, v56
    v_accvgpr_write_b32 a233, v57
    v_accvgpr_write_b32 a234, v58
    v_accvgpr_write_b32 a235, v59
    v_accvgpr_write_b32 a236, v60
    v_accvgpr_write_b32 a237, v61
    v_accvgpr_write_b32 a238, v62
    v_accvgpr_write_b32 a239, v63
    s_waitcnt vmcnt(0)
    v_perm_b32 v48, v194, v192, s60
    v_perm_b32 v49, v198, v196, s60
    v_perm_b32 v50, v202, v200, s60
    v_perm_b32 v51, v206, v204, s60
    v_perm_b32 v52, v194, v192, s61
    v_perm_b32 v53, v198, v196, s61
    v_perm_b32 v54, v202, v200, s61
    v_perm_b32 v55, v206, v204, s61
    v_perm_b32 v56, v195, v193, s60
    v_perm_b32 v57, v199, v197, s60
    v_perm_b32 v58, v203, v201, s60
    v_perm_b32 v59, v207, v205, s60
    v_perm_b32 v60, v195, v193, s61
    v_perm_b32 v61, v199, v197, s61
    v_perm_b32 v62, v203, v201, s61
    v_perm_b32 v63, v207, v205, s61
    v_accvgpr_write_b32 a240, v48
    v_accvgpr_write_b32 a241, v49
    v_accvgpr_write_b32 a242, v50
    v_accvgpr_write_b32 a243, v51
    v_accvgpr_write_b32 a244, v52
    v_accvgpr_write_b32 a245, v53
    v_accvgpr_write_b32 a246, v54
    v_accvgpr_write_b32 a247, v55
    v_accvgpr_write_b32 a248, v56
    v_accvgpr_write_b32 a249, v57
    v_accvgpr_write_b32 a250, v58
    v_accvgpr_write_b32 a251, v59
    v_accvgpr_write_b32 a252, v60
    v_accvgpr_write_b32 a253, v61
    v_accvgpr_write_b32 a254, v62
    v_accvgpr_write_b32 a255, v63
    v_mov_b32 v48, 0xf149f2ca
    v_lshlrev_b32 v49, 2, v43
    v_add_u32 v50, 0, v49
    v_cmp_gt_u32 vcc, v50, v44
    s_nop 1
    v_cndmask_b32 v16, 0, v48, vcc
    v_add_u32 v50, 1, v49
    v_cmp_gt_u32 vcc, v50, v44
    s_nop 1
    v_cndmask_b32 v17, 0, v48, vcc
    v_add_u32 v50, 2, v49
    v_cmp_gt_u32 vcc, v50, v44
    s_nop 1
    v_cndmask_b32 v18, 0, v48, vcc
    v_add_u32 v50, 3, v49
    v_cmp_gt_u32 vcc, v50, v44
    s_nop 1
    v_cndmask_b32 v19, 0, v48, vcc
    v_add_u32 v50, 8, v49
    v_cmp_gt_u32 vcc, v50, v44
    s_nop 1
    v_cndmask_b32 v20, 0, v48, vcc
    v_add_u32 v50, 9, v49
    v_cmp_gt_u32 vcc, v50, v44
    s_nop 1
    v_cndmask_b32 v21, 0, v48, vcc
    v_add_u32 v50, 10, v49
    v_cmp_gt_u32 vcc, v50, v44
    s_nop 1
    v_cndmask_b32 v22, 0, v48, vcc
    v_add_u32 v50, 11, v49
    v_cmp_gt_u32 vcc, v50, v44
    s_nop 1
    v_cndmask_b32 v23, 0, v48, vcc
    v_add_u32 v50, 16, v49
    v_cmp_gt_u32 vcc, v50, v44
    s_nop 1
    v_cndmask_b32 v24, 0, v48, vcc
    v_add_u32 v50, 17, v49
    v_cmp_gt_u32 vcc, v50, v44
    s_nop 1
    v_cndmask_b32 v25, 0, v48, vcc
    v_add_u32 v50, 18, v49
    v_cmp_gt_u32 vcc, v50, v44
    s_nop 1
    v_cndmask_b32 v26, 0, v48, vcc
    v_add_u32 v50, 19, v49
    v_cmp_gt_u32 vcc, v50, v44
    s_nop 1
    v_cndmask_b32 v27, 0, v48, vcc
    v_add_u32 v50, 24, v49
    v_cmp_gt_u32 vcc, v50, v44
    s_nop 1
    v_cndmask_b32 v28, 0, v48, vcc
    v_add_u32 v50, 25, v49
    v_cmp_gt_u32 vcc, v50, v44
    s_nop 1
    v_cndmask_b32 v29, 0, v48, vcc
    v_add_u32 v50, 26, v49
    v_cmp_gt_u32 vcc, v50, v44
    s_nop 1
    v_cndmask_b32 v30, 0, v48, vcc
    v_add_u32 v50, 27, v49
    v_cmp_gt_u32 vcc, v50, v44
    s_nop 1
    v_cndmask_b32 v31, 0, v48, vcc
    v_mov_b32 v48, 0x3f80
    v_and_b32 v49, 1, v0
    v_lshlrev_b32 v49, 4, v49
    v_lshlrev_b32 v48, v49, v48
    v_lshrrev_b32 v49, 1, v41
    v_lshlrev_b32 v50, 2, v43
    v_sub_u32 v49, v49, v50
    v_cmp_eq_u32 vcc, 0, v49
    s_nop 1
    v_cndmask_b32 v8, 0, v48, vcc
    v_cmp_eq_u32 vcc, 1, v49
    s_nop 1
    v_cndmask_b32 v9, 0, v48, vcc
    v_cmp_eq_u32 vcc, 2, v49
    s_nop 1
    v_cndmask_b32 v10, 0, v48, vcc
    v_cmp_eq_u32 vcc, 3, v49
    s_nop 1
    v_cndmask_b32 v11, 0, v48, vcc
    v_and_b32 v48, 7, v0
    v_lshlrev_b32 v7, 4, v48
    v_lshl_add_u32 v7, v43, 7, v7
    v_lshlrev_b32 v14, 8, v43
    v_lshl_add_u32 v14, v41, 3, v14
    v_lshl_add_u32 v14, v42, 2, v14
    v_lshlrev_b32 v12, 12, v43
    v_lshl_add_u32 v12, v44, 2, v12
    s_lshl_b32 s3, s6, 8
    s_lshl_b32 s40, s56, 15
    s_add_u32 s3, s3, s40
    v_add_u32 v12, s3, v12
    s_and_b32 s58, s6, 1
    s_lshl_b32 s3, s56, 1
    s_add_u32 s58, s58, s3
    v_lshlrev_b32 v13, 15, v42
    v_lshl_add_u32 v13, v43, 9, v13
    v_lshl_add_u32 v13, v48, 4, v13
    v_bfe_u32 v48, v0, 3, 1
    v_lshl_add_u32 v13, v48, 8, v13
    v_lshlrev_b32 v48, 9, v43
    v_lshl_add_u32 v48, v41, 5, v48
    v_lshl_add_u32 v48, v42, 4, v48
    v_mov_b32 v244, v48
    s_lshl_b32 s3, s58, 10
    v_add_u32 v13, s3, v13
    s_and_b32 s3, s58, 15
    s_lshl_b32 s3, s3, 4
    v_xor_b32 v15, s3, v244
    v_mov_b32 v6, v1
    s_mov_b32 s44, s57
    s_lshl_b32 s3, s7, 6
    s_add_u32 s3, s3, s44
    s_lshl_b32 s49, s3, 8
    s_add_u32 s49, s49, 540672
    s_lshl_b32 s3, s3, 5
    s_add_u32 s3, s3, s58
    s_lshl_b32 s45, s3, 7
    s_lshl_b32 s3, s7, 5
    s_add_u32 s3, s3, s58
    s_mul_i32 s46, s3, 2099328
    s_mul_i32 s3, s44, 28672
    s_add_u32 s46, s46, s3
    s_add_u32 s46, s46, 50331648
    s_add_u32 s47, s46, 24576
    s_lshl_b32 s48, s7, 23
    s_lshl_b32 s3, s57, 20
    s_add_u32 s48, s48, s3
    s_add_u32 s48, s48, 33554432
    s_lshl_b32 s50, s44, 5
    s_add_u32 s50, s50, s58
    s_lshl_b32 s50, s50, 10
    s_lshl_b32 s51, s7, 21
    s_add_u32 s51, s51, 5242880
    s_mov_b32 s52, 0
    s_mov_b32 s39, 0
    s_mov_b32 s63, 0x20000000
    s_lshl_b32 s53, s56, 4
    s_lshl_b32 s3, s6, 2
    s_add_u32 s53, s53, s3
    s_lshl_b32 s59, s6, 13
    s_lshl_b32 s34, s7, 13
    s_add_u32 s34, s34, 589824
    s_or_b32 s3, s58, s7
    s_cmp_eq_u32 s3, 0
    s_cselect_b32 s35, 532480, s63
    s_mov_b32 s3, s48
    buffer_load_dwordx4 v[64:67], v13, s[8:11], s3 offen offset:0 sc1
    buffer_load_dwordx4 v[64:67], v13, s[8:11], s3 offen offset:128 sc1
    s_add_u32 s3, s3, 65536
    buffer_load_dwordx4 v[64:67], v13, s[8:11], s3 offen offset:0 sc1
    buffer_load_dwordx4 v[64:67], v13, s[8:11], s3 offen offset:128 sc1
    s_add_u32 s3, s3, 65536
    buffer_load_dwordx4 v[64:67], v13, s[8:11], s3 offen offset:0 sc1
    buffer_load_dwordx4 v[64:67], v13, s[8:11], s3 offen offset:128 sc1
    s_add_u32 s3, s3, 65536
    buffer_load_dwordx4 v[64:67], v13, s[8:11], s3 offen offset:0 sc1
    buffer_load_dwordx4 v[64:67], v13, s[8:11], s3 offen offset:128 sc1
    s_add_u32 s3, s3, 65536
    buffer_load_dwordx4 v[64:67], v13, s[8:11], s3 offen offset:0 sc1
    buffer_load_dwordx4 v[64:67], v13, s[8:11], s3 offen offset:128 sc1
    s_add_u32 s3, s3, 65536
    buffer_load_dwordx4 v[64:67], v13, s[8:11], s3 offen offset:0 sc1
    buffer_load_dwordx4 v[64:67], v13, s[8:11], s3 offen offset:128 sc1
    s_add_u32 s3, s3, 65536
    buffer_load_dwordx4 v[64:67], v13, s[8:11], s3 offen offset:0 sc1
    buffer_load_dwordx4 v[64:67], v13, s[8:11], s3 offen offset:128 sc1
    s_add_u32 s3, s3, 65536
    buffer_load_dwordx4 v[64:67], v13, s[8:11], s3 offen offset:0 sc1
    buffer_load_dwordx4 v[64:67], v13, s[8:11], s3 offen offset:128 sc1
    s_add_u32 s3, s3, 65536
    s_add_u32 s3, s50, 11534336
    s_add_u32 s40, s50, 7340032
    s_lshl_b32 s41, s7, 29
    s_add_u32 s3, s3, s41
    s_add_u32 s40, s40, s41
    buffer_load_dword v64, v244, s[8:11], s3 offen sc1
    buffer_load_dword v64, v244, s[8:11], s40 offen sc1
    s_mov_b32 s62, 0
    v_and_b32 v40, 15, v0
    v_lshlrev_b32 v40, 2, v40
    s_lshl_b32 s40, s4, 7
    s_add_u32 s40, s40, 573440
    s_and_b32 s3, s5, 16
    s_lshl_b32 s3, s3, 2
    s_add_u32 s40, s40, s3
Lw_47:
    buffer_load_dword v4, v40, s[8:11], s40 offen offset:0 sc1
    s_waitcnt vmcnt(0)
    v_cmp_eq_u32 vcc, 0, v4
    s_cbranch_vccz Lwd_48
    s_sleep 1
    s_sub_u32 s98, s98, 1
    s_cbranch_scc1 L_end
    s_branch Lw_47
Lwd_48:
    v_readfirstlane_b32 s3, v4
    s_nop 1
    v_cmp_ne_u32 vcc, s3, v4
    s_cbranch_vccnz L_ao_mx
    s_mov_b32 s62, 1
L_ao_mx:
    v_and_b32 v0, 4, v5
    v_add_u32 v0, 12288, v0
    v_lshlrev_b32 v2, 2, v1
    s_mov_b32 s54, 0xff81ff81
    s_cmp_eq_u32 s62, 0
    s_cbranch_scc1 L_ao_mixed
L_ao_pure:
    s_cmp_ge_u32 s6, 2
    s_cbranch_scc1 L_ao_pure_bar
    s_and_b32 s3, s52, s39
    s_cbranch_scc1 L_ao_pure_have
    s_cmp_lt_u32 s44, 3
    s_cbranch_scc1 L_ao_pure_nob
    s_barrier
L_ao_pure_nob:
    s_cmp_lg_u32 s52, 0
    s_cbranch_scc1 L_ao_pure_have
    v_and_b32 v253, 4, v5
Lw_49:
    buffer_load_dword v4, v253, s[8:11], s45 offen offset:0 sc1
    s_waitcnt vmcnt(0)
    v_cmp_eq_u32 vcc, 0, v4
    s_cbranch_vccz Lwd_50
    s_sleep 1
    s_sub_u32 s98, s98, 1
    s_cbranch_scc1 L_end
    s_branch Lw_49
Lwd_50:
    s_add_u32 s3, s46, 0
    s_add_u32 s40, s46, 4096
    buffer_load_dwordx4 v[96:99], v1, s[8:11], s3 offen offset:0 sc1
    buffer_load_dwordx4 v[100:103], v1, s[8:11], s3 offen offset:1024 sc1
    buffer_load_dwordx4 v[104:107], v1, s[8:11], s3 offen offset:2048 sc1
    buffer_load_dwordx4 v[108:111], v1, s[8:11], s3 offen offset:3072 sc1
    buffer_load_dwordx4 v[112:115], v1, s[8:11], s40 offen offset:0 sc1
    buffer_load_dwordx4 v[116:119], v1, s[8:11], s40 offen offset:1024 sc1
    buffer_load_dwordx4 v[120:123], v1, s[8:11], s40 offen offset:2048 sc1
    buffer_load_dwordx4 v[124:127], v1, s[8:11], s40 offen offset:3072 sc1
    s_add_u32 s3, s46, 16384
    s_add_u32 s40, s46, 20480
    buffer_load_dwordx4 v[64:67], v1, s[8:11], s3 offen offset:0 sc1 nt
    buffer_load_dwordx4 v[68:71], v1, s[8:11], s3 offen offset:1024 sc1 nt
    buffer_load_dwordx4 v[72:75], v1, s[8:11], s3 offen offset:2048 sc1 nt
    buffer_load_dwordx4 v[76:79], v1, s[8:11], s3 offen offset:3072 sc1 nt
    buffer_load_dwordx4 v[80:83], v1, s[8:11], s40 offen offset:0 sc1 nt
    buffer_load_dwordx4 v[84:87], v1, s[8:11], s40 offen offset:1024 sc1 nt
    buffer_load_dwordx4 v[88:91], v1, s[8:11], s40 offen offset:2048 sc1 nt
    buffer_load_dwordx4 v[92:95], v1, s[8:11], s40 offen offset:3072 sc1 nt
    s_add_u32 s3, s46, 8192
    s_add_u32 s40, s46, 12288
    buffer_load_dwordx4 v[128:131], v1, s[8:11], s3 offen offset:0 sc1
    buffer_load_dwordx4 v[132:135], v1, s[8:11], s3 offen offset:1024 sc1
    buffer_load_dwordx4 v[136:139], v1, s[8:11], s3 offen offset:2048 sc1
    buffer_load_dwordx4 v[140:143], v1, s[8:11], s3 offen offset:3072 sc1
    buffer_load_dwordx4 v[144:147], v1, s[8:11], s40 offen offset:0 sc1
    buffer_load_dwordx4 v[148:151], v1, s[8:11], s40 offen offset:1024 sc1
    buffer_load_dwordx4 v[152:155], v1, s[8:11], s40 offen offset:2048 sc1
    buffer_load_dwordx4 v[156:159], v1, s[8:11], s40 offen offset:3072 sc1
    s_waitcnt vmcnt(8)
L_ao_pure_have:
    v_mfma_f32_32x32x16_bf16 v[32:47], v[96:99], v[64:67], v[16:31]
    v_mfma_f32_32x32x16_bf16 v[32:47], v[100:103], v[68:71], v[32:47]
    v_mfma_f32_32x32x16_bf16 v[32:47], v[104:107], v[72:75], v[32:47]
    v_mfma_f32_32x32x16_bf16 v[32:47], v[108:111], v[76:79], v[32:47]
    v_mfma_f32_32x32x16_bf16 v[32:47], v[112:115], v[80:83], v[32:47]
    v_mfma_f32_32x32x16_bf16 v[32:47], v[116:119], v[84:87], v[32:47]
    v_mfma_f32_32x32x16_bf16 v[32:47], v[120:123], v[88:91], v[32:47]
    v_mfma_f32_32x32x16_bf16 v[32:47], v[124:127], v[92:95], v[32:47]
    s_and_b32 s33, s52, s39
    s_cbranch_scc1 L_ao_pure_km
    v_mov_b32 v253, 0
Lw_51:
    buffer_load_dword v4, v253, s[8:11], s45 offen offset:32 sc1
    s_waitcnt vmcnt(0)
    v_cmp_eq_u32 vcc, 0, v4
    s_cbranch_vccz Lwd_52
    s_sleep 1
    s_sub_u32 s98, s98, 1
    s_cbranch_scc1 L_end
    s_branch Lw_51
Lwd_52:
    s_sleep 3
L_ao_pure_kw:
    buffer_load_dword v244, v2, s[8:11], s47 offen sc1
    s_waitcnt vmcnt(0)
    v_cmp_eq_u32 vcc, s54, v244
    s_cbranch_vccz L_ao_pure_kl
    s_sleep 1
    s_sub_u32 s98, s98, 1
    s_cbranch_scc1 L_end
    s_branch L_ao_pure_kw
L_ao_pure_kl:
    buffer_load_dwordx4 v[160:163], v7, s[8:11], s47 offen offset:0 sc1
    buffer_load_dwordx4 v[164:167], v7, s[8:11], s47 offen offset:256 sc1
    buffer_load_dwordx4 v[168:171], v7, s[8:11], s47 offen offset:512 sc1
    buffer_load_dwordx4 v[172:175], v7, s[8:11], s47 offen offset:768 sc1
    buffer_load_dwordx4 v[176:179], v7, s[8:11], s47 offen offset:1024 sc1
    buffer_load_dwordx4 v[180:183], v7, s[8:11], s47 offen offset:1280 sc1
    buffer_load_dwordx4 v[184:187], v7, s[8:11], s47 offen offset:1536 sc1
    buffer_load_dwordx4 v[188:191], v7, s[8:11], s47 offen offset:1792 sc1
    buffer_load_dword v192, v14, s[8:11], s47 offen offset:2048 sc1
    buffer_load_dword v193, v14, s[8:11], s47 offen offset:2176 sc1
    buffer_load_dword v194, v14, s[8:11], s47 offen offset:2560 sc1
    buffer_load_dword v195, v14, s[8:11], s47 offen offset:2688 sc1
    buffer_load_dword v196, v14, s[8:11], s47 offen offset:3072 sc1
    buffer_load_dword v197, v14, s[8:11], s47 offen offset:3200 sc1
    buffer_load_dword v198, v14, s[8:11], s47 offen offset:3584 sc1
    buffer_load_dword v199, v14, s[8:11], s47 offen offset:3712 sc1
    buffer_load_dword v4, v0, s[8:11], s45 offen sc1
L_ao_pure_km:
    s_add_u32 s46, s46, 86016
    s_nop 8
    v_max3_f32 v252, v32, v33, v34
    v_max3_f32 v253, v35, v36, v37
    v_max3_f32 v252, v252, v38, v39
    v_max3_f32 v253, v253, v40, v41
    v_max3_f32 v252, v252, v42, v43
    v_max3_f32 v253, v253, v44, v45
    v_max3_f32 v252, v252, v46, v47
    s_waitcnt vmcnt(16)
    v_mfma_f32_32x32x16_bf16 v[48:63], v[160:163], v[64:67], 0
    s_waitcnt vmcnt(15)
    v_mfma_f32_32x32x16_bf16 v[48:63], v[164:167], v[68:71], v[48:63]
    s_waitcnt vmcnt(14)
    v_mfma_f32_32x32x16_bf16 v[48:63], v[168:171], v[72:75], v[48:63]
    s_waitcnt vmcnt(13)
    v_mfma_f32_32x32x16_bf16 v[48:63], v[172:175], v[76:79], v[48:63]
    s_waitcnt vmcnt(12)
    v_mfma_f32_32x32x16_bf16 v[48:63], v[176:179], v[80:83], v[48:63]
    s_waitcnt vmcnt(11)
    v_mfma_f32_32x32x16_bf16 v[48:63], v[180:183], v[84:87], v[48:63]
    s_waitcnt vmcnt(10)
    v_mfma_f32_32x32x16_bf16 v[48:63], v[184:187], v[88:91], v[48:63]
    s_waitcnt vmcnt(9)
    v_mfma_f32_32x32x16_bf16 v[48:63], v[188:191], v[92:95], v[48:63]
    s_add_u32 s45, s45, 12288
    s_add_u32 s47, s47, 86016
    s_nop 9
    v_max3_f32 v253, v253, v48, v49
    v_max3_f32 v252, v252, v50, v51
    v_max_f32 v252, v252, v253
    v_mov_b32 v253, v252
    s_nop 1
    v_permlane32_swap_b32 v253, v252
    v_max_f32 v252, v252, v253
    v_pk_add_f32 v[32:33], v[32:33], v[252:253] op_sel_hi:[1,0] neg_lo:[0,1] neg_hi:[0,1]
    v_pk_add_f32 v[34:35], v[34:35], v[252:253] op_sel_hi:[1,0] neg_lo:[0,1] neg_hi:[0,1]
    v_pk_add_f32 v[36:37], v[36:37], v[252:253] op_sel_hi:[1,0] neg_lo:[0,1] neg_hi:[0,1]
    v_pk_add_f32 v[38:39], v[38:39], v[252:253] op_sel_hi:[1,0] neg_lo:[0,1] neg_hi:[0,1]
    v_pk_add_f32 v[40:41], v[40:41], v[252:253] op_sel_hi:[1,0] neg_lo:[0,1] neg_hi:[0,1]
    v_pk_add_f32 v[42:43], v[42:43], v[252:253] op_sel_hi:[1,0] neg_lo:[0,1] neg_hi:[0,1]
    v_pk_add_f32 v[44:45], v[44:45], v[252:253] op_sel_hi:[1,0] neg_lo:[0,1] neg_hi:[0,1]
    v_pk_add_f32 v[46:47], v[46:47], v[252:253] op_sel_hi:[1,0] neg_lo:[0,1] neg_hi:[0,1]
    v_pk_add_f32 v[48:49], v[48:49], v[252:253] op_sel_hi:[1,0] neg_lo:[0,1] neg_hi:[0,1]
    v_pk_add_f32 v[50:51], v[50:51], v[252:253] op_sel_hi:[1,0] neg_lo:[0,1] neg_hi:[0,1]
    v_exp_f32 v32, v32
    v_exp_f32 v33, v33
    v_exp_f32 v34, v34
    v_exp_f32 v35, v35
    v_exp_f32 v36, v36
    v_exp_f32 v37, v37
    v_exp_f32 v38, v38
    v_exp_f32 v39, v39
    v_exp_f32 v40, v40
    v_exp_f32 v41, v41
    v_exp_f32 v42, v42
    v_exp_f32 v43, v43
    v_exp_f32 v44, v44
    v_exp_f32 v45, v45
    v_exp_f32 v46, v46
    v_exp_f32 v47, v47
    v_exp_f32 v48, v48
    v_exp_f32 v49, v49
    v_exp_f32 v50, v50
    v_exp_f32 v51, v51
    v_pk_add_f32 v[254:255], v[32:33], v[34:35]
    v_pk_add_f32 v[252:253], v[36:37], v[38:39]
    v_pk_add_f32 v[254:255], v[254:255], v[40:41]
    v_pk_add_f32 v[252:253], v[252:253], v[42:43]
    v_pk_add_f32 v[254:255], v[254:255], v[44:45]
    v_pk_add_f32 v[252:253], v[252:253], v[46:47]
    v_pk_add_f32 v[254:255], v[254:255], v[48:49]
    v_pk_add_f32 v[252:253], v[252:253], v[50:51]
    v_pk_add_f32 v[254:255], v[254:255], v[252:253]
    v_add_f32 v254, v254, v255
    v_mov_b32 v253, v254
    s_nop 1
    v_permlane32_swap_b32 v253, v254
    v_add_f32 v254, v254, v253
    v_rcp_f32 v254, v254
    v_add_u32 v253, s59, v6
    v_pk_mul_f32 v[32:33], v[32:33], v[254:255] op_sel_hi:[1,0]
    v_pk_mul_f32 v[34:35], v[34:35], v[254:255] op_sel_hi:[1,0]
    v_pk_mul_f32 v[36:37], v[36:37], v[254:255] op_sel_hi:[1,0]
    v_pk_mul_f32 v[38:39], v[38:39], v[254:255] op_sel_hi:[1,0]
    v_pk_mul_f32 v[40:41], v[40:41], v[254:255] op_sel_hi:[1,0]
    v_pk_mul_f32 v[42:43], v[42:43], v[254:255] op_sel_hi:[1,0]
    v_pk_mul_f32 v[44:45], v[44:45], v[254:255] op_sel_hi:[1,0]
    v_pk_mul_f32 v[46:47], v[46:47], v[254:255] op_sel_hi:[1,0]
    v_pk_mul_f32 v[48:49], v[48:49], v[254:255] op_sel_hi:[1,0]
    v_pk_mul_f32 v[50:51], v[50:51], v[254:255] op_sel_hi:[1,0]
    v_cvt_pk_bf16_f32 v200, v32, v33
    v_cvt_pk_bf16_f32 v201, v34, v35
    v_cvt_pk_bf16_f32 v202, v40, v41
    v_cvt_pk_bf16_f32 v203, v42, v43
    v_cvt_pk_bf16_f32 v204, v36, v37
    v_cvt_pk_bf16_f32 v205, v38, v39
    v_cvt_pk_bf16_f32 v206, v44, v45
    v_cvt_pk_bf16_f32 v207, v46, v47
    v_cvt_pk_bf16_f32 v208, v48, v49
    v_cvt_pk_bf16_f32 v209, v50, v51
    s_waitcnt vmcnt(0)
    s_cmp_eq_u32 s33, 0
    s_cbranch_scc1 Lb_53
    s_barrier
Lb_53:
    v_cmp_eq_u32 vcc, 0, v4
    s_cmp_eq_u32 vcc_lo, 0
    s_cselect_b32 s52, 1, 0
    s_cmp_ge_u32 s44, 61
    s_cselect_b32 s52, 0, s52
    s_cmp_lg_u32 s52, 0
    s_cselect_b32 s64, s46, s63
    s_add_u32 s65, s64, 4096
    v_mfma_f32_32x32x16_bf16 v[212:227], v[128:131], v[200:203], 0
    buffer_load_dwordx4 v[96:99], v1, s[8:11], s64 offen offset:0 sc1
    buffer_load_dwordx4 v[100:103], v1, s[8:11], s64 offen offset:1024 sc1
    v_mfma_f32_32x32x16_bf16 v[212:227], v[132:135], v[204:207], v[212:227]
    buffer_load_dwordx4 v[104:107], v1, s[8:11], s64 offen offset:2048 sc1
    buffer_load_dwordx4 v[108:111], v1, s[8:11], s64 offen offset:3072 sc1
    v_mfma_f32_32x32x8_bf16 v[212:227], v[192:193], v[208:209], v[212:227]
    buffer_load_dwordx4 v[112:115], v1, s[8:11], s65 offen offset:0 sc1
    buffer_load_dwordx4 v[116:119], v1, s[8:11], s65 offen offset:1024 sc1
    v_mfma_f32_32x32x16_bf16 v[228:243], v[136:139], v[200:203], 0
    buffer_load_dwordx4 v[120:123], v1, s[8:11], s65 offen offset:2048 sc1
    v_mfma_f32_32x32x16_bf16 v[228:243], v[140:143], v[204:207], v[228:243]
    s_nop 6
    v_cvt_pk_bf16_f32 v160, v212, v213
    v_cvt_pk_bf16_f32 v161, v214, v215
    v_cvt_pk_bf16_f32 v162, v216, v217
    v_cvt_pk_bf16_f32 v163, v218, v219
    ds_write_b128 v253, v[160:163] offset:0
    v_mfma_f32_32x32x8_bf16 v[228:243], v[194:195], v[208:209], v[228:243]
    v_cvt_pk_bf16_f32 v164, v220, v221
    v_cvt_pk_bf16_f32 v165, v222, v223
    v_cvt_pk_bf16_f32 v166, v224, v225
    v_cvt_pk_bf16_f32 v167, v226, v227
    ds_write_b128 v253, v[164:167] offset:1024
    v_mfma_f32_32x32x16_bf16 v[32:47], v[144:147], v[200:203], 0
    buffer_load_dwordx4 v[124:127], v1, s[8:11], s65 offen offset:3072 sc1
    v_mfma_f32_32x32x16_bf16 v[32:47], v[148:151], v[204:207], v[32:47]
    s_nop 3
    v_cvt_pk_bf16_f32 v168, v228, v229
    v_cvt_pk_bf16_f32 v169, v230, v231
    v_cvt_pk_bf16_f32 v170, v232, v233
    v_cvt_pk_bf16_f32 v171, v234, v235
    ds_write_b128 v253, v[168:171] offset:2048
    v_mfma_f32_32x32x8_bf16 v[32:47], v[196:197], v[208:209], v[32:47]
    v_cvt_pk_bf16_f32 v172, v236, v237
    v_cvt_pk_bf16_f32 v173, v238, v239
    v_cvt_pk_bf16_f32 v174, v240, v241
    v_cvt_pk_bf16_f32 v175, v242, v243
    ds_write_b128 v253, v[172:175] offset:3072
    v_mfma_f32_32x32x16_bf16 v[48:63], v[152:155], v[200:203], 0
    v_mfma_f32_32x32x16_bf16 v[48:63], v[156:159], v[204:207], v[48:63]
    s_nop 4
    v_cvt_pk_bf16_f32 v176, v32, v33
    v_cvt_pk_bf16_f32 v177, v34, v35
    v_cvt_pk_bf16_f32 v178, v36, v37
    v_cvt_pk_bf16_f32 v179, v38, v39
    ds_write_b128 v253, v[176:179] offset:4096
    v_mfma_f32_32x32x8_bf16 v[48:63], v[198:199], v[208:209], v[48:63]
    v_cvt_pk_bf16_f32 v180, v40, v41
    v_cvt_pk_bf16_f32 v181, v42, v43
    v_cvt_pk_bf16_f32 v182, v44, v45
    v_cvt_pk_bf16_f32 v183, v46, v47
    ds_write_b128 v253, v[180:183] offset:5120
    buffer_load_dword v4, v0, s[8:11], s45 offen sc1
    buffer_load_dword v244, v2, s[8:11], s63 offen sc1
    s_add_u32 s66, s64, 8192
    s_add_u32 s67, s64, 12288
    s_add_u32 s68, s64, 16384
    s_add_u32 s69, s64, 20480
    s_nop 0
    v_cvt_pk_bf16_f32 v184, v48, v49
    v_cvt_pk_bf16_f32 v185, v50, v51
    v_cvt_pk_bf16_f32 v186, v52, v53
    v_cvt_pk_bf16_f32 v187, v54, v55
    ds_write_b128 v253, v[184:187] offset:6144
    v_cvt_pk_bf16_f32 v188, v56, v57
    v_cvt_pk_bf16_f32 v189, v58, v59
    v_cvt_pk_bf16_f32 v190, v60, v61
    v_cvt_pk_bf16_f32 v191, v62, v63
    ds_write_b128 v253, v[188:191] offset:7168
    s_waitcnt lgkmcnt(0)
L_ao_pure_bar:
    s_add_u32 s36, s48, 8192
    s_add_u32 s37, s48, 16384
    s_add_u32 s38, s48, 24576
    s_mov_b32 s39, 0
    s_barrier
    ds_read_b128 v[200:203], v6 offset:0
    ds_read_b128 v[204:207], v6 offset:1024
    s_cmp_ge_u32 s6, 2
    s_cbranch_scc1 L_ao_pure_red
    ds_read_b128 v[208:211], v6 offset:2048
    s_waitcnt lgkmcnt(2)
    v_mfma_f32_32x32x16_bf16 v[32:47], v[200:203], a[0:3], 0
    buffer_load_dwordx4 v[64:67], v1, s[8:11], s68 offen offset:0 sc1 nt
    v_mfma_f32_32x32x16_bf16 v[48:63], v[200:203], a[4:7], 0
    buffer_load_dwordx4 v[68:71], v1, s[8:11], s68 offen offset:1024 sc1 nt
    ds_read_b128 v[200:203], v6 offset:3072
    s_waitcnt lgkmcnt(2)
    v_mfma_f32_32x32x16_bf16 v[32:47], v[204:207], a[16:19], v[32:47]
    buffer_load_dwordx4 v[72:75], v1, s[8:11], s68 offen offset:2048 sc1 nt
    v_mfma_f32_32x32x16_bf16 v[48:63], v[204:207], a[20:23], v[48:63]
    buffer_load_dwordx4 v[76:79], v1, s[8:11], s68 offen offset:3072 sc1 nt
    ds_read_b128 v[204:207], v6 offset:4096
    s_waitcnt lgkmcnt(2)
    v_mfma_f32_32x32x16_bf16 v[32:47], v[208:211], a[32:35], v[32:47]
    buffer_load_dwordx4 v[80:83], v1, s[8:11], s69 offen offset:0 sc1 nt
    v_mfma_f32_32x32x16_bf16 v[48:63], v[208:211], a[36:39], v[48:63]
    buffer_load_dwordx4 v[84:87], v1, s[8:11], s69 offen offset:1024 sc1 nt
    ds_read_b128 v[208:211], v6 offset:5120
    s_waitcnt lgkmcnt(2)
    v_mfma_f32_32x32x16_bf16 v[32:47], v[200:203], a[48:51], v[32:47]
    buffer_load_dwordx4 v[88:91], v1, s[8:11], s69 offen offset:2048 sc1 nt
    v_mfma_f32_32x32x16_bf16 v[48:63], v[200:203], a[52:55], v[48:63]
    buffer_load_dwordx4 v[92:95], v1, s[8:11], s69 offen offset:3072 sc1 nt
    ds_read_b128 v[200:203], v6 offset:6144
    s_waitcnt lgkmcnt(2)
    v_mfma_f32_32x32x16_bf16 v[32:47], v[204:207], a[64:67], v[32:47]
    buffer_load_dwordx4 v[128:131], v1, s[8:11], s66 offen offset:0 sc1
    v_mfma_f32_32x32x16_bf16 v[48:63], v[204:207], a[68:71], v[48:63]
    buffer_load_dwordx4 v[132:135], v1, s[8:11], s66 offen offset:1024 sc1
    ds_read_b128 v[204:207], v6 offset:7168
    s_waitcnt lgkmcnt(2)
    v_mfma_f32_32x32x16_bf16 v[32:47], v[208:211], a[80:83], v[32:47]
    buffer_load_dwordx4 v[136:139], v1, s[8:11], s66 offen offset:2048 sc1
    v_mfma_f32_32x32x16_bf16 v[48:63], v[208:211], a[84:87], v[48:63]
    buffer_load_dwordx4 v[140:143], v1, s[8:11], s66 offen offset:3072 sc1
    ds_read_b128 v[208:211], v6 offset:8192
    s_waitcnt lgkmcnt(2)
    v_mfma_f32_32x32x16_bf16 v[32:47], v[200:203], a[96:99], v[32:47]
    buffer_load_dwordx4 v[144:147], v1, s[8:11], s67 offen offset:0 sc1
    v_mfma_f32_32x32x16_bf16 v[48:63], v[200:203], a[100:103], v[48:63]
    buffer_load_dwordx4 v[148:151], v1, s[8:11], s67 offen offset:1024 sc1
    ds_read_b128 v[200:203], v6 offset:9216
    s_waitcnt lgkmcnt(2)
    v_mfma_f32_32x32x16_bf16 v[32:47], v[204:207], a[112:115], v[32:47]
    buffer_load_dwordx4 v[152:155], v1, s[8:11], s67 offen offset:2048 sc1
    v_mfma_f32_32x32x16_bf16 v[48:63], v[204:207], a[116:119], v[48:63]
    buffer_load_dwordx4 v[156:159], v1, s[8:11], s67 offen offset:3072 sc1
    ds_read_b128 v[204:207], v6 offset:10240
    s_waitcnt lgkmcnt(2)
    v_mfma_f32_32x32x16_bf16 v[32:47], v[208:211], a[128:131], v[32:47]
    s_waitcnt vmcnt(16)
    v_cmp_eq_u32 vcc, s54, v244
    v_mfma_f32_32x32x16_bf16 v[48:63], v[208:211], a[132:135], v[48:63]
    s_cmp_eq_u64 vcc, 0
    s_cselect_b32 s39, 0, 0
    s_cmp_lg_u32 s39, 0
    s_cselect_b32 s40, s47, s63
    ds_read_b128 v[208:211], v6 offset:11264
    s_waitcnt lgkmcnt(2)
    v_mfma_f32_32x32x16_bf16 v[32:47], v[200:203], a[144:147], v[32:47]
    buffer_load_dwordx4 v[160:163], v7, s[8:11], s40 offen offset:0 sc1
    v_mfma_f32_32x32x16_bf16 v[48:63], v[200:203], a[148:151], v[48:63]
    buffer_load_dwordx4 v[164:167], v7, s[8:11], s40 offen offset:256 sc1
    ds_read_b128 v[200:203], v6 offset:12288
    s_waitcnt lgkmcnt(2)
    v_mfma_f32_32x32x16_bf16 v[32:47], v[204:207], a[160:163], v[32:47]
    buffer_load_dwordx4 v[168:171], v7, s[8:11], s40 offen offset:512 sc1
    v_mfma_f32_32x32x16_bf16 v[48:63], v[204:207], a[164:167], v[48:63]
    buffer_load_dwordx4 v[172:175], v7, s[8:11], s40 offen offset:768 sc1
    ds_read_b128 v[204:207], v6 offset:13312
    s_waitcnt lgkmcnt(2)
    v_mfma_f32_32x32x16_bf16 v[32:47], v[208:211], a[176:179], v[32:47]
    buffer_load_dwordx4 v[176:179], v7, s[8:11], s40 offen offset:1024 sc1
    v_mfma_f32_32x32x16_bf16 v[48:63], v[208:211], a[180:183], v[48:63]
    buffer_load_dwordx4 v[180:183], v7, s[8:11], s40 offen offset:1280 sc1
    ds_read_b128 v[208:211], v6 offset:14336
    s_waitcnt lgkmcnt(2)
    v_mfma_f32_32x32x16_bf16 v[32:47], v[200:203], a[192:195], v[32:47]
    buffer_load_dwordx4 v[184:187], v7, s[8:11], s40 offen offset:1536 sc1
    v_mfma_f32_32x32x16_bf16 v[48:63], v[200:203], a[196:199], v[48:63]
    buffer_load_dwordx4 v[188:191], v7, s[8:11], s40 offen offset:1792 sc1
    ds_read_b128 v[200:203], v6 offset:15360
    s_waitcnt lgkmcnt(2)
    v_mfma_f32_32x32x16_bf16 v[32:47], v[204:207], a[208:211], v[32:47]
    buffer_load_dword v192, v14, s[8:11], s40 offen offset:2048 sc1
    v_mfma_f32_32x32x16_bf16 v[48:63], v[204:207], a[212:215], v[48:63]
    buffer_load_dword v193, v14, s[8:11], s40 offen offset:2176 sc1
    ds_read_b128 v[204:207], v6 offset:0
    s_waitcnt lgkmcnt(2)
    v_mfma_f32_32x32x16_bf16 v[32:47], v[208:211], a[224:227], v[32:47]
    buffer_load_dword v194, v14, s[8:11], s40 offen offset:2560 sc1
    v_mfma_f32_32x32x16_bf16 v[48:63], v[208:211], a[228:231], v[48:63]
    buffer_load_dword v195, v14, s[8:11], s40 offen offset:2688 sc1
    ds_read_b128 v[208:211], v6 offset:1024
    s_waitcnt lgkmcnt(2)
    v_mfma_f32_32x32x16_bf16 v[32:47], v[200:203], a[240:243], v[32:47]
    buffer_load_dword v196, v14, s[8:11], s40 offen offset:3072 sc1
    v_mfma_f32_32x32x16_bf16 v[48:63], v[200:203], a[244:247], v[48:63]
    buffer_load_dword v197, v14, s[8:11], s40 offen offset:3200 sc1
    ds_read_b128 v[200:203], v6 offset:2048
    s_waitcnt lgkmcnt(2)
    v_mfma_f32_32x32x16_bf16 v[212:227], v[204:207], a[8:11], 0
    buffer_load_dword v198, v14, s[8:11], s40 offen offset:3584 sc1
    v_mfma_f32_32x32x16_bf16 v[228:243], v[204:207], a[12:15], 0
    buffer_load_dword v199, v14, s[8:11], s40 offen offset:3712 sc1
    ds_read_b128 v[204:207], v6 offset:3072
    s_waitcnt lgkmcnt(2)
    v_mfma_f32_32x32x16_bf16 v[212:227], v[208:211], a[24:27], v[212:227]
    v_mfma_f32_32x32x16_bf16 v[228:243], v[208:211], a[28:31], v[228:243]
    ds_read_b128 v[208:211], v6 offset:4096
    s_waitcnt lgkmcnt(2)
    v_mfma_f32_32x32x16_bf16 v[212:227], v[200:203], a[40:43], v[212:227]
    v_cvt_pk_bf16_f32 v32, v32, v48
    buffer_store_dword v32, v12, s[8:11], s48 offen offset:0
    v_mfma_f32_32x32x16_bf16 v[228:243], v[200:203], a[44:47], v[228:243]
    v_cvt_pk_bf16_f32 v33, v33, v49
    buffer_store_dword v33, v12, s[8:11], s48 offen offset:1024
    ds_read_b128 v[200:203], v6 offset:5120
    s_waitcnt lgkmcnt(2)
    v_mfma_f32_32x32x16_bf16 v[212:227], v[204:207], a[56:59], v[212:227]
    v_cvt_pk_bf16_f32 v34, v34, v50
    buffer_store_dword v34, v12, s[8:11], s48 offen offset:2048
    v_mfma_f32_32x32x16_bf16 v[228:243], v[204:207], a[60:63], v[228:243]
    ds_read_b128 v[204:207], v6 offset:6144
    s_waitcnt lgkmcnt(2)
    v_mfma_f32_32x32x16_bf16 v[212:227], v[208:211], a[72:75], v[212:227]
    v_cvt_pk_bf16_f32 v35, v35, v51
    buffer_store_dword v35, v12, s[8:11], s48 offen offset:3072
    v_mfma_f32_32x32x16_bf16 v[228:243], v[208:211], a[76:79], v[228:243]
    ds_read_b128 v[208:211], v6 offset:7168
    s_waitcnt lgkmcnt(2)
    v_mfma_f32_32x32x16_bf16 v[212:227], v[200:203], a[88:91], v[212:227]
    v_cvt_pk_bf16_f32 v36, v36, v52
    buffer_store_dword v36, v12, s[8:11], s36 offen offset:0
    v_mfma_f32_32x32x16_bf16 v[228:243], v[200:203], a[92:95], v[228:243]
    ds_read_b128 v[200:203], v6 offset:8192
    s_waitcnt lgkmcnt(2)
    v_mfma_f32_32x32x16_bf16 v[212:227], v[204:207], a[104:107], v[212:227]
    v_cvt_pk_bf16_f32 v37, v37, v53
    buffer_store_dword v37, v12, s[8:11], s36 offen offset:1024
    v_mfma_f32_32x32x16_bf16 v[228:243], v[204:207], a[108:111], v[228:243]
    v_cvt_pk_bf16_f32 v38, v38, v54
    buffer_store_dword v38, v12, s[8:11], s36 offen offset:2048
    ds_read_b128 v[204:207], v6 offset:9216
    s_waitcnt lgkmcnt(2)
    v_mfma_f32_32x32x16_bf16 v[212:227], v[208:211], a[120:123], v[212:227]
    v_cvt_pk_bf16_f32 v39, v39, v55
    buffer_store_dword v39, v12, s[8:11], s36 offen offset:3072
    v_mfma_f32_32x32x16_bf16 v[228:243], v[208:211], a[124:127], v[228:243]
    ds_read_b128 v[208:211], v6 offset:10240
    s_waitcnt lgkmcnt(2)
    v_mfma_f32_32x32x16_bf16 v[212:227], v[200:203], a[136:139], v[212:227]
    v_cvt_pk_bf16_f32 v40, v40, v56
    buffer_store_dword v40, v12, s[8:11], s37 offen offset:0
    v_mfma_f32_32x32x16_bf16 v[228:243], v[200:203], a[140:143], v[228:243]
    ds_read_b128 v[200:203], v6 offset:11264
    s_waitcnt lgkmcnt(2)
    v_mfma_f32_32x32x16_bf16 v[212:227], v[204:207], a[152:155], v[212:227]
    v_cvt_pk_bf16_f32 v41, v41, v57
    buffer_store_dword v41, v12, s[8:11], s37 offen offset:1024
    v_mfma_f32_32x32x16_bf16 v[228:243], v[204:207], a[156:159], v[228:243]
    ds_read_b128 v[204:207], v6 offset:12288
    s_waitcnt lgkmcnt(2)
    v_mfma_f32_32x32x16_bf16 v[212:227], v[208:211], a[168:171], v[212:227]
    v_cvt_pk_bf16_f32 v42, v42, v58
    buffer_store_dword v42, v12, s[8:11], s37 offen offset:2048
    v_cvt_pk_bf16_f32 v43, v43, v59
    buffer_store_dword v43, v12, s[8:11], s37 offen offset:3072
    v_mfma_f32_32x32x16_bf16 v[228:243], v[208:211], a[172:175], v[228:243]
    ds_read_b128 v[208:211], v6 offset:13312
    s_waitcnt lgkmcnt(2)
    v_mfma_f32_32x32x16_bf16 v[212:227], v[200:203], a[184:187], v[212:227]
    v_mfma_f32_32x32x16_bf16 v[228:243], v[200:203], a[188:191], v[228:243]
    v_cvt_pk_bf16_f32 v44, v44, v60
    buffer_store_dword v44, v12, s[8:11], s38 offen offset:0
    ds_read_b128 v[200:203], v6 offset:14336
    s_waitcnt lgkmcnt(2)
    v_mfma_f32_32x32x16_bf16 v[212:227], v[204:207], a[200:203], v[212:227]
    v_cvt_pk_bf16_f32 v45, v45, v61
    buffer_store_dword v45, v12, s[8:11], s38 offen offset:1024
    v_mfma_f32_32x32x16_bf16 v[228:243], v[204:207], a[204:207], v[228:243]
    ds_read_b128 v[204:207], v6 offset:15360
    s_waitcnt lgkmcnt(2)
    v_mfma_f32_32x32x16_bf16 v[212:227], v[208:211], a[216:219], v[212:227]
    v_cvt_pk_bf16_f32 v46, v46, v62
    buffer_store_dword v46, v12, s[8:11], s38 offen offset:2048
    v_mfma_f32_32x32x16_bf16 v[228:243], v[208:211], a[220:223], v[228:243]
    s_waitcnt lgkmcnt(1)
    v_mfma_f32_32x32x16_bf16 v[212:227], v[200:203], a[232:235], v[212:227]
    v_cvt_pk_bf16_f32 v47, v47, v63
    buffer_store_dword v47, v12, s[8:11], s38 offen offset:3072
    v_mfma_f32_32x32x16_bf16 v[228:243], v[200:203], a[236:239], v[228:243]
    s_waitcnt lgkmcnt(0)
    v_mfma_f32_32x32x16_bf16 v[212:227], v[204:207], a[248:251], v[212:227]
    v_mfma_f32_32x32x16_bf16 v[228:243], v[204:207], a[252:255], v[228:243]
    v_xor_b32 v6, 0x4000, v6
    s_add_u32 s3, s49, s53
    s_nop 9
    v_cvt_pk_bf16_f32 v212, v212, v228
    buffer_store_dword v212, v12, s[8:11], s48 offen offset:128
    v_cvt_pk_bf16_f32 v213, v213, v229
    buffer_store_dword v213, v12, s[8:11], s48 offen offset:1152
    v_cvt_pk_bf16_f32 v214, v214, v230
    buffer_store_dword v214, v12, s[8:11], s48 offen offset:2176
    v_cvt_pk_bf16_f32 v215, v215, v231
    buffer_store_dword v215, v12, s[8:11], s48 offen offset:3200
    v_cvt_pk_bf16_f32 v216, v216, v232
    buffer_store_dword v216, v12, s[8:11], s36 offen offset:128
    v_cvt_pk_bf16_f32 v217, v217, v233
    buffer_store_dword v217, v12, s[8:11], s36 offen offset:1152
    v_cvt_pk_bf16_f32 v218, v218, v234
    buffer_store_dword v218, v12, s[8:11], s36 offen offset:2176
    v_cvt_pk_bf16_f32 v219, v219, v235
    buffer_store_dword v219, v12, s[8:11], s36 offen offset:3200
    v_cvt_pk_bf16_f32 v220, v220, v236
    buffer_store_dword v220, v12, s[8:11], s37 offen offset:128
    v_cvt_pk_bf16_f32 v221, v221, v237
    buffer_store_dword v221, v12, s[8:11], s37 offen offset:1152
    v_cvt_pk_bf16_f32 v222, v222, v238
    buffer_store_dword v222, v12, s[8:11], s37 offen offset:2176
    v_cvt_pk_bf16_f32 v223, v223, v239
    buffer_store_dword v223, v12, s[8:11], s37 offen offset:3200
    v_cvt_pk_bf16_f32 v224, v224, v240
    buffer_store_dword v224, v12, s[8:11], s38 offen offset:128
    v_cvt_pk_bf16_f32 v225, v225, v241
    buffer_store_dword v225, v12, s[8:11], s38 offen offset:1152
    v_cvt_pk_bf16_f32 v226, v226, v242
    buffer_store_dword v226, v12, s[8:11], s38 offen offset:2176
    v_cvt_pk_bf16_f32 v227, v227, v243
    buffer_store_dword v227, v12, s[8:11], s38 offen offset:3200
    s_waitcnt vmcnt(0)
    buffer_store_dword v3, off, s[8:11], s3
    s_branch L_ao_pure_nx
L_ao_pure_red:
    ds_read_b128 v[208:211], v6 offset:2048
    s_waitcnt lgkmcnt(2)
    v_mfma_f32_32x32x16_bf16 v[32:47], v[200:203], a[0:3], 0
    s_add_u32 s3, s51, s50
    buffer_load_dwordx4 v[128:131], v244, s[8:11], s3 offen sc1
    v_mfma_f32_32x32x16_bf16 v[48:63], v[200:203], a[4:7], 0
    ds_read_b128 v[200:203], v6 offset:3072
    s_waitcnt lgkmcnt(2)
    v_mfma_f32_32x32x16_bf16 v[32:47], v[204:207], a[16:19], v[32:47]
    s_add_u32 s3, s50, 3145728
    buffer_load_dwordx4 v[132:135], v244, s[8:11], s3 offen sc1
    v_mfma_f32_32x32x16_bf16 v[48:63], v[204:207], a[20:23], v[48:63]
    ds_read_b128 v[204:207], v6 offset:4096
    s_waitcnt lgkmcnt(2)
    v_mfma_f32_32x32x16_bf16 v[32:47], v[208:211], a[32:35], v[32:47]
    buffer_load_dword v4, v5, s[8:11], s49 offen sc1
    v_mfma_f32_32x32x16_bf16 v[48:63], v[208:211], a[36:39], v[48:63]
    ds_read_b128 v[208:211], v6 offset:5120
    s_waitcnt lgkmcnt(2)
    v_mfma_f32_32x32x16_bf16 v[32:47], v[200:203], a[48:51], v[32:47]
    s_lshl_b32 s3, s44, 7
    s_add_u32 s3, s3, s34
    buffer_load_dword v4, off, s[8:11], s3 sc1
    v_mfma_f32_32x32x16_bf16 v[48:63], v[200:203], a[52:55], v[48:63]
    ds_read_b128 v[200:203], v6 offset:6144
    s_waitcnt lgkmcnt(2)
    v_mfma_f32_32x32x16_bf16 v[32:47], v[204:207], a[64:67], v[32:47]
    v_mfma_f32_32x32x16_bf16 v[48:63], v[204:207], a[68:71], v[48:63]
    ds_read_b128 v[204:207], v6 offset:7168
    s_waitcnt lgkmcnt(2)
    v_mfma_f32_32x32x16_bf16 v[32:47], v[208:211], a[80:83], v[32:47]
    v_mfma_f32_32x32x16_bf16 v[48:63], v[208:211], a[84:87], v[48:63]
    ds_read_b128 v[208:211], v6 offset:8192
    s_waitcnt lgkmcnt(2)
    v_mfma_f32_32x32x16_bf16 v[32:47], v[200:203], a[96:99], v[32:47]
    v_mfma_f32_32x32x16_bf16 v[48:63], v[200:203], a[100:103], v[48:63]
    ds_read_b128 v[200:203], v6 offset:9216
    s_waitcnt lgkmcnt(2)
    v_mfma_f32_32x32x16_bf16 v[32:47], v[204:207], a[112:115], v[32:47]
    v_mfma_f32_32x32x16_bf16 v[48:63], v[204:207], a[116:119], v[48:63]
    ds_read_b128 v[204:207], v6 offset:10240
    s_waitcnt lgkmcnt(2)
    v_mfma_f32_32x32x16_bf16 v[32:47], v[208:211], a[128:131], v[32:47]
    v_mfma_f32_32x32x16_bf16 v[48:63], v[208:211], a[132:135], v[48:63]
    ds_read_b128 v[208:211], v6 offset:11264
    s_waitcnt lgkmcnt(2)
    v_mfma_f32_32x32x16_bf16 v[32:47], v[200:203], a[144:147], v[32:47]
    v_mfma_f32_32x32x16_bf16 v[48:63], v[200:203], a[148:151], v[48:63]
    ds_read_b128 v[200:203], v6 offset:12288
    s_waitcnt lgkmcnt(2)
    v_mfma_f32_32x32x16_bf16 v[32:47], v[204:207], a[160:163], v[32:47]
    v_mfma_f32_32x32x16_bf16 v[48:63], v[204:207], a[164:167], v[48:63]
    ds_read_b128 v[204:207], v6 offset:13312
    s_waitcnt lgkmcnt(2)
    v_mfma_f32_32x32x16_bf16 v[32:47], v[208:211], a[176:179], v[32:47]
    v_mfma_f32_32x32x16_bf16 v[48:63], v[208:211], a[180:183], v[48:63]
    ds_read_b128 v[208:211], v6 offset:14336
    s_waitcnt lgkmcnt(2)
    v_mfma_f32_32x32x16_bf16 v[32:47], v[200:203], a[192:195], v[32:47]
    v_mfma_f32_32x32x16_bf16 v[48:63], v[200:203], a[196:199], v[48:63]
    ds_read_b128 v[200:203], v6 offset:15360
    s_waitcnt lgkmcnt(2)
    v_mfma_f32_32x32x16_bf16 v[32:47], v[204:207], a[208:211], v[32:47]
    v_mfma_f32_32x32x16_bf16 v[48:63], v[204:207], a[212:215], v[48:63]
    ds_read_b128 v[204:207], v6 offset:0
    s_waitcnt lgkmcnt(2)
    v_mfma_f32_32x32x16_bf16 v[32:47], v[208:211], a[224:227], v[32:47]
    v_mfma_f32_32x32x16_bf16 v[48:63], v[208:211], a[228:231], v[48:63]
    ds_read_b128 v[208:211], v6 offset:1024
    s_waitcnt lgkmcnt(2)
    v_mfma_f32_32x32x16_bf16 v[32:47], v[200:203], a[240:243], v[32:47]
    v_mfma_f32_32x32x16_bf16 v[48:63], v[200:203], a[244:247], v[48:63]
    ds_read_b128 v[200:203], v6 offset:2048
    s_waitcnt lgkmcnt(2)
    v_mfma_f32_32x32x16_bf16 v[212:227], v[204:207], a[8:11], 0
    v_mfma_f32_32x32x16_bf16 v[228:243], v[204:207], a[12:15], 0
    ds_read_b128 v[204:207], v6 offset:3072
    s_waitcnt lgkmcnt(2)
    v_mfma_f32_32x32x16_bf16 v[212:227], v[208:211], a[24:27], v[212:227]
    v_mfma_f32_32x32x16_bf16 v[228:243], v[208:211], a[28:31], v[228:243]
    ds_read_b128 v[208:211], v6 offset:4096
    s_waitcnt lgkmcnt(2)
    v_mfma_f32_32x32x16_bf16 v[212:227], v[200:203], a[40:43], v[212:227]
    s_nop 0
    v_cvt_pk_bf16_f32 v32, v32, v48
    buffer_store_dword v32, v12, s[8:11], s48 offen offset:0
    v_mfma_f32_32x32x16_bf16 v[228:243], v[200:203], a[44:47], v[228:243]
    v_cvt_pk_bf16_f32 v33, v33, v49
    buffer_store_dword v33, v12, s[8:11], s48 offen offset:1024
    ds_read_b128 v[200:203], v6 offset:5120
    s_waitcnt lgkmcnt(2)
    v_mfma_f32_32x32x16_bf16 v[212:227], v[204:207], a[56:59], v[212:227]
    v_cvt_pk_bf16_f32 v34, v34, v50
    buffer_store_dword v34, v12, s[8:11], s48 offen offset:2048
    v_mfma_f32_32x32x16_bf16 v[228:243], v[204:207], a[60:63], v[228:243]
    ds_read_b128 v[204:207], v6 offset:6144
    s_waitcnt lgkmcnt(2)
    v_mfma_f32_32x32x16_bf16 v[212:227], v[208:211], a[72:75], v[212:227]
    v_cvt_pk_bf16_f32 v35, v35, v51
    buffer_store_dword v35, v12, s[8:11], s48 offen offset:3072
    v_mfma_f32_32x32x16_bf16 v[228:243], v[208:211], a[76:79], v[228:243]
    ds_read_b128 v[208:211], v6 offset:7168
    s_waitcnt lgkmcnt(2)
    v_mfma_f32_32x32x16_bf16 v[212:227], v[200:203], a[88:91], v[212:227]
    v_cvt_pk_bf16_f32 v36, v36, v52
    buffer_store_dword v36, v12, s[8:11], s36 offen offset:0
    v_mfma_f32_32x32x16_bf16 v[228:243], v[200:203], a[92:95], v[228:243]
    ds_read_b128 v[200:203], v6 offset:8192
    s_waitcnt lgkmcnt(2)
    v_mfma_f32_32x32x16_bf16 v[212:227], v[204:207], a[104:107], v[212:227]
    v_cvt_pk_bf16_f32 v37, v37, v53
    buffer_store_dword v37, v12, s[8:11], s36 offen offset:1024
    v_mfma_f32_32x32x16_bf16 v[228:243], v[204:207], a[108:111], v[228:243]
    v_cvt_pk_bf16_f32 v38, v38, v54
    buffer_store_dword v38, v12, s[8:11], s36 offen offset:2048
    ds_read_b128 v[204:207], v6 offset:9216
    s_waitcnt lgkmcnt(2)
    v_mfma_f32_32x32x16_bf16 v[212:227], v[208:211], a[120:123], v[212:227]
    v_cvt_pk_bf16_f32 v39, v39, v55
    buffer_store_dword v39, v12, s[8:11], s36 offen offset:3072
    v_mfma_f32_32x32x16_bf16 v[228:243], v[208:211], a[124:127], v[228:243]
    ds_read_b128 v[208:211], v6 offset:10240
    s_waitcnt lgkmcnt(2)
    v_mfma_f32_32x32x16_bf16 v[212:227], v[200:203], a[136:139], v[212:227]
    v_cvt_pk_bf16_f32 v40, v40, v56
    buffer_store_dword v40, v12, s[8:11], s37 offen offset:0
    v_mfma_f32_32x32x16_bf16 v[228:243], v[200:203], a[140:143], v[228:243]
    ds_read_b128 v[200:203], v6 offset:11264
    s_waitcnt lgkmcnt(2)
    v_mfma_f32_32x32x16_bf16 v[212:227], v[204:207], a[152:155], v[212:227]
    v_cvt_pk_bf16_f32 v41, v41, v57
    buffer_store_dword v41, v12, s[8:11], s37 offen offset:1024
    v_mfma_f32_32x32x16_bf16 v[228:243], v[204:207], a[156:159], v[228:243]
    ds_read_b128 v[204:207], v6 offset:12288
    s_waitcnt lgkmcnt(2)
    v_mfma_f32_32x32x16_bf16 v[212:227], v[208:211], a[168:171], v[212:227]
    v_cvt_pk_bf16_f32 v42, v42, v58
    buffer_store_dword v42, v12, s[8:11], s37 offen offset:2048
    v_cvt_pk_bf16_f32 v43, v43, v59
    buffer_store_dword v43, v12, s[8:11], s37 offen offset:3072
    v_mfma_f32_32x32x16_bf16 v[228:243], v[208:211], a[172:175], v[228:243]
    ds_read_b128 v[208:211], v6 offset:13312
    s_waitcnt lgkmcnt(2)
    v_mfma_f32_32x32x16_bf16 v[212:227], v[200:203], a[184:187], v[212:227]
    v_mfma_f32_32x32x16_bf16 v[228:243], v[200:203], a[188:191], v[228:243]
    v_cvt_pk_bf16_f32 v44, v44, v60
    buffer_store_dword v44, v12, s[8:11], s38 offen offset:0
    ds_read_b128 v[200:203], v6 offset:14336
    s_waitcnt lgkmcnt(2)
    v_mfma_f32_32x32x16_bf16 v[212:227], v[204:207], a[200:203], v[212:227]
    v_cvt_pk_bf16_f32 v45, v45, v61
    buffer_store_dword v45, v12, s[8:11], s38 offen offset:1024
    v_mfma_f32_32x32x16_bf16 v[228:243], v[204:207], a[204:207], v[228:243]
    ds_read_b128 v[204:207], v6 offset:15360
    s_waitcnt lgkmcnt(2)
    v_mfma_f32_32x32x16_bf16 v[212:227], v[208:211], a[216:219], v[212:227]
    v_cvt_pk_bf16_f32 v46, v46, v62
    buffer_store_dword v46, v12, s[8:11], s38 offen offset:2048
    v_mfma_f32_32x32x16_bf16 v[228:243], v[208:211], a[220:223], v[228:243]
    s_waitcnt lgkmcnt(1)
    v_mfma_f32_32x32x16_bf16 v[212:227], v[200:203], a[232:235], v[212:227]
    v_cvt_pk_bf16_f32 v47, v47, v63
    buffer_store_dword v47, v12, s[8:11], s38 offen offset:3072
    v_mfma_f32_32x32x16_bf16 v[228:243], v[200:203], a[236:239], v[228:243]
    s_waitcnt lgkmcnt(0)
    v_mfma_f32_32x32x16_bf16 v[212:227], v[204:207], a[248:251], v[212:227]
    v_mfma_f32_32x32x16_bf16 v[228:243], v[204:207], a[252:255], v[228:243]
    v_xor_b32 v6, 0x4000, v6
    s_add_u32 s3, s49, s53
    s_nop 9
    v_cvt_pk_bf16_f32 v212, v212, v228
    buffer_store_dword v212, v12, s[8:11], s48 offen offset:128
    v_cvt_pk_bf16_f32 v213, v213, v229
    buffer_store_dword v213, v12, s[8:11], s48 offen offset:1152
    v_cvt_pk_bf16_f32 v214, v214, v230
    buffer_store_dword v214, v12, s[8:11], s48 offen offset:2176
    v_cvt_pk_bf16_f32 v215, v215, v231
    buffer_store_dword v215, v12, s[8:11], s48 offen offset:3200
    v_cvt_pk_bf16_f32 v216, v216, v232
    buffer_store_dword v216, v12, s[8:11], s36 offen offset:128
    v_cvt_pk_bf16_f32 v217, v217, v233
    buffer_store_dword v217, v12, s[8:11], s36 offen offset:1152
    v_cvt_pk_bf16_f32 v218, v218, v234
    buffer_store_dword v218, v12, s[8:11], s36 offen offset:2176
    v_cvt_pk_bf16_f32 v219, v219, v235
    buffer_store_dword v219, v12, s[8:11], s36 offen offset:3200
    v_cvt_pk_bf16_f32 v220, v220, v236
    buffer_store_dword v220, v12, s[8:11], s37 offen offset:128
    v_cvt_pk_bf16_f32 v221, v221, v237
    buffer_store_dword v221, v12, s[8:11], s37 offen offset:1152
    v_cvt_pk_bf16_f32 v222, v222, v238
    buffer_store_dword v222, v12, s[8:11], s37 offen offset:2176
    v_cvt_pk_bf16_f32 v223, v223, v239
    buffer_store_dword v223, v12, s[8:11], s37 offen offset:3200
    v_cvt_pk_bf16_f32 v224, v224, v240
    buffer_store_dword v224, v12, s[8:11], s38 offen offset:128
    v_cvt_pk_bf16_f32 v225, v225, v241
    buffer_store_dword v225, v12, s[8:11], s38 offen offset:1152
    v_cvt_pk_bf16_f32 v226, v226, v242
    buffer_store_dword v226, v12, s[8:11], s38 offen offset:2176
    v_cvt_pk_bf16_f32 v227, v227, v243
    buffer_store_dword v227, v12, s[8:11], s38 offen offset:3200
    s_waitcnt vmcnt(0)
    buffer_store_dword v3, off, s[8:11], s3
    v_lshlrev_b32 v40, 16, v128
    v_and_b32 v41, 0xffff0000, v128
    v_lshlrev_b32 v68, 16, v132
    v_and_b32 v69, 0xffff0000, v132
    v_lshlrev_b32 v42, 16, v129
    v_and_b32 v43, 0xffff0000, v129
    v_lshlrev_b32 v70, 16, v133
    v_and_b32 v71, 0xffff0000, v133
    v_lshlrev_b32 v44, 16, v130
    v_and_b32 v45, 0xffff0000, v130
    v_lshlrev_b32 v72, 16, v134
    v_and_b32 v73, 0xffff0000, v134
    v_lshlrev_b32 v46, 16, v131
    v_and_b32 v47, 0xffff0000, v131
    v_lshlrev_b32 v74, 16, v135
    v_and_b32 v75, 0xffff0000, v135
Lw_54:
    buffer_load_dword v4, v5, s[8:11], s49 offen offset:0 sc1
    s_waitcnt vmcnt(0)
    v_cmp_eq_u32 vcc, 0, v4
    s_cbranch_vccz Lwd_55
    s_sub_u32 s98, s98, 1
    s_cbranch_scc1 L_end
    s_branch Lw_54
Lwd_55:
    s_mov_b32 s3, s48
    buffer_load_dwordx4 v[136:139], v13, s[8:11], s3 offen offset:0 sc1
    buffer_load_dwordx4 v[140:143], v13, s[8:11], s3 offen offset:128 sc1
    s_add_u32 s3, s3, 65536
    buffer_load_dwordx4 v[144:147], v13, s[8:11], s3 offen offset:0 sc1
    buffer_load_dwordx4 v[148:151], v13, s[8:11], s3 offen offset:128 sc1
    s_add_u32 s3, s3, 65536
    buffer_load_dwordx4 v[152:155], v13, s[8:11], s3 offen offset:0 sc1
    buffer_load_dwordx4 v[156:159], v13, s[8:11], s3 offen offset:128 sc1
    s_add_u32 s3, s3, 65536
    buffer_load_dwordx4 v[160:163], v13, s[8:11], s3 offen offset:0 sc1
    buffer_load_dwordx4 v[164:167], v13, s[8:11], s3 offen offset:128 sc1
    s_add_u32 s3, s3, 65536
    buffer_load_dwordx4 v[168:171], v13, s[8:11], s3 offen offset:0 sc1
    buffer_load_dwordx4 v[172:175], v13, s[8:11], s3 offen offset:128 sc1
    s_add_u32 s3, s3, 65536
    buffer_load_dwordx4 v[176:179], v13, s[8:11], s3 offen offset:0 sc1
    buffer_load_dwordx4 v[180:183], v13, s[8:11], s3 offen offset:128 sc1
    s_add_u32 s3, s3, 65536
    buffer_load_dwordx4 v[184:187], v13, s[8:11], s3 offen offset:0 sc1
    buffer_load_dwordx4 v[188:191], v13, s[8:11], s3 offen offset:128 sc1
    s_add_u32 s3, s3, 65536
    buffer_load_dwordx4 v[192:195], v13, s[8:11], s3 offen offset:0 sc1
    buffer_load_dwordx4 v[196:199], v13, s[8:11], s3 offen offset:128 sc1
    s_add_u32 s3, s3, 65536
    s_barrier
    s_waitcnt vmcnt(14)
    v_mfma_f32_16x16x32_bf16 v[32:35], v[8:11], v[136:139], 0
    v_mfma_f32_16x16x32_bf16 v[36:39], v[8:11], v[140:143], 0
    s_waitcnt vmcnt(12)
    v_mfma_f32_16x16x32_bf16 v[32:35], v[8:11], v[144:147], v[32:35]
    v_mfma_f32_16x16x32_bf16 v[36:39], v[8:11], v[148:151], v[36:39]
    s_waitcnt vmcnt(10)
    v_mfma_f32_16x16x32_bf16 v[32:35], v[8:11], v[152:155], v[32:35]
    v_mfma_f32_16x16x32_bf16 v[36:39], v[8:11], v[156:159], v[36:39]
    s_waitcnt vmcnt(8)
    v_mfma_f32_16x16x32_bf16 v[32:35], v[8:11], v[160:163], v[32:35]
    v_mfma_f32_16x16x32_bf16 v[36:39], v[8:11], v[164:167], v[36:39]
    s_waitcnt vmcnt(6)
    v_mfma_f32_16x16x32_bf16 v[32:35], v[8:11], v[168:171], v[32:35]
    v_mfma_f32_16x16x32_bf16 v[36:39], v[8:11], v[172:175], v[36:39]
    s_waitcnt vmcnt(4)
    v_mfma_f32_16x16x32_bf16 v[32:35], v[8:11], v[176:179], v[32:35]
    v_mfma_f32_16x16x32_bf16 v[36:39], v[8:11], v[180:183], v[36:39]
    s_waitcnt vmcnt(2)
    v_mfma_f32_16x16x32_bf16 v[32:35], v[8:11], v[184:187], v[32:35]
    v_mfma_f32_16x16x32_bf16 v[36:39], v[8:11], v[188:191], v[36:39]
    s_waitcnt vmcnt(0)
    v_mfma_f32_16x16x32_bf16 v[32:35], v[8:11], v[192:195], v[32:35]
    v_mfma_f32_16x16x32_bf16 v[36:39], v[8:11], v[196:199], v[36:39]
    s_nop 6
    v_cvt_pk_bf16_f32 v56, v32, v33
    v_cvt_pk_bf16_f32 v57, v36, v37
    v_cvt_pk_bf16_f32 v58, v34, v35
    v_cvt_pk_bf16_f32 v59, v38, v39
    v_lshlrev_b32 v32, 16, v56
    v_and_b32 v33, 0xffff0000, v56
    v_lshlrev_b32 v34, 16, v57
    v_and_b32 v35, 0xffff0000, v57
    v_lshlrev_b32 v36, 16, v58
    v_and_b32 v37, 0xffff0000, v58
    v_lshlrev_b32 v38, 16, v59
    v_and_b32 v39, 0xffff0000, v59
    v_pk_add_f32 v[40:41], v[40:41], v[32:33]
    v_pk_add_f32 v[42:43], v[42:43], v[34:35]
    v_pk_add_f32 v[44:45], v[44:45], v[36:37]
    v_pk_add_f32 v[46:47], v[46:47], v[38:39]
    v_cvt_pk_bf16_f32 v60, v40, v41
    v_cvt_pk_bf16_f32 v61, v42, v43
    v_cvt_pk_bf16_f32 v62, v44, v45
    v_cvt_pk_bf16_f32 v63, v46, v47
    s_cmp_lg_u32 s7, 0
    s_cbranch_scc1 Lao_56
    v_lshlrev_b32 v40, 16, v60
    v_and_b32 v41, 0xffff0000, v60
    v_lshlrev_b32 v42, 16, v61
    v_and_b32 v43, 0xffff0000, v61
    v_lshlrev_b32 v44, 16, v62
    v_and_b32 v45, 0xffff0000, v62
    v_lshlrev_b32 v46, 16, v63
    v_and_b32 v47, 0xffff0000, v63
    s_add_u32 s3, s50, 11534336
    s_add_u32 s40, s50, 7340032
    v_pk_add_f32 v[56:57], v[40:41], v[42:43]
    v_pk_add_f32 v[58:59], v[44:45], v[46:47]
    v_pk_add_f32 v[56:57], v[56:57], v[58:59]
    v_add_f32 v56, v56, v57
    s_nop 1
    v_add_f32_dpp v56, v56, v56 quad_perm:[1,0,3,2] row_mask:0xf bank_mask:0xf
    s_nop 1
    v_add_f32_dpp v56, v56, v56 quad_perm:[2,3,0,1] row_mask:0xf bank_mask:0xf
    s_nop 1
    v_add_f32_dpp v56, v56, v56 row_half_mirror row_mask:0xf bank_mask:0xf
    s_nop 1
    v_add_f32_dpp v56, v56, v56 row_mirror row_mask:0xf bank_mask:0xf
    v_mov_b32 v57, v56
    s_nop 1
    v_permlane16_swap_b32 v57, v56
    v_add_f32 v56, v56, v57
    v_mov_b32 v57, v56
    s_nop 1
    v_permlane32_swap_b32 v57, v56
    v_add_f32 v56, v56, v57
    v_mul_f32 v56, 0x3b000000, v56
    v_pk_add_f32 v[48:49], v[40:41], v[56:57] op_sel_hi:[1,0] neg_lo:[0,1] neg_hi:[0,1]
    v_pk_add_f32 v[50:51], v[42:43], v[56:57] op_sel_hi:[1,0] neg_lo:[0,1] neg_hi:[0,1]
    v_pk_add_f32 v[52:53], v[44:45], v[56:57] op_sel_hi:[1,0] neg_lo:[0,1] neg_hi:[0,1]
    v_pk_add_f32 v[54:55], v[46:47], v[56:57] op_sel_hi:[1,0] neg_lo:[0,1] neg_hi:[0,1]
    v_pk_mul_f32 v[58:59], v[48:49], v[48:49]
    v_pk_fma_f32 v[58:59], v[50:51], v[50:51], v[58:59]
    v_pk_fma_f32 v[58:59], v[52:53], v[52:53], v[58:59]
    v_pk_fma_f32 v[58:59], v[54:55], v[54:55], v[58:59]
    v_add_f32 v58, v58, v59
    v_cvt_pk_bf16_f32 v56, v56, v56
    v_and_b32 v56, 0xffff0000, v56
    v_pk_add_f32 v[48:49], v[40:41], v[56:57] op_sel_hi:[1,0] neg_lo:[0,1] neg_hi:[0,1]
    v_add_f32_dpp v58, v58, v58 quad_perm:[1,0,3,2] row_mask:0xf bank_mask:0xf
    v_pk_add_f32 v[50:51], v[42:43], v[56:57] op_sel_hi:[1,0] neg_lo:[0,1] neg_hi:[0,1]
    v_pk_add_f32 v[52:53], v[44:45], v[56:57] op_sel_hi:[1,0] neg_lo:[0,1] neg_hi:[0,1]
    v_pk_add_f32 v[54:55], v[46:47], v[56:57] op_sel_hi:[1,0] neg_lo:[0,1] neg_hi:[0,1]
    v_add_f32_dpp v58, v58, v58 quad_perm:[2,3,0,1] row_mask:0xf bank_mask:0xf
    v_cvt_pk_bf16_f32 v49, v48, v49
    v_lshlrev_b32 v48, 16, v49
    v_and_b32 v49, 0xffff0000, v49
    v_add_f32_dpp v58, v58, v58 row_half_mirror row_mask:0xf bank_mask:0xf
    v_cvt_pk_bf16_f32 v51, v50, v51
    v_lshlrev_b32 v50, 16, v51
    v_and_b32 v51, 0xffff0000, v51
    v_add_f32_dpp v58, v58, v58 row_mirror row_mask:0xf bank_mask:0xf
    v_mov_b32 v59, v58
    v_cvt_pk_bf16_f32 v53, v52, v53
    v_lshlrev_b32 v52, 16, v53
    v_and_b32 v53, 0xffff0000, v53
    v_permlane16_swap_b32 v59, v58
    v_add_f32 v58, v58, v59
    v_mov_b32 v59, v58
    v_cvt_pk_bf16_f32 v55, v54, v55
    v_lshlrev_b32 v54, 16, v55
    v_and_b32 v55, 0xffff0000, v55
    v_permlane32_swap_b32 v59, v58
    v_add_f32 v58, v58, v59
    v_mul_f32 v58, 0x3b000000, v58
    v_cvt_pk_bf16_f32 v58, v58, v58
    v_and_b32 v58, 0xffff0000, v58
    v_add_f32 v58, 0x3727c5ac, v58
    v_cvt_pk_bf16_f32 v58, v58, v58
    v_and_b32 v58, 0xffff0000, v58
    v_sqrt_f32 v58, v58
    s_nop 0
    v_cvt_pk_bf16_f32 v58, v58, v58
    v_and_b32 v58, 0xffff0000, v58
    v_rcp_f32 v58, v58
    s_nop 0
    v_pk_mul_f32 v[48:49], v[48:49], v[58:59] op_sel_hi:[1,0]
    v_pk_mul_f32 v[50:51], v[50:51], v[58:59] op_sel_hi:[1,0]
    v_pk_mul_f32 v[52:53], v[52:53], v[58:59] op_sel_hi:[1,0]
    v_pk_mul_f32 v[54:55], v[54:55], v[58:59] op_sel_hi:[1,0]
    v_pk_fma_f32 v[40:41], v[48:49], v[68:69], v[40:41]
    v_pk_fma_f32 v[42:43], v[50:51], v[70:71], v[42:43]
    v_pk_fma_f32 v[44:45], v[52:53], v[72:73], v[44:45]
    v_pk_fma_f32 v[46:47], v[54:55], v[74:75], v[46:47]
    v_cvt_pk_bf16_f32 v60, v40, v41
    v_cvt_pk_bf16_f32 v61, v42, v43
    v_cvt_pk_bf16_f32 v62, v44, v45
    v_cvt_pk_bf16_f32 v63, v46, v47
    v_lshlrev_b32 v40, 16, v60
    v_and_b32 v41, 0xffff0000, v60
    v_lshlrev_b32 v42, 16, v61
    v_and_b32 v43, 0xffff0000, v61
    v_lshlrev_b32 v44, 16, v62
    v_and_b32 v45, 0xffff0000, v62
    v_lshlrev_b32 v46, 16, v63
    v_and_b32 v47, 0xffff0000, v63
    buffer_store_dwordx4 v[60:63], v244, s[8:11], s40 offen sc1
    v_pk_add_f32 v[56:57], v[40:41], v[42:43]
    v_pk_add_f32 v[58:59], v[44:45], v[46:47]
    v_pk_add_f32 v[56:57], v[56:57], v[58:59]
    v_add_f32 v56, v56, v57
    s_nop 1
    v_add_f32_dpp v56, v56, v56 quad_perm:[1,0,3,2] row_mask:0xf bank_mask:0xf
    s_nop 1
    v_add_f32_dpp v56, v56, v56 quad_perm:[2,3,0,1] row_mask:0xf bank_mask:0xf
    s_nop 1
    v_add_f32_dpp v56, v56, v56 row_half_mirror row_mask:0xf bank_mask:0xf
    s_nop 1
    v_add_f32_dpp v56, v56, v56 row_mirror row_mask:0xf bank_mask:0xf
    v_mov_b32 v57, v56
    s_nop 1
    v_permlane16_swap_b32 v57, v56
    v_add_f32 v56, v56, v57
    v_mov_b32 v57, v56
    s_nop 1
    v_permlane32_swap_b32 v57, v56
    v_add_f32 v56, v56, v57
    v_mul_f32 v56, 0x3b000000, v56
    v_pk_add_f32 v[48:49], v[40:41], v[56:57] op_sel_hi:[1,0] neg_lo:[0,1] neg_hi:[0,1]
    v_pk_add_f32 v[50:51], v[42:43], v[56:57] op_sel_hi:[1,0] neg_lo:[0,1] neg_hi:[0,1]
    v_pk_add_f32 v[52:53], v[44:45], v[56:57] op_sel_hi:[1,0] neg_lo:[0,1] neg_hi:[0,1]
    v_pk_add_f32 v[54:55], v[46:47], v[56:57] op_sel_hi:[1,0] neg_lo:[0,1] neg_hi:[0,1]
    v_pk_mul_f32 v[58:59], v[48:49], v[48:49]
    v_pk_fma_f32 v[58:59], v[50:51], v[50:51], v[58:59]
    v_pk_fma_f32 v[58:59], v[52:53], v[52:53], v[58:59]
    v_pk_fma_f32 v[58:59], v[54:55], v[54:55], v[58:59]
    v_add_f32 v58, v58, v59
    v_cvt_pk_bf16_f32 v56, v56, v56
    v_and_b32 v56, 0xffff0000, v56
    v_pk_add_f32 v[48:49], v[40:41], v[56:57] op_sel_hi:[1,0] neg_lo:[0,1] neg_hi:[0,1]
    v_add_f32_dpp v58, v58, v58 quad_perm:[1,0,3,2] row_mask:0xf bank_mask:0xf
    v_pk_add_f32 v[50:51], v[42:43], v[56:57] op_sel_hi:[1,0] neg_lo:[0,1] neg_hi:[0,1]
    v_pk_add_f32 v[52:53], v[44:45], v[56:57] op_sel_hi:[1,0] neg_lo:[0,1] neg_hi:[0,1]
    v_pk_add_f32 v[54:55], v[46:47], v[56:57] op_sel_hi:[1,0] neg_lo:[0,1] neg_hi:[0,1]
    v_add_f32_dpp v58, v58, v58 quad_perm:[2,3,0,1] row_mask:0xf bank_mask:0xf
    v_cvt_pk_bf16_f32 v49, v48, v49
    v_lshlrev_b32 v48, 16, v49
    v_and_b32 v49, 0xffff0000, v49
    v_add_f32_dpp v58, v58, v58 row_half_mirror row_mask:0xf bank_mask:0xf
    v_cvt_pk_bf16_f32 v51, v50, v51
    v_lshlrev_b32 v50, 16, v51
    v_and_b32 v51, 0xffff0000, v51
    v_add_f32_dpp v58, v58, v58 row_mirror row_mask:0xf bank_mask:0xf
    v_mov_b32 v59, v58
    v_cvt_pk_bf16_f32 v53, v52, v53
    v_lshlrev_b32 v52, 16, v53
    v_and_b32 v53, 0xffff0000, v53
    v_permlane16_swap_b32 v59, v58
    v_add_f32 v58, v58, v59
    v_mov_b32 v59, v58
    v_cvt_pk_bf16_f32 v55, v54, v55
    v_lshlrev_b32 v54, 16, v55
    v_and_b32 v55, 0xffff0000, v55
    v_permlane32_swap_b32 v59, v58
    v_add_f32 v58, v58, v59
    v_mul_f32 v58, 0x3b000000, v58
    v_cvt_pk_bf16_f32 v58, v58, v58
    v_and_b32 v58, 0xffff0000, v58
    v_add_f32 v58, 0x3727c5ac, v58
    v_cvt_pk_bf16_f32 v58, v58, v58
    v_and_b32 v58, 0xffff0000, v58
    v_sqrt_f32 v58, v58
    s_nop 0
    v_cvt_pk_bf16_f32 v58, v58, v58
    v_and_b32 v58, 0xffff0000, v58
    v_rcp_f32 v58, v58
    s_nop 0
    v_pk_mul_f32 v[48:49], v[48:49], v[58:59] op_sel_hi:[1,0]
    v_pk_mul_f32 v[50:51], v[50:51], v[58:59] op_sel_hi:[1,0]
    v_pk_mul_f32 v[52:53], v[52:53], v[58:59] op_sel_hi:[1,0]
    v_pk_mul_f32 v[54:55], v[54:55], v[58:59] op_sel_hi:[1,0]
    v_cvt_pk_bf16_f32 v64, v48, v49
    v_cvt_pk_bf16_f32 v65, v50, v51
    v_cvt_pk_bf16_f32 v66, v52, v53
    v_cvt_pk_bf16_f32 v67, v54, v55
    buffer_store_dwordx4 v[64:67], v15, s[8:11], s3 offen sc1
    s_waitcnt vmcnt(0)
    s_branch L_ao_pure_dn
Lao_56:
    buffer_store_dwordx4 v[60:63], v244, s[12:15], s50 offen
    s_cmp_ge_u32 s44, 61
    s_cbranch_scc1 L_ao_pure_nx
L_ao_pure_dn:
    s_lshr_b32 s3, s50, 8
    s_add_u32 s3, s3, s34
    buffer_store_dword v3, off, s[8:11], s3
    s_lshl_b32 s40, s44, 7
    s_add_u32 s41, s40, s34
    v_and_b32 v253, 0x7c, v5
Lw_57:
    buffer_load_dword v4, v253, s[8:11], s41 offen offset:0 sc1
    s_waitcnt vmcnt(0)
    v_cmp_eq_u32 vcc, 0, v4
    s_cbranch_vccz Lwd_58
    s_sub_u32 s98, s98, 1
    s_cbranch_scc1 L_end
    s_branch Lw_57
Lwd_58:
    s_add_u32 s40, s40, s35
    buffer_store_dword v3, v253, s[8:11], s40 offen sc1
L_ao_pure_nx:
    s_add_u32 s44, s44, 3
    s_add_u32 s49, s49, 768
    s_add_u32 s50, s50, 98304
    s_cmp_lt_u32 s44, 64
    s_cbranch_scc1 L_ao_pure
    s_endpgm
L_ao_mixed:
    s_cmp_ge_u32 s6, 2
    s_cbranch_scc1 L_ao_mixed_bar
    s_and_b32 s3, s52, s39
    s_cbranch_scc1 L_ao_mixed_have
    s_cmp_lt_u32 s44, 3
    s_cbranch_scc1 L_ao_mixed_nob
    s_barrier
L_ao_mixed_nob:
    s_cmp_lg_u32 s52, 0
    s_cbranch_scc1 L_ao_mixed_have
    v_and_b32 v253, 4, v5
Lw_59:
    buffer_load_dword v4, v253, s[8:11], s45 offen offset:0 sc1
    s_waitcnt vmcnt(0)
    v_cmp_eq_u32 vcc, 0, v4
    s_cbranch_vccz Lwd_60
    s_sleep 1
    s_sub_u32 s98, s98, 1
    s_cbranch_scc1 L_end
    s_branch Lw_59
Lwd_60:
    s_add_u32 s3, s46, 0
    s_add_u32 s40, s46, 4096
    buffer_load_dwordx4 v[96:99], v1, s[8:11], s3 offen offset:0 sc1
    buffer_load_dwordx4 v[100:103], v1, s[8:11], s3 offen offset:1024 sc1
    buffer_load_dwordx4 v[104:107], v1, s[8:11], s3 offen offset:2048 sc1
    buffer_load_dwordx4 v[108:111], v1, s[8:11], s3 offen offset:3072 sc1
    buffer_load_dwordx4 v[112:115], v1, s[8:11], s40 offen offset:0 sc1
    buffer_load_dwordx4 v[116:119], v1, s[8:11], s40 offen offset:1024 sc1
    buffer_load_dwordx4 v[120:123], v1, s[8:11], s40 offen offset:2048 sc1
    buffer_load_dwordx4 v[124:127], v1, s[8:11], s40 offen offset:3072 sc1
    s_add_u32 s3, s46, 16384
    s_add_u32 s40, s46, 20480
    buffer_load_dwordx4 v[64:67], v1, s[8:11], s3 offen offset:0 sc1 nt
    buffer_load_dwordx4 v[68:71], v1, s[8:11], s3 offen offset:1024 sc1 nt
    buffer_load_dwordx4 v[72:75], v1, s[8:11], s3 offen offset:2048 sc1 nt
    buffer_load_dwordx4 v[76:79], v1, s[8:11], s3 offen offset:3072 sc1 nt
    buffer_load_dwordx4 v[80:83], v1, s[8:11], s40 offen offset:0 sc1 nt
    buffer_load_dwordx4 v[84:87], v1, s[8:11], s40 offen offset:1024 sc1 nt
    buffer_load_dwordx4 v[88:91], v1, s[8:11], s40 offen offset:2048 sc1 nt
    buffer_load_dwordx4 v[92:95], v1, s[8:11], s40 offen offset:3072 sc1 nt
    s_add_u32 s3, s46, 8192
    s_add_u32 s40, s46, 12288
    buffer_load_dwordx4 v[128:131], v1, s[8:11], s3 offen offset:0 sc1
    buffer_load_dwordx4 v[132:135], v1, s[8:11], s3 offen offset:1024 sc1
    buffer_load_dwordx4 v[136:139], v1, s[8:11], s3 offen offset:2048 sc1
    buffer_load_dwordx4 v[140:143], v1, s[8:11], s3 offen offset:3072 sc1
    buffer_load_dwordx4 v[144:147], v1, s[8:11], s40 offen offset:0 sc1
    buffer_load_dwordx4 v[148:151], v1, s[8:11], s40 offen offset:1024 sc1
    buffer_load_dwordx4 v[152:155], v1, s[8:11], s40 offen offset:2048 sc1
    buffer_load_dwordx4 v[156:159], v1, s[8:11], s40 offen offset:3072 sc1
    s_waitcnt vmcnt(8)
L_ao_mixed_have:
    v_mfma_f32_32x32x16_bf16 v[32:47], v[96:99], v[64:67], v[16:31]
    v_mfma_f32_32x32x16_bf16 v[32:47], v[100:103], v[68:71], v[32:47]
    v_mfma_f32_32x32x16_bf16 v[32:47], v[104:107], v[72:75], v[32:47]
    v_mfma_f32_32x32x16_bf16 v[32:47], v[108:111], v[76:79], v[32:47]
    v_mfma_f32_32x32x16_bf16 v[32:47], v[112:115], v[80:83], v[32:47]
    v_mfma_f32_32x32x16_bf16 v[32:47], v[116:119], v[84:87], v[32:47]
    v_mfma_f32_32x32x16_bf16 v[32:47], v[120:123], v[88:91], v[32:47]
    v_mfma_f32_32x32x16_bf16 v[32:47], v[124:127], v[92:95], v[32:47]
    s_and_b32 s33, s52, s39
    s_cbranch_scc1 L_ao_mixed_km
    v_mov_b32 v253, 0
Lw_61:
    buffer_load_dword v4, v253, s[8:11], s45 offen offset:32 sc1
    s_waitcnt vmcnt(0)
    v_cmp_eq_u32 vcc, 0, v4
    s_cbranch_vccz Lwd_62
    s_sleep 1
    s_sub_u32 s98, s98, 1
    s_cbranch_scc1 L_end
    s_branch Lw_61
Lwd_62:
    s_sleep 3
L_ao_mixed_kw:
    buffer_load_dword v244, v2, s[8:11], s47 offen sc1
    s_waitcnt vmcnt(0)
    v_cmp_eq_u32 vcc, s54, v244
    s_cbranch_vccz L_ao_mixed_kl
    s_sleep 1
    s_sub_u32 s98, s98, 1
    s_cbranch_scc1 L_end
    s_branch L_ao_mixed_kw
L_ao_mixed_kl:
    buffer_load_dwordx4 v[160:163], v7, s[8:11], s47 offen offset:0 sc1
    buffer_load_dwordx4 v[164:167], v7, s[8:11], s47 offen offset:256 sc1
    buffer_load_dwordx4 v[168:171], v7, s[8:11], s47 offen offset:512 sc1
    buffer_load_dwordx4 v[172:175], v7, s[8:11], s47 offen offset:768 sc1
    buffer_load_dwordx4 v[176:179], v7, s[8:11], s47 offen offset:1024 sc1
    buffer_load_dwordx4 v[180:183], v7, s[8:11], s47 offen offset:1280 sc1
    buffer_load_dwordx4 v[184:187], v7, s[8:11], s47 offen offset:1536 sc1
    buffer_load_dwordx4 v[188:191], v7, s[8:11], s47 offen offset:1792 sc1
    buffer_load_dword v192, v14, s[8:11], s47 offen offset:2048 sc1
    buffer_load_dword v193, v14, s[8:11], s47 offen offset:2176 sc1
    buffer_load_dword v194, v14, s[8:11], s47 offen offset:2560 sc1
    buffer_load_dword v195, v14, s[8:11], s47 offen offset:2688 sc1
    buffer_load_dword v196, v14, s[8:11], s47 offen offset:3072 sc1
    buffer_load_dword v197, v14, s[8:11], s47 offen offset:3200 sc1
    buffer_load_dword v198, v14, s[8:11], s47 offen offset:3584 sc1
    buffer_load_dword v199, v14, s[8:11], s47 offen offset:3712 sc1
    buffer_load_dword v4, v0, s[8:11], s45 offen sc1
L_ao_mixed_km:
    s_add_u32 s46, s46, 86016
    s_nop 8
    v_max3_f32 v252, v32, v33, v34
    v_max3_f32 v253, v35, v36, v37
    v_max3_f32 v252, v252, v38, v39
    v_max3_f32 v253, v253, v40, v41
    v_max3_f32 v252, v252, v42, v43
    v_max3_f32 v253, v253, v44, v45
    v_max3_f32 v252, v252, v46, v47
    s_waitcnt vmcnt(16)
    v_mfma_f32_32x32x16_bf16 v[48:63], v[160:163], v[64:67], 0
    s_waitcnt vmcnt(15)
    v_mfma_f32_32x32x16_bf16 v[48:63], v[164:167], v[68:71], v[48:63]
    s_waitcnt vmcnt(14)
    v_mfma_f32_32x32x16_bf16 v[48:63], v[168:171], v[72:75], v[48:63]
    s_waitcnt vmcnt(13)
    v_mfma_f32_32x32x16_bf16 v[48:63], v[172:175], v[76:79], v[48:63]
    s_waitcnt vmcnt(12)
    v_mfma_f32_32x32x16_bf16 v[48:63], v[176:179], v[80:83], v[48:63]
    s_waitcnt vmcnt(11)
    v_mfma_f32_32x32x16_bf16 v[48:63], v[180:183], v[84:87], v[48:63]
    s_waitcnt vmcnt(10)
    v_mfma_f32_32x32x16_bf16 v[48:63], v[184:187], v[88:91], v[48:63]
    s_waitcnt vmcnt(9)
    v_mfma_f32_32x32x16_bf16 v[48:63], v[188:191], v[92:95], v[48:63]
    s_add_u32 s45, s45, 12288
    s_add_u32 s47, s47, 86016
    s_nop 9
    v_max3_f32 v253, v253, v48, v49
    v_max3_f32 v252, v252, v50, v51
    v_max_f32 v252, v252, v253
    v_mov_b32 v253, v252
    s_nop 1
    v_permlane32_swap_b32 v253, v252
    v_max_f32 v252, v252, v253
    v_pk_add_f32 v[32:33], v[32:33], v[252:253] op_sel_hi:[1,0] neg_lo:[0,1] neg_hi:[0,1]
    v_pk_add_f32 v[34:35], v[34:35], v[252:253] op_sel_hi:[1,0] neg_lo:[0,1] neg_hi:[0,1]
    v_pk_add_f32 v[36:37], v[36:37], v[252:253] op_sel_hi:[1,0] neg_lo:[0,1] neg_hi:[0,1]
    v_pk_add_f32 v[38:39], v[38:39], v[252:253] op_sel_hi:[1,0] neg_lo:[0,1] neg_hi:[0,1]
    v_pk_add_f32 v[40:41], v[40:41], v[252:253] op_sel_hi:[1,0] neg_lo:[0,1] neg_hi:[0,1]
    v_pk_add_f32 v[42:43], v[42:43], v[252:253] op_sel_hi:[1,0] neg_lo:[0,1] neg_hi:[0,1]
    v_pk_add_f32 v[44:45], v[44:45], v[252:253] op_sel_hi:[1,0] neg_lo:[0,1] neg_hi:[0,1]
    v_pk_add_f32 v[46:47], v[46:47], v[252:253] op_sel_hi:[1,0] neg_lo:[0,1] neg_hi:[0,1]
    v_pk_add_f32 v[48:49], v[48:49], v[252:253] op_sel_hi:[1,0] neg_lo:[0,1] neg_hi:[0,1]
    v_pk_add_f32 v[50:51], v[50:51], v[252:253] op_sel_hi:[1,0] neg_lo:[0,1] neg_hi:[0,1]
    v_exp_f32 v32, v32
    v_exp_f32 v33, v33
    v_exp_f32 v34, v34
    v_exp_f32 v35, v35
    v_exp_f32 v36, v36
    v_exp_f32 v37, v37
    v_exp_f32 v38, v38
    v_exp_f32 v39, v39
    v_exp_f32 v40, v40
    v_exp_f32 v41, v41
    v_exp_f32 v42, v42
    v_exp_f32 v43, v43
    v_exp_f32 v44, v44
    v_exp_f32 v45, v45
    v_exp_f32 v46, v46
    v_exp_f32 v47, v47
    v_exp_f32 v48, v48
    v_exp_f32 v49, v49
    v_exp_f32 v50, v50
    v_exp_f32 v51, v51
    v_pk_add_f32 v[254:255], v[32:33], v[34:35]
    v_pk_add_f32 v[252:253], v[36:37], v[38:39]
    v_pk_add_f32 v[254:255], v[254:255], v[40:41]
    v_pk_add_f32 v[252:253], v[252:253], v[42:43]
    v_pk_add_f32 v[254:255], v[254:255], v[44:45]
    v_pk_add_f32 v[252:253], v[252:253], v[46:47]
    v_pk_add_f32 v[254:255], v[254:255], v[48:49]
    v_pk_add_f32 v[252:253], v[252:253], v[50:51]
    v_pk_add_f32 v[254:255], v[254:255], v[252:253]
    v_add_f32 v254, v254, v255
    v_mov_b32 v253, v254
    s_nop 1
    v_permlane32_swap_b32 v253, v254
    v_add_f32 v254, v254, v253
    v_rcp_f32 v254, v254
    v_add_u32 v253, s59, v6
    v_pk_mul_f32 v[32:33], v[32:33], v[254:255] op_sel_hi:[1,0]
    v_pk_mul_f32 v[34:35], v[34:35], v[254:255] op_sel_hi:[1,0]
    v_pk_mul_f32 v[36:37], v[36:37], v[254:255] op_sel_hi:[1,0]
    v_pk_mul_f32 v[38:39], v[38:39], v[254:255] op_sel_hi:[1,0]
    v_pk_mul_f32 v[40:41], v[40:41], v[254:255] op_sel_hi:[1,0]
    v_pk_mul_f32 v[42:43], v[42:43], v[254:255] op_sel_hi:[1,0]
    v_pk_mul_f32 v[44:45], v[44:45], v[254:255] op_sel_hi:[1,0]
    v_pk_mul_f32 v[46:47], v[46:47], v[254:255] op_sel_hi:[1,0]
    v_pk_mul_f32 v[48:49], v[48:49], v[254:255] op_sel_hi:[1,0]
    v_pk_mul_f32 v[50:51], v[50:51], v[254:255] op_sel_hi:[1,0]
    v_cvt_pk_bf16_f32 v200, v32, v33
    v_cvt_pk_bf16_f32 v201, v34, v35
    v_cvt_pk_bf16_f32 v202, v40, v41
    v_cvt_pk_bf16_f32 v203, v42, v43
    v_cvt_pk_bf16_f32 v204, v36, v37
    v_cvt_pk_bf16_f32 v205, v38, v39
    v_cvt_pk_bf16_f32 v206, v44, v45
    v_cvt_pk_bf16_f32 v207, v46, v47
    v_cvt_pk_bf16_f32 v208, v48, v49
    v_cvt_pk_bf16_f32 v209, v50, v51
    s_waitcnt vmcnt(0)
    s_cmp_eq_u32 s33, 0
    s_cbranch_scc1 Lb_63
    s_barrier
Lb_63:
    v_cmp_eq_u32 vcc, 0, v4
    s_cmp_eq_u32 vcc_lo, 0
    s_cselect_b32 s52, 1, 0
    s_cmp_ge_u32 s44, 61
    s_cselect_b32 s52, 0, s52
    s_cmp_lg_u32 s52, 0
    s_cselect_b32 s64, s46, s63
    s_add_u32 s65, s64, 4096
    v_mfma_f32_32x32x16_bf16 v[212:227], v[128:131], v[200:203], 0
    buffer_load_dwordx4 v[96:99], v1, s[8:11], s64 offen offset:0 sc1
    buffer_load_dwordx4 v[100:103], v1, s[8:11], s64 offen offset:1024 sc1
    v_mfma_f32_32x32x16_bf16 v[212:227], v[132:135], v[204:207], v[212:227]
    buffer_load_dwordx4 v[104:107], v1, s[8:11], s64 offen offset:2048 sc1
    buffer_load_dwordx4 v[108:111], v1, s[8:11], s64 offen offset:3072 sc1
    v_mfma_f32_32x32x8_bf16 v[212:227], v[192:193], v[208:209], v[212:227]
    buffer_load_dwordx4 v[112:115], v1, s[8:11], s65 offen offset:0 sc1
    buffer_load_dwordx4 v[116:119], v1, s[8:11], s65 offen offset:1024 sc1
    v_mfma_f32_32x32x16_bf16 v[228:243], v[136:139], v[200:203], 0
    buffer_load_dwordx4 v[120:123], v1, s[8:11], s65 offen offset:2048 sc1
    v_mfma_f32_32x32x16_bf16 v[228:243], v[140:143], v[204:207], v[228:243]
    s_nop 6
    v_cvt_pk_bf16_f32 v160, v212, v213
    v_cvt_pk_bf16_f32 v161, v214, v215
    v_cvt_pk_bf16_f32 v162, v216, v217
    v_cvt_pk_bf16_f32 v163, v218, v219
    ds_write_b128 v253, v[160:163] offset:0
    v_mfma_f32_32x32x8_bf16 v[228:243], v[194:195], v[208:209], v[228:243]
    v_cvt_pk_bf16_f32 v164, v220, v221
    v_cvt_pk_bf16_f32 v165, v222, v223
    v_cvt_pk_bf16_f32 v166, v224, v225
    v_cvt_pk_bf16_f32 v167, v226, v227
    ds_write_b128 v253, v[164:167] offset:1024
    v_mfma_f32_32x32x16_bf16 v[32:47], v[144:147], v[200:203], 0
    buffer_load_dwordx4 v[124:127], v1, s[8:11], s65 offen offset:3072 sc1
    v_mfma_f32_32x32x16_bf16 v[32:47], v[148:151], v[204:207], v[32:47]
    s_nop 3
    v_cvt_pk_bf16_f32 v168, v228, v229
    v_cvt_pk_bf16_f32 v169, v230, v231
    v_cvt_pk_bf16_f32 v170, v232, v233
    v_cvt_pk_bf16_f32 v171, v234, v235
    ds_write_b128 v253, v[168:171] offset:2048
    v_mfma_f32_32x32x8_bf16 v[32:47], v[196:197], v[208:209], v[32:47]
    v_cvt_pk_bf16_f32 v172, v236, v237
    v_cvt_pk_bf16_f32 v173, v238, v239
    v_cvt_pk_bf16_f32 v174, v240, v241
    v_cvt_pk_bf16_f32 v175, v242, v243
    ds_write_b128 v253, v[172:175] offset:3072
    v_mfma_f32_32x32x16_bf16 v[48:63], v[152:155], v[200:203], 0
    v_mfma_f32_32x32x16_bf16 v[48:63], v[156:159], v[204:207], v[48:63]
    s_nop 4
    v_cvt_pk_bf16_f32 v176, v32, v33
    v_cvt_pk_bf16_f32 v177, v34, v35
    v_cvt_pk_bf16_f32 v178, v36, v37
    v_cvt_pk_bf16_f32 v179, v38, v39
    ds_write_b128 v253, v[176:179] offset:4096
    v_mfma_f32_32x32x8_bf16 v[48:63], v[198:199], v[208:209], v[48:63]
    v_cvt_pk_bf16_f32 v180, v40, v41
    v_cvt_pk_bf16_f32 v181, v42, v43
    v_cvt_pk_bf16_f32 v182, v44, v45
    v_cvt_pk_bf16_f32 v183, v46, v47
    ds_write_b128 v253, v[180:183] offset:5120
    buffer_load_dword v4, v0, s[8:11], s45 offen sc1
    buffer_load_dword v244, v2, s[8:11], s63 offen sc1
    s_add_u32 s66, s64, 8192
    s_add_u32 s67, s64, 12288
    s_add_u32 s68, s64, 16384
    s_add_u32 s69, s64, 20480
    s_nop 0
    v_cvt_pk_bf16_f32 v184, v48, v49
    v_cvt_pk_bf16_f32 v185, v50, v51
    v_cvt_pk_bf16_f32 v186, v52, v53
    v_cvt_pk_bf16_f32 v187, v54, v55
    ds_write_b128 v253, v[184:187] offset:6144
    v_cvt_pk_bf16_f32 v188, v56, v57
    v_cvt_pk_bf16_f32 v189, v58, v59
    v_cvt_pk_bf16_f32 v190, v60, v61
    v_cvt_pk_bf16_f32 v191, v62, v63
    ds_write_b128 v253, v[188:191] offset:7168
    s_waitcnt lgkmcnt(0)
L_ao_mixed_bar:
    s_add_u32 s36, s48, 8192
    s_add_u32 s37, s48, 16384
    s_add_u32 s38, s48, 24576
    s_mov_b32 s39, 0
    s_barrier
    ds_read_b128 v[200:203], v6 offset:0
    ds_read_b128 v[204:207], v6 offset:1024
    s_cmp_ge_u32 s6, 2
    s_cbranch_scc1 L_ao_mixed_red
    ds_read_b128 v[208:211], v6 offset:2048
    s_waitcnt lgkmcnt(2)
    v_mfma_f32_32x32x16_bf16 v[32:47], v[200:203], a[0:3], 0
    buffer_load_dwordx4 v[64:67], v1, s[8:11], s68 offen offset:0 sc1 nt
    v_mfma_f32_32x32x16_bf16 v[48:63], v[200:203], a[4:7], 0
    buffer_load_dwordx4 v[68:71], v1, s[8:11], s68 offen offset:1024 sc1 nt
    ds_read_b128 v[200:203], v6 offset:3072
    s_waitcnt lgkmcnt(2)
    v_mfma_f32_32x32x16_bf16 v[32:47], v[204:207], a[16:19], v[32:47]
    buffer_load_dwordx4 v[72:75], v1, s[8:11], s68 offen offset:2048 sc1 nt
    v_mfma_f32_32x32x16_bf16 v[48:63], v[204:207], a[20:23], v[48:63]
    buffer_load_dwordx4 v[76:79], v1, s[8:11], s68 offen offset:3072 sc1 nt
    ds_read_b128 v[204:207], v6 offset:4096
    s_waitcnt lgkmcnt(2)
    v_mfma_f32_32x32x16_bf16 v[32:47], v[208:211], a[32:35], v[32:47]
    buffer_load_dwordx4 v[80:83], v1, s[8:11], s69 offen offset:0 sc1 nt
    v_mfma_f32_32x32x16_bf16 v[48:63], v[208:211], a[36:39], v[48:63]
    buffer_load_dwordx4 v[84:87], v1, s[8:11], s69 offen offset:1024 sc1 nt
    ds_read_b128 v[208:211], v6 offset:5120
    s_waitcnt lgkmcnt(2)
    v_mfma_f32_32x32x16_bf16 v[32:47], v[200:203], a[48:51], v[32:47]
    buffer_load_dwordx4 v[88:91], v1, s[8:11], s69 offen offset:2048 sc1 nt
    v_mfma_f32_32x32x16_bf16 v[48:63], v[200:203], a[52:55], v[48:63]
    buffer_load_dwordx4 v[92:95], v1, s[8:11], s69 offen offset:3072 sc1 nt
    ds_read_b128 v[200:203], v6 offset:6144
    s_waitcnt lgkmcnt(2)
    v_mfma_f32_32x32x16_bf16 v[32:47], v[204:207], a[64:67], v[32:47]
    buffer_load_dwordx4 v[128:131], v1, s[8:11], s66 offen offset:0 sc1
    v_mfma_f32_32x32x16_bf16 v[48:63], v[204:207], a[68:71], v[48:63]
    buffer_load_dwordx4 v[132:135], v1, s[8:11], s66 offen offset:1024 sc1
    ds_read_b128 v[204:207], v6 offset:7168
    s_waitcnt lgkmcnt(2)
    v_mfma_f32_32x32x16_bf16 v[32:47], v[208:211], a[80:83], v[32:47]
    buffer_load_dwordx4 v[136:139], v1, s[8:11], s66 offen offset:2048 sc1
    v_mfma_f32_32x32x16_bf16 v[48:63], v[208:211], a[84:87], v[48:63]
    buffer_load_dwordx4 v[140:143], v1, s[8:11], s66 offen offset:3072 sc1
    ds_read_b128 v[208:211], v6 offset:8192
    s_waitcnt lgkmcnt(2)
    v_mfma_f32_32x32x16_bf16 v[32:47], v[200:203], a[96:99], v[32:47]
    buffer_load_dwordx4 v[144:147], v1, s[8:11], s67 offen offset:0 sc1
    v_mfma_f32_32x32x16_bf16 v[48:63], v[200:203], a[100:103], v[48:63]
    buffer_load_dwordx4 v[148:151], v1, s[8:11], s67 offen offset:1024 sc1
    ds_read_b128 v[200:203], v6 offset:9216
    s_waitcnt lgkmcnt(2)
    v_mfma_f32_32x32x16_bf16 v[32:47], v[204:207], a[112:115], v[32:47]
    buffer_load_dwordx4 v[152:155], v1, s[8:11], s67 offen offset:2048 sc1
    v_mfma_f32_32x32x16_bf16 v[48:63], v[204:207], a[116:119], v[48:63]
    buffer_load_dwordx4 v[156:159], v1, s[8:11], s67 offen offset:3072 sc1
    ds_read_b128 v[204:207], v6 offset:10240
    s_waitcnt lgkmcnt(2)
    v_mfma_f32_32x32x16_bf16 v[32:47], v[208:211], a[128:131], v[32:47]
    s_waitcnt vmcnt(16)
    v_cmp_eq_u32 vcc, s54, v244
    v_mfma_f32_32x32x16_bf16 v[48:63], v[208:211], a[132:135], v[48:63]
    s_cmp_eq_u64 vcc, 0
    s_cselect_b32 s39, 0, 0
    s_cmp_lg_u32 s39, 0
    s_cselect_b32 s40, s47, s63
    ds_read_b128 v[208:211], v6 offset:11264
    s_waitcnt lgkmcnt(2)
    v_mfma_f32_32x32x16_bf16 v[32:47], v[200:203], a[144:147], v[32:47]
    buffer_load_dwordx4 v[160:163], v7, s[8:11], s40 offen offset:0 sc1
    v_mfma_f32_32x32x16_bf16 v[48:63], v[200:203], a[148:151], v[48:63]
    buffer_load_dwordx4 v[164:167], v7, s[8:11], s40 offen offset:256 sc1
    ds_read_b128 v[200:203], v6 offset:12288
    s_waitcnt lgkmcnt(2)
    v_mfma_f32_32x32x16_bf16 v[32:47], v[204:207], a[160:163], v[32:47]
    buffer_load_dwordx4 v[168:171], v7, s[8:11], s40 offen offset:512 sc1
    v_mfma_f32_32x32x16_bf16 v[48:63], v[204:207], a[164:167], v[48:63]
    buffer_load_dwordx4 v[172:175], v7, s[8:11], s40 offen offset:768 sc1
    ds_read_b128 v[204:207], v6 offset:13312
    s_waitcnt lgkmcnt(2)
    v_mfma_f32_32x32x16_bf16 v[32:47], v[208:211], a[176:179], v[32:47]
    buffer_load_dwordx4 v[176:179], v7, s[8:11], s40 offen offset:1024 sc1
    v_mfma_f32_32x32x16_bf16 v[48:63], v[208:211], a[180:183], v[48:63]
    buffer_load_dwordx4 v[180:183], v7, s[8:11], s40 offen offset:1280 sc1
    ds_read_b128 v[208:211], v6 offset:14336
    s_waitcnt lgkmcnt(2)
    v_mfma_f32_32x32x16_bf16 v[32:47], v[200:203], a[192:195], v[32:47]
    buffer_load_dwordx4 v[184:187], v7, s[8:11], s40 offen offset:1536 sc1
    v_mfma_f32_32x32x16_bf16 v[48:63], v[200:203], a[196:199], v[48:63]
    buffer_load_dwordx4 v[188:191], v7, s[8:11], s40 offen offset:1792 sc1
    ds_read_b128 v[200:203], v6 offset:15360
    s_waitcnt lgkmcnt(2)
    v_mfma_f32_32x32x16_bf16 v[32:47], v[204:207], a[208:211], v[32:47]
    buffer_load_dword v192, v14, s[8:11], s40 offen offset:2048 sc1
    v_mfma_f32_32x32x16_bf16 v[48:63], v[204:207], a[212:215], v[48:63]
    buffer_load_dword v193, v14, s[8:11], s40 offen offset:2176 sc1
    ds_read_b128 v[204:207], v6 offset:0
    s_waitcnt lgkmcnt(2)
    v_mfma_f32_32x32x16_bf16 v[32:47], v[208:211], a[224:227], v[32:47]
    buffer_load_dword v194, v14, s[8:11], s40 offen offset:2560 sc1
    v_mfma_f32_32x32x16_bf16 v[48:63], v[208:211], a[228:231], v[48:63]
    buffer_load_dword v195, v14, s[8:11], s40 offen offset:2688 sc1
    ds_read_b128 v[208:211], v6 offset:1024
    s_waitcnt lgkmcnt(2)
    v_mfma_f32_32x32x16_bf16 v[32:47], v[200:203], a[240:243], v[32:47]
    buffer_load_dword v196, v14, s[8:11], s40 offen offset:3072 sc1
    v_mfma_f32_32x32x16_bf16 v[48:63], v[200:203], a[244:247], v[48:63]
    buffer_load_dword v197, v14, s[8:11], s40 offen offset:3200 sc1
    ds_read_b128 v[200:203], v6 offset:2048
    s_waitcnt lgkmcnt(2)
    v_mfma_f32_32x32x16_bf16 v[212:227], v[204:207], a[8:11], 0
    buffer_load_dword v198, v14, s[8:11], s40 offen offset:3584 sc1
    v_mfma_f32_32x32x16_bf16 v[228:243], v[204:207], a[12:15], 0
    buffer_load_dword v199, v14, s[8:11], s40 offen offset:3712 sc1
    ds_read_b128 v[204:207], v6 offset:3072
    s_waitcnt lgkmcnt(2)
    v_mfma_f32_32x32x16_bf16 v[212:227], v[208:211], a[24:27], v[212:227]
    v_mfma_f32_32x32x16_bf16 v[228:243], v[208:211], a[28:31], v[228:243]
    ds_read_b128 v[208:211], v6 offset:4096
    s_waitcnt lgkmcnt(2)
    v_mfma_f32_32x32x16_bf16 v[212:227], v[200:203], a[40:43], v[212:227]
    v_cvt_pk_bf16_f32 v32, v32, v48
    buffer_store_dword v32, v12, s[8:11], s48 offen offset:0 sc1
    v_mfma_f32_32x32x16_bf16 v[228:243], v[200:203], a[44:47], v[228:243]
    v_cvt_pk_bf16_f32 v33, v33, v49
    buffer_store_dword v33, v12, s[8:11], s48 offen offset:1024 sc1
    ds_read_b128 v[200:203], v6 offset:5120
    s_waitcnt lgkmcnt(2)
    v_mfma_f32_32x32x16_bf16 v[212:227], v[204:207], a[56:59], v[212:227]
    v_cvt_pk_bf16_f32 v34, v34, v50
    buffer_store_dword v34, v12, s[8:11], s48 offen offset:2048 sc1
    v_mfma_f32_32x32x16_bf16 v[228:243], v[204:207], a[60:63], v[228:243]
    ds_read_b128 v[204:207], v6 offset:6144
    s_waitcnt lgkmcnt(2)
    v_mfma_f32_32x32x16_bf16 v[212:227], v[208:211], a[72:75], v[212:227]
    v_cvt_pk_bf16_f32 v35, v35, v51
    buffer_store_dword v35, v12, s[8:11], s48 offen offset:3072 sc1
    v_mfma_f32_32x32x16_bf16 v[228:243], v[208:211], a[76:79], v[228:243]
    ds_read_b128 v[208:211], v6 offset:7168
    s_waitcnt lgkmcnt(2)
    v_mfma_f32_32x32x16_bf16 v[212:227], v[200:203], a[88:91], v[212:227]
    v_cvt_pk_bf16_f32 v36, v36, v52
    buffer_store_dword v36, v12, s[8:11], s36 offen offset:0 sc1
    v_mfma_f32_32x32x16_bf16 v[228:243], v[200:203], a[92:95], v[228:243]
    ds_read_b128 v[200:203], v6 offset:8192
    s_waitcnt lgkmcnt(2)
    v_mfma_f32_32x32x16_bf16 v[212:227], v[204:207], a[104:107], v[212:227]
    v_cvt_pk_bf16_f32 v37, v37, v53
    buffer_store_dword v37, v12, s[8:11], s36 offen offset:1024 sc1
    v_mfma_f32_32x32x16_bf16 v[228:243], v[204:207], a[108:111], v[228:243]
    v_cvt_pk_bf16_f32 v38, v38, v54
    buffer_store_dword v38, v12, s[8:11], s36 offen offset:2048 sc1
    ds_read_b128 v[204:207], v6 offset:9216
    s_waitcnt lgkmcnt(2)
    v_mfma_f32_32x32x16_bf16 v[212:227], v[208:211], a[120:123], v[212:227]
    v_cvt_pk_bf16_f32 v39, v39, v55
    buffer_store_dword v39, v12, s[8:11], s36 offen offset:3072 sc1
    v_mfma_f32_32x32x16_bf16 v[228:243], v[208:211], a[124:127], v[228:243]
    ds_read_b128 v[208:211], v6 offset:10240
    s_waitcnt lgkmcnt(2)
    v_mfma_f32_32x32x16_bf16 v[212:227], v[200:203], a[136:139], v[212:227]
    v_cvt_pk_bf16_f32 v40, v40, v56
    buffer_store_dword v40, v12, s[8:11], s37 offen offset:0 sc1
    v_mfma_f32_32x32x16_bf16 v[228:243], v[200:203], a[140:143], v[228:243]
    ds_read_b128 v[200:203], v6 offset:11264
    s_waitcnt lgkmcnt(2)
    v_mfma_f32_32x32x16_bf16 v[212:227], v[204:207], a[152:155], v[212:227]
    v_cvt_pk_bf16_f32 v41, v41, v57
    buffer_store_dword v41, v12, s[8:11], s37 offen offset:1024 sc1
    v_mfma_f32_32x32x16_bf16 v[228:243], v[204:207], a[156:159], v[228:243]
    ds_read_b128 v[204:207], v6 offset:12288
    s_waitcnt lgkmcnt(2)
    v_mfma_f32_32x32x16_bf16 v[212:227], v[208:211], a[168:171], v[212:227]
    v_cvt_pk_bf16_f32 v42, v42, v58
    buffer_store_dword v42, v12, s[8:11], s37 offen offset:2048 sc1
    v_cvt_pk_bf16_f32 v43, v43, v59
    buffer_store_dword v43, v12, s[8:11], s37 offen offset:3072 sc1
    v_mfma_f32_32x32x16_bf16 v[228:243], v[208:211], a[172:175], v[228:243]
    ds_read_b128 v[208:211], v6 offset:13312
    s_waitcnt lgkmcnt(2)
    v_mfma_f32_32x32x16_bf16 v[212:227], v[200:203], a[184:187], v[212:227]
    v_mfma_f32_32x32x16_bf16 v[228:243], v[200:203], a[188:191], v[228:243]
    v_cvt_pk_bf16_f32 v44, v44, v60
    buffer_store_dword v44, v12, s[8:11], s38 offen offset:0 sc1
    ds_read_b128 v[200:203], v6 offset:14336
    s_waitcnt lgkmcnt(2)
    v_mfma_f32_32x32x16_bf16 v[212:227], v[204:207], a[200:203], v[212:227]
    v_cvt_pk_bf16_f32 v45, v45, v61
    buffer_store_dword v45, v12, s[8:11], s38 offen offset:1024 sc1
    v_mfma_f32_32x32x16_bf16 v[228:243], v[204:207], a[204:207], v[228:243]
    ds_read_b128 v[204:207], v6 offset:15360
    s_waitcnt lgkmcnt(2)
    v_mfma_f32_32x32x16_bf16 v[212:227], v[208:211], a[216:219], v[212:227]
    v_cvt_pk_bf16_f32 v46, v46, v62
    buffer_store_dword v46, v12, s[8:11], s38 offen offset:2048 sc1
    v_mfma_f32_32x32x16_bf16 v[228:243], v[208:211], a[220:223], v[228:243]
    s_waitcnt lgkmcnt(1)
    v_mfma_f32_32x32x16_bf16 v[212:227], v[200:203], a[232:235], v[212:227]
    v_cvt_pk_bf16_f32 v47, v47, v63
    buffer_store_dword v47, v12, s[8:11], s38 offen offset:3072 sc1
    v_mfma_f32_32x32x16_bf16 v[228:243], v[200:203], a[236:239], v[228:243]
    s_waitcnt lgkmcnt(0)
    v_mfma_f32_32x32x16_bf16 v[212:227], v[204:207], a[248:251], v[212:227]
    v_mfma_f32_32x32x16_bf16 v[228:243], v[204:207], a[252:255], v[228:243]
    v_xor_b32 v6, 0x4000, v6
    s_add_u32 s3, s49, s53
    s_nop 9
    v_cvt_pk_bf16_f32 v212, v212, v228
    buffer_store_dword v212, v12, s[8:11], s48 offen offset:128 sc1
    v_cvt_pk_bf16_f32 v213, v213, v229
    buffer_store_dword v213, v12, s[8:11], s48 offen offset:1152 sc1
    v_cvt_pk_bf16_f32 v214, v214, v230
    buffer_store_dword v214, v12, s[8:11], s48 offen offset:2176 sc1
    v_cvt_pk_bf16_f32 v215, v215, v231
    buffer_store_dword v215, v12, s[8:11], s48 offen offset:3200 sc1
    v_cvt_pk_bf16_f32 v216, v216, v232
    buffer_store_dword v216, v12, s[8:11], s36 offen offset:128 sc1
    v_cvt_pk_bf16_f32 v217, v217, v233
    buffer_store_dword v217, v12, s[8:11], s36 offen offset:1152 sc1
    v_cvt_pk_bf16_f32 v218, v218, v234
    buffer_store_dword v218, v12, s[8:11], s36 offen offset:2176 sc1
    v_cvt_pk_bf16_f32 v219, v219, v235
    buffer_store_dword v219, v12, s[8:11], s36 offen offset:3200 sc1
    v_cvt_pk_bf16_f32 v220, v220, v236
    buffer_store_dword v220, v12, s[8:11], s37 offen offset:128 sc1
    v_cvt_pk_bf16_f32 v221, v221, v237
    buffer_store_dword v221, v12, s[8:11], s37 offen offset:1152 sc1
    v_cvt_pk_bf16_f32 v222, v222, v238
    buffer_store_dword v222, v12, s[8:11], s37 offen offset:2176 sc1
    v_cvt_pk_bf16_f32 v223, v223, v239
    buffer_store_dword v223, v12, s[8:11], s37 offen offset:3200 sc1
    v_cvt_pk_bf16_f32 v224, v224, v240
    buffer_store_dword v224, v12, s[8:11], s38 offen offset:128 sc1
    v_cvt_pk_bf16_f32 v225, v225, v241
    buffer_store_dword v225, v12, s[8:11], s38 offen offset:1152 sc1
    v_cvt_pk_bf16_f32 v226, v226, v242
    buffer_store_dword v226, v12, s[8:11], s38 offen offset:2176 sc1
    v_cvt_pk_bf16_f32 v227, v227, v243
    buffer_store_dword v227, v12, s[8:11], s38 offen offset:3200 sc1
    s_waitcnt vmcnt(0)
    buffer_store_dword v3, off, s[8:11], s3 sc1
    s_branch L_ao_mixed_nx
L_ao_mixed_red:
    ds_read_b128 v[208:211], v6 offset:2048
    s_waitcnt lgkmcnt(2)
    v_mfma_f32_32x32x16_bf16 v[32:47], v[200:203], a[0:3], 0
    s_add_u32 s3, s51, s50
    buffer_load_dwordx4 v[128:131], v244, s[8:11], s3 offen sc1
    v_mfma_f32_32x32x16_bf16 v[48:63], v[200:203], a[4:7], 0
    ds_read_b128 v[200:203], v6 offset:3072
    s_waitcnt lgkmcnt(2)
    v_mfma_f32_32x32x16_bf16 v[32:47], v[204:207], a[16:19], v[32:47]
    s_add_u32 s3, s50, 3145728
    buffer_load_dwordx4 v[132:135], v244, s[8:11], s3 offen sc1
    v_mfma_f32_32x32x16_bf16 v[48:63], v[204:207], a[20:23], v[48:63]
    ds_read_b128 v[204:207], v6 offset:4096
    s_waitcnt lgkmcnt(2)
    v_mfma_f32_32x32x16_bf16 v[32:47], v[208:211], a[32:35], v[32:47]
    buffer_load_dword v4, v5, s[8:11], s49 offen sc1
    v_mfma_f32_32x32x16_bf16 v[48:63], v[208:211], a[36:39], v[48:63]
    ds_read_b128 v[208:211], v6 offset:5120
    s_waitcnt lgkmcnt(2)
    v_mfma_f32_32x32x16_bf16 v[32:47], v[200:203], a[48:51], v[32:47]
    s_lshl_b32 s3, s44, 7
    s_add_u32 s3, s3, s34
    buffer_load_dword v4, off, s[8:11], s3 sc1
    v_mfma_f32_32x32x16_bf16 v[48:63], v[200:203], a[52:55], v[48:63]
    ds_read_b128 v[200:203], v6 offset:6144
    s_waitcnt lgkmcnt(2)
    v_mfma_f32_32x32x16_bf16 v[32:47], v[204:207], a[64:67], v[32:47]
    v_mfma_f32_32x32x16_bf16 v[48:63], v[204:207], a[68:71], v[48:63]
    ds_read_b128 v[204:207], v6 offset:7168
    s_waitcnt lgkmcnt(2)
    v_mfma_f32_32x32x16_bf16 v[32:47], v[208:211], a[80:83], v[32:47]
    v_mfma_f32_32x32x16_bf16 v[48:63], v[208:211], a[84:87], v[48:63]
    ds_read_b128 v[208:211], v6 offset:8192
    s_waitcnt lgkmcnt(2)
    v_mfma_f32_32x32x16_bf16 v[32:47], v[200:203], a[96:99], v[32:47]
    v_mfma_f32_32x32x16_bf16 v[48:63], v[200:203], a[100:103], v[48:63]
    ds_read_b128 v[200:203], v6 offset:9216
    s_waitcnt lgkmcnt(2)
    v_mfma_f32_32x32x16_bf16 v[32:47], v[204:207], a[112:115], v[32:47]
    v_mfma_f32_32x32x16_bf16 v[48:63], v[204:207], a[116:119], v[48:63]
    ds_read_b128 v[204:207], v6 offset:10240
    s_waitcnt lgkmcnt(2)
    v_mfma_f32_32x32x16_bf16 v[32:47], v[208:211], a[128:131], v[32:47]
    v_mfma_f32_32x32x16_bf16 v[48:63], v[208:211], a[132:135], v[48:63]
    ds_read_b128 v[208:211], v6 offset:11264
    s_waitcnt lgkmcnt(2)
    v_mfma_f32_32x32x16_bf16 v[32:47], v[200:203], a[144:147], v[32:47]
    v_mfma_f32_32x32x16_bf16 v[48:63], v[200:203], a[148:151], v[48:63]
    ds_read_b128 v[200:203], v6 offset:12288
    s_waitcnt lgkmcnt(2)
    v_mfma_f32_32x32x16_bf16 v[32:47], v[204:207], a[160:163], v[32:47]
    v_mfma_f32_32x32x16_bf16 v[48:63], v[204:207], a[164:167], v[48:63]
    ds_read_b128 v[204:207], v6 offset:13312
    s_waitcnt lgkmcnt(2)
    v_mfma_f32_32x32x16_bf16 v[32:47], v[208:211], a[176:179], v[32:47]
    v_mfma_f32_32x32x16_bf16 v[48:63], v[208:211], a[180:183], v[48:63]
    ds_read_b128 v[208:211], v6 offset:14336
    s_waitcnt lgkmcnt(2)
    v_mfma_f32_32x32x16_bf16 v[32:47], v[200:203], a[192:195], v[32:47]
    v_mfma_f32_32x32x16_bf16 v[48:63], v[200:203], a[196:199], v[48:63]
    ds_read_b128 v[200:203], v6 offset:15360
    s_waitcnt lgkmcnt(2)
    v_mfma_f32_32x32x16_bf16 v[32:47], v[204:207], a[208:211], v[32:47]
    v_mfma_f32_32x32x16_bf16 v[48:63], v[204:207], a[212:215], v[48:63]
    ds_read_b128 v[204:207], v6 offset:0
    s_waitcnt lgkmcnt(2)
    v_mfma_f32_32x32x16_bf16 v[32:47], v[208:211], a[224:227], v[32:47]
    v_mfma_f32_32x32x16_bf16 v[48:63], v[208:211], a[228:231], v[48:63]
    ds_read_b128 v[208:211], v6 offset:1024
    s_waitcnt lgkmcnt(2)
    v_mfma_f32_32x32x16_bf16 v[32:47], v[200:203], a[240:243], v[32:47]
    v_mfma_f32_32x32x16_bf16 v[48:63], v[200:203], a[244:247], v[48:63]
    ds_read_b128 v[200:203], v6 offset:2048
    s_waitcnt lgkmcnt(2)
    v_mfma_f32_32x32x16_bf16 v[212:227], v[204:207], a[8:11], 0
    v_mfma_f32_32x32x16_bf16 v[228:243], v[204:207], a[12:15], 0
    ds_read_b128 v[204:207], v6 offset:3072
    s_waitcnt lgkmcnt(2)
    v_mfma_f32_32x32x16_bf16 v[212:227], v[208:211], a[24:27], v[212:227]
    v_mfma_f32_32x32x16_bf16 v[228:243], v[208:211], a[28:31], v[228:243]
    ds_read_b128 v[208:211], v6 offset:4096
    s_waitcnt lgkmcnt(2)
    v_mfma_f32_32x32x16_bf16 v[212:227], v[200:203], a[40:43], v[212:227]
    s_nop 0
    v_cvt_pk_bf16_f32 v32, v32, v48
    buffer_store_dword v32, v12, s[8:11], s48 offen offset:0 sc1
    v_mfma_f32_32x32x16_bf16 v[228:243], v[200:203], a[44:47], v[228:243]
    v_cvt_pk_bf16_f32 v33, v33, v49
    buffer_store_dword v33, v12, s[8:11], s48 offen offset:1024 sc1
    ds_read_b128 v[200:203], v6 offset:5120
    s_waitcnt lgkmcnt(2)
    v_mfma_f32_32x32x16_bf16 v[212:227], v[204:207], a[56:59], v[212:227]
    v_cvt_pk_bf16_f32 v34, v34, v50
    buffer_store_dword v34, v12, s[8:11], s48 offen offset:2048 sc1
    v_mfma_f32_32x32x16_bf16 v[228:243], v[204:207], a[60:63], v[228:243]
    ds_read_b128 v[204:207], v6 offset:6144
    s_waitcnt lgkmcnt(2)
    v_mfma_f32_32x32x16_bf16 v[212:227], v[208:211], a[72:75], v[212:227]
    v_cvt_pk_bf16_f32 v35, v35, v51
    buffer_store_dword v35, v12, s[8:11], s48 offen offset:3072 sc1
    v_mfma_f32_32x32x16_bf16 v[228:243], v[208:211], a[76:79], v[228:243]
    ds_read_b128 v[208:211], v6 offset:7168
    s_waitcnt lgkmcnt(2)
    v_mfma_f32_32x32x16_bf16 v[212:227], v[200:203], a[88:91], v[212:227]
    v_cvt_pk_bf16_f32 v36, v36, v52
    buffer_store_dword v36, v12, s[8:11], s36 offen offset:0 sc1
    v_mfma_f32_32x32x16_bf16 v[228:243], v[200:203], a[92:95], v[228:243]
    ds_read_b128 v[200:203], v6 offset:8192
    s_waitcnt lgkmcnt(2)
    v_mfma_f32_32x32x16_bf16 v[212:227], v[204:207], a[104:107], v[212:227]
    v_cvt_pk_bf16_f32 v37, v37, v53
    buffer_store_dword v37, v12, s[8:11], s36 offen offset:1024 sc1
    v_mfma_f32_32x32x16_bf16 v[228:243], v[204:207], a[108:111], v[228:243]
    v_cvt_pk_bf16_f32 v38, v38, v54
    buffer_store_dword v38, v12, s[8:11], s36 offen offset:2048 sc1
    ds_read_b128 v[204:207], v6 offset:9216
    s_waitcnt lgkmcnt(2)
    v_mfma_f32_32x32x16_bf16 v[212:227], v[208:211], a[120:123], v[212:227]
    v_cvt_pk_bf16_f32 v39, v39, v55
    buffer_store_dword v39, v12, s[8:11], s36 offen offset:3072 sc1
    v_mfma_f32_32x32x16_bf16 v[228:243], v[208:211], a[124:127], v[228:243]
    ds_read_b128 v[208:211], v6 offset:10240
    s_waitcnt lgkmcnt(2)
    v_mfma_f32_32x32x16_bf16 v[212:227], v[200:203], a[136:139], v[212:227]
    v_cvt_pk_bf16_f32 v40, v40, v56
    buffer_store_dword v40, v12, s[8:11], s37 offen offset:0 sc1
    v_mfma_f32_32x32x16_bf16 v[228:243], v[200:203], a[140:143], v[228:243]
    ds_read_b128 v[200:203], v6 offset:11264
    s_waitcnt lgkmcnt(2)
    v_mfma_f32_32x32x16_bf16 v[212:227], v[204:207], a[152:155], v[212:227]
    v_cvt_pk_bf16_f32 v41, v41, v57
    buffer_store_dword v41, v12, s[8:11], s37 offen offset:1024 sc1
    v_mfma_f32_32x32x16_bf16 v[228:243], v[204:207], a[156:159], v[228:243]
    ds_read_b128 v[204:207], v6 offset:12288
    s_waitcnt lgkmcnt(2)
    v_mfma_f32_32x32x16_bf16 v[212:227], v[208:211], a[168:171], v[212:227]
    v_cvt_pk_bf16_f32 v42, v42, v58
    buffer_store_dword v42, v12, s[8:11], s37 offen offset:2048 sc1
    v_cvt_pk_bf16_f32 v43, v43, v59
    buffer_store_dword v43, v12, s[8:11], s37 offen offset:3072 sc1
    v_mfma_f32_32x32x16_bf16 v[228:243], v[208:211], a[172:175], v[228:243]
    ds_read_b128 v[208:211], v6 offset:13312
    s_waitcnt lgkmcnt(2)
    v_mfma_f32_32x32x16_bf16 v[212:227], v[200:203], a[184:187], v[212:227]
    v_mfma_f32_32x32x16_bf16 v[228:243], v[200:203], a[188:191], v[228:243]
    v_cvt_pk_bf16_f32 v44, v44, v60
    buffer_store_dword v44, v12, s[8:11], s38 offen offset:0 sc1
    ds_read_b128 v[200:203], v6 offset:14336
    s_waitcnt lgkmcnt(2)
    v_mfma_f32_32x32x16_bf16 v[212:227], v[204:207], a[200:203], v[212:227]
    v_cvt_pk_bf16_f32 v45, v45, v61
    buffer_store_dword v45, v12, s[8:11], s38 offen offset:1024 sc1
    v_mfma_f32_32x32x16_bf16 v[228:243], v[204:207], a[204:207], v[228:243]
    ds_read_b128 v[204:207], v6 offset:15360
    s_waitcnt lgkmcnt(2)
    v_mfma_f32_32x32x16_bf16 v[212:227], v[208:211], a[216:219], v[212:227]
    v_cvt_pk_bf16_f32 v46, v46, v62
    buffer_store_dword v46, v12, s[8:11], s38 offen offset:2048 sc1
    v_mfma_f32_32x32x16_bf16 v[228:243], v[208:211], a[220:223], v[228:243]
    s_waitcnt lgkmcnt(1)
    v_mfma_f32_32x32x16_bf16 v[212:227], v[200:203], a[232:235], v[212:227]
    v_cvt_pk_bf16_f32 v47, v47, v63
    buffer_store_dword v47, v12, s[8:11], s38 offen offset:3072 sc1
    v_mfma_f32_32x32x16_bf16 v[228:243], v[200:203], a[236:239], v[228:243]
    s_waitcnt lgkmcnt(0)
    v_mfma_f32_32x32x16_bf16 v[212:227], v[204:207], a[248:251], v[212:227]
    v_mfma_f32_32x32x16_bf16 v[228:243], v[204:207], a[252:255], v[228:243]
    v_xor_b32 v6, 0x4000, v6
    s_add_u32 s3, s49, s53
    s_nop 9
    v_cvt_pk_bf16_f32 v212, v212, v228
    buffer_store_dword v212, v12, s[8:11], s48 offen offset:128 sc1
    v_cvt_pk_bf16_f32 v213, v213, v229
    buffer_store_dword v213, v12, s[8:11], s48 offen offset:1152 sc1
    v_cvt_pk_bf16_f32 v214, v214, v230
    buffer_store_dword v214, v12, s[8:11], s48 offen offset:2176 sc1
    v_cvt_pk_bf16_f32 v215, v215, v231
    buffer_store_dword v215, v12, s[8:11], s48 offen offset:3200 sc1
    v_cvt_pk_bf16_f32 v216, v216, v232
    buffer_store_dword v216, v12, s[8:11], s36 offen offset:128 sc1
    v_cvt_pk_bf16_f32 v217, v217, v233
    buffer_store_dword v217, v12, s[8:11], s36 offen offset:1152 sc1
    v_cvt_pk_bf16_f32 v218, v218, v234
    buffer_store_dword v218, v12, s[8:11], s36 offen offset:2176 sc1
    v_cvt_pk_bf16_f32 v219, v219, v235
    buffer_store_dword v219, v12, s[8:11], s36 offen offset:3200 sc1
    v_cvt_pk_bf16_f32 v220, v220, v236
    buffer_store_dword v220, v12, s[8:11], s37 offen offset:128 sc1
    v_cvt_pk_bf16_f32 v221, v221, v237
    buffer_store_dword v221, v12, s[8:11], s37 offen offset:1152 sc1
    v_cvt_pk_bf16_f32 v222, v222, v238
    buffer_store_dword v222, v12, s[8:11], s37 offen offset:2176 sc1
    v_cvt_pk_bf16_f32 v223, v223, v239
    buffer_store_dword v223, v12, s[8:11], s37 offen offset:3200 sc1
    v_cvt_pk_bf16_f32 v224, v224, v240
    buffer_store_dword v224, v12, s[8:11], s38 offen offset:128 sc1
    v_cvt_pk_bf16_f32 v225, v225, v241
    buffer_store_dword v225, v12, s[8:11], s38 offen offset:1152 sc1
    v_cvt_pk_bf16_f32 v226, v226, v242
    buffer_store_dword v226, v12, s[8:11], s38 offen offset:2176 sc1
    v_cvt_pk_bf16_f32 v227, v227, v243
    buffer_store_dword v227, v12, s[8:11], s38 offen offset:3200 sc1
    s_waitcnt vmcnt(0)
    buffer_store_dword v3, off, s[8:11], s3 sc1
    v_lshlrev_b32 v40, 16, v128
    v_and_b32 v41, 0xffff0000, v128
    v_lshlrev_b32 v68, 16, v132
    v_and_b32 v69, 0xffff0000, v132
    v_lshlrev_b32 v42, 16, v129
    v_and_b32 v43, 0xffff0000, v129
    v_lshlrev_b32 v70, 16, v133
    v_and_b32 v71, 0xffff0000, v133
    v_lshlrev_b32 v44, 16, v130
    v_and_b32 v45, 0xffff0000, v130
    v_lshlrev_b32 v72, 16, v134
    v_and_b32 v73, 0xffff0000, v134
    v_lshlrev_b32 v46, 16, v131
    v_and_b32 v47, 0xffff0000, v131
    v_lshlrev_b32 v74, 16, v135
    v_and_b32 v75, 0xffff0000, v135
Lw_64:
    buffer_load_dword v4, v5, s[8:11], s49 offen offset:0 sc1
    s_waitcnt vmcnt(0)
    v_cmp_eq_u32 vcc, 0, v4
    s_cbranch_vccz Lwd_65
    s_sub_u32 s98, s98, 1
    s_cbranch_scc1 L_end
    s_branch Lw_64
Lwd_65:
    s_mov_b32 s3, s48
    buffer_load_dwordx4 v[136:139], v13, s[8:11], s3 offen offset:0 sc1
    buffer_load_dwordx4 v[140:143], v13, s[8:11], s3 offen offset:128 sc1
    s_add_u32 s3, s3, 65536
    buffer_load_dwordx4 v[144:147], v13, s[8:11], s3 offen offset:0 sc1
    buffer_load_dwordx4 v[148:151], v13, s[8:11], s3 offen offset:128 sc1
    s_add_u32 s3, s3, 65536
    buffer_load_dwordx4 v[152:155], v13, s[8:11], s3 offen offset:0 sc1
    buffer_load_dwordx4 v[156:159], v13, s[8:11], s3 offen offset:128 sc1
    s_add_u32 s3, s3, 65536
    buffer_load_dwordx4 v[160:163], v13, s[8:11], s3 offen offset:0 sc1
    buffer_load_dwordx4 v[164:167], v13, s[8:11], s3 offen offset:128 sc1
    s_add_u32 s3, s3, 65536
    buffer_load_dwordx4 v[168:171], v13, s[8:11], s3 offen offset:0 sc1
    buffer_load_dwordx4 v[172:175], v13, s[8:11], s3 offen offset:128 sc1
    s_add_u32 s3, s3, 65536
    buffer_load_dwordx4 v[176:179], v13, s[8:11], s3 offen offset:0 sc1
    buffer_load_dwordx4 v[180:183], v13, s[8:11], s3 offen offset:128 sc1
    s_add_u32 s3, s3, 65536
    buffer_load_dwordx4 v[184:187], v13, s[8:11], s3 offen offset:0 sc1
    buffer_load_dwordx4 v[188:191], v13, s[8:11], s3 offen offset:128 sc1
    s_add_u32 s3, s3, 65536
    buffer_load_dwordx4 v[192:195], v13, s[8:11], s3 offen offset:0 sc1
    buffer_load_dwordx4 v[196:199], v13, s[8:11], s3 offen offset:128 sc1
    s_add_u32 s3, s3, 65536
    s_barrier
    s_waitcnt vmcnt(14)
    v_mfma_f32_16x16x32_bf16 v[32:35], v[8:11], v[136:139], 0
    v_mfma_f32_16x16x32_bf16 v[36:39], v[8:11], v[140:143], 0
    s_waitcnt vmcnt(12)
    v_mfma_f32_16x16x32_bf16 v[32:35], v[8:11], v[144:147], v[32:35]
    v_mfma_f32_16x16x32_bf16 v[36:39], v[8:11], v[148:151], v[36:39]
    s_waitcnt vmcnt(10)
    v_mfma_f32_16x16x32_bf16 v[32:35], v[8:11], v[152:155], v[32:35]
    v_mfma_f32_16x16x32_bf16 v[36:39], v[8:11], v[156:159], v[36:39]
    s_waitcnt vmcnt(8)
    v_mfma_f32_16x16x32_bf16 v[32:35], v[8:11], v[160:163], v[32:35]
    v_mfma_f32_16x16x32_bf16 v[36:39], v[8:11], v[164:167], v[36:39]
    s_waitcnt vmcnt(6)
    v_mfma_f32_16x16x32_bf16 v[32:35], v[8:11], v[168:171], v[32:35]
    v_mfma_f32_16x16x32_bf16 v[36:39], v[8:11], v[172:175], v[36:39]
    s_waitcnt vmcnt(4)
    v_mfma_f32_16x16x32_bf16 v[32:35], v[8:11], v[176:179], v[32:35]
    v_mfma_f32_16x16x32_bf16 v[36:39], v[8:11], v[180:183], v[36:39]
    s_waitcnt vmcnt(2)
    v_mfma_f32_16x16x32_bf16 v[32:35], v[8:11], v[184:187], v[32:35]
    v_mfma_f32_16x16x32_bf16 v[36:39], v[8:11], v[188:191], v[36:39]
    s_waitcnt vmcnt(0)
    v_mfma_f32_16x16x32_bf16 v[32:35], v[8:11], v[192:195], v[32:35]
    v_mfma_f32_16x16x32_bf16 v[36:39], v[8:11], v[196:199], v[36:39]
    s_nop 6
    v_cvt_pk_bf16_f32 v56, v32, v33
    v_cvt_pk_bf16_f32 v57, v36, v37
    v_cvt_pk_bf16_f32 v58, v34, v35
    v_cvt_pk_bf16_f32 v59, v38, v39
    v_lshlrev_b32 v32, 16, v56
    v_and_b32 v33, 0xffff0000, v56
    v_lshlrev_b32 v34, 16, v57
    v_and_b32 v35, 0xffff0000, v57
    v_lshlrev_b32 v36, 16, v58
    v_and_b32 v37, 0xffff0000, v58
    v_lshlrev_b32 v38, 16, v59
    v_and_b32 v39, 0xffff0000, v59
    v_pk_add_f32 v[40:41], v[40:41], v[32:33]
    v_pk_add_f32 v[42:43], v[42:43], v[34:35]
    v_pk_add_f32 v[44:45], v[44:45], v[36:37]
    v_pk_add_f32 v[46:47], v[46:47], v[38:39]
    v_cvt_pk_bf16_f32 v60, v40, v41
    v_cvt_pk_bf16_f32 v61, v42, v43
    v_cvt_pk_bf16_f32 v62, v44, v45
    v_cvt_pk_bf16_f32 v63, v46, v47
    s_cmp_lg_u32 s7, 0
    s_cbranch_scc1 Lao_66
    v_lshlrev_b32 v40, 16, v60
    v_and_b32 v41, 0xffff0000, v60
    v_lshlrev_b32 v42, 16, v61
    v_and_b32 v43, 0xffff0000, v61
    v_lshlrev_b32 v44, 16, v62
    v_and_b32 v45, 0xffff0000, v62
    v_lshlrev_b32 v46, 16, v63
    v_and_b32 v47, 0xffff0000, v63
    s_add_u32 s3, s50, 11534336
    s_add_u32 s40, s50, 7340032
    v_pk_add_f32 v[56:57], v[40:41], v[42:43]
    v_pk_add_f32 v[58:59], v[44:45], v[46:47]
    v_pk_add_f32 v[56:57], v[56:57], v[58:59]
    v_add_f32 v56, v56, v57
    s_nop 1
    v_add_f32_dpp v56, v56, v56 quad_perm:[1,0,3,2] row_mask:0xf bank_mask:0xf
    s_nop 1
    v_add_f32_dpp v56, v56, v56 quad_perm:[2,3,0,1] row_mask:0xf bank_mask:0xf
    s_nop 1
    v_add_f32_dpp v56, v56, v56 row_half_mirror row_mask:0xf bank_mask:0xf
    s_nop 1
    v_add_f32_dpp v56, v56, v56 row_mirror row_mask:0xf bank_mask:0xf
    v_mov_b32 v57, v56
    s_nop 1
    v_permlane16_swap_b32 v57, v56
    v_add_f32 v56, v56, v57
    v_mov_b32 v57, v56
    s_nop 1
    v_permlane32_swap_b32 v57, v56
    v_add_f32 v56, v56, v57
    v_mul_f32 v56, 0x3b000000, v56
    v_pk_add_f32 v[48:49], v[40:41], v[56:57] op_sel_hi:[1,0] neg_lo:[0,1] neg_hi:[0,1]
    v_pk_add_f32 v[50:51], v[42:43], v[56:57] op_sel_hi:[1,0] neg_lo:[0,1] neg_hi:[0,1]
    v_pk_add_f32 v[52:53], v[44:45], v[56:57] op_sel_hi:[1,0] neg_lo:[0,1] neg_hi:[0,1]
    v_pk_add_f32 v[54:55], v[46:47], v[56:57] op_sel_hi:[1,0] neg_lo:[0,1] neg_hi:[0,1]
    v_pk_mul_f32 v[58:59], v[48:49], v[48:49]
    v_pk_fma_f32 v[58:59], v[50:51], v[50:51], v[58:59]
    v_pk_fma_f32 v[58:59], v[52:53], v[52:53], v[58:59]
    v_pk_fma_f32 v[58:59], v[54:55], v[54:55], v[58:59]
    v_add_f32 v58, v58, v59
    v_cvt_pk_bf16_f32 v56, v56, v56
    v_and_b32 v56, 0xffff0000, v56
    v_pk_add_f32 v[48:49], v[40:41], v[56:57] op_sel_hi:[1,0] neg_lo:[0,1] neg_hi:[0,1]
    v_add_f32_dpp v58, v58, v58 quad_perm:[1,0,3,2] row_mask:0xf bank_mask:0xf
    v_pk_add_f32 v[50:51], v[42:43], v[56:57] op_sel_hi:[1,0] neg_lo:[0,1] neg_hi:[0,1]
    v_pk_add_f32 v[52:53], v[44:45], v[56:57] op_sel_hi:[1,0] neg_lo:[0,1] neg_hi:[0,1]
    v_pk_add_f32 v[54:55], v[46:47], v[56:57] op_sel_hi:[1,0] neg_lo:[0,1] neg_hi:[0,1]
    v_add_f32_dpp v58, v58, v58 quad_perm:[2,3,0,1] row_mask:0xf bank_mask:0xf
    v_cvt_pk_bf16_f32 v49, v48, v49
    v_lshlrev_b32 v48, 16, v49
    v_and_b32 v49, 0xffff0000, v49
    v_add_f32_dpp v58, v58, v58 row_half_mirror row_mask:0xf bank_mask:0xf
    v_cvt_pk_bf16_f32 v51, v50, v51
    v_lshlrev_b32 v50, 16, v51
    v_and_b32 v51, 0xffff0000, v51
    v_add_f32_dpp v58, v58, v58 row_mirror row_mask:0xf bank_mask:0xf
    v_mov_b32 v59, v58
    v_cvt_pk_bf16_f32 v53, v52, v53
    v_lshlrev_b32 v52, 16, v53
    v_and_b32 v53, 0xffff0000, v53
    v_permlane16_swap_b32 v59, v58
    v_add_f32 v58, v58, v59
    v_mov_b32 v59, v58
    v_cvt_pk_bf16_f32 v55, v54, v55
    v_lshlrev_b32 v54, 16, v55
    v_and_b32 v55, 0xffff0000, v55
    v_permlane32_swap_b32 v59, v58
    v_add_f32 v58, v58, v59
    v_mul_f32 v58, 0x3b000000, v58
    v_cvt_pk_bf16_f32 v58, v58, v58
    v_and_b32 v58, 0xffff0000, v58
    v_add_f32 v58, 0x3727c5ac, v58
    v_cvt_pk_bf16_f32 v58, v58, v58
    v_and_b32 v58, 0xffff0000, v58
    v_sqrt_f32 v58, v58
    s_nop 0
    v_cvt_pk_bf16_f32 v58, v58, v58
    v_and_b32 v58, 0xffff0000, v58
    v_rcp_f32 v58, v58
    s_nop 0
    v_pk_mul_f32 v[48:49], v[48:49], v[58:59] op_sel_hi:[1,0]
    v_pk_mul_f32 v[50:51], v[50:51], v[58:59] op_sel_hi:[1,0]
    v_pk_mul_f32 v[52:53], v[52:53], v[58:59] op_sel_hi:[1,0]
    v_pk_mul_f32 v[54:55], v[54:55], v[58:59] op_sel_hi:[1,0]
    v_pk_fma_f32 v[40:41], v[48:49], v[68:69], v[40:41]
    v_pk_fma_f32 v[42:43], v[50:51], v[70:71], v[42:43]
    v_pk_fma_f32 v[44:45], v[52:53], v[72:73], v[44:45]
    v_pk_fma_f32 v[46:47], v[54:55], v[74:75], v[46:47]
    v_cvt_pk_bf16_f32 v60, v40, v41
    v_cvt_pk_bf16_f32 v61, v42, v43
    v_cvt_pk_bf16_f32 v62, v44, v45
    v_cvt_pk_bf16_f32 v63, v46, v47
    v_lshlrev_b32 v40, 16, v60
    v_and_b32 v41, 0xffff0000, v60
    v_lshlrev_b32 v42, 16, v61
    v_and_b32 v43, 0xffff0000, v61
    v_lshlrev_b32 v44, 16, v62
    v_and_b32 v45, 0xffff0000, v62
    v_lshlrev_b32 v46, 16, v63
    v_and_b32 v47, 0xffff0000, v63
    buffer_store_dwordx4 v[60:63], v244, s[8:11], s40 offen sc1
    v_pk_add_f32 v[56:57], v[40:41], v[42:43]
    v_pk_add_f32 v[58:59], v[44:45], v[46:47]
    v_pk_add_f32 v[56:57], v[56:57], v[58:59]
    v_add_f32 v56, v56, v57
    s_nop 1
    v_add_f32_dpp v56, v56, v56 quad_perm:[1,0,3,2] row_mask:0xf bank_mask:0xf
    s_nop 1
    v_add_f32_dpp v56, v56, v56 quad_perm:[2,3,0,1] row_mask:0xf bank_mask:0xf
    s_nop 1
    v_add_f32_dpp v56, v56, v56 row_half_mirror row_mask:0xf bank_mask:0xf
    s_nop 1
    v_add_f32_dpp v56, v56, v56 row_mirror row_mask:0xf bank_mask:0xf
    v_mov_b32 v57, v56
    s_nop 1
    v_permlane16_swap_b32 v57, v56
    v_add_f32 v56, v56, v57
    v_mov_b32 v57, v56
    s_nop 1
    v_permlane32_swap_b32 v57, v56
    v_add_f32 v56, v56, v57
    v_mul_f32 v56, 0x3b000000, v56
    v_pk_add_f32 v[48:49], v[40:41], v[56:57] op_sel_hi:[1,0] neg_lo:[0,1] neg_hi:[0,1]
    v_pk_add_f32 v[50:51], v[42:43], v[56:57] op_sel_hi:[1,0] neg_lo:[0,1] neg_hi:[0,1]
    v_pk_add_f32 v[52:53], v[44:45], v[56:57] op_sel_hi:[1,0] neg_lo:[0,1] neg_hi:[0,1]
    v_pk_add_f32 v[54:55], v[46:47], v[56:57] op_sel_hi:[1,0] neg_lo:[0,1] neg_hi:[0,1]
    v_pk_mul_f32 v[58:59], v[48:49], v[48:49]
    v_pk_fma_f32 v[58:59], v[50:51], v[50:51], v[58:59]
    v_pk_fma_f32 v[58:59], v[52:53], v[52:53], v[58:59]
    v_pk_fma_f32 v[58:59], v[54:55], v[54:55], v[58:59]
    v_add_f32 v58, v58, v59
    v_cvt_pk_bf16_f32 v56, v56, v56
    v_and_b32 v56, 0xffff0000, v56
    v_pk_add_f32 v[48:49], v[40:41], v[56:57] op_sel_hi:[1,0] neg_lo:[0,1] neg_hi:[0,1]
    v_add_f32_dpp v58, v58, v58 quad_perm:[1,0,3,2] row_mask:0xf bank_mask:0xf
    v_pk_add_f32 v[50:51], v[42:43], v[56:57] op_sel_hi:[1,0] neg_lo:[0,1] neg_hi:[0,1]
    v_pk_add_f32 v[52:53], v[44:45], v[56:57] op_sel_hi:[1,0] neg_lo:[0,1] neg_hi:[0,1]
    v_pk_add_f32 v[54:55], v[46:47], v[56:57] op_sel_hi:[1,0] neg_lo:[0,1] neg_hi:[0,1]
    v_add_f32_dpp v58, v58, v58 quad_perm:[2,3,0,1] row_mask:0xf bank_mask:0xf
    v_cvt_pk_bf16_f32 v49, v48, v49
    v_lshlrev_b32 v48, 16, v49
    v_and_b32 v49, 0xffff0000, v49
    v_add_f32_dpp v58, v58, v58 row_half_mirror row_mask:0xf bank_mask:0xf
    v_cvt_pk_bf16_f32 v51, v50, v51
    v_lshlrev_b32 v50, 16, v51
    v_and_b32 v51, 0xffff0000, v51
    v_add_f32_dpp v58, v58, v58 row_mirror row_mask:0xf bank_mask:0xf
    v_mov_b32 v59, v58
    v_cvt_pk_bf16_f32 v53, v52, v53
    v_lshlrev_b32 v52, 16, v53
    v_and_b32 v53, 0xffff0000, v53
    v_permlane16_swap_b32 v59, v58
    v_add_f32 v58, v58, v59
    v_mov_b32 v59, v58
    v_cvt_pk_bf16_f32 v55, v54, v55
    v_lshlrev_b32 v54, 16, v55
    v_and_b32 v55, 0xffff0000, v55
    v_permlane32_swap_b32 v59, v58
    v_add_f32 v58, v58, v59
    v_mul_f32 v58, 0x3b000000, v58
    v_cvt_pk_bf16_f32 v58, v58, v58
    v_and_b32 v58, 0xffff0000, v58
    v_add_f32 v58, 0x3727c5ac, v58
    v_cvt_pk_bf16_f32 v58, v58, v58
    v_and_b32 v58, 0xffff0000, v58
    v_sqrt_f32 v58, v58
    s_nop 0
    v_cvt_pk_bf16_f32 v58, v58, v58
    v_and_b32 v58, 0xffff0000, v58
    v_rcp_f32 v58, v58
    s_nop 0
    v_pk_mul_f32 v[48:49], v[48:49], v[58:59] op_sel_hi:[1,0]
    v_pk_mul_f32 v[50:51], v[50:51], v[58:59] op_sel_hi:[1,0]
    v_pk_mul_f32 v[52:53], v[52:53], v[58:59] op_sel_hi:[1,0]
    v_pk_mul_f32 v[54:55], v[54:55], v[58:59] op_sel_hi:[1,0]
    v_cvt_pk_bf16_f32 v64, v48, v49
    v_cvt_pk_bf16_f32 v65, v50, v51
    v_cvt_pk_bf16_f32 v66, v52, v53
    v_cvt_pk_bf16_f32 v67, v54, v55
    buffer_store_dwordx4 v[64:67], v15, s[8:11], s3 offen sc1
    s_waitcnt vmcnt(0)
    s_branch L_ao_mixed_dn
Lao_66:
    buffer_store_dwordx4 v[60:63], v244, s[12:15], s50 offen
    s_cmp_ge_u32 s44, 61
    s_cbranch_scc1 L_ao_mixed_nx
L_ao_mixed_dn:
    s_lshr_b32 s3, s50, 8
    s_add_u32 s3, s3, s34
    buffer_store_dword v3, off, s[8:11], s3 sc1
    s_lshl_b32 s40, s44, 7
    s_add_u32 s41, s40, s34
    v_and_b32 v253, 0x7c, v5
Lw_67:
    buffer_load_dword v4, v253, s[8:11], s41 offen offset:0 sc1
    s_waitcnt vmcnt(0)
    v_cmp_eq_u32 vcc, 0, v4
    s_cbranch_vccz Lwd_68
    s_sub_u32 s98, s98, 1
    s_cbranch_scc1 L_end
    s_branch Lw_67
Lwd_68:
    s_add_u32 s40, s40, s35
    buffer_store_dword v3, v253, s[8:11], s40 offen sc1
L_ao_mixed_nx:
    s_add_u32 s44, s44, 3
    s_add_u32 s49, s49, 768
    s_add_u32 s50, s50, 98304
    s_cmp_lt_u32 s44, 64
    s_cbranch_scc1 L_ao_mixed
    s_endpgm
    s_endpgm
L_chain:
    s_mov_b32 s12, s80
    s_and_b32 s13, s81, 0xffff
    s_mov_b32 s14, 0x400000
    s_mov_b32 s15, 0x20000
    s_mov_b32 s16, s82
    s_and_b32 s17, s83, 0xffff
    s_mov_b32 s18, 0x400000
    s_mov_b32 s19, 0x20000
    s_mov_b32 s20, s84
    s_and_b32 s21, s85, 0xffff
    s_mov_b32 s22, 0x400000
    s_mov_b32 s23, 0x20000
    s_mov_b32 s24, s86
    s_and_b32 s25, s87, 0xffff
    s_mov_b32 s26, 0x400000
    s_mov_b32 s27, 0x20000
    s_mov_b32 s32, s78
    s_and_b32 s33, s79, 0xffff
    s_mov_b32 s34, 0x2000
    s_mov_b32 s35, 0x20000
    v_and_b32 v1, 63, v0
    v_lshlrev_b32 v1, 4, v1
    v_and_b32 v20, 15, v0
    v_bfe_u32 v21, v0, 4, 2
    v_mov_b32 v22, 0
    s_mov_b32 s62, 0xff81ff81
    v_mov_b32 v24, s62
    v_mov_b32 v25, s62
    v_mov_b32 v26, s62
    v_mov_b32 v27, s62
    s_lshl_b32 s46, s7, 20
    s_add_u32 s46, s46, 13631488
    s_lshl_b32 s47, s7, 19
    s_add_u32 s47, s47, 15728640
    s_lshl_b32 s43, s6, 5
    s_add_u32 s43, s43, s5
    s_lshl_b32 s52, s43, 11
    s_add_u32 s52, s52, s47
    v_mov_b32 v16, 0
    v_mov_b32 v17, 0
    v_mov_b32 v18, 0
    v_mov_b32 v19, 0
    buffer_store_dwordx4 v[16:19], v1, s[8:11], s52 offen offset:0 sc1
    buffer_store_dwordx4 v[16:19], v1, s[8:11], s52 offen offset:1024 sc1
    v_lshlrev_b32 v23, 13, v21
    v_lshl_add_u32 v23, v20, 4, v23
    s_lshl_b32 s3, s6, 17
    s_add_u32 s3, s3, s46
    s_lshl_b32 s40, s5, 8
    s_add_u32 s3, s3, s40
    s_add_u32 s3, s3, 8192
    buffer_store_dwordx4 v[24:27], v23, s[8:11], s3 offen sc1
    s_add_u32 s3, s3, 0x8000
    buffer_store_dwordx4 v[24:27], v23, s[8:11], s3 offen sc1
    s_add_u32 s3, s3, 0x8000
    buffer_store_dwordx4 v[24:27], v23, s[8:11], s3 offen sc1
    s_add_u32 s3, s3, 0x8000
    buffer_store_dwordx4 v[24:27], v23, s[8:11], s3 offen sc1
    s_add_u32 s3, s3, 0x8000
    v_lshlrev_b32 v12, 4, v21
    v_and_b32 v28, 3, v20
    v_lshl_add_u32 v12, v28, 2, v12
    s_lshl_b32 s3, s43, 6
    v_add_u32 v12, s3, v12
    v_and_b32 v23, 1, v21
    v_lshlrev_b32 v23, 10, v23
    v_lshl_add_u32 v23, v28, 4, v23
    v_and_b32 v29, 2, v21
    v_lshl_add_u32 v23, v29, 2, v23
    s_and_b32 s3, s5, 3
    s_lshl_b32 s3, s3, 11
    s_lshr_b32 s40, s5, 3
    s_lshl_b32 s40, s40, 8
    s_add_u32 s3, s3, s40
    s_and_b32 s40, s5, 4
    s_lshl_b32 s40, s40, 4
    s_add_u32 s3, s3, s40
    s_and_b32 s40, s6, 2
    s_lshl_b32 s40, s40, 6
    s_add_u32 s3, s3, s40
    s_and_b32 s40, s6, 1
    s_lshl_b32 s40, s40, 2
    s_add_u32 s3, s3, s40
    buffer_load_dword v28, v23, s[32:35], s3 offen
    v_lshlrev_b32 v8, 11, v21
    v_bfe_u32 v9, v0, 2, 2
    v_lshl_add_u32 v8, v9, 6, v8
    s_lshl_b32 s3, s6, 8
    v_add_u32 v8, s3, v8
    v_and_b32 v9, 1, v0
    v_lshl_add_u32 v6, v9, 3, v8
    v_and_b32 v9, 2, v0
    v_lshl_add_u32 v6, v9, 4, v6
    v_add_u32 v7, 0x10000, v6
    v_and_b32 v9, 3, v0
    v_lshl_add_u32 v8, v9, 3, v8
    v_add_u32 v9, 0x10000, v8
    v_and_b32 v5, 1, v21
    v_lshlrev_b32 v5, 14, v5
    v_lshrrev_b32 v10, 1, v21
    v_lshl_add_u32 v5, v10, 12, v5
    v_lshl_add_u32 v5, v20, 3, v5
    s_lshl_b32 s3, s6, 8
    v_add_u32 v5, s3, v5
    s_mov_b32 s60, 0x05040100
    s_mov_b32 s61, 0x07060302
    s_lshl_b32 s55, s5, 17
    s_lshr_b32 s3, s6, 1
    s_lshl_b32 s3, s3, 16
    s_and_b32 s40, s6, 1
    s_lshl_b32 s40, s40, 13
    s_add_u32 s3, s3, s40
    v_add_u32 v31, s3, v1
    v_bfe_u32 v10, v0, 2, 2
    v_and_b32 v11, 2, v10
    v_add_u32 v10, v10, v11
    v_lshlrev_b32 v10, 13, v10
    v_bfe_u32 v11, v0, 4, 2
    v_lshl_add_u32 v10, v11, 6, v10
    v_and_b32 v11, 3, v0
    v_lshl_add_u32 v10, v11, 4, v10
    s_lshl_b32 s40, s5, 8
    v_add_u32 v10, s40, v10
    s_and_b32 s40, s6, 1
    s_lshl_b32 s40, s40, 5
    s_and_b32 s41, s6, 2
    s_lshl_b32 s41, s41, 6
    s_add_u32 s40, s40, s41
    s_lshl_b32 s40, s40, 13
    s_lshl_b32 s41, s6, 12
    s_add_u32 m0, s41, 0
    s_add_u32 s42, s40, 0
    buffer_load_dwordx4 v10, s[16:19], s42 offen lds
    s_add_u32 m0, s41, 1024
    s_add_u32 s42, s40, 65536
    buffer_load_dwordx4 v10, s[16:19], s42 offen lds
    s_add_u32 m0, s41, 2048
    s_add_u32 s42, s40, 131072
    buffer_load_dwordx4 v10, s[16:19], s42 offen lds
    s_add_u32 m0, s41, 3072
    s_add_u32 s42, s40, 196608
    buffer_load_dwordx4 v10, s[16:19], s42 offen lds
    s_add_u32 m0, s41, 16384
    s_add_u32 s42, s40, 2097152
    buffer_load_dwordx4 v10, s[16:19], s42 offen lds
    s_add_u32 m0, s41, 17408
    s_add_u32 s42, s40, 2162688
    buffer_load_dwordx4 v10, s[16:19], s42 offen lds
    s_add_u32 m0, s41, 18432
    s_add_u32 s42, s40, 2228224
    buffer_load_dwordx4 v10, s[16:19], s42 offen lds
    s_add_u32 m0, s41, 19456
    s_add_u32 s42, s40, 2293760
    buffer_load_dwordx4 v10, s[16:19], s42 offen lds
    s_add_u32 m0, s41, 32768
    s_add_u32 s42, s40, 16384
    buffer_load_dwordx4 v10, s[16:19], s42 offen lds
    s_add_u32 m0, s41, 33792
    s_add_u32 s42, s40, 81920
    buffer_load_dwordx4 v10, s[16:19], s42 offen lds
    s_add_u32 m0, s41, 34816
    s_add_u32 s42, s40, 147456
    buffer_load_dwordx4 v10, s[16:19], s42 offen lds
    s_add_u32 m0, s41, 35840
    s_add_u32 s42, s40, 212992
    buffer_load_dwordx4 v10, s[16:19], s42 offen lds
    s_add_u32 m0, s41, 49152
    s_add_u32 s42, s40, 2113536
    buffer_load_dwordx4 v10, s[16:19], s42 offen lds
    s_add_u32 m0, s41, 50176
    s_add_u32 s42, s40, 2179072
    buffer_load_dwordx4 v10, s[16:19], s42 offen lds
    s_add_u32 m0, s41, 51200
    s_add_u32 s42, s40, 2244608
    buffer_load_dwordx4 v10, s[16:19], s42 offen lds
    s_add_u32 m0, s41, 52224
    s_add_u32 s42, s40, 2310144
    buffer_load_dwordx4 v10, s[16:19], s42 offen lds
    s_add_u32 m0, s41, 65536
    s_add_u32 s42, s40, 524288
    buffer_load_dwordx4 v10, s[16:19], s42 offen lds
    s_add_u32 m0, s41, 66560
    s_add_u32 s42, s40, 589824
    buffer_load_dwordx4 v10, s[16:19], s42 offen lds
    s_add_u32 m0, s41, 67584
    s_add_u32 s42, s40, 655360
    buffer_load_dwordx4 v10, s[16:19], s42 offen lds
    s_add_u32 m0, s41, 68608
    s_add_u32 s42, s40, 720896
    buffer_load_dwordx4 v10, s[16:19], s42 offen lds
    s_add_u32 m0, s41, 81920
    s_add_u32 s42, s40, 2621440
    buffer_load_dwordx4 v10, s[16:19], s42 offen lds
    s_add_u32 m0, s41, 82944
    s_add_u32 s42, s40, 2686976
    buffer_load_dwordx4 v10, s[16:19], s42 offen lds
    s_add_u32 m0, s41, 83968
    s_add_u32 s42, s40, 2752512
    buffer_load_dwordx4 v10, s[16:19], s42 offen lds
    s_add_u32 m0, s41, 84992
    s_add_u32 s42, s40, 2818048
    buffer_load_dwordx4 v10, s[16:19], s42 offen lds
    s_add_u32 m0, s41, 98304
    s_add_u32 s42, s40, 540672
    buffer_load_dwordx4 v10, s[16:19], s42 offen lds
    s_add_u32 m0, s41, 99328
    s_add_u32 s42, s40, 606208
    buffer_load_dwordx4 v10, s[16:19], s42 offen lds
    s_add_u32 m0, s41, 100352
    s_add_u32 s42, s40, 671744
    buffer_load_dwordx4 v10, s[16:19], s42 offen lds
    s_add_u32 m0, s41, 101376
    s_add_u32 s42, s40, 737280
    buffer_load_dwordx4 v10, s[16:19], s42 offen lds
    s_add_u32 m0, s41, 114688
    s_add_u32 s42, s40, 2637824
    buffer_load_dwordx4 v10, s[16:19], s42 offen lds
    s_add_u32 m0, s41, 115712
    s_add_u32 s42, s40, 2703360
    buffer_load_dwordx4 v10, s[16:19], s42 offen lds
    s_add_u32 m0, s41, 116736
    s_add_u32 s42, s40, 2768896
    buffer_load_dwordx4 v10, s[16:19], s42 offen lds
    s_add_u32 m0, s41, 117760
    s_add_u32 s42, s40, 2834432
    buffer_load_dwordx4 v10, s[16:19], s42 offen lds
    s_waitcnt vmcnt(28)
    s_barrier
    s_cmp_eq_u32 s6, 1
    s_cbranch_scc1 Lt_70
    s_cmp_eq_u32 s6, 2
    s_cbranch_scc1 Lt_71
    s_cmp_eq_u32 s6, 3
    s_cbranch_scc1 Lt_72
    ds_read_b64_tr_b16 a[128:129], v6 offset:0
    ds_read_b64_tr_b16 a[130:131], v6 offset:1024
    ds_read_b64_tr_b16 a[132:133], v6 offset:8192
    ds_read_b64_tr_b16 a[134:135], v6 offset:9216
    ds_read_b64_tr_b16 a[192:193], v6 offset:16
    ds_read_b64_tr_b16 a[194:195], v6 offset:1040
    ds_read_b64_tr_b16 a[196:197], v6 offset:8208
    ds_read_b64_tr_b16 a[198:199], v6 offset:9232
    s_branch Lt_73
Lt_70:
    ds_read_b64_tr_b16 a[144:145], v6 offset:0
    ds_read_b64_tr_b16 a[146:147], v6 offset:1024
    ds_read_b64_tr_b16 a[148:149], v6 offset:8192
    ds_read_b64_tr_b16 a[150:151], v6 offset:9216
    ds_read_b64_tr_b16 a[208:209], v6 offset:16
    ds_read_b64_tr_b16 a[210:211], v6 offset:1040
    ds_read_b64_tr_b16 a[212:213], v6 offset:8208
    ds_read_b64_tr_b16 a[214:215], v6 offset:9232
    s_branch Lt_73
Lt_71:
    ds_read_b64_tr_b16 a[160:161], v6 offset:0
    ds_read_b64_tr_b16 a[162:163], v6 offset:1024
    ds_read_b64_tr_b16 a[164:165], v6 offset:8192
    ds_read_b64_tr_b16 a[166:167], v6 offset:9216
    ds_read_b64_tr_b16 a[224:225], v6 offset:16
    ds_read_b64_tr_b16 a[226:227], v6 offset:1040
    ds_read_b64_tr_b16 a[228:229], v6 offset:8208
    ds_read_b64_tr_b16 a[230:231], v6 offset:9232
    s_branch Lt_73
Lt_72:
    ds_read_b64_tr_b16 a[176:177], v6 offset:0
    ds_read_b64_tr_b16 a[178:179], v6 offset:1024
    ds_read_b64_tr_b16 a[180:181], v6 offset:8192
    ds_read_b64_tr_b16 a[182:183], v6 offset:9216
    ds_read_b64_tr_b16 a[240:241], v6 offset:16
    ds_read_b64_tr_b16 a[242:243], v6 offset:1040
    ds_read_b64_tr_b16 a[244:245], v6 offset:8208
    ds_read_b64_tr_b16 a[246:247], v6 offset:9232
Lt_73:
    s_waitcnt lgkmcnt(0)
    s_waitcnt vmcnt(24)
    s_barrier
    s_cmp_eq_u32 s6, 1
    s_cbranch_scc1 Lt_75
    s_cmp_eq_u32 s6, 2
    s_cbranch_scc1 Lt_76
    s_cmp_eq_u32 s6, 3
    s_cbranch_scc1 Lt_77
    ds_read_b64_tr_b16 a[136:137], v6 offset:16384
    ds_read_b64_tr_b16 a[138:139], v6 offset:17408
    ds_read_b64_tr_b16 a[140:141], v6 offset:24576
    ds_read_b64_tr_b16 a[142:143], v6 offset:25600
    ds_read_b64_tr_b16 a[200:201], v6 offset:16400
    ds_read_b64_tr_b16 a[202:203], v6 offset:17424
    ds_read_b64_tr_b16 a[204:205], v6 offset:24592
    ds_read_b64_tr_b16 a[206:207], v6 offset:25616
    s_branch Lt_78
Lt_75:
    ds_read_b64_tr_b16 a[152:153], v6 offset:16384
    ds_read_b64_tr_b16 a[154:155], v6 offset:17408
    ds_read_b64_tr_b16 a[156:157], v6 offset:24576
    ds_read_b64_tr_b16 a[158:159], v6 offset:25600
    ds_read_b64_tr_b16 a[216:217], v6 offset:16400
    ds_read_b64_tr_b16 a[218:219], v6 offset:17424
    ds_read_b64_tr_b16 a[220:221], v6 offset:24592
    ds_read_b64_tr_b16 a[222:223], v6 offset:25616
    s_branch Lt_78
Lt_76:
    ds_read_b64_tr_b16 a[168:169], v6 offset:16384
    ds_read_b64_tr_b16 a[170:171], v6 offset:17408
    ds_read_b64_tr_b16 a[172:173], v6 offset:24576
    ds_read_b64_tr_b16 a[174:175], v6 offset:25600
    ds_read_b64_tr_b16 a[232:233], v6 offset:16400
    ds_read_b64_tr_b16 a[234:235], v6 offset:17424
    ds_read_b64_tr_b16 a[236:237], v6 offset:24592
    ds_read_b64_tr_b16 a[238:239], v6 offset:25616
    s_branch Lt_78
Lt_77:
    ds_read_b64_tr_b16 a[184:185], v6 offset:16384
    ds_read_b64_tr_b16 a[186:187], v6 offset:17408
    ds_read_b64_tr_b16 a[188:189], v6 offset:24576
    ds_read_b64_tr_b16 a[190:191], v6 offset:25600
    ds_read_b64_tr_b16 a[248:249], v6 offset:16400
    ds_read_b64_tr_b16 a[250:251], v6 offset:17424
    ds_read_b64_tr_b16 a[252:253], v6 offset:24592
    ds_read_b64_tr_b16 a[254:255], v6 offset:25616
Lt_78:
    s_add_u32 m0, s41, 0
    s_add_u32 s42, s40, 0
    buffer_load_dwordx4 v10, s[20:23], s42 offen lds
    s_add_u32 m0, s41, 1024
    s_add_u32 s42, s40, 65536
    buffer_load_dwordx4 v10, s[20:23], s42 offen lds
    s_add_u32 m0, s41, 2048
    s_add_u32 s42, s40, 131072
    buffer_load_dwordx4 v10, s[20:23], s42 offen lds
    s_add_u32 m0, s41, 3072
    s_add_u32 s42, s40, 196608
    buffer_load_dwordx4 v10, s[20:23], s42 offen lds
    s_waitcnt lgkmcnt(0)
    s_waitcnt vmcnt(24)
    s_barrier
    s_cmp_eq_u32 s6, 1
    s_cbranch_scc1 Lt_80
    s_cmp_eq_u32 s6, 2
    s_cbranch_scc1 Lt_81
    s_cmp_eq_u32 s6, 3
    s_cbranch_scc1 Lt_82
    ds_read_b64_tr_b16 a[144:145], v6 offset:32768
    ds_read_b64_tr_b16 a[146:147], v6 offset:33792
    ds_read_b64_tr_b16 a[148:149], v6 offset:40960
    ds_read_b64_tr_b16 a[150:151], v6 offset:41984
    ds_read_b64_tr_b16 a[208:209], v6 offset:32784
    ds_read_b64_tr_b16 a[210:211], v6 offset:33808
    ds_read_b64_tr_b16 a[212:213], v6 offset:40976
    ds_read_b64_tr_b16 a[214:215], v6 offset:42000
    s_branch Lt_83
Lt_80:
    ds_read_b64_tr_b16 a[128:129], v6 offset:32768
    ds_read_b64_tr_b16 a[130:131], v6 offset:33792
    ds_read_b64_tr_b16 a[132:133], v6 offset:40960
    ds_read_b64_tr_b16 a[134:135], v6 offset:41984
    ds_read_b64_tr_b16 a[192:193], v6 offset:32784
    ds_read_b64_tr_b16 a[194:195], v6 offset:33808
    ds_read_b64_tr_b16 a[196:197], v6 offset:40976
    ds_read_b64_tr_b16 a[198:199], v6 offset:42000
    s_branch Lt_83
Lt_81:
    ds_read_b64_tr_b16 a[176:177], v6 offset:32768
    ds_read_b64_tr_b16 a[178:179], v6 offset:33792
    ds_read_b64_tr_b16 a[180:181], v6 offset:40960
    ds_read_b64_tr_b16 a[182:183], v6 offset:41984
    ds_read_b64_tr_b16 a[240:241], v6 offset:32784
    ds_read_b64_tr_b16 a[242:243], v6 offset:33808
    ds_read_b64_tr_b16 a[244:245], v6 offset:40976
    ds_read_b64_tr_b16 a[246:247], v6 offset:42000
    s_branch Lt_83
Lt_82:
    ds_read_b64_tr_b16 a[160:161], v6 offset:32768
    ds_read_b64_tr_b16 a[162:163], v6 offset:33792
    ds_read_b64_tr_b16 a[164:165], v6 offset:40960
    ds_read_b64_tr_b16 a[166:167], v6 offset:41984
    ds_read_b64_tr_b16 a[224:225], v6 offset:32784
    ds_read_b64_tr_b16 a[226:227], v6 offset:33808
    ds_read_b64_tr_b16 a[228:229], v6 offset:40976
    ds_read_b64_tr_b16 a[230:231], v6 offset:42000
Lt_83:
    s_add_u32 m0, s41, 16384
    s_add_u32 s42, s40, 2097152
    buffer_load_dwordx4 v10, s[20:23], s42 offen lds
    s_add_u32 m0, s41, 17408
    s_add_u32 s42, s40, 2162688
    buffer_load_dwordx4 v10, s[20:23], s42 offen lds
    s_add_u32 m0, s41, 18432
    s_add_u32 s42, s40, 2228224
    buffer_load_dwordx4 v10, s[20:23], s42 offen lds
    s_add_u32 m0, s41, 19456
    s_add_u32 s42, s40, 2293760
    buffer_load_dwordx4 v10, s[20:23], s42 offen lds
    s_waitcnt lgkmcnt(0)
    s_waitcnt vmcnt(24)
    s_barrier
    s_cmp_eq_u32 s6, 1
    s_cbranch_scc1 Lt_85
    s_cmp_eq_u32 s6, 2
    s_cbranch_scc1 Lt_86
    s_cmp_eq_u32 s6, 3
    s_cbranch_scc1 Lt_87
    ds_read_b64_tr_b16 a[152:153], v6 offset:49152
    ds_read_b64_tr_b16 a[154:155], v6 offset:50176
    ds_read_b64_tr_b16 a[156:157], v6 offset:57344
    ds_read_b64_tr_b16 a[158:159], v6 offset:58368
    ds_read_b64_tr_b16 a[216:217], v6 offset:49168
    ds_read_b64_tr_b16 a[218:219], v6 offset:50192
    ds_read_b64_tr_b16 a[220:221], v6 offset:57360
    ds_read_b64_tr_b16 a[222:223], v6 offset:58384
    s_branch Lt_88
Lt_85:
    ds_read_b64_tr_b16 a[136:137], v6 offset:49152
    ds_read_b64_tr_b16 a[138:139], v6 offset:50176
    ds_read_b64_tr_b16 a[140:141], v6 offset:57344
    ds_read_b64_tr_b16 a[142:143], v6 offset:58368
    ds_read_b64_tr_b16 a[200:201], v6 offset:49168
    ds_read_b64_tr_b16 a[202:203], v6 offset:50192
    ds_read_b64_tr_b16 a[204:205], v6 offset:57360
    ds_read_b64_tr_b16 a[206:207], v6 offset:58384
    s_branch Lt_88
Lt_86:
    ds_read_b64_tr_b16 a[184:185], v6 offset:49152
    ds_read_b64_tr_b16 a[186:187], v6 offset:50176
    ds_read_b64_tr_b16 a[188:189], v6 offset:57344
    ds_read_b64_tr_b16 a[190:191], v6 offset:58368
    ds_read_b64_tr_b16 a[248:249], v6 offset:49168
    ds_read_b64_tr_b16 a[250:251], v6 offset:50192
    ds_read_b64_tr_b16 a[252:253], v6 offset:57360
    ds_read_b64_tr_b16 a[254:255], v6 offset:58384
    s_branch Lt_88
Lt_87:
    ds_read_b64_tr_b16 a[168:169], v6 offset:49152
    ds_read_b64_tr_b16 a[170:171], v6 offset:50176
    ds_read_b64_tr_b16 a[172:173], v6 offset:57344
    ds_read_b64_tr_b16 a[174:175], v6 offset:58368
    ds_read_b64_tr_b16 a[232:233], v6 offset:49168
    ds_read_b64_tr_b16 a[234:235], v6 offset:50192
    ds_read_b64_tr_b16 a[236:237], v6 offset:57360
    ds_read_b64_tr_b16 a[238:239], v6 offset:58384
Lt_88:
    v_or_b32 v29, 64, v28
    v_cmp_eq_u32 vcc, s62, v28
    s_nop 1
    v_cndmask_b32 v28, v28, v29, vcc
    buffer_store_dword v28, v12, s[8:11], s46 offen sc1
    buffer_load_dword v30, off, s[28:31], 0 sc1
    s_add_u32 m0, s41, 32768
    s_add_u32 s42, s40, 16384
    buffer_load_dwordx4 v10, s[20:23], s42 offen lds
    s_add_u32 m0, s41, 33792
    s_add_u32 s42, s40, 81920
    buffer_load_dwordx4 v10, s[20:23], s42 offen lds
    s_add_u32 m0, s41, 34816
    s_add_u32 s42, s40, 147456
    buffer_load_dwordx4 v10, s[20:23], s42 offen lds
    s_add_u32 m0, s41, 35840
    s_add_u32 s42, s40, 212992
    buffer_load_dwordx4 v10, s[20:23], s42 offen lds
    s_waitcnt lgkmcnt(0)
    s_waitcnt vmcnt(26)
    s_barrier
    s_cmp_eq_u32 s6, 1
    s_cbranch_scc1 Lt_90
    s_cmp_eq_u32 s6, 2
    s_cbranch_scc1 Lt_91
    s_cmp_eq_u32 s6, 3
    s_cbranch_scc1 Lt_92
    ds_read_b64_tr_b16 a[160:161], v7 offset:0
    ds_read_b64_tr_b16 a[162:163], v7 offset:1024
    ds_read_b64_tr_b16 a[164:165], v7 offset:8192
    ds_read_b64_tr_b16 a[166:167], v7 offset:9216
    ds_read_b64_tr_b16 a[224:225], v7 offset:16
    ds_read_b64_tr_b16 a[226:227], v7 offset:1040
    ds_read_b64_tr_b16 a[228:229], v7 offset:8208
    ds_read_b64_tr_b16 a[230:231], v7 offset:9232
    s_branch Lt_93
Lt_90:
    ds_read_b64_tr_b16 a[176:177], v7 offset:0
    ds_read_b64_tr_b16 a[178:179], v7 offset:1024
    ds_read_b64_tr_b16 a[180:181], v7 offset:8192
    ds_read_b64_tr_b16 a[182:183], v7 offset:9216
    ds_read_b64_tr_b16 a[240:241], v7 offset:16
    ds_read_b64_tr_b16 a[242:243], v7 offset:1040
    ds_read_b64_tr_b16 a[244:245], v7 offset:8208
    ds_read_b64_tr_b16 a[246:247], v7 offset:9232
    s_branch Lt_93
Lt_91:
    ds_read_b64_tr_b16 a[128:129], v7 offset:0
    ds_read_b64_tr_b16 a[130:131], v7 offset:1024
    ds_read_b64_tr_b16 a[132:133], v7 offset:8192
    ds_read_b64_tr_b16 a[134:135], v7 offset:9216
    ds_read_b64_tr_b16 a[192:193], v7 offset:16
    ds_read_b64_tr_b16 a[194:195], v7 offset:1040
    ds_read_b64_tr_b16 a[196:197], v7 offset:8208
    ds_read_b64_tr_b16 a[198:199], v7 offset:9232
    s_branch Lt_93
Lt_92:
    ds_read_b64_tr_b16 a[144:145], v7 offset:0
    ds_read_b64_tr_b16 a[146:147], v7 offset:1024
    ds_read_b64_tr_b16 a[148:149], v7 offset:8192
    ds_read_b64_tr_b16 a[150:151], v7 offset:9216
    ds_read_b64_tr_b16 a[208:209], v7 offset:16
    ds_read_b64_tr_b16 a[210:211], v7 offset:1040
    ds_read_b64_tr_b16 a[212:213], v7 offset:8208
    ds_read_b64_tr_b16 a[214:215], v7 offset:9232
Lt_93:
    s_add_u32 m0, s41, 49152
    s_add_u32 s42, s40, 2113536
    buffer_load_dwordx4 v10, s[20:23], s42 offen lds
    s_add_u32 m0, s41, 50176
    s_add_u32 s42, s40, 2179072
    buffer_load_dwordx4 v10, s[20:23], s42 offen lds
    s_add_u32 m0, s41, 51200
    s_add_u32 s42, s40, 2244608
    buffer_load_dwordx4 v10, s[20:23], s42 offen lds
    s_add_u32 m0, s41, 52224
    s_add_u32 s42, s40, 2310144
    buffer_load_dwordx4 v10, s[20:23], s42 offen lds
    s_waitcnt lgkmcnt(0)
    s_waitcnt vmcnt(26)
    s_barrier
    s_cmp_eq_u32 s6, 1
    s_cbranch_scc1 Lt_95
    s_cmp_eq_u32 s6, 2
    s_cbranch_scc1 Lt_96
    s_cmp_eq_u32 s6, 3
    s_cbranch_scc1 Lt_97
    ds_read_b64_tr_b16 a[168:169], v7 offset:16384
    ds_read_b64_tr_b16 a[170:171], v7 offset:17408
    ds_read_b64_tr_b16 a[172:173], v7 offset:24576
    ds_read_b64_tr_b16 a[174:175], v7 offset:25600
    ds_read_b64_tr_b16 a[232:233], v7 offset:16400
    ds_read_b64_tr_b16 a[234:235], v7 offset:17424
    ds_read_b64_tr_b16 a[236:237], v7 offset:24592
    ds_read_b64_tr_b16 a[238:239], v7 offset:25616
    s_branch Lt_98
Lt_95:
    ds_read_b64_tr_b16 a[184:185], v7 offset:16384
    ds_read_b64_tr_b16 a[186:187], v7 offset:17408
    ds_read_b64_tr_b16 a[188:189], v7 offset:24576
    ds_read_b64_tr_b16 a[190:191], v7 offset:25600
    ds_read_b64_tr_b16 a[248:249], v7 offset:16400
    ds_read_b64_tr_b16 a[250:251], v7 offset:17424
    ds_read_b64_tr_b16 a[252:253], v7 offset:24592
    ds_read_b64_tr_b16 a[254:255], v7 offset:25616
    s_branch Lt_98
Lt_96:
    ds_read_b64_tr_b16 a[136:137], v7 offset:16384
    ds_read_b64_tr_b16 a[138:139], v7 offset:17408
    ds_read_b64_tr_b16 a[140:141], v7 offset:24576
    ds_read_b64_tr_b16 a[142:143], v7 offset:25600
    ds_read_b64_tr_b16 a[200:201], v7 offset:16400
    ds_read_b64_tr_b16 a[202:203], v7 offset:17424
    ds_read_b64_tr_b16 a[204:205], v7 offset:24592
    ds_read_b64_tr_b16 a[206:207], v7 offset:25616
    s_branch Lt_98
Lt_97:
    ds_read_b64_tr_b16 a[152:153], v7 offset:16384
    ds_read_b64_tr_b16 a[154:155], v7 offset:17408
    ds_read_b64_tr_b16 a[156:157], v7 offset:24576
    ds_read_b64_tr_b16 a[158:159], v7 offset:25600
    ds_read_b64_tr_b16 a[216:217], v7 offset:16400
    ds_read_b64_tr_b16 a[218:219], v7 offset:17424
    ds_read_b64_tr_b16 a[220:221], v7 offset:24592
    ds_read_b64_tr_b16 a[222:223], v7 offset:25616
Lt_98:
    s_add_u32 m0, s41, 65536
    s_add_u32 s42, s40, 524288
    buffer_load_dwordx4 v10, s[20:23], s42 offen lds
    s_add_u32 m0, s41, 66560
    s_add_u32 s42, s40, 589824
    buffer_load_dwordx4 v10, s[20:23], s42 offen lds
    s_add_u32 m0, s41, 67584
    s_add_u32 s42, s40, 655360
    buffer_load_dwordx4 v10, s[20:23], s42 offen lds
    s_add_u32 m0, s41, 68608
    s_add_u32 s42, s40, 720896
    buffer_load_dwordx4 v10, s[20:23], s42 offen lds
    s_waitcnt lgkmcnt(0)
    s_waitcnt vmcnt(26)
    s_barrier
    s_cmp_eq_u32 s6, 1
    s_cbranch_scc1 Lt_100
    s_cmp_eq_u32 s6, 2
    s_cbranch_scc1 Lt_101
    s_cmp_eq_u32 s6, 3
    s_cbranch_scc1 Lt_102
    ds_read_b64_tr_b16 a[176:177], v7 offset:32768
    ds_read_b64_tr_b16 a[178:179], v7 offset:33792
    ds_read_b64_tr_b16 a[180:181], v7 offset:40960
    ds_read_b64_tr_b16 a[182:183], v7 offset:41984
    ds_read_b64_tr_b16 a[240:241], v7 offset:32784
    ds_read_b64_tr_b16 a[242:243], v7 offset:33808
    ds_read_b64_tr_b16 a[244:245], v7 offset:40976
    ds_read_b64_tr_b16 a[246:247], v7 offset:42000
    s_branch Lt_103
Lt_100:
    ds_read_b64_tr_b16 a[160:161], v7 offset:32768
    ds_read_b64_tr_b16 a[162:163], v7 offset:33792
    ds_read_b64_tr_b16 a[164:165], v7 offset:40960
    ds_read_b64_tr_b16 a[166:167], v7 offset:41984
    ds_read_b64_tr_b16 a[224:225], v7 offset:32784
    ds_read_b64_tr_b16 a[226:227], v7 offset:33808
    ds_read_b64_tr_b16 a[228:229], v7 offset:40976
    ds_read_b64_tr_b16 a[230:231], v7 offset:42000
    s_branch Lt_103
Lt_101:
    ds_read_b64_tr_b16 a[144:145], v7 offset:32768
    ds_read_b64_tr_b16 a[146:147], v7 offset:33792
    ds_read_b64_tr_b16 a[148:149], v7 offset:40960
    ds_read_b64_tr_b16 a[150:151], v7 offset:41984
    ds_read_b64_tr_b16 a[208:209], v7 offset:32784
    ds_read_b64_tr_b16 a[210:211], v7 offset:33808
    ds_read_b64_tr_b16 a[212:213], v7 offset:40976
    ds_read_b64_tr_b16 a[214:215], v7 offset:42000
    s_branch Lt_103
Lt_102:
    ds_read_b64_tr_b16 a[128:129], v7 offset:32768
    ds_read_b64_tr_b16 a[130:131], v7 offset:33792
    ds_read_b64_tr_b16 a[132:133], v7 offset:40960
    ds_read_b64_tr_b16 a[134:135], v7 offset:41984
    ds_read_b64_tr_b16 a[192:193], v7 offset:32784
    ds_read_b64_tr_b16 a[194:195], v7 offset:33808
    ds_read_b64_tr_b16 a[196:197], v7 offset:40976
    ds_read_b64_tr_b16 a[198:199], v7 offset:42000
Lt_103:
    s_add_u32 m0, s41, 81920
    s_add_u32 s42, s40, 2621440
    buffer_load_dwordx4 v10, s[20:23], s42 offen lds
    s_add_u32 m0, s41, 82944
    s_add_u32 s42, s40, 2686976
    buffer_load_dwordx4 v10, s[20:23], s42 offen lds
    s_add_u32 m0, s41, 83968
    s_add_u32 s42, s40, 2752512
    buffer_load_dwordx4 v10, s[20:23], s42 offen lds
    s_add_u32 m0, s41, 84992
    s_add_u32 s42, s40, 2818048
    buffer_load_dwordx4 v10, s[20:23], s42 offen lds
    s_waitcnt lgkmcnt(0)
    s_waitcnt vmcnt(26)
    s_barrier
    s_cmp_eq_u32 s6, 1
    s_cbranch_scc1 Lt_105
    s_cmp_eq_u32 s6, 2
    s_cbranch_scc1 Lt_106
    s_cmp_eq_u32 s6, 3
    s_cbranch_scc1 Lt_107
    ds_read_b64_tr_b16 a[184:185], v7 offset:49152
    ds_read_b64_tr_b16 a[186:187], v7 offset:50176
    ds_read_b64_tr_b16 a[188:189], v7 offset:57344
    ds_read_b64_tr_b16 a[190:191], v7 offset:58368
    ds_read_b64_tr_b16 a[248:249], v7 offset:49168
    ds_read_b64_tr_b16 a[250:251], v7 offset:50192
    ds_read_b64_tr_b16 a[252:253], v7 offset:57360
    ds_read_b64_tr_b16 a[254:255], v7 offset:58384
    s_branch Lt_108
Lt_105:
    ds_read_b64_tr_b16 a[168:169], v7 offset:49152
    ds_read_b64_tr_b16 a[170:171], v7 offset:50176
    ds_read_b64_tr_b16 a[172:173], v7 offset:57344
    ds_read_b64_tr_b16 a[174:175], v7 offset:58368
    ds_read_b64_tr_b16 a[232:233], v7 offset:49168
    ds_read_b64_tr_b16 a[234:235], v7 offset:50192
    ds_read_b64_tr_b16 a[236:237], v7 offset:57360
    ds_read_b64_tr_b16 a[238:239], v7 offset:58384
    s_branch Lt_108
Lt_106:
    ds_read_b64_tr_b16 a[152:153], v7 offset:49152
    ds_read_b64_tr_b16 a[154:155], v7 offset:50176
    ds_read_b64_tr_b16 a[156:157], v7 offset:57344
    ds_read_b64_tr_b16 a[158:159], v7 offset:58368
    ds_read_b64_tr_b16 a[216:217], v7 offset:49168
    ds_read_b64_tr_b16 a[218:219], v7 offset:50192
    ds_read_b64_tr_b16 a[220:221], v7 offset:57360
    ds_read_b64_tr_b16 a[222:223], v7 offset:58384
    s_branch Lt_108
Lt_107:
    ds_read_b64_tr_b16 a[136:137], v7 offset:49152
    ds_read_b64_tr_b16 a[138:139], v7 offset:50176
    ds_read_b64_tr_b16 a[140:141], v7 offset:57344
    ds_read_b64_tr_b16 a[142:143], v7 offset:58368
    ds_read_b64_tr_b16 a[200:201], v7 offset:49168
    ds_read_b64_tr_b16 a[202:203], v7 offset:50192
    ds_read_b64_tr_b16 a[204:205], v7 offset:57360
    ds_read_b64_tr_b16 a[206:207], v7 offset:58384
Lt_108:
    s_add_u32 m0, s41, 98304
    s_add_u32 s42, s40, 540672
    buffer_load_dwordx4 v10, s[20:23], s42 offen lds
    s_add_u32 m0, s41, 99328
    s_add_u32 s42, s40, 606208
    buffer_load_dwordx4 v10, s[20:23], s42 offen lds
    s_add_u32 m0, s41, 100352
    s_add_u32 s42, s40, 671744
    buffer_load_dwordx4 v10, s[20:23], s42 offen lds
    s_add_u32 m0, s41, 101376
    s_add_u32 s42, s40, 737280
    buffer_load_dwordx4 v10, s[20:23], s42 offen lds
    s_waitcnt lgkmcnt(0)
    s_waitcnt vmcnt(26)
    s_barrier
    s_cmp_eq_u32 s6, 1
    s_cbranch_scc1 Lt_110
    s_cmp_eq_u32 s6, 2
    s_cbranch_scc1 Lt_111
    s_cmp_eq_u32 s6, 3
    s_cbranch_scc1 Lt_112
    ds_read_b64_tr_b16 v[128:129], v8 offset:0
    ds_read_b64_tr_b16 v[130:131], v8 offset:1024
    ds_read_b64_tr_b16 v[132:133], v8 offset:8192
    ds_read_b64_tr_b16 v[134:135], v8 offset:9216
    ds_read_b64_tr_b16 v[192:193], v8 offset:32
    ds_read_b64_tr_b16 v[194:195], v8 offset:1056
    ds_read_b64_tr_b16 v[196:197], v8 offset:8224
    ds_read_b64_tr_b16 v[198:199], v8 offset:9248
    s_branch Lt_113
Lt_110:
    ds_read_b64_tr_b16 v[144:145], v8 offset:0
    ds_read_b64_tr_b16 v[146:147], v8 offset:1024
    ds_read_b64_tr_b16 v[148:149], v8 offset:8192
    ds_read_b64_tr_b16 v[150:151], v8 offset:9216
    ds_read_b64_tr_b16 v[208:209], v8 offset:32
    ds_read_b64_tr_b16 v[210:211], v8 offset:1056
    ds_read_b64_tr_b16 v[212:213], v8 offset:8224
    ds_read_b64_tr_b16 v[214:215], v8 offset:9248
    s_branch Lt_113
Lt_111:
    ds_read_b64_tr_b16 v[160:161], v8 offset:0
    ds_read_b64_tr_b16 v[162:163], v8 offset:1024
    ds_read_b64_tr_b16 v[164:165], v8 offset:8192
    ds_read_b64_tr_b16 v[166:167], v8 offset:9216
    ds_read_b64_tr_b16 v[224:225], v8 offset:32
    ds_read_b64_tr_b16 v[226:227], v8 offset:1056
    ds_read_b64_tr_b16 v[228:229], v8 offset:8224
    ds_read_b64_tr_b16 v[230:231], v8 offset:9248
    s_branch Lt_113
Lt_112:
    ds_read_b64_tr_b16 v[176:177], v8 offset:0
    ds_read_b64_tr_b16 v[178:179], v8 offset:1024
    ds_read_b64_tr_b16 v[180:181], v8 offset:8192
    ds_read_b64_tr_b16 v[182:183], v8 offset:9216
    ds_read_b64_tr_b16 v[240:241], v8 offset:32
    ds_read_b64_tr_b16 v[242:243], v8 offset:1056
    ds_read_b64_tr_b16 v[244:245], v8 offset:8224
    ds_read_b64_tr_b16 v[246:247], v8 offset:9248
Lt_113:
    s_add_u32 m0, s41, 114688
    s_add_u32 s42, s40, 2637824
    buffer_load_dwordx4 v10, s[20:23], s42 offen lds
    s_add_u32 m0, s41, 115712
    s_add_u32 s42, s40, 2703360
    buffer_load_dwordx4 v10, s[20:23], s42 offen lds
    s_add_u32 m0, s41, 116736
    s_add_u32 s42, s40, 2768896
    buffer_load_dwordx4 v10, s[20:23], s42 offen lds
    s_add_u32 m0, s41, 117760
    s_add_u32 s42, s40, 2834432
    buffer_load_dwordx4 v10, s[20:23], s42 offen lds
    s_waitcnt lgkmcnt(0)
    s_waitcnt vmcnt(26)
    s_barrier
    s_cmp_eq_u32 s6, 1
    s_cbranch_scc1 Lt_115
    s_cmp_eq_u32 s6, 2
    s_cbranch_scc1 Lt_116
    s_cmp_eq_u32 s6, 3
    s_cbranch_scc1 Lt_117
    ds_read_b64_tr_b16 v[136:137], v8 offset:16384
    ds_read_b64_tr_b16 v[138:139], v8 offset:17408
    ds_read_b64_tr_b16 v[140:141], v8 offset:24576
    ds_read_b64_tr_b16 v[142:143], v8 offset:25600
    ds_read_b64_tr_b16 v[200:201], v8 offset:16416
    ds_read_b64_tr_b16 v[202:203], v8 offset:17440
    ds_read_b64_tr_b16 v[204:205], v8 offset:24608
    ds_read_b64_tr_b16 v[206:207], v8 offset:25632
    s_branch Lt_118
Lt_115:
    ds_read_b64_tr_b16 v[152:153], v8 offset:16384
    ds_read_b64_tr_b16 v[154:155], v8 offset:17408
    ds_read_b64_tr_b16 v[156:157], v8 offset:24576
    ds_read_b64_tr_b16 v[158:159], v8 offset:25600
    ds_read_b64_tr_b16 v[216:217], v8 offset:16416
    ds_read_b64_tr_b16 v[218:219], v8 offset:17440
    ds_read_b64_tr_b16 v[220:221], v8 offset:24608
    ds_read_b64_tr_b16 v[222:223], v8 offset:25632
    s_branch Lt_118
Lt_116:
    ds_read_b64_tr_b16 v[168:169], v8 offset:16384
    ds_read_b64_tr_b16 v[170:171], v8 offset:17408
    ds_read_b64_tr_b16 v[172:173], v8 offset:24576
    ds_read_b64_tr_b16 v[174:175], v8 offset:25600
    ds_read_b64_tr_b16 v[232:233], v8 offset:16416
    ds_read_b64_tr_b16 v[234:235], v8 offset:17440
    ds_read_b64_tr_b16 v[236:237], v8 offset:24608
    ds_read_b64_tr_b16 v[238:239], v8 offset:25632
    s_branch Lt_118
Lt_117:
    ds_read_b64_tr_b16 v[184:185], v8 offset:16384
    ds_read_b64_tr_b16 v[186:187], v8 offset:17408
    ds_read_b64_tr_b16 v[188:189], v8 offset:24576
    ds_read_b64_tr_b16 v[190:191], v8 offset:25600
    ds_read_b64_tr_b16 v[248:249], v8 offset:16416
    ds_read_b64_tr_b16 v[250:251], v8 offset:17440
    ds_read_b64_tr_b16 v[252:253], v8 offset:24608
    ds_read_b64_tr_b16 v[254:255], v8 offset:25632
Lt_118:
    s_add_u32 m0, s41, 0
    s_add_u32 s42, s40, 0
    buffer_load_dwordx4 v10, s[12:15], s42 offen lds
    s_add_u32 m0, s41, 1024
    s_add_u32 s42, s40, 65536
    buffer_load_dwordx4 v10, s[12:15], s42 offen lds
    s_add_u32 m0, s41, 2048
    s_add_u32 s42, s40, 131072
    buffer_load_dwordx4 v10, s[12:15], s42 offen lds
    s_add_u32 m0, s41, 3072
    s_add_u32 s42, s40, 196608
    buffer_load_dwordx4 v10, s[12:15], s42 offen lds
    s_waitcnt lgkmcnt(0)
    s_waitcnt vmcnt(24)
    s_barrier
    s_cmp_eq_u32 s6, 1
    s_cbranch_scc1 Lt_120
    s_cmp_eq_u32 s6, 2
    s_cbranch_scc1 Lt_121
    s_cmp_eq_u32 s6, 3
    s_cbranch_scc1 Lt_122
    ds_read_b64_tr_b16 v[144:145], v8 offset:32768
    ds_read_b64_tr_b16 v[146:147], v8 offset:33792
    ds_read_b64_tr_b16 v[148:149], v8 offset:40960
    ds_read_b64_tr_b16 v[150:151], v8 offset:41984
    ds_read_b64_tr_b16 v[208:209], v8 offset:32800
    ds_read_b64_tr_b16 v[210:211], v8 offset:33824
    ds_read_b64_tr_b16 v[212:213], v8 offset:40992
    ds_read_b64_tr_b16 v[214:215], v8 offset:42016
    s_branch Lt_123
Lt_120:
    ds_read_b64_tr_b16 v[128:129], v8 offset:32768
    ds_read_b64_tr_b16 v[130:131], v8 offset:33792
    ds_read_b64_tr_b16 v[132:133], v8 offset:40960
    ds_read_b64_tr_b16 v[134:135], v8 offset:41984
    ds_read_b64_tr_b16 v[192:193], v8 offset:32800
    ds_read_b64_tr_b16 v[194:195], v8 offset:33824
    ds_read_b64_tr_b16 v[196:197], v8 offset:40992
    ds_read_b64_tr_b16 v[198:199], v8 offset:42016
    s_branch Lt_123
Lt_121:
    ds_read_b64_tr_b16 v[176:177], v8 offset:32768
    ds_read_b64_tr_b16 v[178:179], v8 offset:33792
    ds_read_b64_tr_b16 v[180:181], v8 offset:40960
    ds_read_b64_tr_b16 v[182:183], v8 offset:41984
    ds_read_b64_tr_b16 v[240:241], v8 offset:32800
    ds_read_b64_tr_b16 v[242:243], v8 offset:33824
    ds_read_b64_tr_b16 v[244:245], v8 offset:40992
    ds_read_b64_tr_b16 v[246:247], v8 offset:42016
    s_branch Lt_123
Lt_122:
    ds_read_b64_tr_b16 v[160:161], v8 offset:32768
    ds_read_b64_tr_b16 v[162:163], v8 offset:33792
    ds_read_b64_tr_b16 v[164:165], v8 offset:40960
    ds_read_b64_tr_b16 v[166:167], v8 offset:41984
    ds_read_b64_tr_b16 v[224:225], v8 offset:32800
    ds_read_b64_tr_b16 v[226:227], v8 offset:33824
    ds_read_b64_tr_b16 v[228:229], v8 offset:40992
    ds_read_b64_tr_b16 v[230:231], v8 offset:42016
Lt_123:
    s_add_u32 m0, s41, 16384
    s_add_u32 s42, s40, 2097152
    buffer_load_dwordx4 v10, s[12:15], s42 offen lds
    s_add_u32 m0, s41, 17408
    s_add_u32 s42, s40, 2162688
    buffer_load_dwordx4 v10, s[12:15], s42 offen lds
    s_add_u32 m0, s41, 18432
    s_add_u32 s42, s40, 2228224
    buffer_load_dwordx4 v10, s[12:15], s42 offen lds
    s_add_u32 m0, s41, 19456
    s_add_u32 s42, s40, 2293760
    buffer_load_dwordx4 v10, s[12:15], s42 offen lds
    s_waitcnt lgkmcnt(0)
    s_waitcnt vmcnt(24)
    s_barrier
    s_cmp_eq_u32 s6, 1
    s_cbranch_scc1 Lt_125
    s_cmp_eq_u32 s6, 2
    s_cbranch_scc1 Lt_126
    s_cmp_eq_u32 s6, 3
    s_cbranch_scc1 Lt_127
    ds_read_b64_tr_b16 v[152:153], v8 offset:49152
    ds_read_b64_tr_b16 v[154:155], v8 offset:50176
    ds_read_b64_tr_b16 v[156:157], v8 offset:57344
    ds_read_b64_tr_b16 v[158:159], v8 offset:58368
    ds_read_b64_tr_b16 v[216:217], v8 offset:49184
    ds_read_b64_tr_b16 v[218:219], v8 offset:50208
    ds_read_b64_tr_b16 v[220:221], v8 offset:57376
    ds_read_b64_tr_b16 v[222:223], v8 offset:58400
    s_branch Lt_128
Lt_125:
    ds_read_b64_tr_b16 v[136:137], v8 offset:49152
    ds_read_b64_tr_b16 v[138:139], v8 offset:50176
    ds_read_b64_tr_b16 v[140:141], v8 offset:57344
    ds_read_b64_tr_b16 v[142:143], v8 offset:58368
    ds_read_b64_tr_b16 v[200:201], v8 offset:49184
    ds_read_b64_tr_b16 v[202:203], v8 offset:50208
    ds_read_b64_tr_b16 v[204:205], v8 offset:57376
    ds_read_b64_tr_b16 v[206:207], v8 offset:58400
    s_branch Lt_128
Lt_126:
    ds_read_b64_tr_b16 v[184:185], v8 offset:49152
    ds_read_b64_tr_b16 v[186:187], v8 offset:50176
    ds_read_b64_tr_b16 v[188:189], v8 offset:57344
    ds_read_b64_tr_b16 v[190:191], v8 offset:58368
    ds_read_b64_tr_b16 v[248:249], v8 offset:49184
    ds_read_b64_tr_b16 v[250:251], v8 offset:50208
    ds_read_b64_tr_b16 v[252:253], v8 offset:57376
    ds_read_b64_tr_b16 v[254:255], v8 offset:58400
    s_branch Lt_128
Lt_127:
    ds_read_b64_tr_b16 v[168:169], v8 offset:49152
    ds_read_b64_tr_b16 v[170:171], v8 offset:50176
    ds_read_b64_tr_b16 v[172:173], v8 offset:57344
    ds_read_b64_tr_b16 v[174:175], v8 offset:58368
    ds_read_b64_tr_b16 v[232:233], v8 offset:49184
    ds_read_b64_tr_b16 v[234:235], v8 offset:50208
    ds_read_b64_tr_b16 v[236:237], v8 offset:57376
    ds_read_b64_tr_b16 v[238:239], v8 offset:58400
Lt_128:
    v_cmp_gt_u32 vcc, 32, v30
    s_cbranch_vccz Lsk_129
Lc_130:
    buffer_load_dword v23, v22, s[28:31], 0 offen offset:0 sc1
    s_waitcnt vmcnt(0)
    v_cmp_gt_u32 vcc, 32, v23
    s_cbranch_vccz Lcd_131
    s_sleep 2
    s_sub_u32 s98, s98, 1
    s_cbranch_scc1 L_end
    s_branch Lc_130
Lcd_131:
Lsk_129:
    s_cmp_lg_u32 s6, 0
    s_cbranch_scc1 Ltp_132
    s_getreg_b32 s3, hwreg(HW_REG_XCC_ID)
    s_and_b32 s3, s3, 15
    s_add_u32 s3, s3, 1
    v_mov_b32 v23, s3
    s_lshl_b32 s3, s4, 5
    s_add_u32 s3, s3, s5
    s_lshl_b32 s3, s3, 2
    s_add_u32 s3, s3, 573440
    s_mov_b64 exec, 1
    buffer_store_dword v23, v22, s[8:11], s3 offen offset:0 sc1
    s_mov_b64 exec, -1
Ltp_132:
    s_add_u32 m0, s41, 32768
    s_add_u32 s42, s40, 16384
    buffer_load_dwordx4 v10, s[12:15], s42 offen lds
    s_add_u32 m0, s41, 33792
    s_add_u32 s42, s40, 81920
    buffer_load_dwordx4 v10, s[12:15], s42 offen lds
    s_add_u32 m0, s41, 34816
    s_add_u32 s42, s40, 147456
    buffer_load_dwordx4 v10, s[12:15], s42 offen lds
    s_add_u32 m0, s41, 35840
    s_add_u32 s42, s40, 212992
    buffer_load_dwordx4 v10, s[12:15], s42 offen lds
    s_waitcnt lgkmcnt(0)
    s_waitcnt vmcnt(24)
    s_barrier
    s_cmp_eq_u32 s6, 1
    s_cbranch_scc1 Lt_134
    s_cmp_eq_u32 s6, 2
    s_cbranch_scc1 Lt_135
    s_cmp_eq_u32 s6, 3
    s_cbranch_scc1 Lt_136
    ds_read_b64_tr_b16 v[160:161], v9 offset:0
    ds_read_b64_tr_b16 v[162:163], v9 offset:1024
    ds_read_b64_tr_b16 v[164:165], v9 offset:8192
    ds_read_b64_tr_b16 v[166:167], v9 offset:9216
    ds_read_b64_tr_b16 v[224:225], v9 offset:32
    ds_read_b64_tr_b16 v[226:227], v9 offset:1056
    ds_read_b64_tr_b16 v[228:229], v9 offset:8224
    ds_read_b64_tr_b16 v[230:231], v9 offset:9248
    s_branch Lt_137
Lt_134:
    ds_read_b64_tr_b16 v[176:177], v9 offset:0
    ds_read_b64_tr_b16 v[178:179], v9 offset:1024
    ds_read_b64_tr_b16 v[180:181], v9 offset:8192
    ds_read_b64_tr_b16 v[182:183], v9 offset:9216
    ds_read_b64_tr_b16 v[240:241], v9 offset:32
    ds_read_b64_tr_b16 v[242:243], v9 offset:1056
    ds_read_b64_tr_b16 v[244:245], v9 offset:8224
    ds_read_b64_tr_b16 v[246:247], v9 offset:9248
    s_branch Lt_137
Lt_135:
    ds_read_b64_tr_b16 v[128:129], v9 offset:0
    ds_read_b64_tr_b16 v[130:131], v9 offset:1024
    ds_read_b64_tr_b16 v[132:133], v9 offset:8192
    ds_read_b64_tr_b16 v[134:135], v9 offset:9216
    ds_read_b64_tr_b16 v[192:193], v9 offset:32
    ds_read_b64_tr_b16 v[194:195], v9 offset:1056
    ds_read_b64_tr_b16 v[196:197], v9 offset:8224
    ds_read_b64_tr_b16 v[198:199], v9 offset:9248
    s_branch Lt_137
Lt_136:
    ds_read_b64_tr_b16 v[144:145], v9 offset:0
    ds_read_b64_tr_b16 v[146:147], v9 offset:1024
    ds_read_b64_tr_b16 v[148:149], v9 offset:8192
    ds_read_b64_tr_b16 v[150:151], v9 offset:9216
    ds_read_b64_tr_b16 v[208:209], v9 offset:32
    ds_read_b64_tr_b16 v[210:211], v9 offset:1056
    ds_read_b64_tr_b16 v[212:213], v9 offset:8224
    ds_read_b64_tr_b16 v[214:215], v9 offset:9248
Lt_137:
    s_add_u32 m0, s41, 49152
    s_add_u32 s42, s40, 2113536
    buffer_load_dwordx4 v10, s[12:15], s42 offen lds
    s_add_u32 m0, s41, 50176
    s_add_u32 s42, s40, 2179072
    buffer_load_dwordx4 v10, s[12:15], s42 offen lds
    s_add_u32 m0, s41, 51200
    s_add_u32 s42, s40, 2244608
    buffer_load_dwordx4 v10, s[12:15], s42 offen lds
    s_add_u32 m0, s41, 52224
    s_add_u32 s42, s40, 2310144
    buffer_load_dwordx4 v10, s[12:15], s42 offen lds
    s_waitcnt lgkmcnt(0)
    s_waitcnt vmcnt(24)
    s_barrier
    s_cmp_eq_u32 s6, 1
    s_cbranch_scc1 Lt_139
    s_cmp_eq_u32 s6, 2
    s_cbranch_scc1 Lt_140
    s_cmp_eq_u32 s6, 3
    s_cbranch_scc1 Lt_141
    ds_read_b64_tr_b16 v[168:169], v9 offset:16384
    ds_read_b64_tr_b16 v[170:171], v9 offset:17408
    ds_read_b64_tr_b16 v[172:173], v9 offset:24576
    ds_read_b64_tr_b16 v[174:175], v9 offset:25600
    ds_read_b64_tr_b16 v[232:233], v9 offset:16416
    ds_read_b64_tr_b16 v[234:235], v9 offset:17440
    ds_read_b64_tr_b16 v[236:237], v9 offset:24608
    ds_read_b64_tr_b16 v[238:239], v9 offset:25632
    s_branch Lt_142
Lt_139:
    ds_read_b64_tr_b16 v[184:185], v9 offset:16384
    ds_read_b64_tr_b16 v[186:187], v9 offset:17408
    ds_read_b64_tr_b16 v[188:189], v9 offset:24576
    ds_read_b64_tr_b16 v[190:191], v9 offset:25600
    ds_read_b64_tr_b16 v[248:249], v9 offset:16416
    ds_read_b64_tr_b16 v[250:251], v9 offset:17440
    ds_read_b64_tr_b16 v[252:253], v9 offset:24608
    ds_read_b64_tr_b16 v[254:255], v9 offset:25632
    s_branch Lt_142
Lt_140:
    ds_read_b64_tr_b16 v[136:137], v9 offset:16384
    ds_read_b64_tr_b16 v[138:139], v9 offset:17408
    ds_read_b64_tr_b16 v[140:141], v9 offset:24576
    ds_read_b64_tr_b16 v[142:143], v9 offset:25600
    ds_read_b64_tr_b16 v[200:201], v9 offset:16416
    ds_read_b64_tr_b16 v[202:203], v9 offset:17440
    ds_read_b64_tr_b16 v[204:205], v9 offset:24608
    ds_read_b64_tr_b16 v[206:207], v9 offset:25632
    s_branch Lt_142
Lt_141:
    ds_read_b64_tr_b16 v[152:153], v9 offset:16384
    ds_read_b64_tr_b16 v[154:155], v9 offset:17408
    ds_read_b64_tr_b16 v[156:157], v9 offset:24576
    ds_read_b64_tr_b16 v[158:159], v9 offset:25600
    ds_read_b64_tr_b16 v[216:217], v9 offset:16416
    ds_read_b64_tr_b16 v[218:219], v9 offset:17440
    ds_read_b64_tr_b16 v[220:221], v9 offset:24608
    ds_read_b64_tr_b16 v[222:223], v9 offset:25632
Lt_142:
    s_xor_b32 s3, s6, 0
    s_lshl_b32 s3, s3, 15
    s_add_u32 s3, s3, s55
    s_add_u32 s3, s3, 0
    s_add_u32 s42, s3, 8192
    buffer_load_dwordx2 v[48:49], v5, s[24:27], s3 offen offset:0
    buffer_load_dwordx2 v[50:51], v5, s[24:27], s3 offen offset:1024
    buffer_load_dwordx2 v[52:53], v5, s[24:27], s3 offen offset:2048
    buffer_load_dwordx2 v[54:55], v5, s[24:27], s3 offen offset:3072
    buffer_load_dwordx2 v[56:57], v5, s[24:27], s42 offen offset:0
    buffer_load_dwordx2 v[58:59], v5, s[24:27], s42 offen offset:1024
    buffer_load_dwordx2 v[60:61], v5, s[24:27], s42 offen offset:2048
    buffer_load_dwordx2 v[62:63], v5, s[24:27], s42 offen offset:3072
    s_add_u32 m0, s41, 65536
    s_add_u32 s42, s40, 524288
    buffer_load_dwordx4 v10, s[12:15], s42 offen lds
    s_add_u32 m0, s41, 66560
    s_add_u32 s42, s40, 589824
    buffer_load_dwordx4 v10, s[12:15], s42 offen lds
    s_add_u32 m0, s41, 67584
    s_add_u32 s42, s40, 655360
    buffer_load_dwordx4 v10, s[12:15], s42 offen lds
    s_add_u32 m0, s41, 68608
    s_add_u32 s42, s40, 720896
    buffer_load_dwordx4 v10, s[12:15], s42 offen lds
    s_waitcnt lgkmcnt(0)
    s_waitcnt vmcnt(32)
    s_barrier
    s_cmp_eq_u32 s6, 1
    s_cbranch_scc1 Lt_144
    s_cmp_eq_u32 s6, 2
    s_cbranch_scc1 Lt_145
    s_cmp_eq_u32 s6, 3
    s_cbranch_scc1 Lt_146
    ds_read_b64_tr_b16 v[176:177], v9 offset:32768
    ds_read_b64_tr_b16 v[178:179], v9 offset:33792
    ds_read_b64_tr_b16 v[180:181], v9 offset:40960
    ds_read_b64_tr_b16 v[182:183], v9 offset:41984
    ds_read_b64_tr_b16 v[240:241], v9 offset:32800
    ds_read_b64_tr_b16 v[242:243], v9 offset:33824
    ds_read_b64_tr_b16 v[244:245], v9 offset:40992
    ds_read_b64_tr_b16 v[246:247], v9 offset:42016
    s_branch Lt_147
Lt_144:
    ds_read_b64_tr_b16 v[160:161], v9 offset:32768
    ds_read_b64_tr_b16 v[162:163], v9 offset:33792
    ds_read_b64_tr_b16 v[164:165], v9 offset:40960
    ds_read_b64_tr_b16 v[166:167], v9 offset:41984
    ds_read_b64_tr_b16 v[224:225], v9 offset:32800
    ds_read_b64_tr_b16 v[226:227], v9 offset:33824
    ds_read_b64_tr_b16 v[228:229], v9 offset:40992
    ds_read_b64_tr_b16 v[230:231], v9 offset:42016
    s_branch Lt_147
Lt_145:
    ds_read_b64_tr_b16 v[144:145], v9 offset:32768
    ds_read_b64_tr_b16 v[146:147], v9 offset:33792
    ds_read_b64_tr_b16 v[148:149], v9 offset:40960
    ds_read_b64_tr_b16 v[150:151], v9 offset:41984
    ds_read_b64_tr_b16 v[208:209], v9 offset:32800
    ds_read_b64_tr_b16 v[210:211], v9 offset:33824
    ds_read_b64_tr_b16 v[212:213], v9 offset:40992
    ds_read_b64_tr_b16 v[214:215], v9 offset:42016
    s_branch Lt_147
Lt_146:
    ds_read_b64_tr_b16 v[128:129], v9 offset:32768
    ds_read_b64_tr_b16 v[130:131], v9 offset:33792
    ds_read_b64_tr_b16 v[132:133], v9 offset:40960
    ds_read_b64_tr_b16 v[134:135], v9 offset:41984
    ds_read_b64_tr_b16 v[192:193], v9 offset:32800
    ds_read_b64_tr_b16 v[194:195], v9 offset:33824
    ds_read_b64_tr_b16 v[196:197], v9 offset:40992
    ds_read_b64_tr_b16 v[198:199], v9 offset:42016
Lt_147:
    s_xor_b32 s3, s6, 0
    s_lshl_b32 s3, s3, 15
    s_add_u32 s3, s3, s55
    s_add_u32 s3, s3, 128
    s_add_u32 s42, s3, 8192
    buffer_load_dwordx2 v[64:65], v5, s[24:27], s3 offen offset:0
    buffer_load_dwordx2 v[66:67], v5, s[24:27], s3 offen offset:1024
    buffer_load_dwordx2 v[68:69], v5, s[24:27], s3 offen offset:2048
    buffer_load_dwordx2 v[70:71], v5, s[24:27], s3 offen offset:3072
    buffer_load_dwordx2 v[72:73], v5, s[24:27], s42 offen offset:0
    buffer_load_dwordx2 v[74:75], v5, s[24:27], s42 offen offset:1024
    buffer_load_dwordx2 v[76:77], v5, s[24:27], s42 offen offset:2048
    buffer_load_dwordx2 v[78:79], v5, s[24:27], s42 offen offset:3072
    s_add_u32 m0, s41, 81920
    s_add_u32 s42, s40, 2621440
    buffer_load_dwordx4 v10, s[12:15], s42 offen lds
    s_add_u32 m0, s41, 82944
    s_add_u32 s42, s40, 2686976
    buffer_load_dwordx4 v10, s[12:15], s42 offen lds
    s_add_u32 m0, s41, 83968
    s_add_u32 s42, s40, 2752512
    buffer_load_dwordx4 v10, s[12:15], s42 offen lds
    s_add_u32 m0, s41, 84992
    s_add_u32 s42, s40, 2818048
    buffer_load_dwordx4 v10, s[12:15], s42 offen lds
    s_waitcnt lgkmcnt(0)
    s_waitcnt vmcnt(40)
    s_barrier
    s_cmp_eq_u32 s6, 1
    s_cbranch_scc1 Lt_149
    s_cmp_eq_u32 s6, 2
    s_cbranch_scc1 Lt_150
    s_cmp_eq_u32 s6, 3
    s_cbranch_scc1 Lt_151
    ds_read_b64_tr_b16 v[184:185], v9 offset:49152
    ds_read_b64_tr_b16 v[186:187], v9 offset:50176
    ds_read_b64_tr_b16 v[188:189], v9 offset:57344
    ds_read_b64_tr_b16 v[190:191], v9 offset:58368
    ds_read_b64_tr_b16 v[248:249], v9 offset:49184
    ds_read_b64_tr_b16 v[250:251], v9 offset:50208
    ds_read_b64_tr_b16 v[252:253], v9 offset:57376
    ds_read_b64_tr_b16 v[254:255], v9 offset:58400
    s_branch Lt_152
Lt_149:
    ds_read_b64_tr_b16 v[168:169], v9 offset:49152
    ds_read_b64_tr_b16 v[170:171], v9 offset:50176
    ds_read_b64_tr_b16 v[172:173], v9 offset:57344
    ds_read_b64_tr_b16 v[174:175], v9 offset:58368
    ds_read_b64_tr_b16 v[232:233], v9 offset:49184
    ds_read_b64_tr_b16 v[234:235], v9 offset:50208
    ds_read_b64_tr_b16 v[236:237], v9 offset:57376
    ds_read_b64_tr_b16 v[238:239], v9 offset:58400
    s_branch Lt_152
Lt_150:
    ds_read_b64_tr_b16 v[152:153], v9 offset:49152
    ds_read_b64_tr_b16 v[154:155], v9 offset:50176
    ds_read_b64_tr_b16 v[156:157], v9 offset:57344
    ds_read_b64_tr_b16 v[158:159], v9 offset:58368
    ds_read_b64_tr_b16 v[216:217], v9 offset:49184
    ds_read_b64_tr_b16 v[218:219], v9 offset:50208
    ds_read_b64_tr_b16 v[220:221], v9 offset:57376
    ds_read_b64_tr_b16 v[222:223], v9 offset:58400
    s_branch Lt_152
Lt_151:
    ds_read_b64_tr_b16 v[136:137], v9 offset:49152
    ds_read_b64_tr_b16 v[138:139], v9 offset:50176
    ds_read_b64_tr_b16 v[140:141], v9 offset:57344
    ds_read_b64_tr_b16 v[142:143], v9 offset:58368
    ds_read_b64_tr_b16 v[200:201], v9 offset:49184
    ds_read_b64_tr_b16 v[202:203], v9 offset:50208
    ds_read_b64_tr_b16 v[204:205], v9 offset:57376
    ds_read_b64_tr_b16 v[206:207], v9 offset:58400
Lt_152:
    s_xor_b32 s3, s6, 1
    s_lshl_b32 s3, s3, 15
    s_add_u32 s3, s3, s55
    s_add_u32 s3, s3, 0
    s_add_u32 s42, s3, 8192
    buffer_load_dwordx2 v[80:81], v5, s[24:27], s3 offen offset:0
    buffer_load_dwordx2 v[82:83], v5, s[24:27], s3 offen offset:1024
    buffer_load_dwordx2 v[84:85], v5, s[24:27], s3 offen offset:2048
    buffer_load_dwordx2 v[86:87], v5, s[24:27], s3 offen offset:3072
    buffer_load_dwordx2 v[88:89], v5, s[24:27], s42 offen offset:0
    buffer_load_dwordx2 v[90:91], v5, s[24:27], s42 offen offset:1024
    buffer_load_dwordx2 v[92:93], v5, s[24:27], s42 offen offset:2048
    buffer_load_dwordx2 v[94:95], v5, s[24:27], s42 offen offset:3072
    s_add_u32 m0, s41, 98304
    s_add_u32 s42, s40, 540672
    buffer_load_dwordx4 v10, s[12:15], s42 offen lds
    s_add_u32 m0, s41, 99328
    s_add_u32 s42, s40, 606208
    buffer_load_dwordx4 v10, s[12:15], s42 offen lds
    s_add_u32 m0, s41, 100352
    s_add_u32 s42, s40, 671744
    buffer_load_dwordx4 v10, s[12:15], s42 offen lds
    s_add_u32 m0, s41, 101376
    s_add_u32 s42, s40, 737280
    buffer_load_dwordx4 v10, s[12:15], s42 offen lds
    s_waitcnt lgkmcnt(0)
    s_waitcnt vmcnt(48)
    s_barrier
    s_cmp_eq_u32 s6, 1
    s_cbranch_scc1 Lt_154
    s_cmp_eq_u32 s6, 2
    s_cbranch_scc1 Lt_155
    s_cmp_eq_u32 s6, 3
    s_cbranch_scc1 Lt_156
    ds_read_b64_tr_b16 a[0:1], v6 offset:0
    ds_read_b64_tr_b16 a[2:3], v6 offset:1024
    ds_read_b64_tr_b16 a[4:5], v6 offset:8192
    ds_read_b64_tr_b16 a[6:7], v6 offset:9216
    ds_read_b64_tr_b16 a[64:65], v6 offset:16
    ds_read_b64_tr_b16 a[66:67], v6 offset:1040
    ds_read_b64_tr_b16 a[68:69], v6 offset:8208
    ds_read_b64_tr_b16 a[70:71], v6 offset:9232
    s_branch Lt_157
Lt_154:
    ds_read_b64_tr_b16 a[16:17], v6 offset:0
    ds_read_b64_tr_b16 a[18:19], v6 offset:1024
    ds_read_b64_tr_b16 a[20:21], v6 offset:8192
    ds_read_b64_tr_b16 a[22:23], v6 offset:9216
    ds_read_b64_tr_b16 a[80:81], v6 offset:16
    ds_read_b64_tr_b16 a[82:83], v6 offset:1040
    ds_read_b64_tr_b16 a[84:85], v6 offset:8208
    ds_read_b64_tr_b16 a[86:87], v6 offset:9232
    s_branch Lt_157
Lt_155:
    ds_read_b64_tr_b16 a[32:33], v6 offset:0
    ds_read_b64_tr_b16 a[34:35], v6 offset:1024
    ds_read_b64_tr_b16 a[36:37], v6 offset:8192
    ds_read_b64_tr_b16 a[38:39], v6 offset:9216
    ds_read_b64_tr_b16 a[96:97], v6 offset:16
    ds_read_b64_tr_b16 a[98:99], v6 offset:1040
    ds_read_b64_tr_b16 a[100:101], v6 offset:8208
    ds_read_b64_tr_b16 a[102:103], v6 offset:9232
    s_branch Lt_157
Lt_156:
    ds_read_b64_tr_b16 a[48:49], v6 offset:0
    ds_read_b64_tr_b16 a[50:51], v6 offset:1024
    ds_read_b64_tr_b16 a[52:53], v6 offset:8192
    ds_read_b64_tr_b16 a[54:55], v6 offset:9216
    ds_read_b64_tr_b16 a[112:113], v6 offset:16
    ds_read_b64_tr_b16 a[114:115], v6 offset:1040
    ds_read_b64_tr_b16 a[116:117], v6 offset:8208
    ds_read_b64_tr_b16 a[118:119], v6 offset:9232
Lt_157:
    s_xor_b32 s3, s6, 2
    s_lshl_b32 s3, s3, 15
    s_add_u32 s3, s3, s55
    s_add_u32 s3, s3, 0
    s_add_u32 s42, s3, 8192
    buffer_load_dwordx2 v[96:97], v5, s[24:27], s3 offen offset:0
    buffer_load_dwordx2 v[98:99], v5, s[24:27], s3 offen offset:1024
    buffer_load_dwordx2 v[100:101], v5, s[24:27], s3 offen offset:2048
    buffer_load_dwordx2 v[102:103], v5, s[24:27], s3 offen offset:3072
    buffer_load_dwordx2 v[104:105], v5, s[24:27], s42 offen offset:0
    buffer_load_dwordx2 v[106:107], v5, s[24:27], s42 offen offset:1024
    buffer_load_dwordx2 v[108:109], v5, s[24:27], s42 offen offset:2048
    buffer_load_dwordx2 v[110:111], v5, s[24:27], s42 offen offset:3072
    s_add_u32 m0, s41, 114688
    s_add_u32 s42, s40, 2637824
    buffer_load_dwordx4 v10, s[12:15], s42 offen lds
    s_add_u32 m0, s41, 115712
    s_add_u32 s42, s40, 2703360
    buffer_load_dwordx4 v10, s[12:15], s42 offen lds
    s_add_u32 m0, s41, 116736
    s_add_u32 s42, s40, 2768896
    buffer_load_dwordx4 v10, s[12:15], s42 offen lds
    s_add_u32 m0, s41, 117760
    s_add_u32 s42, s40, 2834432
    buffer_load_dwordx4 v10, s[12:15], s42 offen lds
    s_waitcnt lgkmcnt(0)
    s_waitcnt vmcnt(56)
    s_barrier
    s_cmp_eq_u32 s6, 1
    s_cbranch_scc1 Lt_159
    s_cmp_eq_u32 s6, 2
    s_cbranch_scc1 Lt_160
    s_cmp_eq_u32 s6, 3
    s_cbranch_scc1 Lt_161
    ds_read_b64_tr_b16 a[8:9], v6 offset:16384
    ds_read_b64_tr_b16 a[10:11], v6 offset:17408
    ds_read_b64_tr_b16 a[12:13], v6 offset:24576
    ds_read_b64_tr_b16 a[14:15], v6 offset:25600
    ds_read_b64_tr_b16 a[72:73], v6 offset:16400
    ds_read_b64_tr_b16 a[74:75], v6 offset:17424
    ds_read_b64_tr_b16 a[76:77], v6 offset:24592
    ds_read_b64_tr_b16 a[78:79], v6 offset:25616
    s_branch Lt_162
Lt_159:
    ds_read_b64_tr_b16 a[24:25], v6 offset:16384
    ds_read_b64_tr_b16 a[26:27], v6 offset:17408
    ds_read_b64_tr_b16 a[28:29], v6 offset:24576
    ds_read_b64_tr_b16 a[30:31], v6 offset:25600
    ds_read_b64_tr_b16 a[88:89], v6 offset:16400
    ds_read_b64_tr_b16 a[90:91], v6 offset:17424
    ds_read_b64_tr_b16 a[92:93], v6 offset:24592
    ds_read_b64_tr_b16 a[94:95], v6 offset:25616
    s_branch Lt_162
Lt_160:
    ds_read_b64_tr_b16 a[40:41], v6 offset:16384
    ds_read_b64_tr_b16 a[42:43], v6 offset:17408
    ds_read_b64_tr_b16 a[44:45], v6 offset:24576
    ds_read_b64_tr_b16 a[46:47], v6 offset:25600
    ds_read_b64_tr_b16 a[104:105], v6 offset:16400
    ds_read_b64_tr_b16 a[106:107], v6 offset:17424
    ds_read_b64_tr_b16 a[108:109], v6 offset:24592
    ds_read_b64_tr_b16 a[110:111], v6 offset:25616
    s_branch Lt_162
Lt_161:
    ds_read_b64_tr_b16 a[56:57], v6 offset:16384
    ds_read_b64_tr_b16 a[58:59], v6 offset:17408
    ds_read_b64_tr_b16 a[60:61], v6 offset:24576
    ds_read_b64_tr_b16 a[62:63], v6 offset:25600
    ds_read_b64_tr_b16 a[120:121], v6 offset:16400
    ds_read_b64_tr_b16 a[122:123], v6 offset:17424
    ds_read_b64_tr_b16 a[124:125], v6 offset:24592
    ds_read_b64_tr_b16 a[126:127], v6 offset:25616
Lt_162:
    s_waitcnt lgkmcnt(0)
    s_waitcnt vmcnt(52)
    s_barrier
    s_cmp_eq_u32 s6, 1
    s_cbranch_scc1 Lt_164
    s_cmp_eq_u32 s6, 2
    s_cbranch_scc1 Lt_165
    s_cmp_eq_u32 s6, 3
    s_cbranch_scc1 Lt_166
    ds_read_b64_tr_b16 a[16:17], v6 offset:32768
    ds_read_b64_tr_b16 a[18:19], v6 offset:33792
    ds_read_b64_tr_b16 a[20:21], v6 offset:40960
    ds_read_b64_tr_b16 a[22:23], v6 offset:41984
    ds_read_b64_tr_b16 a[80:81], v6 offset:32784
    ds_read_b64_tr_b16 a[82:83], v6 offset:33808
    ds_read_b64_tr_b16 a[84:85], v6 offset:40976
    ds_read_b64_tr_b16 a[86:87], v6 offset:42000
    s_branch Lt_167
Lt_164:
    ds_read_b64_tr_b16 a[0:1], v6 offset:32768
    ds_read_b64_tr_b16 a[2:3], v6 offset:33792
    ds_read_b64_tr_b16 a[4:5], v6 offset:40960
    ds_read_b64_tr_b16 a[6:7], v6 offset:41984
    ds_read_b64_tr_b16 a[64:65], v6 offset:32784
    ds_read_b64_tr_b16 a[66:67], v6 offset:33808
    ds_read_b64_tr_b16 a[68:69], v6 offset:40976
    ds_read_b64_tr_b16 a[70:71], v6 offset:42000
    s_branch Lt_167
Lt_165:
    ds_read_b64_tr_b16 a[48:49], v6 offset:32768
    ds_read_b64_tr_b16 a[50:51], v6 offset:33792
    ds_read_b64_tr_b16 a[52:53], v6 offset:40960
    ds_read_b64_tr_b16 a[54:55], v6 offset:41984
    ds_read_b64_tr_b16 a[112:113], v6 offset:32784
    ds_read_b64_tr_b16 a[114:115], v6 offset:33808
    ds_read_b64_tr_b16 a[116:117], v6 offset:40976
    ds_read_b64_tr_b16 a[118:119], v6 offset:42000
    s_branch Lt_167
Lt_166:
    ds_read_b64_tr_b16 a[32:33], v6 offset:32768
    ds_read_b64_tr_b16 a[34:35], v6 offset:33792
    ds_read_b64_tr_b16 a[36:37], v6 offset:40960
    ds_read_b64_tr_b16 a[38:39], v6 offset:41984
    ds_read_b64_tr_b16 a[96:97], v6 offset:32784
    ds_read_b64_tr_b16 a[98:99], v6 offset:33808
    ds_read_b64_tr_b16 a[100:101], v6 offset:40976
    ds_read_b64_tr_b16 a[102:103], v6 offset:42000
Lt_167:
    s_xor_b32 s3, s6, 3
    s_lshl_b32 s3, s3, 15
    s_add_u32 s3, s3, s55
    s_add_u32 s3, s3, 0
    s_add_u32 s42, s3, 8192
    buffer_load_dwordx2 v[112:113], v5, s[24:27], s3 offen offset:0
    buffer_load_dwordx2 v[114:115], v5, s[24:27], s3 offen offset:1024
    buffer_load_dwordx2 v[116:117], v5, s[24:27], s3 offen offset:2048
    buffer_load_dwordx2 v[118:119], v5, s[24:27], s3 offen offset:3072
    buffer_load_dwordx2 v[120:121], v5, s[24:27], s42 offen offset:0
    buffer_load_dwordx2 v[122:123], v5, s[24:27], s42 offen offset:1024
    buffer_load_dwordx2 v[124:125], v5, s[24:27], s42 offen offset:2048
    buffer_load_dwordx2 v[126:127], v5, s[24:27], s42 offen offset:3072
    s_waitcnt lgkmcnt(0)
    s_waitcnt vmcnt(56)
    s_barrier
    s_cmp_eq_u32 s6, 1
    s_cbranch_scc1 Lt_169
    s_cmp_eq_u32 s6, 2
    s_cbranch_scc1 Lt_170
    s_cmp_eq_u32 s6, 3
    s_cbranch_scc1 Lt_171
    ds_read_b64_tr_b16 a[24:25], v6 offset:49152
    ds_read_b64_tr_b16 a[26:27], v6 offset:50176
    ds_read_b64_tr_b16 a[28:29], v6 offset:57344
    ds_read_b64_tr_b16 a[30:31], v6 offset:58368
    ds_read_b64_tr_b16 a[88:89], v6 offset:49168
    ds_read_b64_tr_b16 a[90:91], v6 offset:50192
    ds_read_b64_tr_b16 a[92:93], v6 offset:57360
    ds_read_b64_tr_b16 a[94:95], v6 offset:58384
    s_branch Lt_172
Lt_169:
    ds_read_b64_tr_b16 a[8:9], v6 offset:49152
    ds_read_b64_tr_b16 a[10:11], v6 offset:50176
    ds_read_b64_tr_b16 a[12:13], v6 offset:57344
    ds_read_b64_tr_b16 a[14:15], v6 offset:58368
    ds_read_b64_tr_b16 a[72:73], v6 offset:49168
    ds_read_b64_tr_b16 a[74:75], v6 offset:50192
    ds_read_b64_tr_b16 a[76:77], v6 offset:57360
    ds_read_b64_tr_b16 a[78:79], v6 offset:58384
    s_branch Lt_172
Lt_170:
    ds_read_b64_tr_b16 a[56:57], v6 offset:49152
    ds_read_b64_tr_b16 a[58:59], v6 offset:50176
    ds_read_b64_tr_b16 a[60:61], v6 offset:57344
    ds_read_b64_tr_b16 a[62:63], v6 offset:58368
    ds_read_b64_tr_b16 a[120:121], v6 offset:49168
    ds_read_b64_tr_b16 a[122:123], v6 offset:50192
    ds_read_b64_tr_b16 a[124:125], v6 offset:57360
    ds_read_b64_tr_b16 a[126:127], v6 offset:58384
    s_branch Lt_172
Lt_171:
    ds_read_b64_tr_b16 a[40:41], v6 offset:49152
    ds_read_b64_tr_b16 a[42:43], v6 offset:50176
    ds_read_b64_tr_b16 a[44:45], v6 offset:57344
    ds_read_b64_tr_b16 a[46:47], v6 offset:58368
    ds_read_b64_tr_b16 a[104:105], v6 offset:49168
    ds_read_b64_tr_b16 a[106:107], v6 offset:50192
    ds_read_b64_tr_b16 a[108:109], v6 offset:57360
    ds_read_b64_tr_b16 a[110:111], v6 offset:58384
Lt_172:
    s_waitcnt lgkmcnt(0)
    s_waitcnt vmcnt(44)
    s_barrier
    s_cmp_eq_u32 s6, 1
    s_cbranch_scc1 Lt_174
    s_cmp_eq_u32 s6, 2
    s_cbranch_scc1 Lt_175
    s_cmp_eq_u32 s6, 3
    s_cbranch_scc1 Lt_176
    ds_read_b64_tr_b16 a[32:33], v7 offset:0
    ds_read_b64_tr_b16 a[34:35], v7 offset:1024
    ds_read_b64_tr_b16 a[36:37], v7 offset:8192
    ds_read_b64_tr_b16 a[38:39], v7 offset:9216
    ds_read_b64_tr_b16 a[96:97], v7 offset:16
    ds_read_b64_tr_b16 a[98:99], v7 offset:1040
    ds_read_b64_tr_b16 a[100:101], v7 offset:8208
    ds_read_b64_tr_b16 a[102:103], v7 offset:9232
    s_branch Lt_177
Lt_174:
    ds_read_b64_tr_b16 a[48:49], v7 offset:0
    ds_read_b64_tr_b16 a[50:51], v7 offset:1024
    ds_read_b64_tr_b16 a[52:53], v7 offset:8192
    ds_read_b64_tr_b16 a[54:55], v7 offset:9216
    ds_read_b64_tr_b16 a[112:113], v7 offset:16
    ds_read_b64_tr_b16 a[114:115], v7 offset:1040
    ds_read_b64_tr_b16 a[116:117], v7 offset:8208
    ds_read_b64_tr_b16 a[118:119], v7 offset:9232
    s_branch Lt_177
Lt_175:
    ds_read_b64_tr_b16 a[0:1], v7 offset:0
    ds_read_b64_tr_b16 a[2:3], v7 offset:1024
    ds_read_b64_tr_b16 a[4:5], v7 offset:8192
    ds_read_b64_tr_b16 a[6:7], v7 offset:9216
    ds_read_b64_tr_b16 a[64:65], v7 offset:16
    ds_read_b64_tr_b16 a[66:67], v7 offset:1040
    ds_read_b64_tr_b16 a[68:69], v7 offset:8208
    ds_read_b64_tr_b16 a[70:71], v7 offset:9232
    s_branch Lt_177
Lt_176:
    ds_read_b64_tr_b16 a[16:17], v7 offset:0
    ds_read_b64_tr_b16 a[18:19], v7 offset:1024
    ds_read_b64_tr_b16 a[20:21], v7 offset:8192
    ds_read_b64_tr_b16 a[22:23], v7 offset:9216
    ds_read_b64_tr_b16 a[80:81], v7 offset:16
    ds_read_b64_tr_b16 a[82:83], v7 offset:1040
    ds_read_b64_tr_b16 a[84:85], v7 offset:8208
    ds_read_b64_tr_b16 a[86:87], v7 offset:9232
Lt_177:
    s_waitcnt lgkmcnt(0)
    s_waitcnt vmcnt(32)
    s_barrier
    s_cmp_eq_u32 s6, 1
    s_cbranch_scc1 Lt_179
    s_cmp_eq_u32 s6, 2
    s_cbranch_scc1 Lt_180
    s_cmp_eq_u32 s6, 3
    s_cbranch_scc1 Lt_181
    ds_read_b64_tr_b16 a[40:41], v7 offset:16384
    ds_read_b64_tr_b16 a[42:43], v7 offset:17408
    ds_read_b64_tr_b16 a[44:45], v7 offset:24576
    ds_read_b64_tr_b16 a[46:47], v7 offset:25600
    ds_read_b64_tr_b16 a[104:105], v7 offset:16400
    ds_read_b64_tr_b16 a[106:107], v7 offset:17424
    ds_read_b64_tr_b16 a[108:109], v7 offset:24592
    ds_read_b64_tr_b16 a[110:111], v7 offset:25616
    s_branch Lt_182
Lt_179:
    ds_read_b64_tr_b16 a[56:57], v7 offset:16384
    ds_read_b64_tr_b16 a[58:59], v7 offset:17408
    ds_read_b64_tr_b16 a[60:61], v7 offset:24576
    ds_read_b64_tr_b16 a[62:63], v7 offset:25600
    ds_read_b64_tr_b16 a[120:121], v7 offset:16400
    ds_read_b64_tr_b16 a[122:123], v7 offset:17424
    ds_read_b64_tr_b16 a[124:125], v7 offset:24592
    ds_read_b64_tr_b16 a[126:127], v7 offset:25616
    s_branch Lt_182
Lt_180:
    ds_read_b64_tr_b16 a[8:9], v7 offset:16384
    ds_read_b64_tr_b16 a[10:11], v7 offset:17408
    ds_read_b64_tr_b16 a[12:13], v7 offset:24576
    ds_read_b64_tr_b16 a[14:15], v7 offset:25600
    ds_read_b64_tr_b16 a[72:73], v7 offset:16400
    ds_read_b64_tr_b16 a[74:75], v7 offset:17424
    ds_read_b64_tr_b16 a[76:77], v7 offset:24592
    ds_read_b64_tr_b16 a[78:79], v7 offset:25616
    s_branch Lt_182
Lt_181:
    ds_read_b64_tr_b16 a[24:25], v7 offset:16384
    ds_read_b64_tr_b16 a[26:27], v7 offset:17408
    ds_read_b64_tr_b16 a[28:29], v7 offset:24576
    ds_read_b64_tr_b16 a[30:31], v7 offset:25600
    ds_read_b64_tr_b16 a[88:89], v7 offset:16400
    ds_read_b64_tr_b16 a[90:91], v7 offset:17424
    ds_read_b64_tr_b16 a[92:93], v7 offset:24592
    ds_read_b64_tr_b16 a[94:95], v7 offset:25616
Lt_182:
    s_waitcnt vmcnt(48)
    v_perm_b32 v32, v50, v48, s60
    v_perm_b32 v33, v50, v48, s61
    v_perm_b32 v34, v54, v52, s60
    v_perm_b32 v35, v54, v52, s61
    v_perm_b32 v36, v58, v56, s60
    v_perm_b32 v37, v58, v56, s61
    v_perm_b32 v38, v62, v60, s60
    v_perm_b32 v39, v62, v60, s61
    v_perm_b32 v40, v51, v49, s60
    v_perm_b32 v41, v51, v49, s61
    v_perm_b32 v42, v55, v53, s60
    v_perm_b32 v43, v55, v53, s61
    v_perm_b32 v44, v59, v57, s60
    v_perm_b32 v45, v59, v57, s61
    v_perm_b32 v46, v63, v61, s60
    v_perm_b32 v47, v63, v61, s61
    s_xor_b32 s3, s6, 3
    s_lshl_b32 s3, s3, 15
    s_add_u32 s3, s3, s55
    s_add_u32 s3, s3, 128
    s_add_u32 s42, s3, 8192
    buffer_load_dwordx2 v[48:49], v5, s[24:27], s3 offen offset:0
    buffer_load_dwordx2 v[50:51], v5, s[24:27], s3 offen offset:1024
    buffer_load_dwordx2 v[52:53], v5, s[24:27], s3 offen offset:2048
    buffer_load_dwordx2 v[54:55], v5, s[24:27], s3 offen offset:3072
    buffer_load_dwordx2 v[56:57], v5, s[24:27], s42 offen offset:0
    buffer_load_dwordx2 v[58:59], v5, s[24:27], s42 offen offset:1024
    buffer_load_dwordx2 v[60:61], v5, s[24:27], s42 offen offset:2048
    buffer_load_dwordx2 v[62:63], v5, s[24:27], s42 offen offset:3072
    ds_write_b128 v31, v[32:35] offset:0
    ds_write_b128 v31, v[36:39] offset:1024
    ds_write_b128 v31, v[40:43] offset:2048
    ds_write_b128 v31, v[44:47] offset:3072
    s_waitcnt lgkmcnt(0)
    s_waitcnt vmcnt(44)
    v_perm_b32 v32, v66, v64, s60
    v_perm_b32 v33, v66, v64, s61
    v_perm_b32 v34, v70, v68, s60
    v_perm_b32 v35, v70, v68, s61
    v_perm_b32 v36, v74, v72, s60
    v_perm_b32 v37, v74, v72, s61
    v_perm_b32 v38, v78, v76, s60
    v_perm_b32 v39, v78, v76, s61
    v_perm_b32 v40, v67, v65, s60
    v_perm_b32 v41, v67, v65, s61
    v_perm_b32 v42, v71, v69, s60
    v_perm_b32 v43, v71, v69, s61
    v_perm_b32 v44, v75, v73, s60
    v_perm_b32 v45, v75, v73, s61
    v_perm_b32 v46, v79, v77, s60
    v_perm_b32 v47, v79, v77, s61
    s_xor_b32 s3, s6, 1
    s_lshl_b32 s3, s3, 15
    s_add_u32 s3, s3, s55
    s_add_u32 s3, s3, 128
    s_add_u32 s42, s3, 8192
    buffer_load_dwordx2 v[64:65], v5, s[24:27], s3 offen offset:0
    buffer_load_dwordx2 v[66:67], v5, s[24:27], s3 offen offset:1024
    buffer_load_dwordx2 v[68:69], v5, s[24:27], s3 offen offset:2048
    buffer_load_dwordx2 v[70:71], v5, s[24:27], s3 offen offset:3072
    buffer_load_dwordx2 v[72:73], v5, s[24:27], s42 offen offset:0
    buffer_load_dwordx2 v[74:75], v5, s[24:27], s42 offen offset:1024
    buffer_load_dwordx2 v[76:77], v5, s[24:27], s42 offen offset:2048
    buffer_load_dwordx2 v[78:79], v5, s[24:27], s42 offen offset:3072
    ds_write_b128 v31, v[32:35] offset:4096
    ds_write_b128 v31, v[36:39] offset:5120
    ds_write_b128 v31, v[40:43] offset:6144
    ds_write_b128 v31, v[44:47] offset:7168
    s_waitcnt lgkmcnt(0)
    s_waitcnt lgkmcnt(0)
    s_waitcnt vmcnt(36)
    s_barrier
    s_cmp_eq_u32 s6, 1
    s_cbranch_scc1 Lt_184
    s_cmp_eq_u32 s6, 2
    s_cbranch_scc1 Lt_185
    s_cmp_eq_u32 s6, 3
    s_cbranch_scc1 Lt_186
    ds_read_b64_tr_b16 a[48:49], v7 offset:32768
    ds_read_b64_tr_b16 a[50:51], v7 offset:33792
    ds_read_b64_tr_b16 a[52:53], v7 offset:40960
    ds_read_b64_tr_b16 a[54:55], v7 offset:41984
    ds_read_b64_tr_b16 a[112:113], v7 offset:32784
    ds_read_b64_tr_b16 a[114:115], v7 offset:33808
    ds_read_b64_tr_b16 a[116:117], v7 offset:40976
    ds_read_b64_tr_b16 a[118:119], v7 offset:42000
    s_branch Lt_187
Lt_184:
    ds_read_b64_tr_b16 a[32:33], v7 offset:32768
    ds_read_b64_tr_b16 a[34:35], v7 offset:33792
    ds_read_b64_tr_b16 a[36:37], v7 offset:40960
    ds_read_b64_tr_b16 a[38:39], v7 offset:41984
    ds_read_b64_tr_b16 a[96:97], v7 offset:32784
    ds_read_b64_tr_b16 a[98:99], v7 offset:33808
    ds_read_b64_tr_b16 a[100:101], v7 offset:40976
    ds_read_b64_tr_b16 a[102:103], v7 offset:42000
    s_branch Lt_187
Lt_185:
    ds_read_b64_tr_b16 a[16:17], v7 offset:32768
    ds_read_b64_tr_b16 a[18:19], v7 offset:33792
    ds_read_b64_tr_b16 a[20:21], v7 offset:40960
    ds_read_b64_tr_b16 a[22:23], v7 offset:41984
    ds_read_b64_tr_b16 a[80:81], v7 offset:32784
    ds_read_b64_tr_b16 a[82:83], v7 offset:33808
    ds_read_b64_tr_b16 a[84:85], v7 offset:40976
    ds_read_b64_tr_b16 a[86:87], v7 offset:42000
    s_branch Lt_187
Lt_186:
    ds_read_b64_tr_b16 a[0:1], v7 offset:32768
    ds_read_b64_tr_b16 a[2:3], v7 offset:33792
    ds_read_b64_tr_b16 a[4:5], v7 offset:40960
    ds_read_b64_tr_b16 a[6:7], v7 offset:41984
    ds_read_b64_tr_b16 a[64:65], v7 offset:32784
    ds_read_b64_tr_b16 a[66:67], v7 offset:33808
    ds_read_b64_tr_b16 a[68:69], v7 offset:40976
    ds_read_b64_tr_b16 a[70:71], v7 offset:42000
Lt_187:
    s_waitcnt vmcnt(40)
    v_perm_b32 v32, v82, v80, s60
    v_perm_b32 v33, v82, v80, s61
    v_perm_b32 v34, v86, v84, s60
    v_perm_b32 v35, v86, v84, s61
    v_perm_b32 v36, v90, v88, s60
    v_perm_b32 v37, v90, v88, s61
    v_perm_b32 v38, v94, v92, s60
    v_perm_b32 v39, v94, v92, s61
    v_perm_b32 v40, v83, v81, s60
    v_perm_b32 v41, v83, v81, s61
    v_perm_b32 v42, v87, v85, s60
    v_perm_b32 v43, v87, v85, s61
    v_perm_b32 v44, v91, v89, s60
    v_perm_b32 v45, v91, v89, s61
    v_perm_b32 v46, v95, v93, s60
    v_perm_b32 v47, v95, v93, s61
    s_xor_b32 s3, s6, 2
    s_lshl_b32 s3, s3, 15
    s_add_u32 s3, s3, s55
    s_add_u32 s3, s3, 128
    s_add_u32 s42, s3, 8192
    buffer_load_dwordx2 v[80:81], v5, s[24:27], s3 offen offset:0
    buffer_load_dwordx2 v[82:83], v5, s[24:27], s3 offen offset:1024
    buffer_load_dwordx2 v[84:85], v5, s[24:27], s3 offen offset:2048
    buffer_load_dwordx2 v[86:87], v5, s[24:27], s3 offen offset:3072
    buffer_load_dwordx2 v[88:89], v5, s[24:27], s42 offen offset:0
    buffer_load_dwordx2 v[90:91], v5, s[24:27], s42 offen offset:1024
    buffer_load_dwordx2 v[92:93], v5, s[24:27], s42 offen offset:2048
    buffer_load_dwordx2 v[94:95], v5, s[24:27], s42 offen offset:3072
    ds_write_b128 v31, v[32:35] offset:16384
    ds_write_b128 v31, v[36:39] offset:17408
    ds_write_b128 v31, v[40:43] offset:18432
    ds_write_b128 v31, v[44:47] offset:19456
    s_waitcnt lgkmcnt(0)
    s_waitcnt vmcnt(36)
    v_perm_b32 v32, v98, v96, s60
    v_perm_b32 v33, v98, v96, s61
    v_perm_b32 v34, v102, v100, s60
    v_perm_b32 v35, v102, v100, s61
    v_perm_b32 v36, v106, v104, s60
    v_perm_b32 v37, v106, v104, s61
    v_perm_b32 v38, v110, v108, s60
    v_perm_b32 v39, v110, v108, s61
    v_perm_b32 v40, v99, v97, s60
    v_perm_b32 v41, v99, v97, s61
    v_perm_b32 v42, v103, v101, s60
    v_perm_b32 v43, v103, v101, s61
    v_perm_b32 v44, v107, v105, s60
    v_perm_b32 v45, v107, v105, s61
    v_perm_b32 v46, v111, v109, s60
    v_perm_b32 v47, v111, v109, s61
    ds_write_b128 v31, v[32:35] offset:20480
    ds_write_b128 v31, v[36:39] offset:21504
    ds_write_b128 v31, v[40:43] offset:22528
    ds_write_b128 v31, v[44:47] offset:23552
    s_waitcnt lgkmcnt(0)
    s_lshl_b32 s3, s7, 11
    s_add_u32 s3, s3, s5
    s_lshl_b32 s49, s3, 7
    s_lshl_b32 s3, s7, 5
    s_add_u32 s3, s3, s5
    s_mul_i32 s48, s3, 2099328
    s_add_u32 s48, s48, 50331648
    s_add_u32 s50, s48, 24576
    s_add_u32 s3, s46, 8192
    buffer_load_dword v17, v12, s[8:11], s46 offen sc1
    buffer_load_dword v17, v12, s[8:11], s3 offen sc1
    v_lshlrev_b32 v16, 1, v1
    buffer_load_dword v17, v16, s[8:11], s52 offen sc1
    s_lshl_b32 s3, s4, 7
    s_add_u32 s3, s3, 573440
    buffer_load_dword v17, off, s[8:11], s3 sc1
    s_waitcnt lgkmcnt(0)
    s_waitcnt vmcnt(36)
    s_barrier
    s_cmp_eq_u32 s6, 1
    s_cbranch_scc1 Lt_189
    s_cmp_eq_u32 s6, 2
    s_cbranch_scc1 Lt_190
    s_cmp_eq_u32 s6, 3
    s_cbranch_scc1 Lt_191
    ds_read_b64_tr_b16 a[56:57], v7 offset:49152
    ds_read_b64_tr_b16 a[58:59], v7 offset:50176
    ds_read_b64_tr_b16 a[60:61], v7 offset:57344
    ds_read_b64_tr_b16 a[62:63], v7 offset:58368
    ds_read_b64_tr_b16 a[120:121], v7 offset:49168
    ds_read_b64_tr_b16 a[122:123], v7 offset:50192
    ds_read_b64_tr_b16 a[124:125], v7 offset:57360
    ds_read_b64_tr_b16 a[126:127], v7 offset:58384
    s_branch Lt_192
Lt_189:
    ds_read_b64_tr_b16 a[40:41], v7 offset:49152
    ds_read_b64_tr_b16 a[42:43], v7 offset:50176
    ds_read_b64_tr_b16 a[44:45], v7 offset:57344
    ds_read_b64_tr_b16 a[46:47], v7 offset:58368
    ds_read_b64_tr_b16 a[104:105], v7 offset:49168
    ds_read_b64_tr_b16 a[106:107], v7 offset:50192
    ds_read_b64_tr_b16 a[108:109], v7 offset:57360
    ds_read_b64_tr_b16 a[110:111], v7 offset:58384
    s_branch Lt_192
Lt_190:
    ds_read_b64_tr_b16 a[24:25], v7 offset:49152
    ds_read_b64_tr_b16 a[26:27], v7 offset:50176
    ds_read_b64_tr_b16 a[28:29], v7 offset:57344
    ds_read_b64_tr_b16 a[30:31], v7 offset:58368
    ds_read_b64_tr_b16 a[88:89], v7 offset:49168
    ds_read_b64_tr_b16 a[90:91], v7 offset:50192
    ds_read_b64_tr_b16 a[92:93], v7 offset:57360
    ds_read_b64_tr_b16 a[94:95], v7 offset:58384
    s_branch Lt_192
Lt_191:
    ds_read_b64_tr_b16 a[8:9], v7 offset:49152
    ds_read_b64_tr_b16 a[10:11], v7 offset:50176
    ds_read_b64_tr_b16 a[12:13], v7 offset:57344
    ds_read_b64_tr_b16 a[14:15], v7 offset:58368
    ds_read_b64_tr_b16 a[72:73], v7 offset:49168
    ds_read_b64_tr_b16 a[74:75], v7 offset:50192
    ds_read_b64_tr_b16 a[76:77], v7 offset:57360
    ds_read_b64_tr_b16 a[78:79], v7 offset:58384
Lt_192:
    s_waitcnt vmcnt(28)
    v_perm_b32 v32, v114, v112, s60
    v_perm_b32 v33, v114, v112, s61
    v_perm_b32 v34, v118, v116, s60
    v_perm_b32 v35, v118, v116, s61
    v_perm_b32 v36, v122, v120, s60
    v_perm_b32 v37, v122, v120, s61
    v_perm_b32 v38, v126, v124, s60
    v_perm_b32 v39, v126, v124, s61
    v_perm_b32 v40, v115, v113, s60
    v_perm_b32 v41, v115, v113, s61
    v_perm_b32 v42, v119, v117, s60
    v_perm_b32 v43, v119, v117, s61
    v_perm_b32 v44, v123, v121, s60
    v_perm_b32 v45, v123, v121, s61
    v_perm_b32 v46, v127, v125, s60
    v_perm_b32 v47, v127, v125, s61
    ds_write_b128 v31, v[32:35] offset:32768
    ds_write_b128 v31, v[36:39] offset:33792
    ds_write_b128 v31, v[40:43] offset:34816
    ds_write_b128 v31, v[44:47] offset:35840
    s_waitcnt lgkmcnt(0)
    s_waitcnt vmcnt(20)
    v_perm_b32 v32, v50, v48, s60
    v_perm_b32 v33, v50, v48, s61
    v_perm_b32 v34, v54, v52, s60
    v_perm_b32 v35, v54, v52, s61
    v_perm_b32 v36, v58, v56, s60
    v_perm_b32 v37, v58, v56, s61
    v_perm_b32 v38, v62, v60, s60
    v_perm_b32 v39, v62, v60, s61
    v_perm_b32 v40, v51, v49, s60
    v_perm_b32 v41, v51, v49, s61
    v_perm_b32 v42, v55, v53, s60
    v_perm_b32 v43, v55, v53, s61
    v_perm_b32 v44, v59, v57, s60
    v_perm_b32 v45, v59, v57, s61
    v_perm_b32 v46, v63, v61, s60
    v_perm_b32 v47, v63, v61, s61
    ds_write_b128 v31, v[32:35] offset:36864
    ds_write_b128 v31, v[36:39] offset:37888
    ds_write_b128 v31, v[40:43] offset:38912
    ds_write_b128 v31, v[44:47] offset:39936
    s_waitcnt lgkmcnt(0)
    s_waitcnt lgkmcnt(0)
    s_barrier
    s_lshl_b32 s40, s6, 12
    s_add_u32 s51, s48, s40
    v_lshlrev_b32 v16, 2, v1
    s_lshl_b32 s3, s7, 29
    s_add_u32 s40, s51, s3
    s_add_u32 s3, s49, s3
    buffer_load_dword v15, off, s[8:11], s3 sc1
    buffer_load_dword v17, v16, s[8:11], s40 offen sc1
    s_waitcnt vmcnt(14)
    v_perm_b32 v32, v66, v64, s60
    v_perm_b32 v33, v66, v64, s61
    v_perm_b32 v34, v70, v68, s60
    v_perm_b32 v35, v70, v68, s61
    v_perm_b32 v36, v74, v72, s60
    v_perm_b32 v37, v74, v72, s61
    v_perm_b32 v38, v78, v76, s60
    v_perm_b32 v39, v78, v76, s61
    v_perm_b32 v40, v67, v65, s60
    v_perm_b32 v41, v67, v65, s61
    v_perm_b32 v42, v71, v69, s60
    v_perm_b32 v43, v71, v69, s61
    v_perm_b32 v44, v75, v73, s60
    v_perm_b32 v45, v75, v73, s61
    v_perm_b32 v46, v79, v77, s60
    v_perm_b32 v47, v79, v77, s61
    ds_write_b128 v31, a[0:3] offset:49152
    ds_write_b128 v31, a[4:7] offset:50176
    ds_write_b128 v31, a[64:67] offset:51200
    ds_write_b128 v31, a[68:71] offset:52224
    s_waitcnt lgkmcnt(0)
    v_accvgpr_write_b32 a0, v32
    v_accvgpr_write_b32 a1, v33
    v_accvgpr_write_b32 a2, v34
    v_accvgpr_write_b32 a3, v35
    v_accvgpr_write_b32 a4, v36
    v_accvgpr_write_b32 a5, v37
    v_accvgpr_write_b32 a6, v38
    v_accvgpr_write_b32 a7, v39
    v_accvgpr_write_b32 a64, v40
    v_accvgpr_write_b32 a65, v41
    v_accvgpr_write_b32 a66, v42
    v_accvgpr_write_b32 a67, v43
    v_accvgpr_write_b32 a68, v44
    v_accvgpr_write_b32 a69, v45
    v_accvgpr_write_b32 a70, v46
    v_accvgpr_write_b32 a71, v47
    s_waitcnt vmcnt(6)
    v_perm_b32 v32, v82, v80, s60
    v_perm_b32 v33, v82, v80, s61
    v_perm_b32 v34, v86, v84, s60
    v_perm_b32 v35, v86, v84, s61
    v_perm_b32 v36, v90, v88, s60
    v_perm_b32 v37, v90, v88, s61
    v_perm_b32 v38, v94, v92, s60
    v_perm_b32 v39, v94, v92, s61
    v_perm_b32 v40, v83, v81, s60
    v_perm_b32 v41, v83, v81, s61
    v_perm_b32 v42, v87, v85, s60
    v_perm_b32 v43, v87, v85, s61
    v_perm_b32 v44, v91, v89, s60
    v_perm_b32 v45, v91, v89, s61
    v_perm_b32 v46, v95, v93, s60
    v_perm_b32 v47, v95, v93, s61
    ds_write_b128 v31, a[8:11] offset:53248
    ds_write_b128 v31, a[12:15] offset:54272
    ds_write_b128 v31, a[72:75] offset:55296
    ds_write_b128 v31, a[76:79] offset:56320
    s_waitcnt lgkmcnt(0)
    v_accvgpr_write_b32 a8, v32
    v_accvgpr_write_b32 a9, v33
    v_accvgpr_write_b32 a10, v34
    v_accvgpr_write_b32 a11, v35
    v_accvgpr_write_b32 a12, v36
    v_accvgpr_write_b32 a13, v37
    v_accvgpr_write_b32 a14, v38
    v_accvgpr_write_b32 a15, v39
    v_accvgpr_write_b32 a72, v40
    v_accvgpr_write_b32 a73, v41
    v_accvgpr_write_b32 a74, v42
    v_accvgpr_write_b32 a75, v43
    v_accvgpr_write_b32 a76, v44
    v_accvgpr_write_b32 a77, v45
    v_accvgpr_write_b32 a78, v46
    v_accvgpr_write_b32 a79, v47
    v_mov_b32 v9, v31
    v_mov_b32 v2, 0x4444
    v_bfe_u32 v23, v20, 1, 1
    v_mul_u32_u24 v23, 0xaaaa, v23
    v_or_b32 v2, v2, v23
    s_lshl_b32 s3, s6, 11
    s_add_u32 s3, s3, 131072
    v_add_u32 v3, s3, v1
    v_and_b32 v23, 12, v20
    v_add_u32 v23, v23, v21
    v_lshlrev_b32 v23, 6, v23
    v_and_b32 v25, 3, v20
    v_lshl_add_u32 v23, v25, 2, v23
    s_lshl_b32 s3, s6, 10
    s_add_u32 s3, s3, 155648
    v_and_b32 v25, 4, v20
    v_lshl_add_u32 v23, v25, 3, v23
    v_add_u32 v4, s3, v23
    v_and_b32 v24, 1, v21
    v_lshlrev_b32 v24, 5, v24
    v_xor_b32 v5, v24, v1
    v_add_u32 v5, 155648, v5
    v_and_b32 v23, 1, v21
    v_lshlrev_b32 v23, 5, v23
    v_or_b32 v13, 32, v3
    v_xor_b32 v13, v13, v23
    v_lshrrev_b32 v14, 1, v1
    v_lshlrev_b32 v23, 9, v21
    v_lshl_add_u32 v7, v20, 4, v23
    v_add_u32 v6, 147456, v7
    v_lshrrev_b32 v23, 3, v20
    v_lshl_add_u32 v23, v23, 2, v21
    v_lshlrev_b32 v23, 11, v23
    v_and_b32 v25, 7, v20
    v_lshl_add_u32 v23, v25, 3, v23
    s_lshl_b32 s3, s6, 14
    s_lshl_b32 s40, s5, 6
    s_add_u32 s3, s3, s40
    v_add_u32 v10, s3, v23
    v_and_b32 v23, 12, v20
    v_bfe_u32 v25, v20, 1, 1
    v_add_u32 v23, v23, v25
    v_lshlrev_b32 v23, 4, v23
    v_lshl_add_u32 v23, v21, 8, v23
    v_and_b32 v25, 1, v20
    v_lshl_add_u32 v23, v25, 3, v23
    s_lshl_b32 s3, s6, 10
    s_add_u32 s3, s3, 155648
    v_add3_u32 v11, s3, v23, v24
    v_lshlrev_b32 v8, 7, v20
    v_lshl_add_u32 v8, v21, 13, v8
    v_cmp_eq_u32 vcc, 2, v21
    s_nop 1
    v_cndmask_b32 v8, v8, v22, vcc
    v_cmp_eq_u32 vcc, 3, v21
    s_nop 1
    v_cndmask_b32 v8, v8, v12, vcc
    s_lshl_b32 s3, s7, 11
    s_add_u32 s3, s3, s5
    s_lshl_b32 s40, s6, 11
    s_add_u32 s48, s48, s40
    s_lshl_b32 s63, s6, 9
    s_add_u32 s50, s50, s63
    s_lshl_b32 s41, s6, 29
    s_add_u32 s59, s49, s41
    s_sub_u32 s59, s59, 4064
    s_add_u32 s45, s46, s40
    s_add_u32 s46, s46, 8192
    s_add_u32 m0, s40, 147456
    s_mov_b32 s44, 0
    s_mov_b32 s54, 0x3e0293ee
    s_mov_b32 s56, 0
    s_mov_b32 s57, 0xffff
    s_mov_b32 s36, 0
    s_mov_b32 s37, 0xffff0000
    s_mov_b32 s64, 0x30003
    s_mov_b32 s65, 0x30003
    s_mov_b32 s66, 0x300030
    s_mov_b32 s67, 0x300030
    s_mov_b32 s68, 0x3000300
    s_mov_b32 s69, 0x3000300
    s_mov_b32 s70, 0x30003000
    s_mov_b32 s71, 0x30003000
    s_mov_b32 s72, 0x000f000f
    s_mov_b32 s73, 0x000f000f
    s_mov_b32 s74, 0xcccccccc
    s_mov_b32 s75, 0xcccccccc
    s_mov_b32 s38, 0x3f803f80
    s_mov_b32 s39, 0x3f803f80
    s_add_u32 s58, s47, 0x10000
    s_add_u32 s60, s47, 0x20000
    s_add_u32 s61, s47, 0x30000
    s_mov_b32 s53, 0
    v_and_b32 v25, 31, v0
    v_lshlrev_b32 v25, 2, v25
    s_lshl_b32 s40, s4, 7
    s_add_u32 s40, s40, 573440
    s_and_b32 s3, s5, 0
    s_lshl_b32 s3, s3, 2
    s_add_u32 s40, s40, s3
Lw_193:
    buffer_load_dword v24, v25, s[8:11], s40 offen offset:0 sc1
    s_waitcnt vmcnt(0)
    v_cmp_eq_u32 vcc, 0, v24
    s_cbranch_vccz Lwd_194
    s_sleep 1
    s_sub_u32 s98, s98, 1
    s_cbranch_scc1 L_end
    s_branch Lw_193
Lwd_194:
    v_readfirstlane_b32 s3, v24
    s_nop 1
    v_cmp_ne_u32 vcc, s3, v24
    s_cbranch_vccnz L_chain_mixed_pre
    s_branch L_chain_pure_pre
L_chain_pure_pre:
    v_mov_b32 v0, 0x3f80
    v_mov_b32 v23, 0x3f800000
    s_mov_b32 s40, 0xaaaaaaaa
    s_mov_b32 s41, 0xaaaaaaaa
    v_cndmask_b32 v0, v0, v23, s[40:41]
    ds_read_b128 v[48:51], v9 offset:49152
    ds_read_b128 v[52:55], v9 offset:50176
    ds_read_b128 v[56:59], v9 offset:51200
    ds_read_b128 v[60:63], v9 offset:52224
    ds_read_b128 v[64:67], v9 offset:53248
    ds_read_b128 v[68:71], v9 offset:54272
    ds_read_b128 v[72:75], v9 offset:55296
    ds_read_b128 v[76:79], v9 offset:56320
    s_branch L_chain_pure
    .p2align 6
L_chain_pure:
    v_cmp_eq_u32 vcc, 0, v15
    s_and_b64 vcc, vcc, s[56:57]
    s_cbranch_scc1 L_chain_pure_kvw
L_chain_pure_kvr:
    s_nop 2
    v_mov_b32 v108, 0
    s_nop 2
    v_mov_b32 v108, 0
    s_nop 2
    v_mov_b32 v108, 0
    s_nop 2
    v_mov_b32 v108, 0
    s_nop 2
    v_mov_b32 v108, 0
    s_nop 2
    v_mov_b32 v108, 0
    s_nop 2
    v_mov_b32 v108, 0
    buffer_load_dwordx4 v[16:19], v1, s[8:11], s45 offen sc1
    buffer_load_dwordx4 v[20:23], v1, s[8:11], s45 offen offset:1024 sc1
    s_add_u32 s42, s48, 8192
    s_mov_b32 s55, s48
    s_cmp_lt_u32 s44, 63
    s_cselect_b32 s40, 28672, 0
    s_cselect_b32 s41, 4096, 0
    s_add_u32 s48, s48, s40
    s_add_u32 s49, s49, s41
    s_add_u32 s3, s46, 8192
    v_mov_b32 v104, s48
    v_mov_b32 v112, s49
    v_mov_b32 v113, s3
    v_cndmask_b32 v104, v104, v112, s[56:57]
    v_cndmask_b32 v104, v104, v113, s[36:37]
    v_add_u32 v104, v104, v8
    v_xor_b32 v105, 2048, v3
    v_xor_b32 v106, 4096, v3
    v_xor_b32 v107, 6144, v3
    s_xor_b32 s53, s53, 1
    v_xor_b32 v109, 32, v4
    v_mov_b64 v[80:81], 0
    v_mov_b64 v[82:83], 0
    v_mov_b64 v[84:85], 0
    v_mov_b64 v[86:87], 0
    v_mov_b64 v[88:89], 0
    v_mov_b64 v[90:91], 0
    v_mov_b64 v[92:93], 0
    v_mov_b64 v[94:95], 0
    v_mov_b64 v[96:97], 0
    v_mov_b64 v[98:99], 0
    v_mov_b64 v[100:101], 0
    v_mov_b64 v[102:103], 0
    s_nop 2
    v_mov_b32 v108, 0
    s_nop 0
    v_mov_b32 v108, 0
    buffer_load_dwordx4 v[112:115], v1, s[8:11], s45 offen sc1
    buffer_load_dwordx4 v[116:119], v1, s[8:11], s45 offen offset:1024 sc1
    .p2align 5
    v_mov_b32 v108, 0
    v_mov_b32 v108, 0
    v_mov_b32 v108, 0
    v_mov_b32 v108, 0
    s_waitcnt vmcnt(2) lgkmcnt(0)
    v_max_u32 v108, v16, v20
    v_cmp_eq_u32 vcc, s62, v108
    s_cbranch_vccnz L_chain_pure_h2r
L_chain_pure_h2:
    ds_write_b128 v3, v[16:19]
    v_smfmac_f32_16x16x64_bf16 v[96:99], v[16:19], v[128:135], v2
    ds_write_b128 v3, v[20:23] offset:1024
    v_smfmac_f32_16x16x64_bf16 v[100:103], v[16:19], v[192:199], v2
    buffer_load_dwordx4 v1, s[8:11], s55 offen sc1 lds
    v_smfmac_f32_16x16x64_bf16 v[96:99], v[20:23], v[136:143], v2
    buffer_load_dwordx4 v1, s[8:11], s55 offen offset:1024 sc1 lds
    v_smfmac_f32_16x16x64_bf16 v[80:83], v[16:19], v[48:55], v2
    s_waitcnt lgkmcnt(0)
    s_barrier
    ds_read_b128 v[24:27], v105 offset:0
    v_smfmac_f32_16x16x64_bf16 v[84:87], v[16:19], v[56:63], v2
    ds_read_b128 v[28:31], v105 offset:1024
    v_smfmac_f32_16x16x64_bf16 v[80:83], v[20:23], v[64:71], v2
    ds_read_b128 v[32:35], v106 offset:0
    v_smfmac_f32_16x16x64_bf16 v[84:87], v[20:23], v[72:79], v2
    ds_read_b128 v[36:39], v106 offset:1024
    v_smfmac_f32_16x16x64_bf16 v[88:91], v[16:19], a[128:135], v2
    ds_read_b128 v[40:43], v107 offset:0
    v_smfmac_f32_16x16x64_bf16 v[92:95], v[16:19], a[192:199], v2
    ds_read_b128 v[44:47], v107 offset:1024
    v_smfmac_f32_16x16x64_bf16 v[88:91], v[20:23], a[136:143], v2
    buffer_load_dwordx4 v[120:123], v7, s[8:11], s42 offen sc1
    v_smfmac_f32_16x16x64_bf16 v[92:95], v[20:23], a[200:207], v2
    s_waitcnt lgkmcnt(5)
    v_smfmac_f32_16x16x64_bf16 v[80:83], v[24:27], a[16:23], v2
    buffer_load_dwordx4 v[124:127], v7, s[8:11], s42 offen offset:256 sc1
    v_smfmac_f32_16x16x64_bf16 v[84:87], v[24:27], a[80:87], v2
    s_waitcnt lgkmcnt(3)
    v_smfmac_f32_16x16x64_bf16 v[80:83], v[28:31], a[24:31], v2
    v_smfmac_f32_16x16x64_bf16 v[84:87], v[28:31], a[88:95], v2
    v_smfmac_f32_16x16x64_bf16 v[80:83], v[32:35], a[32:39], v2
    v_smfmac_f32_16x16x64_bf16 v[84:87], v[32:35], a[96:103], v2
    s_waitcnt lgkmcnt(0)
    v_smfmac_f32_16x16x64_bf16 v[80:83], v[36:39], a[40:47], v2
    v_smfmac_f32_16x16x64_bf16 v[84:87], v[36:39], a[104:111], v2
    buffer_load_dword v15, v104, s[8:11], 0 offen sc1
    v_smfmac_f32_16x16x64_bf16 v[80:83], v[40:43], a[48:55], v2
    s_add_u32 s59, s59, 4096
    s_add_u32 s45, s45, 8192
    v_smfmac_f32_16x16x64_bf16 v[84:87], v[40:43], a[112:119], v2
    v_smfmac_f32_16x16x64_bf16 v[80:83], v[44:47], a[56:63], v2
    v_smfmac_f32_16x16x64_bf16 v[84:87], v[44:47], a[120:127], v2
    buffer_store_dword v2, off, s[8:11], s59 sc1
    v_smfmac_f32_16x16x64_bf16 v[88:91], v[24:27], a[144:151], v2
    s_nop 1
    v_smfmac_f32_16x16x64_bf16 v[92:95], v[24:27], a[208:215], v2
    s_nop 1
    v_add_f32 v80, v80, v82
    v_smfmac_f32_16x16x64_bf16 v[88:91], v[28:31], a[152:159], v2
    s_waitcnt vmcnt(4)
    s_barrier
    v_add_f32 v81, v81, v83
    v_smfmac_f32_16x16x64_bf16 v[92:95], v[28:31], a[216:223], v2
    ds_read_b128 v[48:51], v6 offset:0
    v_add_f32 v84, v84, v86
    v_smfmac_f32_16x16x64_bf16 v[88:91], v[32:35], a[160:167], v2
    ds_read_b128 v[52:55], v6 offset:256
    v_add_f32 v85, v85, v87
    v_smfmac_f32_16x16x64_bf16 v[92:95], v[32:35], a[224:231], v2
    ds_read_b128 v[56:59], v6 offset:2048
    v_mul_f32 v80, s54, v80
    v_smfmac_f32_16x16x64_bf16 v[88:91], v[36:39], a[168:175], v2
    ds_read_b128 v[60:63], v6 offset:2304
    v_mul_f32 v84, s54, v84
    v_smfmac_f32_16x16x64_bf16 v[92:95], v[36:39], a[232:239], v2
    ds_read_b128 v[64:67], v6 offset:4096
    v_mul_f32 v81, s54, v81
    v_smfmac_f32_16x16x64_bf16 v[88:91], v[40:43], a[176:183], v2
    ds_read_b128 v[68:71], v6 offset:4352
    v_mul_f32 v85, s54, v85
    v_smfmac_f32_16x16x64_bf16 v[92:95], v[40:43], a[240:247], v2
    ds_read_b128 v[72:75], v6 offset:6144
    v_cvt_pk_bf16_f32 v82, v80, v84
    v_smfmac_f32_16x16x64_bf16 v[88:91], v[44:47], a[184:191], v2
    ds_read_b128 v[76:79], v6 offset:6400
    v_cvt_pk_bf16_f32 v83, v81, v85
    v_smfmac_f32_16x16x64_bf16 v[92:95], v[44:47], a[248:255], v2
    ds_write2_b32 v109, v82, v83 offset1:4
    s_nop 1
    v_smfmac_f32_16x16x64_bf16 v[100:103], v[20:23], v[200:207], v2
    ds_read_b128 v[16:19], v9 offset:0
    ds_read_b128 v[20:23], v9 offset:1024
    v_add_f32 v88, v88, v90
    v_add_f32 v89, v89, v91
    v_smfmac_f32_16x16x64_bf16 v[96:99], v[24:27], v[144:151], v2
    v_add_f32 v92, v92, v94
    v_add_f32 v93, v93, v95
    v_smfmac_f32_16x16x64_bf16 v[100:103], v[24:27], v[208:215], v2
    v_cvt_pk_bf16_f32 v90, v88, v92
    v_cvt_pk_bf16_f32 v91, v89, v93
    v_smfmac_f32_16x16x64_bf16 v[96:99], v[28:31], v[152:159], v2
    ds_write2_b32 v4, v90, v91 offset1:4
    v_smfmac_f32_16x16x64_bf16 v[100:103], v[28:31], v[216:223], v2
    ds_read_b128 v[24:27], v9 offset:2048
    v_smfmac_f32_16x16x64_bf16 v[96:99], v[32:35], v[160:167], v2
    ds_read_b128 v[28:31], v9 offset:3072
    v_smfmac_f32_16x16x64_bf16 v[100:103], v[32:35], v[224:231], v2
    v_smfmac_f32_16x16x64_bf16 v[96:99], v[36:39], v[168:175], v2
    s_waitcnt lgkmcnt(2)
    s_barrier
    ds_read_b128 v[104:107], v5 offset:0
    v_smfmac_f32_16x16x64_bf16 v[100:103], v[36:39], v[232:239], v2
    ds_read_b128 v[108:111], v5 offset:1024
    ds_read_b128 v[112:115], v5 offset:2048
    v_smfmac_f32_16x16x64_bf16 v[96:99], v[40:43], v[176:183], v2
    ds_read_b128 v[116:119], v5 offset:3072
    ds_read_b64 v[94:95], v11
    v_smfmac_f32_16x16x64_bf16 v[100:103], v[40:43], v[240:247], v2
    ds_read_b128 v[32:35], v9 offset:4096
    v_smfmac_f32_16x16x64_bf16 v[96:99], v[44:47], v[184:191], v2
    ds_read_b128 v[36:39], v9 offset:5120
    v_smfmac_f32_16x16x64_bf16 v[100:103], v[44:47], v[248:255], v2
    s_waitcnt lgkmcnt(6)
    ds_read_b128 v[40:43], v9 offset:6144
    v_mfma_f32_16x16x32_bf16 v[88:91], v[104:107], v[104:107], 0
    ds_read_b128 v[44:47], v9 offset:7168
    v_mfma_f32_16x16x32_bf16 v[80:83], v[48:51], v[104:107], 0
    s_waitcnt vmcnt(2) lgkmcnt(4)
    v_mfma_f32_16x16x32_bf16 v[84:87], v[52:55], v[104:107], 0
    buffer_store_dwordx2 v[94:95], v14, s[8:11], s50 offen sc1
    v_add_f32 v96, v96, v98
    v_mfma_f32_16x16x32_bf16 v[88:91], v[108:111], v[108:111], v[88:91]
    ds_read_b128 v[48:51], v9 offset:16384
    v_add_f32 v97, v97, v99
    v_add_f32 v100, v100, v102
    v_mfma_f32_16x16x32_bf16 v[80:83], v[56:59], v[108:111], v[80:83]
    ds_read_b128 v[52:55], v9 offset:17408
    v_add_f32 v101, v101, v103
    v_cvt_pk_bf16_f32 v98, v96, v97
    v_mfma_f32_16x16x32_bf16 v[84:87], v[60:63], v[108:111], v[84:87]
    v_cvt_pk_bf16_f32 v99, v100, v101
    v_mfma_f32_16x16x32_bf16 v[88:91], v[112:115], v[112:115], v[88:91]
    buffer_store_dwordx2 v[98:99], v14, s[8:11], s50 offen offset:2048 sc1
    v_mov_b64 v[100:101], s[38:39]
    v_mfma_f32_16x16x32_bf16 v[80:83], v[64:67], v[112:115], v[80:83]
    ds_read_b128 v[56:59], v9 offset:20480
    v_mov_b64 v[102:103], s[38:39]
    v_mov_b32 v109, 0
    v_mfma_f32_16x16x32_bf16 v[84:87], v[68:71], v[112:115], v[84:87]
    ds_read_b128 v[60:63], v9 offset:21504
    v_mov_b32 v110, 0
    v_mfma_f32_16x16x32_bf16 v[88:91], v[116:119], v[116:119], v[88:91]
    ds_read_b128 v[64:67], v9 offset:32768
    s_cmp_eq_u32 s44, 63
    v_mfma_f32_16x16x32_bf16 v[80:83], v[72:75], v[116:119], v[80:83]
    ds_read_b128 v[68:71], v9 offset:33792
    s_cbranch_scc1 L_chain_done
    v_mfma_f32_16x16x32_bf16 v[84:87], v[76:79], v[116:119], v[84:87]
    ds_read_b128 v[72:75], v9 offset:18432
    ds_read_b128 v[76:79], v9 offset:19456
    v_max_f32 v92, v88, v89
    s_add_u32 s50, s50, 28672
    s_add_u32 s44, s44, 1
    v_max3_f32 v92, v92, v80, v81
    v_max3_f32 v92, v92, v82, v83
    v_xor_b32 v90, 4096, v13
    v_max3_f32 v93, v92, v84, v85
    v_max3_f32 v92, v93, v86, v87
    v_max3_f32 v93, v93, v86, v87
    s_nop 1
    v_permlane16_swap_b32 v93, v92
    v_max_f32 v94, v92, v93
    v_max_f32 v92, v92, v93
    s_nop 1
    v_permlane32_swap_b32 v94, v92
    v_max_f32 v92, v92, v94
    v_pk_add_f32 v[88:89], v[88:89], v[92:93] op_sel_hi:[1,0] neg_lo:[0,1] neg_hi:[0,1]
    v_pk_add_f32 v[80:81], v[80:81], v[92:93] op_sel_hi:[1,0] neg_lo:[0,1] neg_hi:[0,1]
    v_pk_add_f32 v[82:83], v[82:83], v[92:93] op_sel_hi:[1,0] neg_lo:[0,1] neg_hi:[0,1]
    v_pk_add_f32 v[84:85], v[84:85], v[92:93] op_sel_hi:[1,0] neg_lo:[0,1] neg_hi:[0,1]
    v_pk_add_f32 v[86:87], v[86:87], v[92:93] op_sel_hi:[1,0] neg_lo:[0,1] neg_hi:[0,1]
    v_exp_f32 v88, v88
    v_exp_f32 v89, v89
    v_exp_f32 v80, v80
    v_cvt_pk_bf16_f32 v108, v88, v89
    v_cvt_pk_bf16_f32 v111, v88, v89
    v_exp_f32 v81, v81
    v_mfma_f32_16x16x16_bf16 v[92:95], v[100:101], v[108:109], 0
    v_exp_f32 v82, v82
    v_mfma_f32_16x16x16_bf16 v[112:115], v[98:99], v[108:109], 0
    v_exp_f32 v83, v83
    v_mfma_f32_16x16x16_bf16 v[116:119], v[98:99], v[110:111], 0
    v_exp_f32 v84, v84
    v_exp_f32 v85, v85
    v_exp_f32 v86, v86
    v_exp_f32 v87, v87
    v_cvt_pk_bf16_f32 v104, v80, v81
    v_cvt_pk_bf16_f32 v107, v86, v87
    v_cvt_pk_bf16_f32 v105, v82, v83
    v_cvt_pk_bf16_f32 v106, v84, v85
    v_mov_b64 v[108:109], 0
    v_mov_b64 v[110:111], 0
    v_mfma_f32_16x16x32_bf16 v[92:95], v[100:103], v[104:107], v[92:95]
    v_mov_b64 v[96:97], 0
    v_mov_b64 v[98:99], 0
    v_mfma_f32_16x16x32_bf16 v[112:115], v[120:123], v[104:107], v[112:115]
    v_mov_b64 v[100:101], 0
    v_mov_b64 v[102:103], 0
    v_mfma_f32_16x16x32_bf16 v[116:119], v[124:127], v[104:107], v[116:119]
    ds_read_b128 v[120:123], v9 offset:22528
    v_mov_b64 v[104:105], 0
    v_rcp_f32 v92, v92
    ds_read_b128 v[124:127], v9 offset:23552
    v_mov_b64 v[106:107], 0
    v_pk_mul_f32 v[112:113], v[112:113], v[92:93] op_sel_hi:[1,0]
    v_pk_mul_f32 v[114:115], v[114:115], v[92:93] op_sel_hi:[1,0]
    v_cvt_pk_bf16_f32 v80, v112, v113
    v_pk_mul_f32 v[116:117], v[116:117], v[92:93] op_sel_hi:[1,0]
    v_pk_mul_f32 v[118:119], v[118:119], v[92:93] op_sel_hi:[1,0]
    v_cvt_pk_bf16_f32 v81, v114, v115
    v_cvt_pk_bf16_f32 v82, v116, v117
    v_cvt_pk_bf16_f32 v83, v118, v119
    s_mov_b64 exec, s[74:75]
    ds_write_b128 v13, v[80:83] offset:8192
    s_mov_b64 exec, -1
    v_mov_b32_dpp v80, v80 quad_perm:[2,3,2,3] row_mask:0xf bank_mask:0xf
    v_mov_b32_dpp v81, v81 quad_perm:[2,3,2,3] row_mask:0xf bank_mask:0xf
    v_mov_b32_dpp v82, v82 quad_perm:[2,3,2,3] row_mask:0xf bank_mask:0xf
    v_mov_b32_dpp v83, v83 quad_perm:[2,3,2,3] row_mask:0xf bank_mask:0xf
    v_xor_b32 v85, 2048, v13
    v_xor_b32 v94, 6144, v13
    v_smfmac_f32_16x16x64_bf16 v[104:107], v[80:83], v[16:23], v2
    s_waitcnt lgkmcnt(15)
    ds_read_b128 v[112:115], v9 offset:34816
    ds_read_b128 v[116:119], v9 offset:35840
    v_smfmac_f32_16x16x64_bf16 v[108:111], v[80:83], v[24:31], v2
    s_waitcnt lgkmcnt(2)
    s_barrier
    ds_read_b128 v[84:87], v85 offset:8192
    ds_read_b128 v[88:91], v90 offset:8192
    ds_read_b128 v[92:95], v94 offset:8192
    v_smfmac_f32_16x16x64_bf16 v[96:99], v[80:83], v[32:39], v2
    ds_read_b128 v[16:19], v9 offset:36864
    ds_read_b128 v[20:23], v9 offset:37888
    v_smfmac_f32_16x16x64_bf16 v[100:103], v[80:83], v[40:47], v2
    s_waitcnt lgkmcnt(4)
    v_smfmac_f32_16x16x64_bf16 v[104:107], v[84:87], v[48:55], v2
    s_waitcnt lgkmcnt(2)
    v_smfmac_f32_16x16x64_bf16 v[104:107], v[88:91], v[56:63], v2
    ds_read_b128 v[24:27], v9 offset:38912
    v_smfmac_f32_16x16x64_bf16 v[104:107], v[92:95], v[64:71], v2
    ds_read_b128 v[28:31], v9 offset:39936
    s_nop 0
    v_smfmac_f32_16x16x64_bf16 v[108:111], v[84:87], v[72:79], v2
    s_nop 1
    v_smfmac_f32_16x16x64_bf16 v[108:111], v[88:91], v[120:127], v2
    s_nop 1
    v_cvt_pk_bf16_f32 v104, v104, v106
    v_smfmac_f32_16x16x64_bf16 v[108:111], v[92:95], v[112:119], v2
    s_nop 0
    v_cvt_pk_bf16_f32 v105, v105, v107
    v_smfmac_f32_16x16x64_bf16 v[96:99], v[84:87], a[0:7], v2
    s_waitcnt lgkmcnt(0)
    s_nop 0
    v_bfi_b32 v104, 1, s53, v104
    v_smfmac_f32_16x16x64_bf16 v[96:99], v[88:91], a[8:15], v2
    buffer_store_dwordx2 v[104:105], v10, s[8:11], s47 offen
    v_cvt_pk_bf16_f32 v108, v108, v110
    v_smfmac_f32_16x16x64_bf16 v[96:99], v[92:95], v[16:23], v2
    s_nop 0
    v_cvt_pk_bf16_f32 v109, v109, v111
    v_smfmac_f32_16x16x64_bf16 v[100:103], v[84:87], a[64:71], v2
    s_nop 1
    v_bfi_b32 v108, 1, s53, v108
    v_smfmac_f32_16x16x64_bf16 v[100:103], v[88:91], a[72:79], v2
    buffer_store_dwordx2 v[108:109], v10, s[8:11], s58 offen
    v_cvt_pk_bf16_f32 v96, v96, v98
    v_smfmac_f32_16x16x64_bf16 v[100:103], v[92:95], v[24:31], v2
    s_nop 1
    v_cvt_pk_bf16_f32 v97, v97, v99
    v_bfi_b32 v96, 1, s53, v96
    buffer_store_dwordx2 v[96:97], v10, s[8:11], s60 offen
    v_cndmask_b32 v108, 0, v0, s[64:65]
    v_cndmask_b32 v109, 0, v0, s[66:67]
    v_cndmask_b32 v110, 0, v0, s[68:69]
    v_cvt_pk_bf16_f32 v100, v100, v102
    v_cvt_pk_bf16_f32 v101, v101, v103
    v_bfi_b32 v100, 1, s53, v100
    buffer_store_dwordx2 v[100:101], v10, s[8:11], s61 offen
    v_cndmask_b32 v111, 0, v0, s[70:71]
    s_nop 2
    v_mov_b32 v80, 0
    s_nop 2
    v_mov_b32 v80, 0
    s_nop 2
    v_mov_b32 v80, 0
    s_nop 2
    v_mov_b32 v80, 0
    s_nop 2
    v_mov_b32 v80, 0
    s_nop 0
    v_mov_b32 v80, 0
    s_cmp_lt_u32 s6, 1
    s_cbranch_scc1 L_chain_pure_p1
    s_nop 2
    v_mov_b32 v80, 0
    s_nop 2
    v_mov_b32 v80, 0
    s_nop 2
    v_mov_b32 v80, 0
    s_nop 0
    v_mov_b32 v80, 0
    s_cmp_lt_u32 s6, 2
    s_cbranch_scc1 L_chain_pure_p1
    s_nop 2
    v_mov_b32 v80, 0
    s_nop 2
    v_mov_b32 v80, 0
    s_nop 2
    v_mov_b32 v80, 0
    s_nop 0
    v_mov_b32 v80, 0
    s_cmp_lt_u32 s6, 3
    s_cbranch_scc1 L_chain_pure_p1
    s_nop 2
    v_mov_b32 v80, 0
    s_nop 2
    v_mov_b32 v80, 0
    s_nop 2
    v_mov_b32 v80, 0
    s_nop 2
    v_mov_b32 v80, 0
    s_nop 0
    v_mov_b32 v80, 0
L_chain_pure_p1:
    buffer_load_dwordx4 v[24:27], v1, s[8:11], s52 offen sc1
    buffer_load_dwordx4 v[28:31], v1, s[8:11], s52 offen offset:1024 sc1
    ds_read_b128 v[48:51], v9 offset:49152
    ds_read_b128 v[52:55], v9 offset:50176
    ds_read_b128 v[56:59], v9 offset:51200
    ds_read_b128 v[60:63], v9 offset:52224
    ds_read_b128 v[64:67], v9 offset:53248
    ds_read_b128 v[68:71], v9 offset:54272
    ds_read_b128 v[72:75], v9 offset:55296
    ds_read_b128 v[76:79], v9 offset:56320
    s_nop 2
    v_mov_b32 v80, 0
    s_nop 2
    v_mov_b32 v80, 0
    s_nop 2
    v_mov_b32 v80, 0
    s_nop 2
    v_mov_b32 v80, 0
    s_nop 2
    v_mov_b32 v80, 0
    s_nop 2
    v_mov_b32 v80, 0
    s_nop 2
    v_mov_b32 v80, 0
    buffer_load_dwordx4 v[32:35], v1, s[8:11], s52 offen sc1
    buffer_load_dwordx4 v[36:39], v1, s[8:11], s52 offen offset:1024 sc1
    s_waitcnt vmcnt(2)
L_chain_pure_h1:
    v_mfma_f32_16x16x32_bf16 v[96:99], v[108:111], v[24:27], 0
    v_mfma_f32_16x16x32_bf16 v[96:99], v[108:111], v[28:31], v[96:99]
    v_bitop3_b32 v80, v24, v26, s53 bitop3:0x7e
    v_bitop3_b32 v81, v28, v30, s53 bitop3:0x7e
    v_bitop3_b32 v80, v80, v81, 1 bitop3:0xa8
    v_cmp_ne_u32 vcc, 0, v80
    s_cbranch_vccnz L_chain_pure_h1r
    s_nop 2
    v_add_f32_dpp v96, v96, v96 row_ror:4 row_mask:0xf bank_mask:0xf
    v_add_f32_dpp v97, v97, v97 row_ror:4 row_mask:0xf bank_mask:0xf
    s_nop 0
    v_add_f32_dpp v96, v96, v96 row_ror:8 row_mask:0xf bank_mask:0xf
    v_add_f32_dpp v97, v97, v97 row_ror:8 row_mask:0xf bank_mask:0xf
    s_mov_b64 exec, s[72:73]
    v_cvt_pk_bf16_f32 v82, v96, v97
    buffer_store_dword v82, v12, s[8:11], s46 offen
    s_mov_b64 exec, -1
    s_add_u32 s46, s46, 8192
    s_branch L_chain_pure
L_chain_pure_h2r:
    s_mov_b64 exec, vcc
    buffer_load_dwordx4 v[120:123], v1, s[8:11], s45 offen sc1
    buffer_load_dwordx4 v[124:127], v1, s[8:11], s45 offen offset:1024 sc1
    s_waitcnt vmcnt(2)
    v_max_u32 v108, v112, v116
    v_cmp_eq_u32 vcc, s62, v108
    v_mov_b64 v[16:17], v[112:113]
    v_mov_b64 v[18:19], v[114:115]
    v_mov_b64 v[20:21], v[116:117]
    v_mov_b64 v[22:23], v[118:119]
    s_mov_b64 exec, -1
    s_cbranch_vccz L_chain_pure_h2
    s_mov_b64 exec, vcc
    buffer_load_dwordx4 v[112:115], v1, s[8:11], s45 offen sc1
    buffer_load_dwordx4 v[116:119], v1, s[8:11], s45 offen offset:1024 sc1
    s_sub_u32 s98, s98, 1
    s_cbranch_scc1 L_end
    s_waitcnt vmcnt(2)
    v_max_u32 v108, v120, v124
    v_cmp_eq_u32 vcc, s62, v108
    v_mov_b64 v[16:17], v[120:121]
    v_mov_b64 v[18:19], v[122:123]
    v_mov_b64 v[20:21], v[124:125]
    v_mov_b64 v[22:23], v[126:127]
    s_mov_b64 exec, -1
    s_cbranch_vccz L_chain_pure_h2
    s_branch L_chain_pure_h2r
L_chain_pure_h1r:
    s_mov_b64 exec, vcc
    buffer_load_dwordx4 v[40:43], v1, s[8:11], s52 offen sc1
    buffer_load_dwordx4 v[44:47], v1, s[8:11], s52 offen offset:1024 sc1
    s_waitcnt vmcnt(2)
    v_bitop3_b32 v80, v32, v34, s53 bitop3:0x7e
    v_bitop3_b32 v81, v36, v38, s53 bitop3:0x7e
    v_bitop3_b32 v80, v80, v81, 1 bitop3:0xa8
    v_cmp_ne_u32 vcc, 0, v80
    v_mov_b64 v[24:25], v[32:33]
    v_mov_b64 v[26:27], v[34:35]
    v_mov_b64 v[28:29], v[36:37]
    v_mov_b64 v[30:31], v[38:39]
    s_mov_b64 exec, -1
    s_cbranch_vccz L_chain_pure_h1
    s_mov_b64 exec, vcc
    buffer_load_dwordx4 v[32:35], v1, s[8:11], s52 offen sc1
    buffer_load_dwordx4 v[36:39], v1, s[8:11], s52 offen offset:1024 sc1
    s_sub_u32 s98, s98, 1
    s_cbranch_scc1 L_end
    s_waitcnt vmcnt(2)
    v_bitop3_b32 v80, v40, v42, s53 bitop3:0x7e
    v_bitop3_b32 v81, v44, v46, s53 bitop3:0x7e
    v_bitop3_b32 v80, v80, v81, 1 bitop3:0xa8
    v_cmp_ne_u32 vcc, 0, v80
    v_mov_b64 v[24:25], v[40:41]
    v_mov_b64 v[26:27], v[42:43]
    v_mov_b64 v[28:29], v[44:45]
    v_mov_b64 v[30:31], v[46:47]
    s_mov_b64 exec, -1
    s_cbranch_vccz L_chain_pure_h1
    s_branch L_chain_pure_h1r
L_chain_pure_kvw:
    v_mov_b32 v112, 0
Lw_195:
    buffer_load_dword v15, v112, s[8:11], s49 offen offset:0 sc1
    s_waitcnt vmcnt(0)
    v_cmp_eq_u32 vcc, 0, v15
    s_cbranch_vccz Lwd_196
    s_sleep 1
    s_sub_u32 s98, s98, 1
    s_cbranch_scc1 L_end
    s_branch Lw_195
Lwd_196:
    s_branch L_chain_pure_kvr
L_chain_mixed_pre:
    v_mov_b32 v0, 0x3f80
    v_mov_b32 v23, 0x3f800000
    s_mov_b32 s40, 0xaaaaaaaa
    s_mov_b32 s41, 0xaaaaaaaa
    v_cndmask_b32 v0, v0, v23, s[40:41]
    ds_read_b128 v[48:51], v9 offset:49152
    ds_read_b128 v[52:55], v9 offset:50176
    ds_read_b128 v[56:59], v9 offset:51200
    ds_read_b128 v[60:63], v9 offset:52224
    ds_read_b128 v[64:67], v9 offset:53248
    ds_read_b128 v[68:71], v9 offset:54272
    ds_read_b128 v[72:75], v9 offset:55296
    ds_read_b128 v[76:79], v9 offset:56320
    s_branch L_chain_mixed
    .p2align 6
L_chain_mixed:
    v_cmp_eq_u32 vcc, 0, v15
    s_and_b64 vcc, vcc, s[56:57]
    s_cbranch_scc1 L_chain_mixed_kvw
L_chain_mixed_kvr:
    s_nop 2
    v_mov_b32 v108, 0
    s_nop 2
    v_mov_b32 v108, 0
    s_nop 2
    v_mov_b32 v108, 0
    s_nop 2
    v_mov_b32 v108, 0
    s_nop 2
    v_mov_b32 v108, 0
    s_nop 2
    v_mov_b32 v108, 0
    s_nop 2
    v_mov_b32 v108, 0
    buffer_load_dwordx4 v[16:19], v1, s[8:11], s45 offen sc1
    buffer_load_dwordx4 v[20:23], v1, s[8:11], s45 offen offset:1024 sc1
    s_add_u32 s42, s48, 8192
    s_mov_b32 s55, s48
    s_cmp_lt_u32 s44, 63
    s_cselect_b32 s40, 28672, 0
    s_cselect_b32 s41, 4096, 0
    s_add_u32 s48, s48, s40
    s_add_u32 s49, s49, s41
    s_add_u32 s3, s46, 8192
    v_mov_b32 v104, s48
    v_mov_b32 v112, s49
    v_mov_b32 v113, s3
    v_cndmask_b32 v104, v104, v112, s[56:57]
    v_cndmask_b32 v104, v104, v113, s[36:37]
    v_add_u32 v104, v104, v8
    v_xor_b32 v105, 2048, v3
    v_xor_b32 v106, 4096, v3
    v_xor_b32 v107, 6144, v3
    s_xor_b32 s53, s53, 1
    v_xor_b32 v109, 32, v4
    v_mov_b64 v[80:81], 0
    v_mov_b64 v[82:83], 0
    v_mov_b64 v[84:85], 0
    v_mov_b64 v[86:87], 0
    v_mov_b64 v[88:89], 0
    v_mov_b64 v[90:91], 0
    v_mov_b64 v[92:93], 0
    v_mov_b64 v[94:95], 0
    v_mov_b64 v[96:97], 0
    v_mov_b64 v[98:99], 0
    v_mov_b64 v[100:101], 0
    v_mov_b64 v[102:103], 0
    s_nop 2
    v_mov_b32 v108, 0
    s_nop 0
    v_mov_b32 v108, 0
    buffer_load_dwordx4 v[112:115], v1, s[8:11], s45 offen sc1
    buffer_load_dwordx4 v[116:119], v1, s[8:11], s45 offen offset:1024 sc1
    .p2align 5
    v_mov_b32 v108, 0
    v_mov_b32 v108, 0
    v_mov_b32 v108, 0
    v_mov_b32 v108, 0
    s_waitcnt vmcnt(2) lgkmcnt(0)
    v_max_u32 v108, v16, v20
    v_cmp_eq_u32 vcc, s62, v108
    s_cbranch_vccnz L_chain_mixed_h2r
L_chain_mixed_h2:
    ds_write_b128 v3, v[16:19]
    v_smfmac_f32_16x16x64_bf16 v[96:99], v[16:19], v[128:135], v2
    ds_write_b128 v3, v[20:23] offset:1024
    v_smfmac_f32_16x16x64_bf16 v[100:103], v[16:19], v[192:199], v2
    buffer_load_dwordx4 v1, s[8:11], s55 offen sc1 lds
    v_smfmac_f32_16x16x64_bf16 v[96:99], v[20:23], v[136:143], v2
    buffer_load_dwordx4 v1, s[8:11], s55 offen offset:1024 sc1 lds
    v_smfmac_f32_16x16x64_bf16 v[80:83], v[16:19], v[48:55], v2
    s_waitcnt lgkmcnt(0)
    s_barrier
    ds_read_b128 v[24:27], v105 offset:0
    v_smfmac_f32_16x16x64_bf16 v[84:87], v[16:19], v[56:63], v2
    ds_read_b128 v[28:31], v105 offset:1024
    v_smfmac_f32_16x16x64_bf16 v[80:83], v[20:23], v[64:71], v2
    ds_read_b128 v[32:35], v106 offset:0
    v_smfmac_f32_16x16x64_bf16 v[84:87], v[20:23], v[72:79], v2
    ds_read_b128 v[36:39], v106 offset:1024
    v_smfmac_f32_16x16x64_bf16 v[88:91], v[16:19], a[128:135], v2
    ds_read_b128 v[40:43], v107 offset:0
    v_smfmac_f32_16x16x64_bf16 v[92:95], v[16:19], a[192:199], v2
    ds_read_b128 v[44:47], v107 offset:1024
    v_smfmac_f32_16x16x64_bf16 v[88:91], v[20:23], a[136:143], v2
    buffer_load_dwordx4 v[120:123], v7, s[8:11], s42 offen sc1
    v_smfmac_f32_16x16x64_bf16 v[92:95], v[20:23], a[200:207], v2
    s_waitcnt lgkmcnt(5)
    v_smfmac_f32_16x16x64_bf16 v[80:83], v[24:27], a[16:23], v2
    buffer_load_dwordx4 v[124:127], v7, s[8:11], s42 offen offset:256 sc1
    v_smfmac_f32_16x16x64_bf16 v[84:87], v[24:27], a[80:87], v2
    s_waitcnt lgkmcnt(3)
    v_smfmac_f32_16x16x64_bf16 v[80:83], v[28:31], a[24:31], v2
    v_smfmac_f32_16x16x64_bf16 v[84:87], v[28:31], a[88:95], v2
    v_smfmac_f32_16x16x64_bf16 v[80:83], v[32:35], a[32:39], v2
    v_smfmac_f32_16x16x64_bf16 v[84:87], v[32:35], a[96:103], v2
    s_waitcnt lgkmcnt(0)
    v_smfmac_f32_16x16x64_bf16 v[80:83], v[36:39], a[40:47], v2
    v_smfmac_f32_16x16x64_bf16 v[84:87], v[36:39], a[104:111], v2
    buffer_load_dword v15, v104, s[8:11], 0 offen sc1
    v_smfmac_f32_16x16x64_bf16 v[80:83], v[40:43], a[48:55], v2
    s_add_u32 s59, s59, 4096
    s_add_u32 s45, s45, 8192
    v_smfmac_f32_16x16x64_bf16 v[84:87], v[40:43], a[112:119], v2
    v_smfmac_f32_16x16x64_bf16 v[80:83], v[44:47], a[56:63], v2
    v_smfmac_f32_16x16x64_bf16 v[84:87], v[44:47], a[120:127], v2
    buffer_store_dword v2, off, s[8:11], s59 sc1
    v_smfmac_f32_16x16x64_bf16 v[88:91], v[24:27], a[144:151], v2
    s_nop 1
    v_smfmac_f32_16x16x64_bf16 v[92:95], v[24:27], a[208:215], v2
    s_nop 1
    v_add_f32 v80, v80, v82
    v_smfmac_f32_16x16x64_bf16 v[88:91], v[28:31], a[152:159], v2
    s_waitcnt vmcnt(4)
    s_barrier
    v_add_f32 v81, v81, v83
    v_smfmac_f32_16x16x64_bf16 v[92:95], v[28:31], a[216:223], v2
    ds_read_b128 v[48:51], v6 offset:0
    v_add_f32 v84, v84, v86
    v_smfmac_f32_16x16x64_bf16 v[88:91], v[32:35], a[160:167], v2
    ds_read_b128 v[52:55], v6 offset:256
    v_add_f32 v85, v85, v87
    v_smfmac_f32_16x16x64_bf16 v[92:95], v[32:35], a[224:231], v2
    ds_read_b128 v[56:59], v6 offset:2048
    v_mul_f32 v80, s54, v80
    v_smfmac_f32_16x16x64_bf16 v[88:91], v[36:39], a[168:175], v2
    ds_read_b128 v[60:63], v6 offset:2304
    v_mul_f32 v84, s54, v84
    v_smfmac_f32_16x16x64_bf16 v[92:95], v[36:39], a[232:239], v2
    ds_read_b128 v[64:67], v6 offset:4096
    v_mul_f32 v81, s54, v81
    v_smfmac_f32_16x16x64_bf16 v[88:91], v[40:43], a[176:183], v2
    ds_read_b128 v[68:71], v6 offset:4352
    v_mul_f32 v85, s54, v85
    v_smfmac_f32_16x16x64_bf16 v[92:95], v[40:43], a[240:247], v2
    ds_read_b128 v[72:75], v6 offset:6144
    v_cvt_pk_bf16_f32 v82, v80, v84
    v_smfmac_f32_16x16x64_bf16 v[88:91], v[44:47], a[184:191], v2
    ds_read_b128 v[76:79], v6 offset:6400
    v_cvt_pk_bf16_f32 v83, v81, v85
    v_smfmac_f32_16x16x64_bf16 v[92:95], v[44:47], a[248:255], v2
    ds_write2_b32 v109, v82, v83 offset1:4
    s_nop 1
    v_smfmac_f32_16x16x64_bf16 v[100:103], v[20:23], v[200:207], v2
    ds_read_b128 v[16:19], v9 offset:0
    ds_read_b128 v[20:23], v9 offset:1024
    v_add_f32 v88, v88, v90
    v_add_f32 v89, v89, v91
    v_smfmac_f32_16x16x64_bf16 v[96:99], v[24:27], v[144:151], v2
    v_add_f32 v92, v92, v94
    v_add_f32 v93, v93, v95
    v_smfmac_f32_16x16x64_bf16 v[100:103], v[24:27], v[208:215], v2
    v_cvt_pk_bf16_f32 v90, v88, v92
    v_cvt_pk_bf16_f32 v91, v89, v93
    v_smfmac_f32_16x16x64_bf16 v[96:99], v[28:31], v[152:159], v2
    ds_write2_b32 v4, v90, v91 offset1:4
    v_smfmac_f32_16x16x64_bf16 v[100:103], v[28:31], v[216:223], v2
    ds_read_b128 v[24:27], v9 offset:2048
    v_smfmac_f32_16x16x64_bf16 v[96:99], v[32:35], v[160:167], v2
    ds_read_b128 v[28:31], v9 offset:3072
    v_smfmac_f32_16x16x64_bf16 v[100:103], v[32:35], v[224:231], v2
    v_smfmac_f32_16x16x64_bf16 v[96:99], v[36:39], v[168:175], v2
    s_waitcnt lgkmcnt(2)
    s_barrier
    ds_read_b128 v[104:107], v5 offset:0
    v_smfmac_f32_16x16x64_bf16 v[100:103], v[36:39], v[232:239], v2
    ds_read_b128 v[108:111], v5 offset:1024
    ds_read_b128 v[112:115], v5 offset:2048
    v_smfmac_f32_16x16x64_bf16 v[96:99], v[40:43], v[176:183], v2
    ds_read_b128 v[116:119], v5 offset:3072
    ds_read_b64 v[94:95], v11
    v_smfmac_f32_16x16x64_bf16 v[100:103], v[40:43], v[240:247], v2
    ds_read_b128 v[32:35], v9 offset:4096
    v_smfmac_f32_16x16x64_bf16 v[96:99], v[44:47], v[184:191], v2
    ds_read_b128 v[36:39], v9 offset:5120
    v_smfmac_f32_16x16x64_bf16 v[100:103], v[44:47], v[248:255], v2
    s_waitcnt lgkmcnt(6)
    ds_read_b128 v[40:43], v9 offset:6144
    v_mfma_f32_16x16x32_bf16 v[88:91], v[104:107], v[104:107], 0
    ds_read_b128 v[44:47], v9 offset:7168
    v_mfma_f32_16x16x32_bf16 v[80:83], v[48:51], v[104:107], 0
    s_waitcnt vmcnt(2) lgkmcnt(4)
    v_mfma_f32_16x16x32_bf16 v[84:87], v[52:55], v[104:107], 0
    buffer_store_dwordx2 v[94:95], v14, s[8:11], s50 offen sc1
    v_add_f32 v96, v96, v98
    v_mfma_f32_16x16x32_bf16 v[88:91], v[108:111], v[108:111], v[88:91]
    ds_read_b128 v[48:51], v9 offset:16384
    v_add_f32 v97, v97, v99
    v_add_f32 v100, v100, v102
    v_mfma_f32_16x16x32_bf16 v[80:83], v[56:59], v[108:111], v[80:83]
    ds_read_b128 v[52:55], v9 offset:17408
    v_add_f32 v101, v101, v103
    v_cvt_pk_bf16_f32 v98, v96, v97
    v_mfma_f32_16x16x32_bf16 v[84:87], v[60:63], v[108:111], v[84:87]
    v_cvt_pk_bf16_f32 v99, v100, v101
    v_mfma_f32_16x16x32_bf16 v[88:91], v[112:115], v[112:115], v[88:91]
    buffer_store_dwordx2 v[98:99], v14, s[8:11], s50 offen offset:2048 sc1
    v_mov_b64 v[100:101], s[38:39]
    v_mfma_f32_16x16x32_bf16 v[80:83], v[64:67], v[112:115], v[80:83]
    ds_read_b128 v[56:59], v9 offset:20480
    v_mov_b64 v[102:103], s[38:39]
    v_mov_b32 v109, 0
    v_mfma_f32_16x16x32_bf16 v[84:87], v[68:71], v[112:115], v[84:87]
    ds_read_b128 v[60:63], v9 offset:21504
    v_mov_b32 v110, 0
    v_mfma_f32_16x16x32_bf16 v[88:91], v[116:119], v[116:119], v[88:91]
    ds_read_b128 v[64:67], v9 offset:32768
    s_cmp_eq_u32 s44, 63
    v_mfma_f32_16x16x32_bf16 v[80:83], v[72:75], v[116:119], v[80:83]
    ds_read_b128 v[68:71], v9 offset:33792
    s_cbranch_scc1 L_chain_done
    v_mfma_f32_16x16x32_bf16 v[84:87], v[76:79], v[116:119], v[84:87]
    ds_read_b128 v[72:75], v9 offset:18432
    ds_read_b128 v[76:79], v9 offset:19456
    v_max_f32 v92, v88, v89
    s_add_u32 s50, s50, 28672
    s_add_u32 s44, s44, 1
    v_max3_f32 v92, v92, v80, v81
    v_max3_f32 v92, v92, v82, v83
    v_xor_b32 v90, 4096, v13
    v_max3_f32 v93, v92, v84, v85
    v_max3_f32 v92, v93, v86, v87
    v_max3_f32 v93, v93, v86, v87
    s_nop 1
    v_permlane16_swap_b32 v93, v92
    v_max_f32 v94, v92, v93
    v_max_f32 v92, v92, v93
    s_nop 1
    v_permlane32_swap_b32 v94, v92
    v_max_f32 v92, v92, v94
    v_pk_add_f32 v[88:89], v[88:89], v[92:93] op_sel_hi:[1,0] neg_lo:[0,1] neg_hi:[0,1]
    v_pk_add_f32 v[80:81], v[80:81], v[92:93] op_sel_hi:[1,0] neg_lo:[0,1] neg_hi:[0,1]
    v_pk_add_f32 v[82:83], v[82:83], v[92:93] op_sel_hi:[1,0] neg_lo:[0,1] neg_hi:[0,1]
    v_pk_add_f32 v[84:85], v[84:85], v[92:93] op_sel_hi:[1,0] neg_lo:[0,1] neg_hi:[0,1]
    v_pk_add_f32 v[86:87], v[86:87], v[92:93] op_sel_hi:[1,0] neg_lo:[0,1] neg_hi:[0,1]
    v_exp_f32 v88, v88
    v_exp_f32 v89, v89
    v_exp_f32 v80, v80
    v_cvt_pk_bf16_f32 v108, v88, v89
    v_cvt_pk_bf16_f32 v111, v88, v89
    v_exp_f32 v81, v81
    v_mfma_f32_16x16x16_bf16 v[92:95], v[100:101], v[108:109], 0
    v_exp_f32 v82, v82
    v_mfma_f32_16x16x16_bf16 v[112:115], v[98:99], v[108:109], 0
    v_exp_f32 v83, v83
    v_mfma_f32_16x16x16_bf16 v[116:119], v[98:99], v[110:111], 0
    v_exp_f32 v84, v84
    v_exp_f32 v85, v85
    v_exp_f32 v86, v86
    v_exp_f32 v87, v87
    v_cvt_pk_bf16_f32 v104, v80, v81
    v_cvt_pk_bf16_f32 v107, v86, v87
    v_cvt_pk_bf16_f32 v105, v82, v83
    v_cvt_pk_bf16_f32 v106, v84, v85
    v_mov_b64 v[108:109], 0
    v_mov_b64 v[110:111], 0
    v_mfma_f32_16x16x32_bf16 v[92:95], v[100:103], v[104:107], v[92:95]
    v_mov_b64 v[96:97], 0
    v_mov_b64 v[98:99], 0
    v_mfma_f32_16x16x32_bf16 v[112:115], v[120:123], v[104:107], v[112:115]
    v_mov_b64 v[100:101], 0
    v_mov_b64 v[102:103], 0
    v_mfma_f32_16x16x32_bf16 v[116:119], v[124:127], v[104:107], v[116:119]
    ds_read_b128 v[120:123], v9 offset:22528
    v_mov_b64 v[104:105], 0
    v_rcp_f32 v92, v92
    ds_read_b128 v[124:127], v9 offset:23552
    v_mov_b64 v[106:107], 0
    v_pk_mul_f32 v[112:113], v[112:113], v[92:93] op_sel_hi:[1,0]
    v_pk_mul_f32 v[114:115], v[114:115], v[92:93] op_sel_hi:[1,0]
    v_cvt_pk_bf16_f32 v80, v112, v113
    v_pk_mul_f32 v[116:117], v[116:117], v[92:93] op_sel_hi:[1,0]
    v_pk_mul_f32 v[118:119], v[118:119], v[92:93] op_sel_hi:[1,0]
    v_cvt_pk_bf16_f32 v81, v114, v115
    v_cvt_pk_bf16_f32 v82, v116, v117
    v_cvt_pk_bf16_f32 v83, v118, v119
    s_mov_b64 exec, s[74:75]
    ds_write_b128 v13, v[80:83] offset:8192
    s_mov_b64 exec, -1
    v_mov_b32_dpp v80, v80 quad_perm:[2,3,2,3] row_mask:0xf bank_mask:0xf
    v_mov_b32_dpp v81, v81 quad_perm:[2,3,2,3] row_mask:0xf bank_mask:0xf
    v_mov_b32_dpp v82, v82 quad_perm:[2,3,2,3] row_mask:0xf bank_mask:0xf
    v_mov_b32_dpp v83, v83 quad_perm:[2,3,2,3] row_mask:0xf bank_mask:0xf
    v_xor_b32 v85, 2048, v13
    v_xor_b32 v94, 6144, v13
    v_smfmac_f32_16x16x64_bf16 v[104:107], v[80:83], v[16:23], v2
    s_waitcnt lgkmcnt(15)
    ds_read_b128 v[112:115], v9 offset:34816
    ds_read_b128 v[116:119], v9 offset:35840
    v_smfmac_f32_16x16x64_bf16 v[108:111], v[80:83], v[24:31], v2
    s_waitcnt lgkmcnt(2)
    s_barrier
    ds_read_b128 v[84:87], v85 offset:8192
    ds_read_b128 v[88:91], v90 offset:8192
    ds_read_b128 v[92:95], v94 offset:8192
    v_smfmac_f32_16x16x64_bf16 v[96:99], v[80:83], v[32:39], v2
    ds_read_b128 v[16:19], v9 offset:36864
    ds_read_b128 v[20:23], v9 offset:37888
    v_smfmac_f32_16x16x64_bf16 v[100:103], v[80:83], v[40:47], v2
    s_waitcnt lgkmcnt(4)
    v_smfmac_f32_16x16x64_bf16 v[104:107], v[84:87], v[48:55], v2
    s_waitcnt lgkmcnt(2)
    v_smfmac_f32_16x16x64_bf16 v[104:107], v[88:91], v[56:63], v2
    ds_read_b128 v[24:27], v9 offset:38912
    v_smfmac_f32_16x16x64_bf16 v[104:107], v[92:95], v[64:71], v2
    ds_read_b128 v[28:31], v9 offset:39936
    s_nop 0
    v_smfmac_f32_16x16x64_bf16 v[108:111], v[84:87], v[72:79], v2
    s_nop 1
    v_smfmac_f32_16x16x64_bf16 v[108:111], v[88:91], v[120:127], v2
    s_nop 1
    v_cvt_pk_bf16_f32 v104, v104, v106
    v_smfmac_f32_16x16x64_bf16 v[108:111], v[92:95], v[112:119], v2
    s_nop 0
    v_cvt_pk_bf16_f32 v105, v105, v107
    v_smfmac_f32_16x16x64_bf16 v[96:99], v[84:87], a[0:7], v2
    s_waitcnt lgkmcnt(0)
    s_nop 0
    v_bfi_b32 v104, 1, s53, v104
    v_smfmac_f32_16x16x64_bf16 v[96:99], v[88:91], a[8:15], v2
    buffer_store_dwordx2 v[104:105], v10, s[8:11], s47 offen sc1
    v_cvt_pk_bf16_f32 v108, v108, v110
    v_smfmac_f32_16x16x64_bf16 v[96:99], v[92:95], v[16:23], v2
    s_nop 0
    v_cvt_pk_bf16_f32 v109, v109, v111
    v_smfmac_f32_16x16x64_bf16 v[100:103], v[84:87], a[64:71], v2
    s_nop 1
    v_bfi_b32 v108, 1, s53, v108
    v_smfmac_f32_16x16x64_bf16 v[100:103], v[88:91], a[72:79], v2
    buffer_store_dwordx2 v[108:109], v10, s[8:11], s58 offen sc1
    v_cvt_pk_bf16_f32 v96, v96, v98
    v_smfmac_f32_16x16x64_bf16 v[100:103], v[92:95], v[24:31], v2
    s_nop 1
    v_cvt_pk_bf16_f32 v97, v97, v99
    v_bfi_b32 v96, 1, s53, v96
    buffer_store_dwordx2 v[96:97], v10, s[8:11], s60 offen sc1
    v_cndmask_b32 v108, 0, v0, s[64:65]
    v_cndmask_b32 v109, 0, v0, s[66:67]
    v_cndmask_b32 v110, 0, v0, s[68:69]
    v_cvt_pk_bf16_f32 v100, v100, v102
    v_cvt_pk_bf16_f32 v101, v101, v103
    v_bfi_b32 v100, 1, s53, v100
    buffer_store_dwordx2 v[100:101], v10, s[8:11], s61 offen sc1
    v_cndmask_b32 v111, 0, v0, s[70:71]
    s_nop 2
    v_mov_b32 v80, 0
    s_nop 2
    v_mov_b32 v80, 0
    s_nop 2
    v_mov_b32 v80, 0
    s_nop 2
    v_mov_b32 v80, 0
    s_nop 2
    v_mov_b32 v80, 0
    s_nop 0
    v_mov_b32 v80, 0
    s_cmp_lt_u32 s6, 1
    s_cbranch_scc1 L_chain_mixed_p1
    s_nop 2
    v_mov_b32 v80, 0
    s_nop 2
    v_mov_b32 v80, 0
    s_nop 2
    v_mov_b32 v80, 0
    s_nop 0
    v_mov_b32 v80, 0
    s_cmp_lt_u32 s6, 2
    s_cbranch_scc1 L_chain_mixed_p1
    s_nop 2
    v_mov_b32 v80, 0
    s_nop 2
    v_mov_b32 v80, 0
    s_nop 2
    v_mov_b32 v80, 0
    s_nop 0
    v_mov_b32 v80, 0
    s_cmp_lt_u32 s6, 3
    s_cbranch_scc1 L_chain_mixed_p1
    s_nop 2
    v_mov_b32 v80, 0
    s_nop 2
    v_mov_b32 v80, 0
    s_nop 2
    v_mov_b32 v80, 0
    s_nop 2
    v_mov_b32 v80, 0
    s_nop 0
    v_mov_b32 v80, 0
L_chain_mixed_p1:
    buffer_load_dwordx4 v[24:27], v1, s[8:11], s52 offen sc1
    buffer_load_dwordx4 v[28:31], v1, s[8:11], s52 offen offset:1024 sc1
    ds_read_b128 v[48:51], v9 offset:49152
    ds_read_b128 v[52:55], v9 offset:50176
    ds_read_b128 v[56:59], v9 offset:51200
    ds_read_b128 v[60:63], v9 offset:52224
    ds_read_b128 v[64:67], v9 offset:53248
    ds_read_b128 v[68:71], v9 offset:54272
    ds_read_b128 v[72:75], v9 offset:55296
    ds_read_b128 v[76:79], v9 offset:56320
    s_nop 2
    v_mov_b32 v80, 0
    s_nop 2
    v_mov_b32 v80, 0
    s_nop 2
    v_mov_b32 v80, 0
    s_nop 2
    v_mov_b32 v80, 0
    s_nop 2
    v_mov_b32 v80, 0
    s_nop 2
    v_mov_b32 v80, 0
    s_nop 2
    v_mov_b32 v80, 0
    buffer_load_dwordx4 v[32:35], v1, s[8:11], s52 offen sc1
    buffer_load_dwordx4 v[36:39], v1, s[8:11], s52 offen offset:1024 sc1
    s_waitcnt vmcnt(2)
L_chain_mixed_h1:
    v_mfma_f32_16x16x32_bf16 v[96:99], v[108:111], v[24:27], 0
    v_mfma_f32_16x16x32_bf16 v[96:99], v[108:111], v[28:31], v[96:99]
    v_bitop3_b32 v80, v24, v26, s53 bitop3:0x7e
    v_bitop3_b32 v81, v28, v30, s53 bitop3:0x7e
    v_bitop3_b32 v80, v80, v81, 1 bitop3:0xa8
    v_cmp_ne_u32 vcc, 0, v80
    s_cbranch_vccnz L_chain_mixed_h1r
    s_nop 2
    v_add_f32_dpp v96, v96, v96 row_ror:4 row_mask:0xf bank_mask:0xf
    v_add_f32_dpp v97, v97, v97 row_ror:4 row_mask:0xf bank_mask:0xf
    s_nop 0
    v_add_f32_dpp v96, v96, v96 row_ror:8 row_mask:0xf bank_mask:0xf
    v_add_f32_dpp v97, v97, v97 row_ror:8 row_mask:0xf bank_mask:0xf
    s_mov_b64 exec, s[72:73]
    v_cvt_pk_bf16_f32 v82, v96, v97
    buffer_store_dword v82, v12, s[8:11], s46 offen sc1
    s_mov_b64 exec, -1
    s_add_u32 s46, s46, 8192
    s_branch L_chain_mixed
L_chain_mixed_h2r:
    s_mov_b64 exec, vcc
    buffer_load_dwordx4 v[120:123], v1, s[8:11], s45 offen sc1
    buffer_load_dwordx4 v[124:127], v1, s[8:11], s45 offen offset:1024 sc1
    s_waitcnt vmcnt(2)
    v_max_u32 v108, v112, v116
    v_cmp_eq_u32 vcc, s62, v108
    v_mov_b64 v[16:17], v[112:113]
    v_mov_b64 v[18:19], v[114:115]
    v_mov_b64 v[20:21], v[116:117]
    v_mov_b64 v[22:23], v[118:119]
    s_mov_b64 exec, -1
    s_cbranch_vccz L_chain_mixed_h2
    s_mov_b64 exec, vcc
    buffer_load_dwordx4 v[112:115], v1, s[8:11], s45 offen sc1
    buffer_load_dwordx4 v[116:119], v1, s[8:11], s45 offen offset:1024 sc1
    s_sub_u32 s98, s98, 1
    s_cbranch_scc1 L_end
    s_waitcnt vmcnt(2)
    v_max_u32 v108, v120, v124
    v_cmp_eq_u32 vcc, s62, v108
    v_mov_b64 v[16:17], v[120:121]
    v_mov_b64 v[18:19], v[122:123]
    v_mov_b64 v[20:21], v[124:125]
    v_mov_b64 v[22:23], v[126:127]
    s_mov_b64 exec, -1
    s_cbranch_vccz L_chain_mixed_h2
    s_branch L_chain_mixed_h2r
L_chain_mixed_h1r:
    s_mov_b64 exec, vcc
    buffer_load_dwordx4 v[40:43], v1, s[8:11], s52 offen sc1
    buffer_load_dwordx4 v[44:47], v1, s[8:11], s52 offen offset:1024 sc1
    s_waitcnt vmcnt(2)
    v_bitop3_b32 v80, v32, v34, s53 bitop3:0x7e
    v_bitop3_b32 v81, v36, v38, s53 bitop3:0x7e
    v_bitop3_b32 v80, v80, v81, 1 bitop3:0xa8
    v_cmp_ne_u32 vcc, 0, v80
    v_mov_b64 v[24:25], v[32:33]
    v_mov_b64 v[26:27], v[34:35]
    v_mov_b64 v[28:29], v[36:37]
    v_mov_b64 v[30:31], v[38:39]
    s_mov_b64 exec, -1
    s_cbranch_vccz L_chain_mixed_h1
    s_mov_b64 exec, vcc
    buffer_load_dwordx4 v[32:35], v1, s[8:11], s52 offen sc1
    buffer_load_dwordx4 v[36:39], v1, s[8:11], s52 offen offset:1024 sc1
    s_sub_u32 s98, s98, 1
    s_cbranch_scc1 L_end
    s_waitcnt vmcnt(2)
    v_bitop3_b32 v80, v40, v42, s53 bitop3:0x7e
    v_bitop3_b32 v81, v44, v46, s53 bitop3:0x7e
    v_bitop3_b32 v80, v80, v81, 1 bitop3:0xa8
    v_cmp_ne_u32 vcc, 0, v80
    v_mov_b64 v[24:25], v[40:41]
    v_mov_b64 v[26:27], v[42:43]
    v_mov_b64 v[28:29], v[44:45]
    v_mov_b64 v[30:31], v[46:47]
    s_mov_b64 exec, -1
    s_cbranch_vccz L_chain_mixed_h1
    s_branch L_chain_mixed_h1r
L_chain_mixed_kvw:
    v_mov_b32 v112, 0
Lw_197:
    buffer_load_dword v15, v112, s[8:11], s49 offen offset:0 sc1
    s_waitcnt vmcnt(0)
    v_cmp_eq_u32 vcc, 0, v15
    s_cbranch_vccz Lwd_198
    s_sleep 1
    s_sub_u32 s98, s98, 1
    s_cbranch_scc1 L_end
    s_branch Lw_197
Lwd_198:
    s_branch L_chain_mixed_kvr
L_chain_done:
    s_endpgm

.section .rodata,"a"
.p2align 6
.amdhsa_kernel interleave_layers__ssm_conv_h3__memory_aug_recurrent_mem_tr__prompt_kernel
  .amdhsa_next_free_vgpr 512
  .amdhsa_next_free_sgpr 102
  .amdhsa_accum_offset 256
  .amdhsa_group_segment_fixed_size 0
  .amdhsa_kernarg_size 128
  .amdhsa_user_sgpr_count 2
  .amdhsa_user_sgpr_kernarg_segment_ptr 1
  .amdhsa_system_sgpr_workgroup_id_x 1
  .amdhsa_float_denorm_mode_32 3
  .amdhsa_float_denorm_mode_16_64 3
.end_amdhsa_kernel
```
